```python
import torch

def _softmax(x, axis=-1):
    return torch.softmax(x, dim=axis)
def _gelu(x):
    return torch.nn.functional.gelu(x, approximate="tanh")
def _silu(x):
    return torch.nn.functional.silu(x)
def _sigmoid(x):
    return torch.sigmoid(x)
def _layernorm(x, axis=-1, eps=1e-5):
    m = x.mean(dim=axis, keepdim=True)
    v = x.var(dim=axis, keepdim=True, unbiased=False)
    return (x - m) / torch.sqrt(v + eps)
def _scatter_add(tgt, idx, src, axis=0):
    return tgt.clone().index_add_(axis, idx, src)
def _segment_sum(src, seg, n):
    out = torch.zeros((n,) + src.shape[1:], dtype=src.dtype)
    return out.index_add_(0, seg, src)
def _pad(x, pw):
    flat = tuple(v for pair in reversed(pw) for v in pair)
    return torch.nn.functional.pad(x, flat)

kernel_name = 'recurrent_scan__sliding_block_cached__dense_activation_silu__prompt'

def setup_inputs():

    _w = (lambda a: (lambda t: t.to(torch.bfloat16) if t.is_floating_point() else t)(torch.as_tensor(a)))
    def _A_setup():
        B, Sq, D = 1, 2048, 1024
        Hq, Hkv, Sk, Dh = 32, 4, 2048, 128
        assert Hq % Hkv == 0, (Hq, Hkv)
        return {
            "x": _w((lambda *s: torch.randn(*s, dtype=torch.bfloat16) * 0.05)(B, Sq, D)),
            "k_cache": _w((lambda *s: torch.randn(*s, dtype=torch.bfloat16) * 3.2)(B, Hkv, Sk, Dh)),
            "v_cache": _w((lambda *s: torch.randn(*s, dtype=torch.bfloat16) * 3.2)(B, Hkv, Sk, Dh)),
            "wq": _w((lambda *s: torch.randn(*s, dtype=torch.bfloat16) * 3.2)(D, Hq * Dh) * (D ** -0.5)),
            "wo": _w((lambda *s: torch.randn(*s, dtype=torch.bfloat16) * 3.2)(Hq * Dh, D) * ((Hq * Dh) ** -0.5)),
        }
    _A_in = _A_setup()

    def _B_setup():
        B, S, D, F = 1, 2048, 1024, 3584
        return {
            "x": _w((lambda *s: torch.randn(*s, dtype=torch.bfloat16) * 0.05)(B, S, D)),
            "w1": _w((lambda *s: torch.randn(*s, dtype=torch.bfloat16) * 3.2)(D, F) * (D ** -0.5)),
            "w2": _w((lambda *s: torch.randn(*s, dtype=torch.bfloat16) * 0.4)(F, D) * (F ** -0.5)),
        }
    _B_in = _B_setup()

    return {
        "A_x": _A_in["x"],
        "A_k_cache": _A_in["k_cache"],
        "A_v_cache": _A_in["v_cache"],
        "A_wq": _A_in["wq"],
        "A_wo": _A_in["wo"],
        "B_x": _B_in["x"],
        "B_w1": _B_in["w1"],
        "B_w2": _B_in["w2"],
    }

def reference(A_x, A_k_cache, A_v_cache, A_wq, A_wo, B_x, B_w1, B_w2):
    def _A_ref(x, k_cache, v_cache, wq, wo):
        B, Sq, D = x.shape
        Hq, Dh = 32, 128
        Hkv, Sk = k_cache.shape[1], k_cache.shape[2]
        W = min(4096, max(256, Sk // 4))
        rep = Hq // Hkv
        q = (lambda x, *d: x.permute(*d))((x @ wq).reshape(B, Sq, Hq, Dh), 0, 2, 1, 3)
        k = (lambda x, n, axis: torch.repeat_interleave(x, n, dim=axis))(k_cache[:, :, Sk - W:, :], rep, axis=1)
        v = (lambda x, n, axis: torch.repeat_interleave(x, n, dim=axis))(v_cache[:, :, Sk - W:, :], rep, axis=1)
        scores = torch.einsum("bhqd,bhkd->bhqk", q, k) * (Dh ** -0.5)
        p = _softmax(scores, axis=-1)
        o = torch.einsum("bhqk,bhkd->bhqd", p, v)
        return (lambda x, *d: x.permute(*d))(o, 0, 2, 1, 3).reshape(B, Sq, Hq * Dh) @ wo

    def _B_ref(x, w1, w2):
        h = torch.einsum("bsd,df->bsf", x, w1)
        h = _silu(h)
        out = torch.einsum("bsf,fd->bsd", h, w2)
        return out

    x = A_x
    xn = _layernorm(x, axis=-1)
    s = _A_ref(xn, A_k_cache, A_v_cache, A_wq, A_wo)
    g = _silu(_B_ref(xn, B_w1, B_w2))
    return x + s * g
```

```asm
; @launch grid=(256,1,1) block=(256,1,1) lds=163840
.amdgcn_target "amdgcn-amd-amdhsa--gfx950"
.text
.globl recurrent_scan__sliding_block_cached__dense_activation_silu__prompt_kernel
.p2align 8
.type recurrent_scan__sliding_block_cached__dense_activation_silu__prompt_kernel,@function
recurrent_scan__sliding_block_cached__dense_activation_silu__prompt_kernel:
  s_cmp_ge_u32 s2, 256
  s_cbranch_scc1 L_main_done
  s_load_dwordx2 s[16:17], s[0:1], 80
  s_load_dwordx2 s[20:21], s[0:1], 0
  s_load_dwordx2 s[4:5], s[0:1], 24
  s_load_dwordx2 s[8:9], s[0:1], 48
  s_load_dwordx2 s[24:25], s[0:1], 8
  s_load_dwordx2 s[28:29], s[0:1], 16
  v_lshrrev_b32 v1, 6, v0
  v_and_b32 v0, 63, v0
  v_readfirstlane_b32 s36, v1
  s_and_b32 s84, s2, 7
  s_lshr_b32 s85, s2, 3
  s_lshl_b32 s37, s84, 2
  s_and_b32 s86, s85, 3
  s_add_u32 s37, s37, s86
  s_lshr_b32 s38, s85, 2
  s_lshl_b32 s3, s85, 12
  s_lshl_b32 s86, s36, 10
  s_add_u32 s3, s3, s86
  v_lshrrev_b32 v1, 4, v0
  v_bfe_u32 v2, v0, 2, 2
  v_and_b32 v3, 3, v0
  v_lshlrev_b32 v20, 4, v0
  v_cmp_gt_u32 vcc, 16, v0
  v_mov_b32 v23, 0x40000000
  v_lshlrev_b32 v24, 6, v0
  v_cndmask_b32 v24, v23, v24, vcc
  v_cmp_eq_u32 vcc, 0, v0
  v_bfe_u32 v176, v0, 2, 3
  v_lshrrev_b32 v177, 5, v0
  v_cndmask_b32 v23, v23, 0, vcc
  v_lshl_add_u32 v177, v177, 2, v3
  s_lshl_b32 s84, s36, 3
  v_add_u32 v177, s84, v177
  v_lshlrev_b32 v178, 11, v176
  v_lshl_add_u32 v178, v177, 4, v178
  s_lshl_b32 s84, s38, 5
  s_add_u32 s89, s84, s37
  s_lshl_b32 s84, s89, 14
  s_mov_b32 s85, 58720256
  s_waitcnt lgkmcnt(0)
  s_mov_b32 s22, 4194304
  s_mov_b32 s23, 0x00020000
  s_mov_b32 s18, 134217728
  s_mov_b32 s19, 0x00020000
  buffer_load_dwordx4 v[160:163], v178, s[20:23], s84 offen offset:0
  buffer_load_dwordx4 v[164:167], v178, s[20:23], s84 offen offset:512
  buffer_load_dwordx4 v[168:171], v178, s[20:23], s84 offen offset:1024
  buffer_load_dwordx4 v[172:175], v178, s[20:23], s84 offen offset:1536
  buffer_load_dword v25, v23, s[16:19], s85 offen sc1
  s_getpc_b64 s[32:33]
L_main_pc:
  s_mov_b32 s34, L_main_end-L_main_pc
  s_mov_b32 s35, 0x00020000
  buffer_load_dword v251, v24, s[32:35], s3 offen
  s_mov_b32 s6, 8388608
  s_mov_b32 s7, 0x00020000
  s_mov_b32 s10, 7340032
  s_mov_b32 s11, 0x00020000
  s_mov_b32 s26, 2097152
  s_mov_b32 s27, 0x00020000
  s_mov_b32 s30, 2097152
  s_mov_b32 s31, 0x00020000
  s_and_b32 s39, s37, 1
  s_lshr_b32 s40, s37, 1
  s_lshl_b32 s41, s38, 4
  s_lshl_b32 s84, s36, 2
  s_add_u32 s41, s41, s84
  s_lshl_b32 s46, s36, 12
  v_lshlrev_b32 v252, 13, v2
  v_lshl_add_u32 v252, v1, 6, v252
  s_lshl_b32 s84, s36, 17
  s_lshl_b32 s85, s37, 8
  s_add_u32 s84, s84, s85
  v_add_u32 v252, s84, v252
  v_lshlrev_b32 v253, 4, v3
  v_xor_b32 v254, 32, v253
  v_add_u32 v4, v252, v253
  v_add_u32 v5, 31744, v4
  v_add_u32 v6, v252, v254
  v_add_u32 v6, 63488, v6
  v_add_u32 v7, 31744, v6
  s_lshl_b32 s84, s39, 2
  v_cmp_eq_u32 vcc, 3, v1
  v_add_u32 v255, s84, v1
  v_mul_u32_u24 v252, 7168, v2
  v_cndmask_b32 v255, v255, v1, vcc
  v_lshl_add_u32 v252, v255, 6, v252
  s_mul_i32 s84, s36, 114688
  s_mul_i32 s85, s40, 448
  s_add_u32 s84, s84, s85
  v_add_u32 v252, s84, v252
  v_add_u32 v8, v252, v253
  v_add_u32 v9, 27648, v8
  v_add_u32 v10, v252, v254
  v_add_u32 v10, 55296, v10
  v_add_u32 v11, 27648, v10
  s_add_u32 m0, s46, 0
  s_mov_b32 s42, 0
  buffer_load_dwordx4 v4, s[4:7], s42 offen offset:0 lds
  buffer_load_dwordx4 v5, s[4:7], s42 offen offset:1024 lds
  buffer_load_dwordx4 v6, s[4:7], s42 offen offset:2048 lds
  buffer_load_dwordx4 v7, s[4:7], s42 offen offset:3072 lds
  s_add_u32 m0, s46, 16384
  s_mov_b32 s43, 0
  buffer_load_dwordx4 v8, s[8:11], s43 offen offset:0 lds
  buffer_load_dwordx4 v9, s[8:11], s43 offen offset:1024 lds
  buffer_load_dwordx4 v10, s[8:11], s43 offen offset:2048 lds
  buffer_load_dwordx4 v11, s[8:11], s43 offen offset:3072 lds
  s_lshl_b32 s49, s36, 11
  v_lshlrev_b32 v180, 5, v176
  v_add_u32 v180, 0x18000, v180
  s_lshl_b32 s84, s36, 3
  v_add_u32 v179, s84, v180
  v_lshrrev_b32 v178, 5, v0
  v_lshlrev_b32 v178, 10, v178
  v_bfe_u32 v252, v0, 3, 2
  v_lshl_add_u32 v178, v252, 8, v178
  v_and_b32 v252, 7, v0
  v_lshl_add_u32 v178, v252, 4, v178
  v_add_u32 v178, s49, v178
  v_and_b32 v252, 7, v177
  v_lshlrev_b32 v252, 7, v252
  v_lshl_add_u32 v252, v176, 4, v252
  s_add_u32 s84, s46, 0x18400
  v_add_u32 v184, s84, v252
  v_add_u32 v185, s84, v20
  s_lshr_b32 s88, s89, 1
  s_mul_i32 s88, s88, 32768
  s_and_b32 s84, s89, 1
  s_lshl_b32 s84, s84, 7
  s_add_u32 s88, s88, s84
  s_lshr_b32 s84, s89, 3
  s_mul_i32 s84, s84, 256
  s_and_b32 s85, s89, 7
  s_lshl_b32 s85, s85, 4
  s_add_u32 s84, s84, s85
  s_add_u32 s82, s84, 58785792
  s_lshl_b32 s84, s38, 2
  s_add_u32 s84, s84, s36
  s_mul_i32 s84, s84, 256
  s_add_u32 s83, s84, 58785792
  s_waitcnt vmcnt(10)
  v_lshlrev_b32 v32, 16, v160
  v_and_b32 v33, 0xffff0000, v160
  v_lshlrev_b32 v34, 16, v161
  v_and_b32 v35, 0xffff0000, v161
  v_lshlrev_b32 v36, 16, v162
  v_and_b32 v37, 0xffff0000, v162
  v_lshlrev_b32 v38, 16, v163
  v_and_b32 v39, 0xffff0000, v163
  v_lshlrev_b32 v40, 16, v164
  v_and_b32 v41, 0xffff0000, v164
  v_lshlrev_b32 v42, 16, v165
  v_and_b32 v43, 0xffff0000, v165
  v_lshlrev_b32 v44, 16, v166
  v_and_b32 v45, 0xffff0000, v166
  v_lshlrev_b32 v46, 16, v167
  v_and_b32 v47, 0xffff0000, v167
  v_lshlrev_b32 v48, 16, v168
  v_and_b32 v49, 0xffff0000, v168
  v_lshlrev_b32 v50, 16, v169
  v_and_b32 v51, 0xffff0000, v169
  v_lshlrev_b32 v52, 16, v170
  v_and_b32 v53, 0xffff0000, v170
  v_lshlrev_b32 v54, 16, v171
  v_and_b32 v55, 0xffff0000, v171
  v_lshlrev_b32 v56, 16, v172
  v_and_b32 v57, 0xffff0000, v172
  v_lshlrev_b32 v58, 16, v173
  v_and_b32 v59, 0xffff0000, v173
  v_lshlrev_b32 v60, 16, v174
  v_and_b32 v61, 0xffff0000, v174
  v_lshlrev_b32 v62, 16, v175
  v_and_b32 v63, 0xffff0000, v175
  v_add_f32 v182, v32, v33
  v_add_f32 v64, v34, v35
  v_add_f32 v182, v182, v36
  v_add_f32 v64, v64, v37
  v_add_f32 v182, v182, v38
  v_add_f32 v64, v64, v39
  v_add_f32 v182, v182, v40
  v_add_f32 v64, v64, v41
  v_add_f32 v182, v182, v42
  v_add_f32 v64, v64, v43
  v_add_f32 v182, v182, v44
  v_add_f32 v64, v64, v45
  v_add_f32 v182, v182, v46
  v_add_f32 v64, v64, v47
  v_add_f32 v182, v182, v48
  v_add_f32 v64, v64, v49
  v_add_f32 v182, v182, v50
  v_add_f32 v64, v64, v51
  v_add_f32 v182, v182, v52
  v_add_f32 v64, v64, v53
  v_add_f32 v182, v182, v54
  v_add_f32 v64, v64, v55
  v_add_f32 v182, v182, v56
  v_add_f32 v64, v64, v57
  v_add_f32 v182, v182, v58
  v_add_f32 v64, v64, v59
  v_add_f32 v182, v182, v60
  v_add_f32 v64, v64, v61
  v_add_f32 v182, v182, v62
  v_add_f32 v64, v64, v63
  v_add_f32 v182, v182, v64
  v_mul_f32 v66, 0x3d000000, v182
  v_sub_f32 v64, v32, v66
  v_mul_f32 v183, v64, v64
  v_sub_f32 v65, v33, v66
  v_mul_f32 v67, v65, v65
  v_sub_f32 v64, v34, v66
  v_fmac_f32 v183, v64, v64
  v_sub_f32 v65, v35, v66
  v_fmac_f32 v67, v65, v65
  v_sub_f32 v64, v36, v66
  v_fmac_f32 v183, v64, v64
  v_sub_f32 v65, v37, v66
  v_fmac_f32 v67, v65, v65
  v_sub_f32 v64, v38, v66
  v_fmac_f32 v183, v64, v64
  v_sub_f32 v65, v39, v66
  v_fmac_f32 v67, v65, v65
  v_sub_f32 v64, v40, v66
  v_fmac_f32 v183, v64, v64
  v_sub_f32 v65, v41, v66
  v_fmac_f32 v67, v65, v65
  v_sub_f32 v64, v42, v66
  v_fmac_f32 v183, v64, v64
  v_sub_f32 v65, v43, v66
  v_fmac_f32 v67, v65, v65
  v_sub_f32 v64, v44, v66
  v_fmac_f32 v183, v64, v64
  v_sub_f32 v65, v45, v66
  v_fmac_f32 v67, v65, v65
  v_sub_f32 v64, v46, v66
  v_fmac_f32 v183, v64, v64
  v_sub_f32 v65, v47, v66
  v_fmac_f32 v67, v65, v65
  v_sub_f32 v64, v48, v66
  v_fmac_f32 v183, v64, v64
  v_sub_f32 v65, v49, v66
  v_fmac_f32 v67, v65, v65
  v_sub_f32 v64, v50, v66
  v_fmac_f32 v183, v64, v64
  v_sub_f32 v65, v51, v66
  v_fmac_f32 v67, v65, v65
  v_sub_f32 v64, v52, v66
  v_fmac_f32 v183, v64, v64
  v_sub_f32 v65, v53, v66
  v_fmac_f32 v67, v65, v65
  v_sub_f32 v64, v54, v66
  v_fmac_f32 v183, v64, v64
  v_sub_f32 v65, v55, v66
  v_fmac_f32 v67, v65, v65
  v_sub_f32 v64, v56, v66
  v_fmac_f32 v183, v64, v64
  v_sub_f32 v65, v57, v66
  v_fmac_f32 v67, v65, v65
  v_sub_f32 v64, v58, v66
  v_fmac_f32 v183, v64, v64
  v_sub_f32 v65, v59, v66
  v_fmac_f32 v67, v65, v65
  v_sub_f32 v64, v60, v66
  v_fmac_f32 v183, v64, v64
  v_sub_f32 v65, v61, v66
  v_fmac_f32 v67, v65, v65
  v_sub_f32 v64, v62, v66
  v_fmac_f32 v183, v64, v64
  v_sub_f32 v65, v63, v66
  v_fmac_f32 v67, v65, v65
  v_add_f32 v183, v183, v67
  s_nop 1
  v_mov_b32_dpp v64, v182 quad_perm:[1,0,3,2] row_mask:0xf bank_mask:0xf
  v_mov_b32_dpp v65, v183 quad_perm:[1,0,3,2] row_mask:0xf bank_mask:0xf
  v_sub_f32 v68, v182, v64
  v_add_f32 v183, v183, v65
  v_add_f32 v182, v182, v64
  v_mul_f32 v69, 0x3c800000, v68
  v_fmac_f32 v183, v68, v69
  s_nop 1
  v_mov_b32_dpp v64, v182 quad_perm:[2,3,0,1] row_mask:0xf bank_mask:0xf
  v_mov_b32_dpp v65, v183 quad_perm:[2,3,0,1] row_mask:0xf bank_mask:0xf
  v_sub_f32 v68, v182, v64
  v_add_f32 v183, v183, v65
  v_add_f32 v182, v182, v64
  v_mul_f32 v69, 0x3c000000, v68
  v_fmac_f32 v183, v68, v69
  v_mov_b32 v64, v182
  v_mov_b32 v65, v183
  s_nop 1
  v_permlane32_swap_b32 v182, v64
  v_permlane32_swap_b32 v183, v65
  v_sub_f32 v68, v182, v64
  v_add_f32 v183, v183, v65
  v_add_f32 v182, v182, v64
  v_mul_f32 v69, 0x3b800000, v68
  v_fmac_f32 v183, v68, v69
  ds_write_b64 v179, v[182:183]
  s_waitcnt lgkmcnt(0)
  s_barrier
  ds_read_b128 v[72:75], v180
  ds_read_b128 v[76:79], v180 offset:16
  s_waitcnt lgkmcnt(0)
  v_sub_f32 v68, v76, v78
  v_add_f32 v65, v77, v79
  v_add_f32 v64, v76, v78
  v_mul_f32 v69, 0x3b000000, v68
  v_fmac_f32 v65, v68, v69
  v_mov_b32 v182, v72
  v_mov_b32 v183, v73
  v_sub_f32 v68, v182, v74
  v_add_f32 v183, v183, v75
  v_add_f32 v182, v182, v74
  v_mul_f32 v69, 0x3b000000, v68
  v_fmac_f32 v183, v68, v69
  v_sub_f32 v68, v182, v64
  v_add_f32 v183, v183, v65
  v_add_f32 v182, v182, v64
  v_mul_f32 v69, 0x3a800000, v68
  v_fmac_f32 v183, v68, v69
  v_mul_f32 v182, 0x3a800000, v182
  v_mul_f32 v183, 0x3a800000, v183
  v_cvt_pk_bf16_f32 v64, v182, v183
  v_lshlrev_b32 v182, 16, v64
  v_and_b32 v183, 0xffff0000, v64
  v_add_f32 v183, 0x3727c5ac, v183
  v_cvt_pk_bf16_f32 v183, v183, v183
  v_lshlrev_b32 v183, 16, v183
  v_sqrt_f32 v183, v183
  s_nop 0
  v_cvt_pk_bf16_f32 v64, v183, v182
  v_lshlrev_b32 v183, 16, v64
  v_rcp_f32 v183, v183
  v_sub_f32 v32, v32, v182
  v_sub_f32 v33, v33, v182
  v_cvt_pk_bf16_f32 v32, v32, v33
  v_and_b32 v33, 0xffff0000, v32
  v_lshlrev_b32 v32, 16, v32
  v_mul_f32 v32, v32, v183
  v_mul_f32 v33, v33, v183
  v_cvt_pk_bf16_f32 v160, v32, v33
  v_sub_f32 v34, v34, v182
  v_sub_f32 v35, v35, v182
  v_cvt_pk_bf16_f32 v34, v34, v35
  v_and_b32 v35, 0xffff0000, v34
  v_lshlrev_b32 v34, 16, v34
  v_mul_f32 v34, v34, v183
  v_mul_f32 v35, v35, v183
  v_cvt_pk_bf16_f32 v161, v34, v35
  v_sub_f32 v36, v36, v182
  v_sub_f32 v37, v37, v182
  v_cvt_pk_bf16_f32 v36, v36, v37
  v_and_b32 v37, 0xffff0000, v36
  v_lshlrev_b32 v36, 16, v36
  v_mul_f32 v36, v36, v183
  v_mul_f32 v37, v37, v183
  v_cvt_pk_bf16_f32 v162, v36, v37
  v_sub_f32 v38, v38, v182
  v_sub_f32 v39, v39, v182
  v_cvt_pk_bf16_f32 v38, v38, v39
  v_and_b32 v39, 0xffff0000, v38
  v_lshlrev_b32 v38, 16, v38
  v_mul_f32 v38, v38, v183
  v_mul_f32 v39, v39, v183
  v_cvt_pk_bf16_f32 v163, v38, v39
  ds_write_b128 v184, v[160:163] offset:0
  ds_read_b128 v[80:83], v185 offset:0
  v_sub_f32 v40, v40, v182
  v_sub_f32 v41, v41, v182
  v_cvt_pk_bf16_f32 v40, v40, v41
  v_and_b32 v41, 0xffff0000, v40
  v_lshlrev_b32 v40, 16, v40
  v_mul_f32 v40, v40, v183
  v_mul_f32 v41, v41, v183
  v_cvt_pk_bf16_f32 v164, v40, v41
  v_sub_f32 v42, v42, v182
  v_sub_f32 v43, v43, v182
  v_cvt_pk_bf16_f32 v42, v42, v43
  v_and_b32 v43, 0xffff0000, v42
  v_lshlrev_b32 v42, 16, v42
  v_mul_f32 v42, v42, v183
  v_mul_f32 v43, v43, v183
  v_cvt_pk_bf16_f32 v165, v42, v43
  v_sub_f32 v44, v44, v182
  v_sub_f32 v45, v45, v182
  v_cvt_pk_bf16_f32 v44, v44, v45
  v_and_b32 v45, 0xffff0000, v44
  v_lshlrev_b32 v44, 16, v44
  v_mul_f32 v44, v44, v183
  v_mul_f32 v45, v45, v183
  v_cvt_pk_bf16_f32 v166, v44, v45
  v_sub_f32 v46, v46, v182
  v_sub_f32 v47, v47, v182
  v_cvt_pk_bf16_f32 v46, v46, v47
  v_and_b32 v47, 0xffff0000, v46
  v_lshlrev_b32 v46, 16, v46
  v_mul_f32 v46, v46, v183
  v_mul_f32 v47, v47, v183
  v_cvt_pk_bf16_f32 v167, v46, v47
  ds_write_b128 v184, v[164:167] offset:1024
  ds_read_b128 v[84:87], v185 offset:1024
  s_waitcnt lgkmcnt(2)
  s_add_u32 s84, s88, 0
  buffer_store_dwordx4 v[80:83], v178, s[16:19], s84 offen sc1
  v_sub_f32 v48, v48, v182
  v_sub_f32 v49, v49, v182
  v_cvt_pk_bf16_f32 v48, v48, v49
  v_and_b32 v49, 0xffff0000, v48
  v_lshlrev_b32 v48, 16, v48
  v_mul_f32 v48, v48, v183
  v_mul_f32 v49, v49, v183
  v_cvt_pk_bf16_f32 v168, v48, v49
  v_sub_f32 v50, v50, v182
  v_sub_f32 v51, v51, v182
  v_cvt_pk_bf16_f32 v50, v50, v51
  v_and_b32 v51, 0xffff0000, v50
  v_lshlrev_b32 v50, 16, v50
  v_mul_f32 v50, v50, v183
  v_mul_f32 v51, v51, v183
  v_cvt_pk_bf16_f32 v169, v50, v51
  v_sub_f32 v52, v52, v182
  v_sub_f32 v53, v53, v182
  v_cvt_pk_bf16_f32 v52, v52, v53
  v_and_b32 v53, 0xffff0000, v52
  v_lshlrev_b32 v52, 16, v52
  v_mul_f32 v52, v52, v183
  v_mul_f32 v53, v53, v183
  v_cvt_pk_bf16_f32 v170, v52, v53
  v_sub_f32 v54, v54, v182
  v_sub_f32 v55, v55, v182
  v_cvt_pk_bf16_f32 v54, v54, v55
  v_and_b32 v55, 0xffff0000, v54
  v_lshlrev_b32 v54, 16, v54
  v_mul_f32 v54, v54, v183
  v_mul_f32 v55, v55, v183
  v_cvt_pk_bf16_f32 v171, v54, v55
  ds_write_b128 v184, v[168:171] offset:2048
  ds_read_b128 v[88:91], v185 offset:2048
  s_waitcnt lgkmcnt(2)
  s_add_u32 s84, s88, 8192
  buffer_store_dwordx4 v[84:87], v178, s[16:19], s84 offen sc1
  v_sub_f32 v56, v56, v182
  v_sub_f32 v57, v57, v182
  v_cvt_pk_bf16_f32 v56, v56, v57
  v_and_b32 v57, 0xffff0000, v56
  v_lshlrev_b32 v56, 16, v56
  v_mul_f32 v56, v56, v183
  v_mul_f32 v57, v57, v183
  v_cvt_pk_bf16_f32 v172, v56, v57
  v_sub_f32 v58, v58, v182
  v_sub_f32 v59, v59, v182
  v_cvt_pk_bf16_f32 v58, v58, v59
  v_and_b32 v59, 0xffff0000, v58
  v_lshlrev_b32 v58, 16, v58
  v_mul_f32 v58, v58, v183
  v_mul_f32 v59, v59, v183
  v_cvt_pk_bf16_f32 v173, v58, v59
  v_sub_f32 v60, v60, v182
  v_sub_f32 v61, v61, v182
  v_cvt_pk_bf16_f32 v60, v60, v61
  v_and_b32 v61, 0xffff0000, v60
  v_lshlrev_b32 v60, 16, v60
  v_mul_f32 v60, v60, v183
  v_mul_f32 v61, v61, v183
  v_cvt_pk_bf16_f32 v174, v60, v61
  v_sub_f32 v62, v62, v182
  v_sub_f32 v63, v63, v182
  v_cvt_pk_bf16_f32 v62, v62, v63
  v_and_b32 v63, 0xffff0000, v62
  v_lshlrev_b32 v62, 16, v62
  v_mul_f32 v62, v62, v183
  v_mul_f32 v63, v63, v183
  v_cvt_pk_bf16_f32 v175, v62, v63
  ds_write_b128 v184, v[172:175] offset:3072
  ds_read_b128 v[92:95], v185 offset:3072
  s_waitcnt lgkmcnt(2)
  s_add_u32 s84, s88, 16384
  buffer_store_dwordx4 v[88:91], v178, s[16:19], s84 offen sc1
  s_waitcnt lgkmcnt(0)
  s_add_u32 s84, s88, 24576
  buffer_store_dwordx4 v[92:95], v178, s[16:19], s84 offen sc1
  s_waitcnt vmcnt(13)
  v_readfirstlane_b32 s79, v25
  s_add_u32 s79, s79, 1
  s_mul_i32 s78, s79, 0x9e3779b1
  s_add_u32 s78, s78, 0x7f4a7c16
  v_mov_b32 v26, s78
  s_lshl_b32 s88, s39, 1
  s_mul_i32 s89, s40, 7
  s_lshl_b32 s87, s39, 2
  s_add_u32 s87, s87, s89
  s_add_u32 s89, s89, 3
  s_xor_b32 s84, s88, 0
  s_add_u32 s84, s84, s41
  s_mul_i32 s85, s84, 114944
  s_lshl_b32 s86, s87, 10
  s_add_u32 s86, s86, s85
  s_add_u32 s50, s86, 8388608
  s_lshl_b32 s86, s89, 10
  s_add_u32 s86, s86, s85
  s_add_u32 s54, s86, 8388608
  s_mul_i32 s85, s84, 131328
  s_lshl_b32 s86, s37, 12
  s_add_u32 s85, s85, s86
  s_add_u32 s56, s85, 25165824
  s_xor_b32 s84, s88, 1
  s_add_u32 s84, s84, s41
  s_mul_i32 s85, s84, 114944
  s_lshl_b32 s86, s87, 10
  s_add_u32 s86, s86, s85
  s_add_u32 s51, s86, 8388608
  s_lshl_b32 s86, s89, 10
  s_add_u32 s86, s86, s85
  s_add_u32 s55, s86, 8388608
  s_mul_i32 s85, s84, 131328
  s_lshl_b32 s86, s37, 12
  s_add_u32 s85, s85, s86
  s_add_u32 s57, s85, 25165824
  s_xor_b32 s84, s88, 2
  s_add_u32 s84, s84, s41
  s_mul_i32 s85, s84, 114944
  s_lshl_b32 s86, s87, 10
  s_add_u32 s86, s86, s85
  s_add_u32 s52, s86, 8388608
  s_mul_i32 s85, s84, 131328
  s_lshl_b32 s86, s37, 12
  s_add_u32 s85, s85, s86
  s_add_u32 s58, s85, 25165824
  s_xor_b32 s84, s88, 3
  s_add_u32 s84, s84, s41
  s_mul_i32 s85, s84, 114944
  s_lshl_b32 s86, s87, 10
  s_add_u32 s86, s86, s85
  s_add_u32 s53, s86, 8388608
  s_mul_i32 s85, s84, 131328
  s_lshl_b32 s86, s37, 12
  s_add_u32 s85, s85, s86
  s_add_u32 s59, s85, 25165824
  s_cmp_eq_u32 s36, 0
  s_cselect_b32 s82, s82, 0x40000000
  s_waitcnt vmcnt(0)
  s_barrier
  buffer_store_dword v26, v23, s[16:19], s82 offen offset:0 sc1
  s_lshl_b32 s60, s2, 15
  s_lshl_b32 s63, s36, 13
  s_add_u32 s60, s60, s63
  s_add_u32 s61, s60, 4096
  s_lshl_b32 s90, s2, 2
  s_add_u32 s90, s90, s36
  s_lshl_b32 s90, s90, 10
  s_cmp_lt_u32 s90, 917504
  s_mov_b32 s91, 0x40000000
  s_cselect_b32 s91, s90, s91
  s_mul_i32 s84, s39, 65536
  s_sub_u32 s85, 65536, s84
  v_add_u32 v12, s84, v20
  v_add_u32 v13, 32768, v12
  v_add_u32 v14, s85, v20
  v_add_u32 v15, 32768, v14
  v_lshlrev_b32 v252, 11, v1
  v_lshl_add_u32 v252, v2, 6, v252
  v_lshl_add_u32 v252, v3, 3, v252
  v_and_b32 v253, 1, v1
  v_lshl_add_u32 v16, v253, 5, v252
  v_xor_b32 v17, 32, v16
  v_add_u32 v18, 0x10000, v16
  v_add_u32 v19, 0x10000, v17
  s_mul_i32 s84, s41, 32768
  s_add_u32 s12, s16, s84
  s_addc_u32 s13, s17, 0
  s_mov_b32 s14, 131072
  s_mov_b32 s15, 0x00020000
  s_lshr_b32 s84, s37, 3
  s_lshl_b32 s84, s84, 19
  s_add_u32 s48, s84, 391168
  v_lshrrev_b32 v252, 2, v0
  v_lshrrev_b32 v253, 5, v0
  v_xor_b32 v253, v1, v253
  v_xor_b32 v253, v3, v253
  v_lshlrev_b32 v252, 8, v252
  v_lshl_add_u32 v252, v253, 4, v252
  s_lshr_b32 s84, s36, 1
  s_lshl_b32 s85, s84, 12
  s_and_b32 s86, s36, 1
  s_lshl_b32 s87, s86, 7
  s_add_u32 s85, s85, s87
  s_add_u32 s85, s85, 2048
  v_add_u32 v21, s85, v252
  v_add_u32 v22, -1984, v21
  s_lshl_b32 s47, s86, 12
  s_lshl_b32 s84, s84, 10
  s_add_u32 s47, s47, s84
  v_lshlrev_b32 v252, 8, v2
  v_lshl_add_u32 v252, v1, 6, v252
  v_lshl_add_u32 v252, v3, 4, v252
  s_add_u32 s85, s49, 2048
  v_add_u32 v28, s85, v252
  v_xor_b32 v29, 32, v28
  v_cmp_gt_u32 vcc, 32, v0
  v_lshlrev_b32 v27, 2, v0
  v_mov_b32 v252, 0x40000000
  v_cndmask_b32 v27, v252, v27, vcc
  s_lshr_b32 s62, s37, 3
  s_mul_i32 s64, s62, 1835008
  s_mul_i32 s65, s62, 2097152
  s_mul_i32 s86, s41, 114944
  s_mul_i32 s87, s62, 28672
  s_add_u32 s86, s86, s87
  s_add_u32 s66, s86, 8388608
  s_mul_i32 s86, s41, 131328
  s_lshl_b32 s87, s62, 15
  s_add_u32 s86, s86, s87
  s_add_u32 s67, s86, 25165824
  s_add_u32 s87, s41, s62
  s_lshl_b32 s87, s87, 7
  s_add_u32 s73, s87, 58851328
  s_and_b32 s81, s37, 7
  s_lshl_b32 s87, s81, 2
  s_add_u32 s72, s73, s87
  s_lshl_b32 s81, s81, 8
  s_lshl_b32 s87, s2, 2
  s_add_u32 s87, s87, s36
  s_lshl_b32 s74, s87, 10
  s_lshl_b32 s87, s2, 2
  s_add_u32 s87, s87, s36
  s_lshl_b32 s76, s87, 7
  s_lshl_b32 s80, s41, 15
  s_add_u32 s80, s80, s81
  s_lshl_b32 s87, s62, 6
  s_add_u32 s80, s80, s87
  ds_read_b64_tr_b16 v[32:33], v16 offset:0
  ds_read_b64_tr_b16 v[34:35], v16 offset:1024
  ds_read_b64_tr_b16 v[36:37], v17 offset:0
  ds_read_b64_tr_b16 v[38:39], v17 offset:1024
  ds_read_b64_tr_b16 v[40:41], v16 offset:256
  ds_read_b64_tr_b16 v[42:43], v16 offset:1280
  ds_read_b64_tr_b16 v[44:45], v17 offset:256
  ds_read_b64_tr_b16 v[46:47], v17 offset:1280
  ds_read_b64_tr_b16 v[48:49], v16 offset:512
  ds_read_b64_tr_b16 v[50:51], v16 offset:1536
  ds_read_b64_tr_b16 v[52:53], v17 offset:512
  ds_read_b64_tr_b16 v[54:55], v17 offset:1536
  ds_read_b64_tr_b16 v[56:57], v16 offset:768
  ds_read_b64_tr_b16 v[58:59], v16 offset:1792
  ds_read_b64_tr_b16 v[60:61], v17 offset:768
  ds_read_b64_tr_b16 v[62:63], v17 offset:1792
  ds_read_b64_tr_b16 v[64:65], v16 offset:16384
  ds_read_b64_tr_b16 v[66:67], v16 offset:17408
  ds_read_b64_tr_b16 v[68:69], v17 offset:16384
  ds_read_b64_tr_b16 v[70:71], v17 offset:17408
  ds_read_b64_tr_b16 v[72:73], v16 offset:16640
  ds_read_b64_tr_b16 v[74:75], v16 offset:17664
  ds_read_b64_tr_b16 v[76:77], v17 offset:16640
  ds_read_b64_tr_b16 v[78:79], v17 offset:17664
  ds_read_b64_tr_b16 v[80:81], v16 offset:16896
  ds_read_b64_tr_b16 v[82:83], v16 offset:17920
  ds_read_b64_tr_b16 v[84:85], v17 offset:16896
  ds_read_b64_tr_b16 v[86:87], v17 offset:17920
  ds_read_b64_tr_b16 v[88:89], v16 offset:17152
  ds_read_b64_tr_b16 v[90:91], v16 offset:18176
  ds_read_b64_tr_b16 v[92:93], v17 offset:17152
  ds_read_b64_tr_b16 v[94:95], v17 offset:18176
  buffer_load_dword v25, v27, s[16:19], s83 offen offset:0 sc1
  s_waitcnt vmcnt(0)
  v_cmp_eq_u32 vcc, v26, v25
  s_and_b32 s84, vcc_lo, 0x11111111
  s_cmp_eq_u32 s84, 0x11111111
  s_cbranch_scc0 L_main_spin_1
L_main_spin_1_ok:
  s_mov_b32 s44, 0
  buffer_load_dwordx4 v[96:99], v12, s[12:15], s44 offen offset:0 sc1
  buffer_load_dwordx4 v[100:103], v13, s[12:15], s44 offen offset:0 sc1
  buffer_load_dwordx4 v[104:107], v14, s[12:15], s44 offen offset:0 sc1
  buffer_load_dwordx4 v[108:111], v15, s[12:15], s44 offen offset:0 sc1
  buffer_load_dwordx4 v[112:115], v12, s[12:15], s44 offen offset:1024 sc1
  buffer_load_dwordx4 v[116:119], v13, s[12:15], s44 offen offset:1024 sc1
  buffer_load_dwordx4 v[120:123], v14, s[12:15], s44 offen offset:1024 sc1
  buffer_load_dwordx4 v[124:127], v15, s[12:15], s44 offen offset:1024 sc1
  s_add_u32 m0, s46, 32768
  s_mov_b32 s42, 524288
  buffer_load_dwordx4 v4, s[4:7], s42 offen offset:0 lds
  buffer_load_dwordx4 v5, s[4:7], s42 offen offset:1024 lds
  buffer_load_dwordx4 v6, s[4:7], s42 offen offset:2048 lds
  buffer_load_dwordx4 v7, s[4:7], s42 offen offset:3072 lds
  s_add_u32 m0, s46, 49152
  s_mov_b32 s43, 458752
  buffer_load_dwordx4 v8, s[8:11], s43 offen offset:0 lds
  buffer_load_dwordx4 v9, s[8:11], s43 offen offset:1024 lds
  buffer_load_dwordx4 v10, s[8:11], s43 offen offset:2048 lds
  buffer_load_dwordx4 v11, s[8:11], s43 offen offset:3072 lds
  buffer_load_dwordx4 v[128:131], v12, s[12:15], s44 offen offset:2048 sc1
  buffer_load_dwordx4 v[132:135], v13, s[12:15], s44 offen offset:2048 sc1
  buffer_load_dwordx4 v[136:139], v14, s[12:15], s44 offen offset:2048 sc1
  buffer_load_dwordx4 v[140:143], v15, s[12:15], s44 offen offset:2048 sc1
  s_add_u32 m0, s46, 65536
  s_mov_b32 s42, 1048576
  buffer_load_dwordx4 v4, s[4:7], s42 offen offset:0 lds
  buffer_load_dwordx4 v5, s[4:7], s42 offen offset:1024 lds
  buffer_load_dwordx4 v6, s[4:7], s42 offen offset:2048 lds
  buffer_load_dwordx4 v7, s[4:7], s42 offen offset:3072 lds
  s_add_u32 s84, s90, 1048576
  buffer_load_dword a242, v24, s[4:7], s84 offen
  s_add_u32 s84, s91, 917504
  buffer_load_dword a243, v24, s[8:11], s84 offen
  s_add_u32 s84, s90, 2097152
  buffer_load_dword a244, v24, s[4:7], s84 offen
  s_add_u32 s84, s91, 1835008
  buffer_load_dword a245, v24, s[8:11], s84 offen
  s_waitcnt vmcnt(24) lgkmcnt(15)
  v_mfma_f32_16x16x32_bf16 a[0:3], v[32:35], v[96:99], 0
  v_mfma_f32_16x16x32_bf16 a[4:7], v[32:35], v[100:103], 0
  buffer_load_dwordx4 v[144:147], v12, s[12:15], s44 offen offset:3072 sc1
  v_mfma_f32_16x16x32_bf16 a[8:11], v[32:35], v[104:107], 0
  v_mfma_f32_16x16x32_bf16 a[12:15], v[32:35], v[108:111], 0
  ds_read_b64_tr_b16 v[32:33], v16 offset:8192
  v_mfma_f32_16x16x32_bf16 a[28:31], v[36:39], v[108:111], 0
  ds_read_b64_tr_b16 v[34:35], v16 offset:9216
  v_mfma_f32_16x16x32_bf16 a[24:27], v[36:39], v[104:107], 0
  v_mfma_f32_16x16x32_bf16 a[20:23], v[36:39], v[100:103], 0
  s_add_u32 m0, s46, 81920
  s_mov_b32 s43, 917504
  v_mfma_f32_16x16x32_bf16 a[16:19], v[36:39], v[96:99], 0
  ds_read_b64_tr_b16 v[36:37], v17 offset:8192
  v_mfma_f32_16x16x32_bf16 a[32:35], v[40:43], v[96:99], 0
  ds_read_b64_tr_b16 v[38:39], v17 offset:9216
  v_mfma_f32_16x16x32_bf16 a[36:39], v[40:43], v[100:103], 0
  buffer_load_dwordx4 v8, s[8:11], s43 offen offset:0 lds
  v_mfma_f32_16x16x32_bf16 a[40:43], v[40:43], v[104:107], 0
  v_mfma_f32_16x16x32_bf16 a[44:47], v[40:43], v[108:111], 0
  ds_read_b64_tr_b16 v[40:41], v16 offset:8448
  v_mfma_f32_16x16x32_bf16 a[60:63], v[44:47], v[108:111], 0
  ds_read_b64_tr_b16 v[42:43], v16 offset:9472
  v_mfma_f32_16x16x32_bf16 a[56:59], v[44:47], v[104:107], 0
  buffer_load_dwordx4 v9, s[8:11], s43 offen offset:1024 lds
  v_mfma_f32_16x16x32_bf16 a[52:55], v[44:47], v[100:103], 0
  v_mfma_f32_16x16x32_bf16 a[48:51], v[44:47], v[96:99], 0
  s_waitcnt lgkmcnt(15)
  v_mfma_f32_16x16x32_bf16 a[64:67], v[48:51], v[96:99], 0
  ds_read_b64_tr_b16 v[44:45], v17 offset:8448
  v_mfma_f32_16x16x32_bf16 a[68:71], v[48:51], v[100:103], 0
  ds_read_b64_tr_b16 v[46:47], v17 offset:9472
  v_mfma_f32_16x16x32_bf16 a[72:75], v[48:51], v[104:107], 0
  v_mfma_f32_16x16x32_bf16 a[76:79], v[48:51], v[108:111], 0
  ds_read_b64_tr_b16 v[48:49], v16 offset:8704
  v_mfma_f32_16x16x32_bf16 a[92:95], v[52:55], v[108:111], 0
  ds_read_b64_tr_b16 v[50:51], v16 offset:9728
  v_mfma_f32_16x16x32_bf16 a[88:91], v[52:55], v[104:107], 0
  buffer_load_dwordx4 v[148:151], v13, s[12:15], s44 offen offset:3072 sc1
  v_mfma_f32_16x16x32_bf16 a[84:87], v[52:55], v[100:103], 0
  v_mfma_f32_16x16x32_bf16 a[80:83], v[52:55], v[96:99], 0
  ds_read_b64_tr_b16 v[52:53], v17 offset:8704
  v_mfma_f32_16x16x32_bf16 a[96:99], v[56:59], v[96:99], 0
  ds_read_b64_tr_b16 v[54:55], v17 offset:9728
  v_mfma_f32_16x16x32_bf16 a[100:103], v[56:59], v[100:103], 0
  v_mfma_f32_16x16x32_bf16 a[104:107], v[56:59], v[104:107], 0
  buffer_load_dwordx4 v10, s[8:11], s43 offen offset:2048 lds
  v_mfma_f32_16x16x32_bf16 a[108:111], v[56:59], v[108:111], 0
  ds_read_b64_tr_b16 v[56:57], v16 offset:8960
  v_mfma_f32_16x16x32_bf16 a[124:127], v[60:63], v[108:111], 0
  ds_read_b64_tr_b16 v[58:59], v16 offset:9984
  v_mfma_f32_16x16x32_bf16 a[120:123], v[60:63], v[104:107], 0
  v_mfma_f32_16x16x32_bf16 a[116:119], v[60:63], v[100:103], 0
  v_mfma_f32_16x16x32_bf16 a[112:115], v[60:63], v[96:99], 0
  s_waitcnt lgkmcnt(15)
  v_mfma_f32_16x16x32_bf16 v[160:163], v[64:67], v[96:99], 0
  ds_read_b64_tr_b16 v[60:61], v17 offset:8960
  v_mfma_f32_16x16x32_bf16 v[164:167], v[64:67], v[100:103], 0
  ds_read_b64_tr_b16 v[62:63], v17 offset:9984
  v_mfma_f32_16x16x32_bf16 v[168:171], v[64:67], v[104:107], 0
  buffer_load_dwordx4 v[152:155], v14, s[12:15], s44 offen offset:3072 sc1
  v_mfma_f32_16x16x32_bf16 v[172:175], v[64:67], v[108:111], 0
  ds_read_b64_tr_b16 v[64:65], v16 offset:24576
  v_mfma_f32_16x16x32_bf16 v[188:191], v[68:71], v[108:111], 0
  ds_read_b64_tr_b16 v[66:67], v16 offset:25600
  v_mfma_f32_16x16x32_bf16 v[184:187], v[68:71], v[104:107], 0
  v_mfma_f32_16x16x32_bf16 v[180:183], v[68:71], v[100:103], 0
  v_mfma_f32_16x16x32_bf16 v[176:179], v[68:71], v[96:99], 0
  ds_read_b64_tr_b16 v[68:69], v17 offset:24576
  v_mfma_f32_16x16x32_bf16 v[192:195], v[72:75], v[96:99], 0
  ds_read_b64_tr_b16 v[70:71], v17 offset:25600
  v_mfma_f32_16x16x32_bf16 v[196:199], v[72:75], v[100:103], 0
  buffer_load_dwordx4 v11, s[8:11], s43 offen offset:3072 lds
  v_mfma_f32_16x16x32_bf16 v[200:203], v[72:75], v[104:107], 0
  v_mfma_f32_16x16x32_bf16 v[204:207], v[72:75], v[108:111], 0
  ds_read_b64_tr_b16 v[72:73], v16 offset:24832
  v_mfma_f32_16x16x32_bf16 v[220:223], v[76:79], v[108:111], 0
  ds_read_b64_tr_b16 v[74:75], v16 offset:25856
  v_mfma_f32_16x16x32_bf16 v[216:219], v[76:79], v[104:107], 0
  v_mfma_f32_16x16x32_bf16 v[212:215], v[76:79], v[100:103], 0
  buffer_load_dwordx4 v[156:159], v15, s[12:15], s44 offen offset:3072 sc1
  v_mfma_f32_16x16x32_bf16 v[208:211], v[76:79], v[96:99], 0
  s_waitcnt lgkmcnt(15)
  v_mfma_f32_16x16x32_bf16 v[224:227], v[80:83], v[96:99], 0
  ds_read_b64_tr_b16 v[76:77], v17 offset:24832
  v_mfma_f32_16x16x32_bf16 v[228:231], v[80:83], v[100:103], 0
  ds_read_b64_tr_b16 v[78:79], v17 offset:25856
  v_mfma_f32_16x16x32_bf16 v[232:235], v[80:83], v[104:107], 0
  v_mfma_f32_16x16x32_bf16 v[236:239], v[80:83], v[108:111], 0
  ds_read_b64_tr_b16 v[80:81], v16 offset:25088
  ds_read_b64_tr_b16 v[82:83], v16 offset:26112
  v_mfma_f32_16x16x32_bf16 a[132:135], v[84:87], v[108:111], 0
  s_add_u32 s84, s90, 3145728
  v_mfma_f32_16x16x32_bf16 a[128:131], v[84:87], v[104:107], 0
  buffer_load_dword a246, v24, s[4:7], s84 offen
  v_mfma_f32_16x16x32_bf16 v[244:247], v[84:87], v[100:103], 0
  v_mfma_f32_16x16x32_bf16 v[240:243], v[84:87], v[96:99], 0
  ds_read_b64_tr_b16 v[84:85], v17 offset:25088
  v_mfma_f32_16x16x32_bf16 a[136:139], v[88:91], v[96:99], 0
  ds_read_b64_tr_b16 v[86:87], v17 offset:26112
  v_mfma_f32_16x16x32_bf16 a[140:143], v[88:91], v[100:103], 0
  ds_read_b64_tr_b16 v[88:89], v16 offset:25344
  v_mfma_f32_16x16x32_bf16 a[148:151], v[92:95], v[100:103], 0
  ds_read_b64_tr_b16 v[90:91], v16 offset:26368
  v_mfma_f32_16x16x32_bf16 a[144:147], v[92:95], v[96:99], 0
  s_waitcnt vmcnt(29) lgkmcnt(15)
  v_mfma_f32_16x16x32_bf16 a[0:3], v[32:35], v[112:115], a[0:3]
  ds_read_b64_tr_b16 v[92:93], v17 offset:25344
  v_mfma_f32_16x16x32_bf16 a[4:7], v[32:35], v[116:119], a[4:7]
  ds_read_b64_tr_b16 v[94:95], v17 offset:26368
  v_mfma_f32_16x16x32_bf16 a[8:11], v[32:35], v[120:123], a[8:11]
  s_mov_b32 s44, 4096
  buffer_load_dwordx4 v[96:99], v12, s[12:15], s44 offen offset:0 sc1
  v_mfma_f32_16x16x32_bf16 a[12:15], v[32:35], v[124:127], a[12:15]
  v_mfma_f32_16x16x32_bf16 a[28:31], v[36:39], v[124:127], a[28:31]
  v_mfma_f32_16x16x32_bf16 a[24:27], v[36:39], v[120:123], a[24:27]
  v_mfma_f32_16x16x32_bf16 a[20:23], v[36:39], v[116:119], a[20:23]
  v_mfma_f32_16x16x32_bf16 a[16:19], v[36:39], v[112:115], a[16:19]
  v_mfma_f32_16x16x32_bf16 a[32:35], v[40:43], v[112:115], a[32:35]
  buffer_load_dwordx4 v[100:103], v13, s[12:15], s44 offen offset:0 sc1
  v_mfma_f32_16x16x32_bf16 a[36:39], v[40:43], v[116:119], a[36:39]
  v_mfma_f32_16x16x32_bf16 a[40:43], v[40:43], v[120:123], a[40:43]
  v_mfma_f32_16x16x32_bf16 a[44:47], v[40:43], v[124:127], a[44:47]
  v_mfma_f32_16x16x32_bf16 a[60:63], v[44:47], v[124:127], a[60:63]
  v_mfma_f32_16x16x32_bf16 a[56:59], v[44:47], v[120:123], a[56:59]
  v_mfma_f32_16x16x32_bf16 a[52:55], v[44:47], v[116:119], a[52:55]
  v_mfma_f32_16x16x32_bf16 a[48:51], v[44:47], v[112:115], a[48:51]
  s_waitcnt vmcnt(23) lgkmcnt(0)
  s_barrier
  s_waitcnt lgkmcnt(15)
  v_mfma_f32_16x16x32_bf16 a[64:67], v[48:51], v[112:115], a[64:67]
  ds_read_b64_tr_b16 v[32:33], v16 offset:32768
  ds_read_b64_tr_b16 v[34:35], v16 offset:33792
  v_mfma_f32_16x16x32_bf16 a[68:71], v[48:51], v[116:119], a[68:71]
  ds_read_b64_tr_b16 v[36:37], v17 offset:32768
  ds_read_b64_tr_b16 v[38:39], v17 offset:33792
  v_mfma_f32_16x16x32_bf16 a[72:75], v[48:51], v[120:123], a[72:75]
  ds_read_b64_tr_b16 v[40:41], v16 offset:33024
  ds_read_b64_tr_b16 v[42:43], v16 offset:34048
  v_mfma_f32_16x16x32_bf16 a[76:79], v[48:51], v[124:127], a[76:79]
  ds_read_b64_tr_b16 v[44:45], v17 offset:33024
  ds_read_b64_tr_b16 v[46:47], v17 offset:34048
  v_mfma_f32_16x16x32_bf16 a[92:95], v[52:55], v[124:127], a[92:95]
  ds_read_b64_tr_b16 v[48:49], v16 offset:33280
  ds_read_b64_tr_b16 v[50:51], v16 offset:34304
  v_mfma_f32_16x16x32_bf16 a[88:91], v[52:55], v[120:123], a[88:91]
  s_add_u32 m0, s46, 0
  s_mov_b32 s42, 1572864
  v_mfma_f32_16x16x32_bf16 a[84:87], v[52:55], v[116:119], a[84:87]
  buffer_load_dwordx4 v4, s[4:7], s42 offen offset:0 lds
  v_mfma_f32_16x16x32_bf16 a[80:83], v[52:55], v[112:115], a[80:83]
  ds_read_b64_tr_b16 v[52:53], v17 offset:33280
  v_mfma_f32_16x16x32_bf16 a[96:99], v[56:59], v[112:115], a[96:99]
  ds_read_b64_tr_b16 v[54:55], v17 offset:34304
  v_mfma_f32_16x16x32_bf16 a[100:103], v[56:59], v[116:119], a[100:103]
  buffer_load_dwordx4 v[104:107], v14, s[12:15], s44 offen offset:0 sc1
  v_mfma_f32_16x16x32_bf16 a[104:107], v[56:59], v[120:123], a[104:107]
  v_mfma_f32_16x16x32_bf16 a[108:111], v[56:59], v[124:127], a[108:111]
  ds_read_b64_tr_b16 v[56:57], v16 offset:33536
  v_mfma_f32_16x16x32_bf16 a[124:127], v[60:63], v[124:127], a[124:127]
  ds_read_b64_tr_b16 v[58:59], v16 offset:34560
  v_mfma_f32_16x16x32_bf16 a[120:123], v[60:63], v[120:123], a[120:123]
  v_mfma_f32_16x16x32_bf16 a[116:119], v[60:63], v[116:119], a[116:119]
  v_mfma_f32_16x16x32_bf16 a[112:115], v[60:63], v[112:115], a[112:115]
  s_waitcnt lgkmcnt(15)
  v_mfma_f32_16x16x32_bf16 v[160:163], v[64:67], v[112:115], v[160:163]
  ds_read_b64_tr_b16 v[60:61], v17 offset:33536
  v_mfma_f32_16x16x32_bf16 v[164:167], v[64:67], v[116:119], v[164:167]
  ds_read_b64_tr_b16 v[62:63], v17 offset:34560
  v_mfma_f32_16x16x32_bf16 v[168:171], v[64:67], v[120:123], v[168:171]
  buffer_load_dwordx4 v5, s[4:7], s42 offen offset:1024 lds
  v_mfma_f32_16x16x32_bf16 v[172:175], v[64:67], v[124:127], v[172:175]
  ds_read_b64_tr_b16 v[64:65], v16 offset:49152
  v_mfma_f32_16x16x32_bf16 v[188:191], v[68:71], v[124:127], v[188:191]
  ds_read_b64_tr_b16 v[66:67], v16 offset:50176
  v_mfma_f32_16x16x32_bf16 v[184:187], v[68:71], v[120:123], v[184:187]
  buffer_load_dwordx4 v6, s[4:7], s42 offen offset:2048 lds
  v_mfma_f32_16x16x32_bf16 v[180:183], v[68:71], v[116:119], v[180:183]
  v_mfma_f32_16x16x32_bf16 v[176:179], v[68:71], v[112:115], v[176:179]
  ds_read_b64_tr_b16 v[68:69], v17 offset:49152
  v_mfma_f32_16x16x32_bf16 v[192:195], v[72:75], v[112:115], v[192:195]
  ds_read_b64_tr_b16 v[70:71], v17 offset:50176
  v_mfma_f32_16x16x32_bf16 v[196:199], v[72:75], v[116:119], v[196:199]
  v_mfma_f32_16x16x32_bf16 v[200:203], v[72:75], v[120:123], v[200:203]
  buffer_load_dwordx4 v[108:111], v15, s[12:15], s44 offen offset:0 sc1
  v_mfma_f32_16x16x32_bf16 v[204:207], v[72:75], v[124:127], v[204:207]
  ds_read_b64_tr_b16 v[72:73], v16 offset:49408
  v_mfma_f32_16x16x32_bf16 v[220:223], v[76:79], v[124:127], v[220:223]
  ds_read_b64_tr_b16 v[74:75], v16 offset:50432
  v_mfma_f32_16x16x32_bf16 v[216:219], v[76:79], v[120:123], v[216:219]
  v_mfma_f32_16x16x32_bf16 v[212:215], v[76:79], v[116:119], v[212:215]
  v_mfma_f32_16x16x32_bf16 v[208:211], v[76:79], v[112:115], v[208:211]
  s_waitcnt lgkmcnt(15)
  v_mfma_f32_16x16x32_bf16 v[224:227], v[80:83], v[112:115], v[224:227]
  ds_read_b64_tr_b16 v[76:77], v17 offset:49408
  v_mfma_f32_16x16x32_bf16 v[228:231], v[80:83], v[116:119], v[228:231]
  ds_read_b64_tr_b16 v[78:79], v17 offset:50432
  v_mfma_f32_16x16x32_bf16 v[232:235], v[80:83], v[120:123], v[232:235]
  buffer_load_dwordx4 v7, s[4:7], s42 offen offset:3072 lds
  v_mfma_f32_16x16x32_bf16 v[236:239], v[80:83], v[124:127], v[236:239]
  ds_read_b64_tr_b16 v[80:81], v16 offset:49664
  v_mfma_f32_16x16x32_bf16 a[132:135], v[84:87], v[124:127], a[132:135]
  ds_read_b64_tr_b16 v[82:83], v16 offset:50688
  v_mfma_f32_16x16x32_bf16 a[128:131], v[84:87], v[120:123], a[128:131]
  s_add_u32 s84, s91, 2752512
  v_mfma_f32_16x16x32_bf16 v[244:247], v[84:87], v[116:119], v[244:247]
  buffer_load_dword a247, v24, s[8:11], s84 offen
  v_mfma_f32_16x16x32_bf16 v[240:243], v[84:87], v[112:115], v[240:243]
  ds_read_b64_tr_b16 v[84:85], v17 offset:49664
  v_mfma_f32_16x16x32_bf16 a[136:139], v[88:91], v[112:115], a[136:139]
  ds_read_b64_tr_b16 v[86:87], v17 offset:50688
  v_mfma_f32_16x16x32_bf16 a[140:143], v[88:91], v[116:119], a[140:143]
  ds_read_b64_tr_b16 v[88:89], v16 offset:49920
  v_mfma_f32_16x16x32_bf16 a[148:151], v[92:95], v[116:119], a[148:151]
  ds_read_b64_tr_b16 v[90:91], v16 offset:50944
  v_mfma_f32_16x16x32_bf16 a[144:147], v[92:95], v[112:115], a[144:147]
  s_waitcnt vmcnt(26) lgkmcnt(15)
  v_mfma_f32_16x16x32_bf16 a[0:3], v[32:35], v[128:131], a[0:3]
  ds_read_b64_tr_b16 v[92:93], v17 offset:49920
  v_mfma_f32_16x16x32_bf16 a[4:7], v[32:35], v[132:135], a[4:7]
  ds_read_b64_tr_b16 v[94:95], v17 offset:50944
  v_mfma_f32_16x16x32_bf16 a[8:11], v[32:35], v[136:139], a[8:11]
  buffer_load_dwordx4 v[112:115], v12, s[12:15], s44 offen offset:1024 sc1
  v_mfma_f32_16x16x32_bf16 a[12:15], v[32:35], v[140:143], a[12:15]
  ds_read_b64_tr_b16 v[32:33], v16 offset:40960
  v_mfma_f32_16x16x32_bf16 a[28:31], v[36:39], v[140:143], a[28:31]
  ds_read_b64_tr_b16 v[34:35], v16 offset:41984
  v_mfma_f32_16x16x32_bf16 a[24:27], v[36:39], v[136:139], a[24:27]
  v_mfma_f32_16x16x32_bf16 a[20:23], v[36:39], v[132:135], a[20:23]
  v_mfma_f32_16x16x32_bf16 a[16:19], v[36:39], v[128:131], a[16:19]
  ds_read_b64_tr_b16 v[36:37], v17 offset:40960
  ds_read_b64_tr_b16 v[38:39], v17 offset:41984
  v_mfma_f32_16x16x32_bf16 a[32:35], v[40:43], v[128:131], a[32:35]
  s_add_u32 m0, s46, 16384
  s_mov_b32 s43, 1376256
  v_mfma_f32_16x16x32_bf16 a[36:39], v[40:43], v[132:135], a[36:39]
  buffer_load_dwordx4 v8, s[8:11], s43 offen offset:0 lds
  v_mfma_f32_16x16x32_bf16 a[40:43], v[40:43], v[136:139], a[40:43]
  v_mfma_f32_16x16x32_bf16 a[44:47], v[40:43], v[140:143], a[44:47]
  ds_read_b64_tr_b16 v[40:41], v16 offset:41216
  v_mfma_f32_16x16x32_bf16 a[60:63], v[44:47], v[140:143], a[60:63]
  ds_read_b64_tr_b16 v[42:43], v16 offset:42240
  v_mfma_f32_16x16x32_bf16 a[56:59], v[44:47], v[136:139], a[56:59]
  v_mfma_f32_16x16x32_bf16 a[52:55], v[44:47], v[132:135], a[52:55]
  v_mfma_f32_16x16x32_bf16 a[48:51], v[44:47], v[128:131], a[48:51]
  s_waitcnt lgkmcnt(15)
  v_mfma_f32_16x16x32_bf16 a[64:67], v[48:51], v[128:131], a[64:67]
  ds_read_b64_tr_b16 v[44:45], v17 offset:41216
  v_mfma_f32_16x16x32_bf16 a[68:71], v[48:51], v[132:135], a[68:71]
  ds_read_b64_tr_b16 v[46:47], v17 offset:42240
  v_mfma_f32_16x16x32_bf16 a[72:75], v[48:51], v[136:139], a[72:75]
  buffer_load_dwordx4 v[116:119], v13, s[12:15], s44 offen offset:1024 sc1
  v_mfma_f32_16x16x32_bf16 a[76:79], v[48:51], v[140:143], a[76:79]
  ds_read_b64_tr_b16 v[48:49], v16 offset:41472
  v_mfma_f32_16x16x32_bf16 a[92:95], v[52:55], v[140:143], a[92:95]
  ds_read_b64_tr_b16 v[50:51], v16 offset:42496
  v_mfma_f32_16x16x32_bf16 a[88:91], v[52:55], v[136:139], a[88:91]
  v_mfma_f32_16x16x32_bf16 a[84:87], v[52:55], v[132:135], a[84:87]
  buffer_load_dwordx4 v9, s[8:11], s43 offen offset:1024 lds
  v_mfma_f32_16x16x32_bf16 a[80:83], v[52:55], v[128:131], a[80:83]
  ds_read_b64_tr_b16 v[52:53], v17 offset:41472
  v_mfma_f32_16x16x32_bf16 a[96:99], v[56:59], v[128:131], a[96:99]
  ds_read_b64_tr_b16 v[54:55], v17 offset:42496
  v_mfma_f32_16x16x32_bf16 a[100:103], v[56:59], v[132:135], a[100:103]
  v_mfma_f32_16x16x32_bf16 a[104:107], v[56:59], v[136:139], a[104:107]
  v_mfma_f32_16x16x32_bf16 a[108:111], v[56:59], v[140:143], a[108:111]
  ds_read_b64_tr_b16 v[56:57], v16 offset:41728
  v_mfma_f32_16x16x32_bf16 a[124:127], v[60:63], v[140:143], a[124:127]
  ds_read_b64_tr_b16 v[58:59], v16 offset:42752
  v_mfma_f32_16x16x32_bf16 a[120:123], v[60:63], v[136:139], a[120:123]
  v_mfma_f32_16x16x32_bf16 a[116:119], v[60:63], v[132:135], a[116:119]
  buffer_load_dwordx4 v[120:123], v14, s[12:15], s44 offen offset:1024 sc1
  v_mfma_f32_16x16x32_bf16 a[112:115], v[60:63], v[128:131], a[112:115]
  s_waitcnt lgkmcnt(15)
  v_mfma_f32_16x16x32_bf16 v[160:163], v[64:67], v[128:131], v[160:163]
  ds_read_b64_tr_b16 v[60:61], v17 offset:41728
  v_mfma_f32_16x16x32_bf16 v[164:167], v[64:67], v[132:135], v[164:167]
  ds_read_b64_tr_b16 v[62:63], v17 offset:42752
  v_mfma_f32_16x16x32_bf16 v[168:171], v[64:67], v[136:139], v[168:171]
  v_mfma_f32_16x16x32_bf16 v[172:175], v[64:67], v[140:143], v[172:175]
  ds_read_b64_tr_b16 v[64:65], v16 offset:57344
  v_mfma_f32_16x16x32_bf16 v[188:191], v[68:71], v[140:143], v[188:191]
  ds_read_b64_tr_b16 v[66:67], v16 offset:58368
  v_mfma_f32_16x16x32_bf16 v[184:187], v[68:71], v[136:139], v[184:187]
  buffer_load_dwordx4 v10, s[8:11], s43 offen offset:2048 lds
  v_mfma_f32_16x16x32_bf16 v[180:183], v[68:71], v[132:135], v[180:183]
  v_mfma_f32_16x16x32_bf16 v[176:179], v[68:71], v[128:131], v[176:179]
  ds_read_b64_tr_b16 v[68:69], v17 offset:57344
  v_mfma_f32_16x16x32_bf16 v[192:195], v[72:75], v[128:131], v[192:195]
  ds_read_b64_tr_b16 v[70:71], v17 offset:58368
  v_mfma_f32_16x16x32_bf16 v[196:199], v[72:75], v[132:135], v[196:199]
  v_mfma_f32_16x16x32_bf16 v[200:203], v[72:75], v[136:139], v[200:203]
  v_mfma_f32_16x16x32_bf16 v[204:207], v[72:75], v[140:143], v[204:207]
  ds_read_b64_tr_b16 v[72:73], v16 offset:57600
  v_mfma_f32_16x16x32_bf16 v[220:223], v[76:79], v[140:143], v[220:223]
  ds_read_b64_tr_b16 v[74:75], v16 offset:58624
  v_mfma_f32_16x16x32_bf16 v[216:219], v[76:79], v[136:139], v[216:219]
  buffer_load_dwordx4 v[124:127], v15, s[12:15], s44 offen offset:1024 sc1
  v_mfma_f32_16x16x32_bf16 v[212:215], v[76:79], v[132:135], v[212:215]
  v_mfma_f32_16x16x32_bf16 v[208:211], v[76:79], v[128:131], v[208:211]
  s_waitcnt lgkmcnt(15)
  v_mfma_f32_16x16x32_bf16 v[224:227], v[80:83], v[128:131], v[224:227]
  ds_read_b64_tr_b16 v[76:77], v17 offset:57600
  v_mfma_f32_16x16x32_bf16 v[228:231], v[80:83], v[132:135], v[228:231]
  ds_read_b64_tr_b16 v[78:79], v17 offset:58624
  v_mfma_f32_16x16x32_bf16 v[232:235], v[80:83], v[136:139], v[232:235]
  v_mfma_f32_16x16x32_bf16 v[236:239], v[80:83], v[140:143], v[236:239]
  ds_read_b64_tr_b16 v[80:81], v16 offset:57856
  v_mfma_f32_16x16x32_bf16 a[132:135], v[84:87], v[140:143], a[132:135]
  ds_read_b64_tr_b16 v[82:83], v16 offset:58880
  v_mfma_f32_16x16x32_bf16 a[128:131], v[84:87], v[136:139], a[128:131]
  buffer_load_dwordx4 v11, s[8:11], s43 offen offset:3072 lds
  v_mfma_f32_16x16x32_bf16 v[244:247], v[84:87], v[132:135], v[244:247]
  v_mfma_f32_16x16x32_bf16 v[240:243], v[84:87], v[128:131], v[240:243]
  ds_read_b64_tr_b16 v[84:85], v17 offset:57856
  v_mfma_f32_16x16x32_bf16 a[136:139], v[88:91], v[128:131], a[136:139]
  ds_read_b64_tr_b16 v[86:87], v17 offset:58880
  v_mfma_f32_16x16x32_bf16 a[140:143], v[88:91], v[132:135], a[140:143]
  ds_read_b64_tr_b16 v[88:89], v16 offset:58112
  v_mfma_f32_16x16x32_bf16 a[148:151], v[92:95], v[132:135], a[148:151]
  ds_read_b64_tr_b16 v[90:91], v16 offset:59136
  v_mfma_f32_16x16x32_bf16 a[144:147], v[92:95], v[128:131], a[144:147]
  s_waitcnt vmcnt(18) lgkmcnt(15)
  v_mfma_f32_16x16x32_bf16 a[0:3], v[32:35], v[144:147], a[0:3]
  ds_read_b64_tr_b16 v[92:93], v17 offset:58112
  v_mfma_f32_16x16x32_bf16 a[4:7], v[32:35], v[148:151], a[4:7]
  ds_read_b64_tr_b16 v[94:95], v17 offset:59136
  v_mfma_f32_16x16x32_bf16 a[8:11], v[32:35], v[152:155], a[8:11]
  buffer_load_dwordx4 v[128:131], v12, s[12:15], s44 offen offset:2048 sc1
  v_mfma_f32_16x16x32_bf16 a[12:15], v[32:35], v[156:159], a[12:15]
  v_mfma_f32_16x16x32_bf16 a[28:31], v[36:39], v[156:159], a[28:31]
  v_mfma_f32_16x16x32_bf16 a[24:27], v[36:39], v[152:155], a[24:27]
  v_mfma_f32_16x16x32_bf16 a[20:23], v[36:39], v[148:151], a[20:23]
  v_mfma_f32_16x16x32_bf16 a[16:19], v[36:39], v[144:147], a[16:19]
  v_mfma_f32_16x16x32_bf16 a[32:35], v[40:43], v[144:147], a[32:35]
  buffer_load_dwordx4 v[132:135], v13, s[12:15], s44 offen offset:2048 sc1
  v_mfma_f32_16x16x32_bf16 a[36:39], v[40:43], v[148:151], a[36:39]
  v_mfma_f32_16x16x32_bf16 a[40:43], v[40:43], v[152:155], a[40:43]
  v_mfma_f32_16x16x32_bf16 a[44:47], v[40:43], v[156:159], a[44:47]
  v_mfma_f32_16x16x32_bf16 a[60:63], v[44:47], v[156:159], a[60:63]
  v_mfma_f32_16x16x32_bf16 a[56:59], v[44:47], v[152:155], a[56:59]
  v_mfma_f32_16x16x32_bf16 a[52:55], v[44:47], v[148:151], a[52:55]
  v_mfma_f32_16x16x32_bf16 a[48:51], v[44:47], v[144:147], a[48:51]
  s_waitcnt vmcnt(21) lgkmcnt(0)
  s_barrier
  s_waitcnt lgkmcnt(15)
  v_mfma_f32_16x16x32_bf16 a[64:67], v[48:51], v[144:147], a[64:67]
  ds_read_b64_tr_b16 v[32:33], v18 offset:0
  ds_read_b64_tr_b16 v[34:35], v18 offset:1024
  v_mfma_f32_16x16x32_bf16 a[68:71], v[48:51], v[148:151], a[68:71]
  ds_read_b64_tr_b16 v[36:37], v19 offset:0
  ds_read_b64_tr_b16 v[38:39], v19 offset:1024
  v_mfma_f32_16x16x32_bf16 a[72:75], v[48:51], v[152:155], a[72:75]
  ds_read_b64_tr_b16 v[40:41], v18 offset:256
  ds_read_b64_tr_b16 v[42:43], v18 offset:1280
  v_mfma_f32_16x16x32_bf16 a[76:79], v[48:51], v[156:159], a[76:79]
  ds_read_b64_tr_b16 v[44:45], v19 offset:256
  ds_read_b64_tr_b16 v[46:47], v19 offset:1280
  v_mfma_f32_16x16x32_bf16 a[92:95], v[52:55], v[156:159], a[92:95]
  ds_read_b64_tr_b16 v[48:49], v18 offset:512
  ds_read_b64_tr_b16 v[50:51], v18 offset:1536
  v_mfma_f32_16x16x32_bf16 a[88:91], v[52:55], v[152:155], a[88:91]
  s_add_u32 m0, s46, 32768
  s_mov_b32 s42, 2097152
  v_mfma_f32_16x16x32_bf16 a[84:87], v[52:55], v[148:151], a[84:87]
  buffer_load_dwordx4 v4, s[4:7], s42 offen offset:0 lds
  v_mfma_f32_16x16x32_bf16 a[80:83], v[52:55], v[144:147], a[80:83]
  ds_read_b64_tr_b16 v[52:53], v19 offset:512
  v_mfma_f32_16x16x32_bf16 a[96:99], v[56:59], v[144:147], a[96:99]
  ds_read_b64_tr_b16 v[54:55], v19 offset:1536
  v_mfma_f32_16x16x32_bf16 a[100:103], v[56:59], v[148:151], a[100:103]
  v_mfma_f32_16x16x32_bf16 a[104:107], v[56:59], v[152:155], a[104:107]
  buffer_load_dwordx4 v[136:139], v14, s[12:15], s44 offen offset:2048 sc1
  v_mfma_f32_16x16x32_bf16 a[108:111], v[56:59], v[156:159], a[108:111]
  ds_read_b64_tr_b16 v[56:57], v18 offset:768
  v_mfma_f32_16x16x32_bf16 a[124:127], v[60:63], v[156:159], a[124:127]
  ds_read_b64_tr_b16 v[58:59], v18 offset:1792
  v_mfma_f32_16x16x32_bf16 a[120:123], v[60:63], v[152:155], a[120:123]
  v_mfma_f32_16x16x32_bf16 a[116:119], v[60:63], v[148:151], a[116:119]
  v_mfma_f32_16x16x32_bf16 a[112:115], v[60:63], v[144:147], a[112:115]
  s_waitcnt lgkmcnt(15)
  v_mfma_f32_16x16x32_bf16 v[160:163], v[64:67], v[144:147], v[160:163]
  ds_read_b64_tr_b16 v[60:61], v19 offset:768
  v_mfma_f32_16x16x32_bf16 v[164:167], v[64:67], v[148:151], v[164:167]
  ds_read_b64_tr_b16 v[62:63], v19 offset:1792
  v_mfma_f32_16x16x32_bf16 v[168:171], v[64:67], v[152:155], v[168:171]
  buffer_load_dwordx4 v5, s[4:7], s42 offen offset:1024 lds
  v_mfma_f32_16x16x32_bf16 v[172:175], v[64:67], v[156:159], v[172:175]
  ds_read_b64_tr_b16 v[64:65], v18 offset:16384
  v_mfma_f32_16x16x32_bf16 v[188:191], v[68:71], v[156:159], v[188:191]
  ds_read_b64_tr_b16 v[66:67], v18 offset:17408
  v_mfma_f32_16x16x32_bf16 v[184:187], v[68:71], v[152:155], v[184:187]
  v_mfma_f32_16x16x32_bf16 v[180:183], v[68:71], v[148:151], v[180:183]
  v_mfma_f32_16x16x32_bf16 v[176:179], v[68:71], v[144:147], v[176:179]
  ds_read_b64_tr_b16 v[68:69], v19 offset:16384
  v_mfma_f32_16x16x32_bf16 v[192:195], v[72:75], v[144:147], v[192:195]
  ds_read_b64_tr_b16 v[70:71], v19 offset:17408
  v_mfma_f32_16x16x32_bf16 v[196:199], v[72:75], v[148:151], v[196:199]
  buffer_load_dwordx4 v6, s[4:7], s42 offen offset:2048 lds
  v_mfma_f32_16x16x32_bf16 v[200:203], v[72:75], v[152:155], v[200:203]
  v_mfma_f32_16x16x32_bf16 v[204:207], v[72:75], v[156:159], v[204:207]
  ds_read_b64_tr_b16 v[72:73], v18 offset:16640
  v_mfma_f32_16x16x32_bf16 v[220:223], v[76:79], v[156:159], v[220:223]
  ds_read_b64_tr_b16 v[74:75], v18 offset:17664
  v_mfma_f32_16x16x32_bf16 v[216:219], v[76:79], v[152:155], v[216:219]
  v_mfma_f32_16x16x32_bf16 v[212:215], v[76:79], v[148:151], v[212:215]
  buffer_load_dwordx4 v[140:143], v15, s[12:15], s44 offen offset:2048 sc1
  v_mfma_f32_16x16x32_bf16 v[208:211], v[76:79], v[144:147], v[208:211]
  s_waitcnt lgkmcnt(15)
  v_mfma_f32_16x16x32_bf16 v[224:227], v[80:83], v[144:147], v[224:227]
  ds_read_b64_tr_b16 v[76:77], v19 offset:16640
  v_mfma_f32_16x16x32_bf16 v[228:231], v[80:83], v[148:151], v[228:231]
  ds_read_b64_tr_b16 v[78:79], v19 offset:17664
  v_mfma_f32_16x16x32_bf16 v[232:235], v[80:83], v[152:155], v[232:235]
  v_mfma_f32_16x16x32_bf16 v[236:239], v[80:83], v[156:159], v[236:239]
  ds_read_b64_tr_b16 v[80:81], v18 offset:16896
  v_mfma_f32_16x16x32_bf16 a[132:135], v[84:87], v[156:159], a[132:135]
  ds_read_b64_tr_b16 v[82:83], v18 offset:17920
  v_mfma_f32_16x16x32_bf16 a[128:131], v[84:87], v[152:155], a[128:131]
  buffer_load_dwordx4 v7, s[4:7], s42 offen offset:3072 lds
  v_mfma_f32_16x16x32_bf16 v[244:247], v[84:87], v[148:151], v[244:247]
  v_mfma_f32_16x16x32_bf16 v[240:243], v[84:87], v[144:147], v[240:243]
  ds_read_b64_tr_b16 v[84:85], v19 offset:16896
  v_mfma_f32_16x16x32_bf16 a[136:139], v[88:91], v[144:147], a[136:139]
  ds_read_b64_tr_b16 v[86:87], v19 offset:17920
  v_mfma_f32_16x16x32_bf16 a[140:143], v[88:91], v[148:151], a[140:143]
  ds_read_b64_tr_b16 v[88:89], v18 offset:17152
  v_mfma_f32_16x16x32_bf16 a[148:151], v[92:95], v[148:151], a[148:151]
  ds_read_b64_tr_b16 v[90:91], v18 offset:18176
  v_mfma_f32_16x16x32_bf16 a[144:147], v[92:95], v[144:147], a[144:147]
  s_waitcnt vmcnt(18) lgkmcnt(15)
  v_mfma_f32_16x16x32_bf16 a[0:3], v[32:35], v[96:99], a[0:3]
  ds_read_b64_tr_b16 v[92:93], v19 offset:17152
  v_mfma_f32_16x16x32_bf16 a[4:7], v[32:35], v[100:103], a[4:7]
  ds_read_b64_tr_b16 v[94:95], v19 offset:18176
  v_mfma_f32_16x16x32_bf16 a[8:11], v[32:35], v[104:107], a[8:11]
  buffer_load_dwordx4 v[144:147], v12, s[12:15], s44 offen offset:3072 sc1
  v_mfma_f32_16x16x32_bf16 a[12:15], v[32:35], v[108:111], a[12:15]
  ds_read_b64_tr_b16 v[32:33], v18 offset:8192
  v_mfma_f32_16x16x32_bf16 a[28:31], v[36:39], v[108:111], a[28:31]
  ds_read_b64_tr_b16 v[34:35], v18 offset:9216
  v_mfma_f32_16x16x32_bf16 a[24:27], v[36:39], v[104:107], a[24:27]
  s_add_u32 m0, s46, 49152
  s_mov_b32 s43, 1835008
  v_mfma_f32_16x16x32_bf16 a[20:23], v[36:39], v[100:103], a[20:23]
  buffer_load_dwordx4 v8, s[8:11], s43 offen offset:0 lds
  v_mfma_f32_16x16x32_bf16 a[16:19], v[36:39], v[96:99], a[16:19]
  ds_read_b64_tr_b16 v[36:37], v19 offset:8192
  v_mfma_f32_16x16x32_bf16 a[32:35], v[40:43], v[96:99], a[32:35]
  ds_read_b64_tr_b16 v[38:39], v19 offset:9216
  v_mfma_f32_16x16x32_bf16 a[36:39], v[40:43], v[100:103], a[36:39]
  v_mfma_f32_16x16x32_bf16 a[40:43], v[40:43], v[104:107], a[40:43]
  v_mfma_f32_16x16x32_bf16 a[44:47], v[40:43], v[108:111], a[44:47]
  ds_read_b64_tr_b16 v[40:41], v18 offset:8448
  v_mfma_f32_16x16x32_bf16 a[60:63], v[44:47], v[108:111], a[60:63]
  ds_read_b64_tr_b16 v[42:43], v18 offset:9472
  v_mfma_f32_16x16x32_bf16 a[56:59], v[44:47], v[104:107], a[56:59]
  buffer_load_dwordx4 v9, s[8:11], s43 offen offset:1024 lds
  v_mfma_f32_16x16x32_bf16 a[52:55], v[44:47], v[100:103], a[52:55]
  v_mfma_f32_16x16x32_bf16 a[48:51], v[44:47], v[96:99], a[48:51]
  s_waitcnt lgkmcnt(15)
  v_mfma_f32_16x16x32_bf16 a[64:67], v[48:51], v[96:99], a[64:67]
  ds_read_b64_tr_b16 v[44:45], v19 offset:8448
  v_mfma_f32_16x16x32_bf16 a[68:71], v[48:51], v[100:103], a[68:71]
  ds_read_b64_tr_b16 v[46:47], v19 offset:9472
  v_mfma_f32_16x16x32_bf16 a[72:75], v[48:51], v[104:107], a[72:75]
  buffer_load_dwordx4 v[148:151], v13, s[12:15], s44 offen offset:3072 sc1
  v_mfma_f32_16x16x32_bf16 a[76:79], v[48:51], v[108:111], a[76:79]
  ds_read_b64_tr_b16 v[48:49], v18 offset:8704
  v_mfma_f32_16x16x32_bf16 a[92:95], v[52:55], v[108:111], a[92:95]
  ds_read_b64_tr_b16 v[50:51], v18 offset:9728
  v_mfma_f32_16x16x32_bf16 a[88:91], v[52:55], v[104:107], a[88:91]
  v_mfma_f32_16x16x32_bf16 a[84:87], v[52:55], v[100:103], a[84:87]
  buffer_load_dwordx4 v10, s[8:11], s43 offen offset:2048 lds
  v_mfma_f32_16x16x32_bf16 a[80:83], v[52:55], v[96:99], a[80:83]
  ds_read_b64_tr_b16 v[52:53], v19 offset:8704
  v_mfma_f32_16x16x32_bf16 a[96:99], v[56:59], v[96:99], a[96:99]
  ds_read_b64_tr_b16 v[54:55], v19 offset:9728
  v_mfma_f32_16x16x32_bf16 a[100:103], v[56:59], v[100:103], a[100:103]
  v_mfma_f32_16x16x32_bf16 a[104:107], v[56:59], v[104:107], a[104:107]
  v_mfma_f32_16x16x32_bf16 a[108:111], v[56:59], v[108:111], a[108:111]
  ds_read_b64_tr_b16 v[56:57], v18 offset:8960
  v_mfma_f32_16x16x32_bf16 a[124:127], v[60:63], v[108:111], a[124:127]
  ds_read_b64_tr_b16 v[58:59], v18 offset:9984
  v_mfma_f32_16x16x32_bf16 a[120:123], v[60:63], v[104:107], a[120:123]
  buffer_load_dwordx4 v11, s[8:11], s43 offen offset:3072 lds
  v_mfma_f32_16x16x32_bf16 a[116:119], v[60:63], v[100:103], a[116:119]
  v_mfma_f32_16x16x32_bf16 a[112:115], v[60:63], v[96:99], a[112:115]
  s_waitcnt lgkmcnt(15)
  v_mfma_f32_16x16x32_bf16 v[160:163], v[64:67], v[96:99], v[160:163]
  ds_read_b64_tr_b16 v[60:61], v19 offset:8960
  v_mfma_f32_16x16x32_bf16 v[164:167], v[64:67], v[100:103], v[164:167]
  ds_read_b64_tr_b16 v[62:63], v19 offset:9984
  v_mfma_f32_16x16x32_bf16 v[168:171], v[64:67], v[104:107], v[168:171]
  buffer_load_dwordx4 v[152:155], v14, s[12:15], s44 offen offset:3072 sc1
  v_mfma_f32_16x16x32_bf16 v[172:175], v[64:67], v[108:111], v[172:175]
  ds_read_b64_tr_b16 v[64:65], v18 offset:24576
  v_mfma_f32_16x16x32_bf16 v[188:191], v[68:71], v[108:111], v[188:191]
  ds_read_b64_tr_b16 v[66:67], v18 offset:25600
  v_mfma_f32_16x16x32_bf16 v[184:187], v[68:71], v[104:107], v[184:187]
  s_add_u32 m0, s47, 98304
  s_add_u32 s45, s48, 0
  v_mfma_f32_16x16x32_bf16 v[180:183], v[68:71], v[100:103], v[180:183]
  buffer_load_dwordx4 v21, s[24:27], s45 offen offset:0 lds
  v_mfma_f32_16x16x32_bf16 v[176:179], v[68:71], v[96:99], v[176:179]
  ds_read_b64_tr_b16 v[68:69], v19 offset:24576
  v_mfma_f32_16x16x32_bf16 v[192:195], v[72:75], v[96:99], v[192:195]
  ds_read_b64_tr_b16 v[70:71], v19 offset:25600
  v_mfma_f32_16x16x32_bf16 v[196:199], v[72:75], v[100:103], v[196:199]
  v_mfma_f32_16x16x32_bf16 v[200:203], v[72:75], v[104:107], v[200:203]
  v_mfma_f32_16x16x32_bf16 v[204:207], v[72:75], v[108:111], v[204:207]
  ds_read_b64_tr_b16 v[72:73], v18 offset:24832
  v_mfma_f32_16x16x32_bf16 v[220:223], v[76:79], v[108:111], v[220:223]
  ds_read_b64_tr_b16 v[74:75], v18 offset:25856
  v_mfma_f32_16x16x32_bf16 v[216:219], v[76:79], v[104:107], v[216:219]
  buffer_load_dwordx4 v22, s[24:27], s45 offen offset:2048 lds
  v_mfma_f32_16x16x32_bf16 v[212:215], v[76:79], v[100:103], v[212:215]
  v_mfma_f32_16x16x32_bf16 v[208:211], v[76:79], v[96:99], v[208:211]
  s_waitcnt lgkmcnt(15)
  v_mfma_f32_16x16x32_bf16 v[224:227], v[80:83], v[96:99], v[224:227]
  ds_read_b64_tr_b16 v[76:77], v19 offset:24832
  v_mfma_f32_16x16x32_bf16 v[228:231], v[80:83], v[100:103], v[228:231]
  ds_read_b64_tr_b16 v[78:79], v19 offset:25856
  v_mfma_f32_16x16x32_bf16 v[232:235], v[80:83], v[104:107], v[232:235]
  buffer_load_dwordx4 v[156:159], v15, s[12:15], s44 offen offset:3072 sc1
  v_mfma_f32_16x16x32_bf16 v[236:239], v[80:83], v[108:111], v[236:239]
  ds_read_b64_tr_b16 v[80:81], v18 offset:25088
  v_mfma_f32_16x16x32_bf16 a[132:135], v[84:87], v[108:111], a[132:135]
  ds_read_b64_tr_b16 v[82:83], v18 offset:26112
  v_mfma_f32_16x16x32_bf16 a[128:131], v[84:87], v[104:107], a[128:131]
  s_add_u32 s84, s90, 4194304
  v_mfma_f32_16x16x32_bf16 v[244:247], v[84:87], v[100:103], v[244:247]
  buffer_load_dword a248, v24, s[4:7], s84 offen
  v_mfma_f32_16x16x32_bf16 v[240:243], v[84:87], v[96:99], v[240:243]
  ds_read_b64_tr_b16 v[84:85], v19 offset:25088
  v_mfma_f32_16x16x32_bf16 a[136:139], v[88:91], v[96:99], a[136:139]
  ds_read_b64_tr_b16 v[86:87], v19 offset:26112
  v_mfma_f32_16x16x32_bf16 a[140:143], v[88:91], v[100:103], a[140:143]
  ds_read_b64_tr_b16 v[88:89], v18 offset:25344
  v_mfma_f32_16x16x32_bf16 a[148:151], v[92:95], v[100:103], a[148:151]
  ds_read_b64_tr_b16 v[90:91], v18 offset:26368
  v_mfma_f32_16x16x32_bf16 a[144:147], v[92:95], v[96:99], a[144:147]
  s_waitcnt vmcnt(20) lgkmcnt(15)
  v_mfma_f32_16x16x32_bf16 a[0:3], v[32:35], v[112:115], a[0:3]
  ds_read_b64_tr_b16 v[92:93], v19 offset:25344
  v_mfma_f32_16x16x32_bf16 a[4:7], v[32:35], v[116:119], a[4:7]
  ds_read_b64_tr_b16 v[94:95], v19 offset:26368
  v_mfma_f32_16x16x32_bf16 a[8:11], v[32:35], v[120:123], a[8:11]
  s_mov_b32 s44, 8192
  buffer_load_dwordx4 v[96:99], v12, s[12:15], s44 offen offset:0 sc1
  v_mfma_f32_16x16x32_bf16 a[12:15], v[32:35], v[124:127], a[12:15]
  v_mfma_f32_16x16x32_bf16 a[28:31], v[36:39], v[124:127], a[28:31]
  v_mfma_f32_16x16x32_bf16 a[24:27], v[36:39], v[120:123], a[24:27]
  v_mfma_f32_16x16x32_bf16 a[20:23], v[36:39], v[116:119], a[20:23]
  v_mfma_f32_16x16x32_bf16 a[16:19], v[36:39], v[112:115], a[16:19]
  v_mfma_f32_16x16x32_bf16 a[32:35], v[40:43], v[112:115], a[32:35]
  buffer_load_dwordx4 v[100:103], v13, s[12:15], s44 offen offset:0 sc1
  v_mfma_f32_16x16x32_bf16 a[36:39], v[40:43], v[116:119], a[36:39]
  v_mfma_f32_16x16x32_bf16 a[40:43], v[40:43], v[120:123], a[40:43]
  v_mfma_f32_16x16x32_bf16 a[44:47], v[40:43], v[124:127], a[44:47]
  v_mfma_f32_16x16x32_bf16 a[60:63], v[44:47], v[124:127], a[60:63]
  v_mfma_f32_16x16x32_bf16 a[56:59], v[44:47], v[120:123], a[56:59]
  v_mfma_f32_16x16x32_bf16 a[52:55], v[44:47], v[116:119], a[52:55]
  v_mfma_f32_16x16x32_bf16 a[48:51], v[44:47], v[112:115], a[48:51]
  s_waitcnt vmcnt(21) lgkmcnt(0)
  s_barrier
  s_waitcnt lgkmcnt(15)
  v_mfma_f32_16x16x32_bf16 a[64:67], v[48:51], v[112:115], a[64:67]
  ds_read_b64_tr_b16 v[32:33], v16 offset:0
  ds_read_b64_tr_b16 v[34:35], v16 offset:1024
  v_mfma_f32_16x16x32_bf16 a[68:71], v[48:51], v[116:119], a[68:71]
  ds_read_b64_tr_b16 v[36:37], v17 offset:0
  ds_read_b64_tr_b16 v[38:39], v17 offset:1024
  v_mfma_f32_16x16x32_bf16 a[72:75], v[48:51], v[120:123], a[72:75]
  ds_read_b64_tr_b16 v[40:41], v16 offset:256
  ds_read_b64_tr_b16 v[42:43], v16 offset:1280
  v_mfma_f32_16x16x32_bf16 a[76:79], v[48:51], v[124:127], a[76:79]
  ds_read_b64_tr_b16 v[44:45], v17 offset:256
  ds_read_b64_tr_b16 v[46:47], v17 offset:1280
  v_mfma_f32_16x16x32_bf16 a[92:95], v[52:55], v[124:127], a[92:95]
  ds_read_b64_tr_b16 v[48:49], v16 offset:512
  ds_read_b64_tr_b16 v[50:51], v16 offset:1536
  v_mfma_f32_16x16x32_bf16 a[88:91], v[52:55], v[120:123], a[88:91]
  s_add_u32 m0, s46, 65536
  s_mov_b32 s42, 2621440
  v_mfma_f32_16x16x32_bf16 a[84:87], v[52:55], v[116:119], a[84:87]
  buffer_load_dwordx4 v4, s[4:7], s42 offen offset:0 lds
  v_mfma_f32_16x16x32_bf16 a[80:83], v[52:55], v[112:115], a[80:83]
  ds_read_b64_tr_b16 v[52:53], v17 offset:512
  v_mfma_f32_16x16x32_bf16 a[96:99], v[56:59], v[112:115], a[96:99]
  ds_read_b64_tr_b16 v[54:55], v17 offset:1536
  v_mfma_f32_16x16x32_bf16 a[100:103], v[56:59], v[116:119], a[100:103]
  buffer_load_dwordx4 v[104:107], v14, s[12:15], s44 offen offset:0 sc1
  v_mfma_f32_16x16x32_bf16 a[104:107], v[56:59], v[120:123], a[104:107]
  v_mfma_f32_16x16x32_bf16 a[108:111], v[56:59], v[124:127], a[108:111]
  ds_read_b64_tr_b16 v[56:57], v16 offset:768
  v_mfma_f32_16x16x32_bf16 a[124:127], v[60:63], v[124:127], a[124:127]
  ds_read_b64_tr_b16 v[58:59], v16 offset:1792
  v_mfma_f32_16x16x32_bf16 a[120:123], v[60:63], v[120:123], a[120:123]
  v_mfma_f32_16x16x32_bf16 a[116:119], v[60:63], v[116:119], a[116:119]
  v_mfma_f32_16x16x32_bf16 a[112:115], v[60:63], v[112:115], a[112:115]
  s_waitcnt lgkmcnt(15)
  v_mfma_f32_16x16x32_bf16 v[160:163], v[64:67], v[112:115], v[160:163]
  ds_read_b64_tr_b16 v[60:61], v17 offset:768
  v_mfma_f32_16x16x32_bf16 v[164:167], v[64:67], v[116:119], v[164:167]
  ds_read_b64_tr_b16 v[62:63], v17 offset:1792
  v_mfma_f32_16x16x32_bf16 v[168:171], v[64:67], v[120:123], v[168:171]
  buffer_load_dwordx4 v5, s[4:7], s42 offen offset:1024 lds
  v_mfma_f32_16x16x32_bf16 v[172:175], v[64:67], v[124:127], v[172:175]
  ds_read_b64_tr_b16 v[64:65], v16 offset:16384
  v_mfma_f32_16x16x32_bf16 v[188:191], v[68:71], v[124:127], v[188:191]
  ds_read_b64_tr_b16 v[66:67], v16 offset:17408
  v_mfma_f32_16x16x32_bf16 v[184:187], v[68:71], v[120:123], v[184:187]
  buffer_load_dwordx4 v6, s[4:7], s42 offen offset:2048 lds
  v_mfma_f32_16x16x32_bf16 v[180:183], v[68:71], v[116:119], v[180:183]
  v_mfma_f32_16x16x32_bf16 v[176:179], v[68:71], v[112:115], v[176:179]
  ds_read_b64_tr_b16 v[68:69], v17 offset:16384
  v_mfma_f32_16x16x32_bf16 v[192:195], v[72:75], v[112:115], v[192:195]
  ds_read_b64_tr_b16 v[70:71], v17 offset:17408
  v_mfma_f32_16x16x32_bf16 v[196:199], v[72:75], v[116:119], v[196:199]
  v_mfma_f32_16x16x32_bf16 v[200:203], v[72:75], v[120:123], v[200:203]
  buffer_load_dwordx4 v[108:111], v15, s[12:15], s44 offen offset:0 sc1
  v_mfma_f32_16x16x32_bf16 v[204:207], v[72:75], v[124:127], v[204:207]
  ds_read_b64_tr_b16 v[72:73], v16 offset:16640
  v_mfma_f32_16x16x32_bf16 v[220:223], v[76:79], v[124:127], v[220:223]
  ds_read_b64_tr_b16 v[74:75], v16 offset:17664
  v_mfma_f32_16x16x32_bf16 v[216:219], v[76:79], v[120:123], v[216:219]
  v_mfma_f32_16x16x32_bf16 v[212:215], v[76:79], v[116:119], v[212:215]
  v_mfma_f32_16x16x32_bf16 v[208:211], v[76:79], v[112:115], v[208:211]
  s_waitcnt lgkmcnt(15)
  v_mfma_f32_16x16x32_bf16 v[224:227], v[80:83], v[112:115], v[224:227]
  ds_read_b64_tr_b16 v[76:77], v17 offset:16640
  v_mfma_f32_16x16x32_bf16 v[228:231], v[80:83], v[116:119], v[228:231]
  ds_read_b64_tr_b16 v[78:79], v17 offset:17664
  v_mfma_f32_16x16x32_bf16 v[232:235], v[80:83], v[120:123], v[232:235]
  buffer_load_dwordx4 v7, s[4:7], s42 offen offset:3072 lds
  v_mfma_f32_16x16x32_bf16 v[236:239], v[80:83], v[124:127], v[236:239]
  ds_read_b64_tr_b16 v[80:81], v16 offset:16896
  v_mfma_f32_16x16x32_bf16 a[132:135], v[84:87], v[124:127], a[132:135]
  ds_read_b64_tr_b16 v[82:83], v16 offset:17920
  v_mfma_f32_16x16x32_bf16 a[128:131], v[84:87], v[120:123], a[128:131]
  s_add_u32 s84, s91, 3670016
  v_mfma_f32_16x16x32_bf16 v[244:247], v[84:87], v[116:119], v[244:247]
  buffer_load_dword a249, v24, s[8:11], s84 offen
  v_mfma_f32_16x16x32_bf16 v[240:243], v[84:87], v[112:115], v[240:243]
  ds_read_b64_tr_b16 v[84:85], v17 offset:16896
  v_mfma_f32_16x16x32_bf16 a[136:139], v[88:91], v[112:115], a[136:139]
  ds_read_b64_tr_b16 v[86:87], v17 offset:17920
  v_mfma_f32_16x16x32_bf16 a[140:143], v[88:91], v[116:119], a[140:143]
  ds_read_b64_tr_b16 v[88:89], v16 offset:17152
  v_mfma_f32_16x16x32_bf16 a[148:151], v[92:95], v[116:119], a[148:151]
  ds_read_b64_tr_b16 v[90:91], v16 offset:18176
  v_mfma_f32_16x16x32_bf16 a[144:147], v[92:95], v[112:115], a[144:147]
  s_waitcnt vmcnt(21) lgkmcnt(15)
  v_mfma_f32_16x16x32_bf16 a[0:3], v[32:35], v[128:131], a[0:3]
  ds_read_b64_tr_b16 v[92:93], v17 offset:17152
  v_mfma_f32_16x16x32_bf16 a[4:7], v[32:35], v[132:135], a[4:7]
  ds_read_b64_tr_b16 v[94:95], v17 offset:18176
  v_mfma_f32_16x16x32_bf16 a[8:11], v[32:35], v[136:139], a[8:11]
  buffer_load_dwordx4 v[112:115], v12, s[12:15], s44 offen offset:1024 sc1
  v_mfma_f32_16x16x32_bf16 a[12:15], v[32:35], v[140:143], a[12:15]
  ds_read_b64_tr_b16 v[32:33], v16 offset:8192
  v_mfma_f32_16x16x32_bf16 a[28:31], v[36:39], v[140:143], a[28:31]
  ds_read_b64_tr_b16 v[34:35], v16 offset:9216
  v_mfma_f32_16x16x32_bf16 a[24:27], v[36:39], v[136:139], a[24:27]
  s_add_u32 m0, s46, 81920
  s_mov_b32 s43, 2293760
  v_mfma_f32_16x16x32_bf16 a[20:23], v[36:39], v[132:135], a[20:23]
  buffer_load_dwordx4 v8, s[8:11], s43 offen offset:0 lds
  v_mfma_f32_16x16x32_bf16 a[16:19], v[36:39], v[128:131], a[16:19]
  ds_read_b64_tr_b16 v[36:37], v17 offset:8192
  v_mfma_f32_16x16x32_bf16 a[32:35], v[40:43], v[128:131], a[32:35]
  ds_read_b64_tr_b16 v[38:39], v17 offset:9216
  v_mfma_f32_16x16x32_bf16 a[36:39], v[40:43], v[132:135], a[36:39]
  v_mfma_f32_16x16x32_bf16 a[40:43], v[40:43], v[136:139], a[40:43]
  v_mfma_f32_16x16x32_bf16 a[44:47], v[40:43], v[140:143], a[44:47]
  ds_read_b64_tr_b16 v[40:41], v16 offset:8448
  v_mfma_f32_16x16x32_bf16 a[60:63], v[44:47], v[140:143], a[60:63]
  ds_read_b64_tr_b16 v[42:43], v16 offset:9472
  v_mfma_f32_16x16x32_bf16 a[56:59], v[44:47], v[136:139], a[56:59]
  buffer_load_dwordx4 v9, s[8:11], s43 offen offset:1024 lds
  v_mfma_f32_16x16x32_bf16 a[52:55], v[44:47], v[132:135], a[52:55]
  v_mfma_f32_16x16x32_bf16 a[48:51], v[44:47], v[128:131], a[48:51]
  s_waitcnt lgkmcnt(15)
  v_mfma_f32_16x16x32_bf16 a[64:67], v[48:51], v[128:131], a[64:67]
  ds_read_b64_tr_b16 v[44:45], v17 offset:8448
  v_mfma_f32_16x16x32_bf16 a[68:71], v[48:51], v[132:135], a[68:71]
  ds_read_b64_tr_b16 v[46:47], v17 offset:9472
  v_mfma_f32_16x16x32_bf16 a[72:75], v[48:51], v[136:139], a[72:75]
  buffer_load_dwordx4 v[116:119], v13, s[12:15], s44 offen offset:1024 sc1
  v_mfma_f32_16x16x32_bf16 a[76:79], v[48:51], v[140:143], a[76:79]
  ds_read_b64_tr_b16 v[48:49], v16 offset:8704
  v_mfma_f32_16x16x32_bf16 a[92:95], v[52:55], v[140:143], a[92:95]
  ds_read_b64_tr_b16 v[50:51], v16 offset:9728
  v_mfma_f32_16x16x32_bf16 a[88:91], v[52:55], v[136:139], a[88:91]
  v_mfma_f32_16x16x32_bf16 a[84:87], v[52:55], v[132:135], a[84:87]
  v_mfma_f32_16x16x32_bf16 a[80:83], v[52:55], v[128:131], a[80:83]
  ds_read_b64_tr_b16 v[52:53], v17 offset:8704
  v_mfma_f32_16x16x32_bf16 a[96:99], v[56:59], v[128:131], a[96:99]
  ds_read_b64_tr_b16 v[54:55], v17 offset:9728
  v_mfma_f32_16x16x32_bf16 a[100:103], v[56:59], v[132:135], a[100:103]
  buffer_load_dwordx4 v10, s[8:11], s43 offen offset:2048 lds
  v_mfma_f32_16x16x32_bf16 a[104:107], v[56:59], v[136:139], a[104:107]
  v_mfma_f32_16x16x32_bf16 a[108:111], v[56:59], v[140:143], a[108:111]
  ds_read_b64_tr_b16 v[56:57], v16 offset:8960
  v_mfma_f32_16x16x32_bf16 a[124:127], v[60:63], v[140:143], a[124:127]
  ds_read_b64_tr_b16 v[58:59], v16 offset:9984
  v_mfma_f32_16x16x32_bf16 a[120:123], v[60:63], v[136:139], a[120:123]
  v_mfma_f32_16x16x32_bf16 a[116:119], v[60:63], v[132:135], a[116:119]
  buffer_load_dwordx4 v[120:123], v14, s[12:15], s44 offen offset:1024 sc1
  v_mfma_f32_16x16x32_bf16 a[112:115], v[60:63], v[128:131], a[112:115]
  s_waitcnt lgkmcnt(15)
  v_mfma_f32_16x16x32_bf16 v[160:163], v[64:67], v[128:131], v[160:163]
  ds_read_b64_tr_b16 v[60:61], v17 offset:8960
  v_mfma_f32_16x16x32_bf16 v[164:167], v[64:67], v[132:135], v[164:167]
  ds_read_b64_tr_b16 v[62:63], v17 offset:9984
  v_mfma_f32_16x16x32_bf16 v[168:171], v[64:67], v[136:139], v[168:171]
  v_mfma_f32_16x16x32_bf16 v[172:175], v[64:67], v[140:143], v[172:175]
  ds_read_b64_tr_b16 v[64:65], v16 offset:24576
  v_mfma_f32_16x16x32_bf16 v[188:191], v[68:71], v[140:143], v[188:191]
  ds_read_b64_tr_b16 v[66:67], v16 offset:25600
  v_mfma_f32_16x16x32_bf16 v[184:187], v[68:71], v[136:139], v[184:187]
  buffer_load_dwordx4 v11, s[8:11], s43 offen offset:3072 lds
  v_mfma_f32_16x16x32_bf16 v[180:183], v[68:71], v[132:135], v[180:183]
  v_mfma_f32_16x16x32_bf16 v[176:179], v[68:71], v[128:131], v[176:179]
  ds_read_b64_tr_b16 v[68:69], v17 offset:24576
  v_mfma_f32_16x16x32_bf16 v[192:195], v[72:75], v[128:131], v[192:195]
  ds_read_b64_tr_b16 v[70:71], v17 offset:25600
  v_mfma_f32_16x16x32_bf16 v[196:199], v[72:75], v[132:135], v[196:199]
  s_add_u32 m0, s47, 106496
  s_add_u32 s45, s48, 8192
  v_mfma_f32_16x16x32_bf16 v[200:203], v[72:75], v[136:139], v[200:203]
  buffer_load_dwordx4 v21, s[24:27], s45 offen offset:0 lds
  v_mfma_f32_16x16x32_bf16 v[204:207], v[72:75], v[140:143], v[204:207]
  ds_read_b64_tr_b16 v[72:73], v16 offset:24832
  v_mfma_f32_16x16x32_bf16 v[220:223], v[76:79], v[140:143], v[220:223]
  ds_read_b64_tr_b16 v[74:75], v16 offset:25856
  v_mfma_f32_16x16x32_bf16 v[216:219], v[76:79], v[136:139], v[216:219]
  v_mfma_f32_16x16x32_bf16 v[212:215], v[76:79], v[132:135], v[212:215]
  v_mfma_f32_16x16x32_bf16 v[208:211], v[76:79], v[128:131], v[208:211]
  s_waitcnt lgkmcnt(15)
  v_mfma_f32_16x16x32_bf16 v[224:227], v[80:83], v[128:131], v[224:227]
  ds_read_b64_tr_b16 v[76:77], v17 offset:24832
  v_mfma_f32_16x16x32_bf16 v[228:231], v[80:83], v[132:135], v[228:231]
  ds_read_b64_tr_b16 v[78:79], v17 offset:25856
  v_mfma_f32_16x16x32_bf16 v[232:235], v[80:83], v[136:139], v[232:235]
  buffer_load_dwordx4 v[124:127], v15, s[12:15], s44 offen offset:1024 sc1
  v_mfma_f32_16x16x32_bf16 v[236:239], v[80:83], v[140:143], v[236:239]
  ds_read_b64_tr_b16 v[80:81], v16 offset:25088
  v_mfma_f32_16x16x32_bf16 a[132:135], v[84:87], v[140:143], a[132:135]
  ds_read_b64_tr_b16 v[82:83], v16 offset:26112
  v_mfma_f32_16x16x32_bf16 a[128:131], v[84:87], v[136:139], a[128:131]
  buffer_load_dwordx4 v22, s[24:27], s45 offen offset:2048 lds
  v_mfma_f32_16x16x32_bf16 v[244:247], v[84:87], v[132:135], v[244:247]
  v_mfma_f32_16x16x32_bf16 v[240:243], v[84:87], v[128:131], v[240:243]
  ds_read_b64_tr_b16 v[84:85], v17 offset:25088
  v_mfma_f32_16x16x32_bf16 a[136:139], v[88:91], v[128:131], a[136:139]
  ds_read_b64_tr_b16 v[86:87], v17 offset:26112
  v_mfma_f32_16x16x32_bf16 a[140:143], v[88:91], v[132:135], a[140:143]
  ds_read_b64_tr_b16 v[88:89], v16 offset:25344
  v_mfma_f32_16x16x32_bf16 a[148:151], v[92:95], v[132:135], a[148:151]
  ds_read_b64_tr_b16 v[90:91], v16 offset:26368
  v_mfma_f32_16x16x32_bf16 a[144:147], v[92:95], v[128:131], a[144:147]
  s_waitcnt vmcnt(20) lgkmcnt(15)
  v_mfma_f32_16x16x32_bf16 a[0:3], v[32:35], v[144:147], a[0:3]
  ds_read_b64_tr_b16 v[92:93], v17 offset:25344
  v_mfma_f32_16x16x32_bf16 a[4:7], v[32:35], v[148:151], a[4:7]
  ds_read_b64_tr_b16 v[94:95], v17 offset:26368
  v_mfma_f32_16x16x32_bf16 a[8:11], v[32:35], v[152:155], a[8:11]
  buffer_load_dwordx4 v[128:131], v12, s[12:15], s44 offen offset:2048 sc1
  v_mfma_f32_16x16x32_bf16 a[12:15], v[32:35], v[156:159], a[12:15]
  v_mfma_f32_16x16x32_bf16 a[28:31], v[36:39], v[156:159], a[28:31]
  v_mfma_f32_16x16x32_bf16 a[24:27], v[36:39], v[152:155], a[24:27]
  v_mfma_f32_16x16x32_bf16 a[20:23], v[36:39], v[148:151], a[20:23]
  v_mfma_f32_16x16x32_bf16 a[16:19], v[36:39], v[144:147], a[16:19]
  v_mfma_f32_16x16x32_bf16 a[32:35], v[40:43], v[144:147], a[32:35]
  buffer_load_dwordx4 v[132:135], v13, s[12:15], s44 offen offset:2048 sc1
  v_mfma_f32_16x16x32_bf16 a[36:39], v[40:43], v[148:151], a[36:39]
  v_mfma_f32_16x16x32_bf16 a[40:43], v[40:43], v[152:155], a[40:43]
  v_mfma_f32_16x16x32_bf16 a[44:47], v[40:43], v[156:159], a[44:47]
  v_mfma_f32_16x16x32_bf16 a[60:63], v[44:47], v[156:159], a[60:63]
  v_mfma_f32_16x16x32_bf16 a[56:59], v[44:47], v[152:155], a[56:59]
  v_mfma_f32_16x16x32_bf16 a[52:55], v[44:47], v[148:151], a[52:55]
  v_mfma_f32_16x16x32_bf16 a[48:51], v[44:47], v[144:147], a[48:51]
  s_waitcnt vmcnt(26) lgkmcnt(0)
  s_barrier
  s_waitcnt lgkmcnt(15)
  v_mfma_f32_16x16x32_bf16 a[64:67], v[48:51], v[144:147], a[64:67]
  ds_read_b64_tr_b16 v[32:33], v16 offset:32768
  ds_read_b64_tr_b16 v[34:35], v16 offset:33792
  v_mfma_f32_16x16x32_bf16 a[68:71], v[48:51], v[148:151], a[68:71]
  ds_read_b64_tr_b16 v[36:37], v17 offset:32768
  ds_read_b64_tr_b16 v[38:39], v17 offset:33792
  v_mfma_f32_16x16x32_bf16 a[72:75], v[48:51], v[152:155], a[72:75]
  ds_read_b64_tr_b16 v[40:41], v16 offset:33024
  ds_read_b64_tr_b16 v[42:43], v16 offset:34048
  v_mfma_f32_16x16x32_bf16 a[76:79], v[48:51], v[156:159], a[76:79]
  ds_read_b64_tr_b16 v[44:45], v17 offset:33024
  ds_read_b64_tr_b16 v[46:47], v17 offset:34048
  v_mfma_f32_16x16x32_bf16 a[92:95], v[52:55], v[156:159], a[92:95]
  ds_read_b64_tr_b16 v[48:49], v16 offset:33280
  ds_read_b64_tr_b16 v[50:51], v16 offset:34304
  v_mfma_f32_16x16x32_bf16 a[88:91], v[52:55], v[152:155], a[88:91]
  s_add_u32 m0, s46, 0
  s_mov_b32 s42, 3145728
  v_mfma_f32_16x16x32_bf16 a[84:87], v[52:55], v[148:151], a[84:87]
  buffer_load_dwordx4 v4, s[4:7], s42 offen offset:0 lds
  v_mfma_f32_16x16x32_bf16 a[80:83], v[52:55], v[144:147], a[80:83]
  ds_read_b64_tr_b16 v[52:53], v17 offset:33280
  v_mfma_f32_16x16x32_bf16 a[96:99], v[56:59], v[144:147], a[96:99]
  ds_read_b64_tr_b16 v[54:55], v17 offset:34304
  v_mfma_f32_16x16x32_bf16 a[100:103], v[56:59], v[148:151], a[100:103]
  v_mfma_f32_16x16x32_bf16 a[104:107], v[56:59], v[152:155], a[104:107]
  buffer_load_dwordx4 v[136:139], v14, s[12:15], s44 offen offset:2048 sc1
  v_mfma_f32_16x16x32_bf16 a[108:111], v[56:59], v[156:159], a[108:111]
  ds_read_b64_tr_b16 v[56:57], v16 offset:33536
  v_mfma_f32_16x16x32_bf16 a[124:127], v[60:63], v[156:159], a[124:127]
  ds_read_b64_tr_b16 v[58:59], v16 offset:34560
  v_mfma_f32_16x16x32_bf16 a[120:123], v[60:63], v[152:155], a[120:123]
  v_mfma_f32_16x16x32_bf16 a[116:119], v[60:63], v[148:151], a[116:119]
  v_mfma_f32_16x16x32_bf16 a[112:115], v[60:63], v[144:147], a[112:115]
  s_waitcnt lgkmcnt(15)
  v_mfma_f32_16x16x32_bf16 v[160:163], v[64:67], v[144:147], v[160:163]
  ds_read_b64_tr_b16 v[60:61], v17 offset:33536
  v_mfma_f32_16x16x32_bf16 v[164:167], v[64:67], v[148:151], v[164:167]
  ds_read_b64_tr_b16 v[62:63], v17 offset:34560
  v_mfma_f32_16x16x32_bf16 v[168:171], v[64:67], v[152:155], v[168:171]
  buffer_load_dwordx4 v5, s[4:7], s42 offen offset:1024 lds
  v_mfma_f32_16x16x32_bf16 v[172:175], v[64:67], v[156:159], v[172:175]
  ds_read_b64_tr_b16 v[64:65], v16 offset:49152
  v_mfma_f32_16x16x32_bf16 v[188:191], v[68:71], v[156:159], v[188:191]
  ds_read_b64_tr_b16 v[66:67], v16 offset:50176
  v_mfma_f32_16x16x32_bf16 v[184:187], v[68:71], v[152:155], v[184:187]
  v_mfma_f32_16x16x32_bf16 v[180:183], v[68:71], v[148:151], v[180:183]
  v_mfma_f32_16x16x32_bf16 v[176:179], v[68:71], v[144:147], v[176:179]
  ds_read_b64_tr_b16 v[68:69], v17 offset:49152
  v_mfma_f32_16x16x32_bf16 v[192:195], v[72:75], v[144:147], v[192:195]
  ds_read_b64_tr_b16 v[70:71], v17 offset:50176
  v_mfma_f32_16x16x32_bf16 v[196:199], v[72:75], v[148:151], v[196:199]
  buffer_load_dwordx4 v6, s[4:7], s42 offen offset:2048 lds
  v_mfma_f32_16x16x32_bf16 v[200:203], v[72:75], v[152:155], v[200:203]
  v_mfma_f32_16x16x32_bf16 v[204:207], v[72:75], v[156:159], v[204:207]
  ds_read_b64_tr_b16 v[72:73], v16 offset:49408
  v_mfma_f32_16x16x32_bf16 v[220:223], v[76:79], v[156:159], v[220:223]
  ds_read_b64_tr_b16 v[74:75], v16 offset:50432
  v_mfma_f32_16x16x32_bf16 v[216:219], v[76:79], v[152:155], v[216:219]
  v_mfma_f32_16x16x32_bf16 v[212:215], v[76:79], v[148:151], v[212:215]
  buffer_load_dwordx4 v[140:143], v15, s[12:15], s44 offen offset:2048 sc1
  v_mfma_f32_16x16x32_bf16 v[208:211], v[76:79], v[144:147], v[208:211]
  s_waitcnt lgkmcnt(15)
  v_mfma_f32_16x16x32_bf16 v[224:227], v[80:83], v[144:147], v[224:227]
  ds_read_b64_tr_b16 v[76:77], v17 offset:49408
  v_mfma_f32_16x16x32_bf16 v[228:231], v[80:83], v[148:151], v[228:231]
  ds_read_b64_tr_b16 v[78:79], v17 offset:50432
  v_mfma_f32_16x16x32_bf16 v[232:235], v[80:83], v[152:155], v[232:235]
  v_mfma_f32_16x16x32_bf16 v[236:239], v[80:83], v[156:159], v[236:239]
  ds_read_b64_tr_b16 v[80:81], v16 offset:49664
  v_mfma_f32_16x16x32_bf16 a[132:135], v[84:87], v[156:159], a[132:135]
  ds_read_b64_tr_b16 v[82:83], v16 offset:50688
  v_mfma_f32_16x16x32_bf16 a[128:131], v[84:87], v[152:155], a[128:131]
  buffer_load_dwordx4 v7, s[4:7], s42 offen offset:3072 lds
  v_mfma_f32_16x16x32_bf16 v[244:247], v[84:87], v[148:151], v[244:247]
  v_mfma_f32_16x16x32_bf16 v[240:243], v[84:87], v[144:147], v[240:243]
  ds_read_b64_tr_b16 v[84:85], v17 offset:49664
  v_mfma_f32_16x16x32_bf16 a[136:139], v[88:91], v[144:147], a[136:139]
  ds_read_b64_tr_b16 v[86:87], v17 offset:50688
  v_mfma_f32_16x16x32_bf16 a[140:143], v[88:91], v[148:151], a[140:143]
  ds_read_b64_tr_b16 v[88:89], v16 offset:49920
  v_mfma_f32_16x16x32_bf16 a[148:151], v[92:95], v[148:151], a[148:151]
  ds_read_b64_tr_b16 v[90:91], v16 offset:50944
  v_mfma_f32_16x16x32_bf16 a[144:147], v[92:95], v[144:147], a[144:147]
  s_waitcnt vmcnt(20) lgkmcnt(15)
  v_mfma_f32_16x16x32_bf16 a[0:3], v[32:35], v[96:99], a[0:3]
  ds_read_b64_tr_b16 v[92:93], v17 offset:49920
  v_mfma_f32_16x16x32_bf16 a[4:7], v[32:35], v[100:103], a[4:7]
  ds_read_b64_tr_b16 v[94:95], v17 offset:50944
  v_mfma_f32_16x16x32_bf16 a[8:11], v[32:35], v[104:107], a[8:11]
  buffer_load_dwordx4 v[144:147], v12, s[12:15], s44 offen offset:3072 sc1
  v_mfma_f32_16x16x32_bf16 a[12:15], v[32:35], v[108:111], a[12:15]
  ds_read_b64_tr_b16 v[32:33], v16 offset:40960
  v_mfma_f32_16x16x32_bf16 a[28:31], v[36:39], v[108:111], a[28:31]
  ds_read_b64_tr_b16 v[34:35], v16 offset:41984
  v_mfma_f32_16x16x32_bf16 a[24:27], v[36:39], v[104:107], a[24:27]
  s_add_u32 m0, s46, 16384
  s_mov_b32 s43, 2752512
  v_mfma_f32_16x16x32_bf16 a[20:23], v[36:39], v[100:103], a[20:23]
  buffer_load_dwordx4 v8, s[8:11], s43 offen offset:0 lds
  v_mfma_f32_16x16x32_bf16 a[16:19], v[36:39], v[96:99], a[16:19]
  ds_read_b64_tr_b16 v[36:37], v17 offset:40960
  v_mfma_f32_16x16x32_bf16 a[32:35], v[40:43], v[96:99], a[32:35]
  ds_read_b64_tr_b16 v[38:39], v17 offset:41984
  v_mfma_f32_16x16x32_bf16 a[36:39], v[40:43], v[100:103], a[36:39]
  v_mfma_f32_16x16x32_bf16 a[40:43], v[40:43], v[104:107], a[40:43]
  v_mfma_f32_16x16x32_bf16 a[44:47], v[40:43], v[108:111], a[44:47]
  ds_read_b64_tr_b16 v[40:41], v16 offset:41216
  v_mfma_f32_16x16x32_bf16 a[60:63], v[44:47], v[108:111], a[60:63]
  ds_read_b64_tr_b16 v[42:43], v16 offset:42240
  v_mfma_f32_16x16x32_bf16 a[56:59], v[44:47], v[104:107], a[56:59]
  buffer_load_dwordx4 v9, s[8:11], s43 offen offset:1024 lds
  v_mfma_f32_16x16x32_bf16 a[52:55], v[44:47], v[100:103], a[52:55]
  v_mfma_f32_16x16x32_bf16 a[48:51], v[44:47], v[96:99], a[48:51]
  s_waitcnt lgkmcnt(15)
  v_mfma_f32_16x16x32_bf16 a[64:67], v[48:51], v[96:99], a[64:67]
  ds_read_b64_tr_b16 v[44:45], v17 offset:41216
  v_mfma_f32_16x16x32_bf16 a[68:71], v[48:51], v[100:103], a[68:71]
  ds_read_b64_tr_b16 v[46:47], v17 offset:42240
  v_mfma_f32_16x16x32_bf16 a[72:75], v[48:51], v[104:107], a[72:75]
  buffer_load_dwordx4 v[148:151], v13, s[12:15], s44 offen offset:3072 sc1
  v_mfma_f32_16x16x32_bf16 a[76:79], v[48:51], v[108:111], a[76:79]
  ds_read_b64_tr_b16 v[48:49], v16 offset:41472
  v_mfma_f32_16x16x32_bf16 a[92:95], v[52:55], v[108:111], a[92:95]
  ds_read_b64_tr_b16 v[50:51], v16 offset:42496
  v_mfma_f32_16x16x32_bf16 a[88:91], v[52:55], v[104:107], a[88:91]
  v_mfma_f32_16x16x32_bf16 a[84:87], v[52:55], v[100:103], a[84:87]
  buffer_load_dwordx4 v10, s[8:11], s43 offen offset:2048 lds
  v_mfma_f32_16x16x32_bf16 a[80:83], v[52:55], v[96:99], a[80:83]
  ds_read_b64_tr_b16 v[52:53], v17 offset:41472
  v_mfma_f32_16x16x32_bf16 a[96:99], v[56:59], v[96:99], a[96:99]
  ds_read_b64_tr_b16 v[54:55], v17 offset:42496
  v_mfma_f32_16x16x32_bf16 a[100:103], v[56:59], v[100:103], a[100:103]
  v_mfma_f32_16x16x32_bf16 a[104:107], v[56:59], v[104:107], a[104:107]
  v_mfma_f32_16x16x32_bf16 a[108:111], v[56:59], v[108:111], a[108:111]
  ds_read_b64_tr_b16 v[56:57], v16 offset:41728
  v_mfma_f32_16x16x32_bf16 a[124:127], v[60:63], v[108:111], a[124:127]
  ds_read_b64_tr_b16 v[58:59], v16 offset:42752
  v_mfma_f32_16x16x32_bf16 a[120:123], v[60:63], v[104:107], a[120:123]
  buffer_load_dwordx4 v11, s[8:11], s43 offen offset:3072 lds
  v_mfma_f32_16x16x32_bf16 a[116:119], v[60:63], v[100:103], a[116:119]
  v_mfma_f32_16x16x32_bf16 a[112:115], v[60:63], v[96:99], a[112:115]
  s_waitcnt lgkmcnt(15)
  v_mfma_f32_16x16x32_bf16 v[160:163], v[64:67], v[96:99], v[160:163]
  ds_read_b64_tr_b16 v[60:61], v17 offset:41728
  v_mfma_f32_16x16x32_bf16 v[164:167], v[64:67], v[100:103], v[164:167]
  ds_read_b64_tr_b16 v[62:63], v17 offset:42752
  v_mfma_f32_16x16x32_bf16 v[168:171], v[64:67], v[104:107], v[168:171]
  buffer_load_dwordx4 v[152:155], v14, s[12:15], s44 offen offset:3072 sc1
  v_mfma_f32_16x16x32_bf16 v[172:175], v[64:67], v[108:111], v[172:175]
  ds_read_b64_tr_b16 v[64:65], v16 offset:57344
  v_mfma_f32_16x16x32_bf16 v[188:191], v[68:71], v[108:111], v[188:191]
  ds_read_b64_tr_b16 v[66:67], v16 offset:58368
  v_mfma_f32_16x16x32_bf16 v[184:187], v[68:71], v[104:107], v[184:187]
  s_add_u32 m0, s47, 114688
  s_add_u32 s45, s48, 16384
  v_mfma_f32_16x16x32_bf16 v[180:183], v[68:71], v[100:103], v[180:183]
  buffer_load_dwordx4 v21, s[24:27], s45 offen offset:0 lds
  v_mfma_f32_16x16x32_bf16 v[176:179], v[68:71], v[96:99], v[176:179]
  ds_read_b64_tr_b16 v[68:69], v17 offset:57344
  v_mfma_f32_16x16x32_bf16 v[192:195], v[72:75], v[96:99], v[192:195]
  ds_read_b64_tr_b16 v[70:71], v17 offset:58368
  v_mfma_f32_16x16x32_bf16 v[196:199], v[72:75], v[100:103], v[196:199]
  v_mfma_f32_16x16x32_bf16 v[200:203], v[72:75], v[104:107], v[200:203]
  v_mfma_f32_16x16x32_bf16 v[204:207], v[72:75], v[108:111], v[204:207]
  ds_read_b64_tr_b16 v[72:73], v16 offset:57600
  v_mfma_f32_16x16x32_bf16 v[220:223], v[76:79], v[108:111], v[220:223]
  ds_read_b64_tr_b16 v[74:75], v16 offset:58624
  v_mfma_f32_16x16x32_bf16 v[216:219], v[76:79], v[104:107], v[216:219]
  buffer_load_dwordx4 v22, s[24:27], s45 offen offset:2048 lds
  v_mfma_f32_16x16x32_bf16 v[212:215], v[76:79], v[100:103], v[212:215]
  v_mfma_f32_16x16x32_bf16 v[208:211], v[76:79], v[96:99], v[208:211]
  s_waitcnt lgkmcnt(15)
  v_mfma_f32_16x16x32_bf16 v[224:227], v[80:83], v[96:99], v[224:227]
  ds_read_b64_tr_b16 v[76:77], v17 offset:57600
  v_mfma_f32_16x16x32_bf16 v[228:231], v[80:83], v[100:103], v[228:231]
  ds_read_b64_tr_b16 v[78:79], v17 offset:58624
  v_mfma_f32_16x16x32_bf16 v[232:235], v[80:83], v[104:107], v[232:235]
  buffer_load_dwordx4 v[156:159], v15, s[12:15], s44 offen offset:3072 sc1
  v_mfma_f32_16x16x32_bf16 v[236:239], v[80:83], v[108:111], v[236:239]
  ds_read_b64_tr_b16 v[80:81], v16 offset:57856
  v_mfma_f32_16x16x32_bf16 a[132:135], v[84:87], v[108:111], a[132:135]
  ds_read_b64_tr_b16 v[82:83], v16 offset:58880
  v_mfma_f32_16x16x32_bf16 a[128:131], v[84:87], v[104:107], a[128:131]
  s_add_u32 s84, s90, 5242880
  v_mfma_f32_16x16x32_bf16 v[244:247], v[84:87], v[100:103], v[244:247]
  buffer_load_dword a250, v24, s[4:7], s84 offen
  v_mfma_f32_16x16x32_bf16 v[240:243], v[84:87], v[96:99], v[240:243]
  ds_read_b64_tr_b16 v[84:85], v17 offset:57856
  v_mfma_f32_16x16x32_bf16 a[136:139], v[88:91], v[96:99], a[136:139]
  ds_read_b64_tr_b16 v[86:87], v17 offset:58880
  v_mfma_f32_16x16x32_bf16 a[140:143], v[88:91], v[100:103], a[140:143]
  ds_read_b64_tr_b16 v[88:89], v16 offset:58112
  v_mfma_f32_16x16x32_bf16 a[148:151], v[92:95], v[100:103], a[148:151]
  ds_read_b64_tr_b16 v[90:91], v16 offset:59136
  v_mfma_f32_16x16x32_bf16 a[144:147], v[92:95], v[96:99], a[144:147]
  s_waitcnt vmcnt(20) lgkmcnt(15)
  v_mfma_f32_16x16x32_bf16 a[0:3], v[32:35], v[112:115], a[0:3]
  ds_read_b64_tr_b16 v[92:93], v17 offset:58112
  v_mfma_f32_16x16x32_bf16 a[4:7], v[32:35], v[116:119], a[4:7]
  ds_read_b64_tr_b16 v[94:95], v17 offset:59136
  v_mfma_f32_16x16x32_bf16 a[8:11], v[32:35], v[120:123], a[8:11]
  s_mov_b32 s44, 12288
  buffer_load_dwordx4 v[96:99], v12, s[12:15], s44 offen offset:0 sc1
  v_mfma_f32_16x16x32_bf16 a[12:15], v[32:35], v[124:127], a[12:15]
  v_mfma_f32_16x16x32_bf16 a[28:31], v[36:39], v[124:127], a[28:31]
  v_mfma_f32_16x16x32_bf16 a[24:27], v[36:39], v[120:123], a[24:27]
  v_mfma_f32_16x16x32_bf16 a[20:23], v[36:39], v[116:119], a[20:23]
  v_mfma_f32_16x16x32_bf16 a[16:19], v[36:39], v[112:115], a[16:19]
  v_mfma_f32_16x16x32_bf16 a[32:35], v[40:43], v[112:115], a[32:35]
  buffer_load_dwordx4 v[100:103], v13, s[12:15], s44 offen offset:0 sc1
  v_mfma_f32_16x16x32_bf16 a[36:39], v[40:43], v[116:119], a[36:39]
  v_mfma_f32_16x16x32_bf16 a[40:43], v[40:43], v[120:123], a[40:43]
  v_mfma_f32_16x16x32_bf16 a[44:47], v[40:43], v[124:127], a[44:47]
  v_mfma_f32_16x16x32_bf16 a[60:63], v[44:47], v[124:127], a[60:63]
  v_mfma_f32_16x16x32_bf16 a[56:59], v[44:47], v[120:123], a[56:59]
  v_mfma_f32_16x16x32_bf16 a[52:55], v[44:47], v[116:119], a[52:55]
  v_mfma_f32_16x16x32_bf16 a[48:51], v[44:47], v[112:115], a[48:51]
  s_waitcnt vmcnt(24) lgkmcnt(0)
  s_barrier
  s_waitcnt lgkmcnt(15)
  v_mfma_f32_16x16x32_bf16 a[64:67], v[48:51], v[112:115], a[64:67]
  ds_read_b64_tr_b16 v[32:33], v18 offset:0
  ds_read_b64_tr_b16 v[34:35], v18 offset:1024
  v_mfma_f32_16x16x32_bf16 a[68:71], v[48:51], v[116:119], a[68:71]
  ds_read_b64_tr_b16 v[36:37], v19 offset:0
  ds_read_b64_tr_b16 v[38:39], v19 offset:1024
  v_mfma_f32_16x16x32_bf16 a[72:75], v[48:51], v[120:123], a[72:75]
  ds_read_b64_tr_b16 v[40:41], v18 offset:256
  ds_read_b64_tr_b16 v[42:43], v18 offset:1280
  v_mfma_f32_16x16x32_bf16 a[76:79], v[48:51], v[124:127], a[76:79]
  ds_read_b64_tr_b16 v[44:45], v19 offset:256
  ds_read_b64_tr_b16 v[46:47], v19 offset:1280
  v_mfma_f32_16x16x32_bf16 a[92:95], v[52:55], v[124:127], a[92:95]
  ds_read_b64_tr_b16 v[48:49], v18 offset:512
  ds_read_b64_tr_b16 v[50:51], v18 offset:1536
  v_mfma_f32_16x16x32_bf16 a[88:91], v[52:55], v[120:123], a[88:91]
  s_add_u32 m0, s46, 32768
  s_mov_b32 s42, 3670016
  v_mfma_f32_16x16x32_bf16 a[84:87], v[52:55], v[116:119], a[84:87]
  buffer_load_dwordx4 v4, s[4:7], s42 offen offset:0 lds
  v_mfma_f32_16x16x32_bf16 a[80:83], v[52:55], v[112:115], a[80:83]
  ds_read_b64_tr_b16 v[52:53], v19 offset:512
  v_mfma_f32_16x16x32_bf16 a[96:99], v[56:59], v[112:115], a[96:99]
  ds_read_b64_tr_b16 v[54:55], v19 offset:1536
  v_mfma_f32_16x16x32_bf16 a[100:103], v[56:59], v[116:119], a[100:103]
  buffer_load_dwordx4 v[104:107], v14, s[12:15], s44 offen offset:0 sc1
  v_mfma_f32_16x16x32_bf16 a[104:107], v[56:59], v[120:123], a[104:107]
  v_mfma_f32_16x16x32_bf16 a[108:111], v[56:59], v[124:127], a[108:111]
  ds_read_b64_tr_b16 v[56:57], v18 offset:768
  v_mfma_f32_16x16x32_bf16 a[124:127], v[60:63], v[124:127], a[124:127]
  ds_read_b64_tr_b16 v[58:59], v18 offset:1792
  v_mfma_f32_16x16x32_bf16 a[120:123], v[60:63], v[120:123], a[120:123]
  v_mfma_f32_16x16x32_bf16 a[116:119], v[60:63], v[116:119], a[116:119]
  v_mfma_f32_16x16x32_bf16 a[112:115], v[60:63], v[112:115], a[112:115]
  s_waitcnt lgkmcnt(15)
  v_mfma_f32_16x16x32_bf16 v[160:163], v[64:67], v[112:115], v[160:163]
  ds_read_b64_tr_b16 v[60:61], v19 offset:768
  v_mfma_f32_16x16x32_bf16 v[164:167], v[64:67], v[116:119], v[164:167]
  ds_read_b64_tr_b16 v[62:63], v19 offset:1792
  v_mfma_f32_16x16x32_bf16 v[168:171], v[64:67], v[120:123], v[168:171]
  buffer_load_dwordx4 v5, s[4:7], s42 offen offset:1024 lds
  v_mfma_f32_16x16x32_bf16 v[172:175], v[64:67], v[124:127], v[172:175]
  ds_read_b64_tr_b16 v[64:65], v18 offset:16384
  v_mfma_f32_16x16x32_bf16 v[188:191], v[68:71], v[124:127], v[188:191]
  ds_read_b64_tr_b16 v[66:67], v18 offset:17408
  v_mfma_f32_16x16x32_bf16 v[184:187], v[68:71], v[120:123], v[184:187]
  buffer_load_dwordx4 v6, s[4:7], s42 offen offset:2048 lds
  v_mfma_f32_16x16x32_bf16 v[180:183], v[68:71], v[116:119], v[180:183]
  v_mfma_f32_16x16x32_bf16 v[176:179], v[68:71], v[112:115], v[176:179]
  ds_read_b64_tr_b16 v[68:69], v19 offset:16384
  v_mfma_f32_16x16x32_bf16 v[192:195], v[72:75], v[112:115], v[192:195]
  ds_read_b64_tr_b16 v[70:71], v19 offset:17408
  v_mfma_f32_16x16x32_bf16 v[196:199], v[72:75], v[116:119], v[196:199]
  v_mfma_f32_16x16x32_bf16 v[200:203], v[72:75], v[120:123], v[200:203]
  buffer_load_dwordx4 v[108:111], v15, s[12:15], s44 offen offset:0 sc1
  v_mfma_f32_16x16x32_bf16 v[204:207], v[72:75], v[124:127], v[204:207]
  ds_read_b64_tr_b16 v[72:73], v18 offset:16640
  v_mfma_f32_16x16x32_bf16 v[220:223], v[76:79], v[124:127], v[220:223]
  ds_read_b64_tr_b16 v[74:75], v18 offset:17664
  v_mfma_f32_16x16x32_bf16 v[216:219], v[76:79], v[120:123], v[216:219]
  v_mfma_f32_16x16x32_bf16 v[212:215], v[76:79], v[116:119], v[212:215]
  v_mfma_f32_16x16x32_bf16 v[208:211], v[76:79], v[112:115], v[208:211]
  s_waitcnt lgkmcnt(15)
  v_mfma_f32_16x16x32_bf16 v[224:227], v[80:83], v[112:115], v[224:227]
  ds_read_b64_tr_b16 v[76:77], v19 offset:16640
  v_mfma_f32_16x16x32_bf16 v[228:231], v[80:83], v[116:119], v[228:231]
  ds_read_b64_tr_b16 v[78:79], v19 offset:17664
  v_mfma_f32_16x16x32_bf16 v[232:235], v[80:83], v[120:123], v[232:235]
  buffer_load_dwordx4 v7, s[4:7], s42 offen offset:3072 lds
  v_mfma_f32_16x16x32_bf16 v[236:239], v[80:83], v[124:127], v[236:239]
  ds_read_b64_tr_b16 v[80:81], v18 offset:16896
  v_mfma_f32_16x16x32_bf16 a[132:135], v[84:87], v[124:127], a[132:135]
  ds_read_b64_tr_b16 v[82:83], v18 offset:17920
  v_mfma_f32_16x16x32_bf16 a[128:131], v[84:87], v[120:123], a[128:131]
  s_add_u32 s84, s91, 4587520
  v_mfma_f32_16x16x32_bf16 v[244:247], v[84:87], v[116:119], v[244:247]
  buffer_load_dword a251, v24, s[8:11], s84 offen
  v_mfma_f32_16x16x32_bf16 v[240:243], v[84:87], v[112:115], v[240:243]
  ds_read_b64_tr_b16 v[84:85], v19 offset:16896
  v_mfma_f32_16x16x32_bf16 a[136:139], v[88:91], v[112:115], a[136:139]
  ds_read_b64_tr_b16 v[86:87], v19 offset:17920
  v_mfma_f32_16x16x32_bf16 a[140:143], v[88:91], v[116:119], a[140:143]
  ds_read_b64_tr_b16 v[88:89], v18 offset:17152
  v_mfma_f32_16x16x32_bf16 a[148:151], v[92:95], v[116:119], a[148:151]
  ds_read_b64_tr_b16 v[90:91], v18 offset:18176
  v_mfma_f32_16x16x32_bf16 a[144:147], v[92:95], v[112:115], a[144:147]
  s_waitcnt vmcnt(21) lgkmcnt(15)
  v_mfma_f32_16x16x32_bf16 a[0:3], v[32:35], v[128:131], a[0:3]
  ds_read_b64_tr_b16 v[92:93], v19 offset:17152
  v_mfma_f32_16x16x32_bf16 a[4:7], v[32:35], v[132:135], a[4:7]
  ds_read_b64_tr_b16 v[94:95], v19 offset:18176
  v_mfma_f32_16x16x32_bf16 a[8:11], v[32:35], v[136:139], a[8:11]
  buffer_load_dwordx4 v[112:115], v12, s[12:15], s44 offen offset:1024 sc1
  v_mfma_f32_16x16x32_bf16 a[12:15], v[32:35], v[140:143], a[12:15]
  ds_read_b64_tr_b16 v[32:33], v18 offset:8192
  v_mfma_f32_16x16x32_bf16 a[28:31], v[36:39], v[140:143], a[28:31]
  ds_read_b64_tr_b16 v[34:35], v18 offset:9216
  v_mfma_f32_16x16x32_bf16 a[24:27], v[36:39], v[136:139], a[24:27]
  s_add_u32 m0, s46, 49152
  s_mov_b32 s43, 3211264
  v_mfma_f32_16x16x32_bf16 a[20:23], v[36:39], v[132:135], a[20:23]
  buffer_load_dwordx4 v8, s[8:11], s43 offen offset:0 lds
  v_mfma_f32_16x16x32_bf16 a[16:19], v[36:39], v[128:131], a[16:19]
  ds_read_b64_tr_b16 v[36:37], v19 offset:8192
  v_mfma_f32_16x16x32_bf16 a[32:35], v[40:43], v[128:131], a[32:35]
  ds_read_b64_tr_b16 v[38:39], v19 offset:9216
  v_mfma_f32_16x16x32_bf16 a[36:39], v[40:43], v[132:135], a[36:39]
  v_mfma_f32_16x16x32_bf16 a[40:43], v[40:43], v[136:139], a[40:43]
  v_mfma_f32_16x16x32_bf16 a[44:47], v[40:43], v[140:143], a[44:47]
  ds_read_b64_tr_b16 v[40:41], v18 offset:8448
  v_mfma_f32_16x16x32_bf16 a[60:63], v[44:47], v[140:143], a[60:63]
  ds_read_b64_tr_b16 v[42:43], v18 offset:9472
  v_mfma_f32_16x16x32_bf16 a[56:59], v[44:47], v[136:139], a[56:59]
  buffer_load_dwordx4 v9, s[8:11], s43 offen offset:1024 lds
  v_mfma_f32_16x16x32_bf16 a[52:55], v[44:47], v[132:135], a[52:55]
  v_mfma_f32_16x16x32_bf16 a[48:51], v[44:47], v[128:131], a[48:51]
  s_waitcnt lgkmcnt(15)
  v_mfma_f32_16x16x32_bf16 a[64:67], v[48:51], v[128:131], a[64:67]
  ds_read_b64_tr_b16 v[44:45], v19 offset:8448
  v_mfma_f32_16x16x32_bf16 a[68:71], v[48:51], v[132:135], a[68:71]
  ds_read_b64_tr_b16 v[46:47], v19 offset:9472
  v_mfma_f32_16x16x32_bf16 a[72:75], v[48:51], v[136:139], a[72:75]
  buffer_load_dwordx4 v[116:119], v13, s[12:15], s44 offen offset:1024 sc1
  v_mfma_f32_16x16x32_bf16 a[76:79], v[48:51], v[140:143], a[76:79]
  ds_read_b64_tr_b16 v[48:49], v18 offset:8704
  v_mfma_f32_16x16x32_bf16 a[92:95], v[52:55], v[140:143], a[92:95]
  ds_read_b64_tr_b16 v[50:51], v18 offset:9728
  v_mfma_f32_16x16x32_bf16 a[88:91], v[52:55], v[136:139], a[88:91]
  v_mfma_f32_16x16x32_bf16 a[84:87], v[52:55], v[132:135], a[84:87]
  v_mfma_f32_16x16x32_bf16 a[80:83], v[52:55], v[128:131], a[80:83]
  ds_read_b64_tr_b16 v[52:53], v19 offset:8704
  v_mfma_f32_16x16x32_bf16 a[96:99], v[56:59], v[128:131], a[96:99]
  ds_read_b64_tr_b16 v[54:55], v19 offset:9728
  v_mfma_f32_16x16x32_bf16 a[100:103], v[56:59], v[132:135], a[100:103]
  buffer_load_dwordx4 v10, s[8:11], s43 offen offset:2048 lds
  v_mfma_f32_16x16x32_bf16 a[104:107], v[56:59], v[136:139], a[104:107]
  v_mfma_f32_16x16x32_bf16 a[108:111], v[56:59], v[140:143], a[108:111]
  ds_read_b64_tr_b16 v[56:57], v18 offset:8960
  v_mfma_f32_16x16x32_bf16 a[124:127], v[60:63], v[140:143], a[124:127]
  ds_read_b64_tr_b16 v[58:59], v18 offset:9984
  v_mfma_f32_16x16x32_bf16 a[120:123], v[60:63], v[136:139], a[120:123]
  v_mfma_f32_16x16x32_bf16 a[116:119], v[60:63], v[132:135], a[116:119]
  buffer_load_dwordx4 v[120:123], v14, s[12:15], s44 offen offset:1024 sc1
  v_mfma_f32_16x16x32_bf16 a[112:115], v[60:63], v[128:131], a[112:115]
  s_waitcnt lgkmcnt(15)
  v_mfma_f32_16x16x32_bf16 v[160:163], v[64:67], v[128:131], v[160:163]
  ds_read_b64_tr_b16 v[60:61], v19 offset:8960
  v_mfma_f32_16x16x32_bf16 v[164:167], v[64:67], v[132:135], v[164:167]
  ds_read_b64_tr_b16 v[62:63], v19 offset:9984
  v_mfma_f32_16x16x32_bf16 v[168:171], v[64:67], v[136:139], v[168:171]
  v_mfma_f32_16x16x32_bf16 v[172:175], v[64:67], v[140:143], v[172:175]
  ds_read_b64_tr_b16 v[64:65], v18 offset:24576
  v_mfma_f32_16x16x32_bf16 v[188:191], v[68:71], v[140:143], v[188:191]
  ds_read_b64_tr_b16 v[66:67], v18 offset:25600
  v_mfma_f32_16x16x32_bf16 v[184:187], v[68:71], v[136:139], v[184:187]
  buffer_load_dwordx4 v11, s[8:11], s43 offen offset:3072 lds
  v_mfma_f32_16x16x32_bf16 v[180:183], v[68:71], v[132:135], v[180:183]
  v_mfma_f32_16x16x32_bf16 v[176:179], v[68:71], v[128:131], v[176:179]
  ds_read_b64_tr_b16 v[68:69], v19 offset:24576
  v_mfma_f32_16x16x32_bf16 v[192:195], v[72:75], v[128:131], v[192:195]
  ds_read_b64_tr_b16 v[70:71], v19 offset:25600
  v_mfma_f32_16x16x32_bf16 v[196:199], v[72:75], v[132:135], v[196:199]
  s_add_u32 m0, s49, 122880
  s_add_u32 s45, s48, 0
  v_mfma_f32_16x16x32_bf16 v[200:203], v[72:75], v[136:139], v[200:203]
  buffer_load_dwordx4 v28, s[28:31], s45 offen offset:0 lds
  v_mfma_f32_16x16x32_bf16 v[204:207], v[72:75], v[140:143], v[204:207]
  ds_read_b64_tr_b16 v[72:73], v18 offset:24832
  v_mfma_f32_16x16x32_bf16 v[220:223], v[76:79], v[140:143], v[220:223]
  ds_read_b64_tr_b16 v[74:75], v18 offset:25856
  v_mfma_f32_16x16x32_bf16 v[216:219], v[76:79], v[136:139], v[216:219]
  v_mfma_f32_16x16x32_bf16 v[212:215], v[76:79], v[132:135], v[212:215]
  v_mfma_f32_16x16x32_bf16 v[208:211], v[76:79], v[128:131], v[208:211]
  s_waitcnt lgkmcnt(15)
  v_mfma_f32_16x16x32_bf16 v[224:227], v[80:83], v[128:131], v[224:227]
  ds_read_b64_tr_b16 v[76:77], v19 offset:24832
  v_mfma_f32_16x16x32_bf16 v[228:231], v[80:83], v[132:135], v[228:231]
  ds_read_b64_tr_b16 v[78:79], v19 offset:25856
  v_mfma_f32_16x16x32_bf16 v[232:235], v[80:83], v[136:139], v[232:235]
  buffer_load_dwordx4 v[124:127], v15, s[12:15], s44 offen offset:1024 sc1
  v_mfma_f32_16x16x32_bf16 v[236:239], v[80:83], v[140:143], v[236:239]
  ds_read_b64_tr_b16 v[80:81], v18 offset:25088
  v_mfma_f32_16x16x32_bf16 a[132:135], v[84:87], v[140:143], a[132:135]
  ds_read_b64_tr_b16 v[82:83], v18 offset:26112
  v_mfma_f32_16x16x32_bf16 a[128:131], v[84:87], v[136:139], a[128:131]
  buffer_load_dwordx4 v29, s[28:31], s45 offen offset:1024 lds
  v_mfma_f32_16x16x32_bf16 v[244:247], v[84:87], v[132:135], v[244:247]
  v_mfma_f32_16x16x32_bf16 v[240:243], v[84:87], v[128:131], v[240:243]
  ds_read_b64_tr_b16 v[84:85], v19 offset:25088
  v_mfma_f32_16x16x32_bf16 a[136:139], v[88:91], v[128:131], a[136:139]
  ds_read_b64_tr_b16 v[86:87], v19 offset:26112
  v_mfma_f32_16x16x32_bf16 a[140:143], v[88:91], v[132:135], a[140:143]
  ds_read_b64_tr_b16 v[88:89], v18 offset:25344
  v_mfma_f32_16x16x32_bf16 a[148:151], v[92:95], v[132:135], a[148:151]
  ds_read_b64_tr_b16 v[90:91], v18 offset:26368
  v_mfma_f32_16x16x32_bf16 a[144:147], v[92:95], v[128:131], a[144:147]
  s_waitcnt vmcnt(20) lgkmcnt(15)
  v_mfma_f32_16x16x32_bf16 a[0:3], v[32:35], v[144:147], a[0:3]
  ds_read_b64_tr_b16 v[92:93], v19 offset:25344
  v_mfma_f32_16x16x32_bf16 a[4:7], v[32:35], v[148:151], a[4:7]
  ds_read_b64_tr_b16 v[94:95], v19 offset:26368
  v_mfma_f32_16x16x32_bf16 a[8:11], v[32:35], v[152:155], a[8:11]
  buffer_load_dwordx4 v[128:131], v12, s[12:15], s44 offen offset:2048 sc1
  v_mfma_f32_16x16x32_bf16 a[12:15], v[32:35], v[156:159], a[12:15]
  v_mfma_f32_16x16x32_bf16 a[28:31], v[36:39], v[156:159], a[28:31]
  v_mfma_f32_16x16x32_bf16 a[24:27], v[36:39], v[152:155], a[24:27]
  v_mfma_f32_16x16x32_bf16 a[20:23], v[36:39], v[148:151], a[20:23]
  v_mfma_f32_16x16x32_bf16 a[16:19], v[36:39], v[144:147], a[16:19]
  v_mfma_f32_16x16x32_bf16 a[32:35], v[40:43], v[144:147], a[32:35]
  buffer_load_dwordx4 v[132:135], v13, s[12:15], s44 offen offset:2048 sc1
  v_mfma_f32_16x16x32_bf16 a[36:39], v[40:43], v[148:151], a[36:39]
  v_mfma_f32_16x16x32_bf16 a[40:43], v[40:43], v[152:155], a[40:43]
  v_mfma_f32_16x16x32_bf16 a[44:47], v[40:43], v[156:159], a[44:47]
  v_mfma_f32_16x16x32_bf16 a[60:63], v[44:47], v[156:159], a[60:63]
  v_mfma_f32_16x16x32_bf16 a[56:59], v[44:47], v[152:155], a[56:59]
  v_mfma_f32_16x16x32_bf16 a[52:55], v[44:47], v[148:151], a[52:55]
  v_mfma_f32_16x16x32_bf16 a[48:51], v[44:47], v[144:147], a[48:51]
  s_waitcnt vmcnt(26) lgkmcnt(0)
  s_barrier
  s_waitcnt lgkmcnt(15)
  v_mfma_f32_16x16x32_bf16 a[64:67], v[48:51], v[144:147], a[64:67]
  ds_read_b64_tr_b16 v[32:33], v16 offset:0
  ds_read_b64_tr_b16 v[34:35], v16 offset:1024
  v_mfma_f32_16x16x32_bf16 a[68:71], v[48:51], v[148:151], a[68:71]
  ds_read_b64_tr_b16 v[36:37], v17 offset:0
  ds_read_b64_tr_b16 v[38:39], v17 offset:1024
  v_mfma_f32_16x16x32_bf16 a[72:75], v[48:51], v[152:155], a[72:75]
  ds_read_b64_tr_b16 v[40:41], v16 offset:256
  ds_read_b64_tr_b16 v[42:43], v16 offset:1280
  v_mfma_f32_16x16x32_bf16 a[76:79], v[48:51], v[156:159], a[76:79]
  ds_read_b64_tr_b16 v[44:45], v17 offset:256
  ds_read_b64_tr_b16 v[46:47], v17 offset:1280
  v_mfma_f32_16x16x32_bf16 a[92:95], v[52:55], v[156:159], a[92:95]
  ds_read_b64_tr_b16 v[48:49], v16 offset:512
  ds_read_b64_tr_b16 v[50:51], v16 offset:1536
  v_mfma_f32_16x16x32_bf16 a[88:91], v[52:55], v[152:155], a[88:91]
  s_add_u32 m0, s46, 65536
  s_mov_b32 s42, 4194304
  v_mfma_f32_16x16x32_bf16 a[84:87], v[52:55], v[148:151], a[84:87]
  buffer_load_dwordx4 v4, s[4:7], s42 offen offset:0 lds
  v_mfma_f32_16x16x32_bf16 a[80:83], v[52:55], v[144:147], a[80:83]
  ds_read_b64_tr_b16 v[52:53], v17 offset:512
  v_mfma_f32_16x16x32_bf16 a[96:99], v[56:59], v[144:147], a[96:99]
  ds_read_b64_tr_b16 v[54:55], v17 offset:1536
  v_mfma_f32_16x16x32_bf16 a[100:103], v[56:59], v[148:151], a[100:103]
  v_mfma_f32_16x16x32_bf16 a[104:107], v[56:59], v[152:155], a[104:107]
  buffer_load_dwordx4 v[136:139], v14, s[12:15], s44 offen offset:2048 sc1
  v_mfma_f32_16x16x32_bf16 a[108:111], v[56:59], v[156:159], a[108:111]
  ds_read_b64_tr_b16 v[56:57], v16 offset:768
  v_mfma_f32_16x16x32_bf16 a[124:127], v[60:63], v[156:159], a[124:127]
  ds_read_b64_tr_b16 v[58:59], v16 offset:1792
  v_mfma_f32_16x16x32_bf16 a[120:123], v[60:63], v[152:155], a[120:123]
  v_mfma_f32_16x16x32_bf16 a[116:119], v[60:63], v[148:151], a[116:119]
  v_mfma_f32_16x16x32_bf16 a[112:115], v[60:63], v[144:147], a[112:115]
  s_waitcnt lgkmcnt(15)
  v_mfma_f32_16x16x32_bf16 v[160:163], v[64:67], v[144:147], v[160:163]
  ds_read_b64_tr_b16 v[60:61], v17 offset:768
  v_mfma_f32_16x16x32_bf16 v[164:167], v[64:67], v[148:151], v[164:167]
  ds_read_b64_tr_b16 v[62:63], v17 offset:1792
  v_mfma_f32_16x16x32_bf16 v[168:171], v[64:67], v[152:155], v[168:171]
  buffer_load_dwordx4 v5, s[4:7], s42 offen offset:1024 lds
  v_mfma_f32_16x16x32_bf16 v[172:175], v[64:67], v[156:159], v[172:175]
  ds_read_b64_tr_b16 v[64:65], v16 offset:16384
  v_mfma_f32_16x16x32_bf16 v[188:191], v[68:71], v[156:159], v[188:191]
  ds_read_b64_tr_b16 v[66:67], v16 offset:17408
  v_mfma_f32_16x16x32_bf16 v[184:187], v[68:71], v[152:155], v[184:187]
  v_mfma_f32_16x16x32_bf16 v[180:183], v[68:71], v[148:151], v[180:183]
  v_mfma_f32_16x16x32_bf16 v[176:179], v[68:71], v[144:147], v[176:179]
  ds_read_b64_tr_b16 v[68:69], v17 offset:16384
  v_mfma_f32_16x16x32_bf16 v[192:195], v[72:75], v[144:147], v[192:195]
  ds_read_b64_tr_b16 v[70:71], v17 offset:17408
  v_mfma_f32_16x16x32_bf16 v[196:199], v[72:75], v[148:151], v[196:199]
  buffer_load_dwordx4 v6, s[4:7], s42 offen offset:2048 lds
  v_mfma_f32_16x16x32_bf16 v[200:203], v[72:75], v[152:155], v[200:203]
  v_mfma_f32_16x16x32_bf16 v[204:207], v[72:75], v[156:159], v[204:207]
  ds_read_b64_tr_b16 v[72:73], v16 offset:16640
  v_mfma_f32_16x16x32_bf16 v[220:223], v[76:79], v[156:159], v[220:223]
  ds_read_b64_tr_b16 v[74:75], v16 offset:17664
  v_mfma_f32_16x16x32_bf16 v[216:219], v[76:79], v[152:155], v[216:219]
  v_mfma_f32_16x16x32_bf16 v[212:215], v[76:79], v[148:151], v[212:215]
  buffer_load_dwordx4 v[140:143], v15, s[12:15], s44 offen offset:2048 sc1
  v_mfma_f32_16x16x32_bf16 v[208:211], v[76:79], v[144:147], v[208:211]
  s_waitcnt lgkmcnt(15)
  v_mfma_f32_16x16x32_bf16 v[224:227], v[80:83], v[144:147], v[224:227]
  ds_read_b64_tr_b16 v[76:77], v17 offset:16640
  v_mfma_f32_16x16x32_bf16 v[228:231], v[80:83], v[148:151], v[228:231]
  ds_read_b64_tr_b16 v[78:79], v17 offset:17664
  v_mfma_f32_16x16x32_bf16 v[232:235], v[80:83], v[152:155], v[232:235]
  v_mfma_f32_16x16x32_bf16 v[236:239], v[80:83], v[156:159], v[236:239]
  ds_read_b64_tr_b16 v[80:81], v16 offset:16896
  v_mfma_f32_16x16x32_bf16 a[132:135], v[84:87], v[156:159], a[132:135]
  ds_read_b64_tr_b16 v[82:83], v16 offset:17920
  v_mfma_f32_16x16x32_bf16 a[128:131], v[84:87], v[152:155], a[128:131]
  buffer_load_dwordx4 v7, s[4:7], s42 offen offset:3072 lds
  v_mfma_f32_16x16x32_bf16 v[244:247], v[84:87], v[148:151], v[244:247]
  v_mfma_f32_16x16x32_bf16 v[240:243], v[84:87], v[144:147], v[240:243]
  ds_read_b64_tr_b16 v[84:85], v17 offset:16896
  v_mfma_f32_16x16x32_bf16 a[136:139], v[88:91], v[144:147], a[136:139]
  ds_read_b64_tr_b16 v[86:87], v17 offset:17920
  v_mfma_f32_16x16x32_bf16 a[140:143], v[88:91], v[148:151], a[140:143]
  ds_read_b64_tr_b16 v[88:89], v16 offset:17152
  v_mfma_f32_16x16x32_bf16 a[148:151], v[92:95], v[148:151], a[148:151]
  ds_read_b64_tr_b16 v[90:91], v16 offset:18176
  v_mfma_f32_16x16x32_bf16 a[144:147], v[92:95], v[144:147], a[144:147]
  s_waitcnt vmcnt(20) lgkmcnt(15)
  v_mfma_f32_16x16x32_bf16 a[0:3], v[32:35], v[96:99], a[0:3]
  ds_read_b64_tr_b16 v[92:93], v17 offset:17152
  v_mfma_f32_16x16x32_bf16 a[4:7], v[32:35], v[100:103], a[4:7]
  ds_read_b64_tr_b16 v[94:95], v17 offset:18176
  v_mfma_f32_16x16x32_bf16 a[8:11], v[32:35], v[104:107], a[8:11]
  buffer_load_dwordx4 v[144:147], v12, s[12:15], s44 offen offset:3072 sc1
  v_mfma_f32_16x16x32_bf16 a[12:15], v[32:35], v[108:111], a[12:15]
  ds_read_b64_tr_b16 v[32:33], v16 offset:8192
  v_mfma_f32_16x16x32_bf16 a[28:31], v[36:39], v[108:111], a[28:31]
  ds_read_b64_tr_b16 v[34:35], v16 offset:9216
  v_mfma_f32_16x16x32_bf16 a[24:27], v[36:39], v[104:107], a[24:27]
  s_add_u32 m0, s46, 81920
  s_mov_b32 s43, 3670016
  v_mfma_f32_16x16x32_bf16 a[20:23], v[36:39], v[100:103], a[20:23]
  buffer_load_dwordx4 v8, s[8:11], s43 offen offset:0 lds
  v_mfma_f32_16x16x32_bf16 a[16:19], v[36:39], v[96:99], a[16:19]
  ds_read_b64_tr_b16 v[36:37], v17 offset:8192
  v_mfma_f32_16x16x32_bf16 a[32:35], v[40:43], v[96:99], a[32:35]
  ds_read_b64_tr_b16 v[38:39], v17 offset:9216
  v_mfma_f32_16x16x32_bf16 a[36:39], v[40:43], v[100:103], a[36:39]
  v_mfma_f32_16x16x32_bf16 a[40:43], v[40:43], v[104:107], a[40:43]
  v_mfma_f32_16x16x32_bf16 a[44:47], v[40:43], v[108:111], a[44:47]
  ds_read_b64_tr_b16 v[40:41], v16 offset:8448
  v_mfma_f32_16x16x32_bf16 a[60:63], v[44:47], v[108:111], a[60:63]
  ds_read_b64_tr_b16 v[42:43], v16 offset:9472
  v_mfma_f32_16x16x32_bf16 a[56:59], v[44:47], v[104:107], a[56:59]
  buffer_load_dwordx4 v9, s[8:11], s43 offen offset:1024 lds
  v_mfma_f32_16x16x32_bf16 a[52:55], v[44:47], v[100:103], a[52:55]
  v_mfma_f32_16x16x32_bf16 a[48:51], v[44:47], v[96:99], a[48:51]
  s_waitcnt lgkmcnt(15)
  v_mfma_f32_16x16x32_bf16 a[64:67], v[48:51], v[96:99], a[64:67]
  ds_read_b64_tr_b16 v[44:45], v17 offset:8448
  v_mfma_f32_16x16x32_bf16 a[68:71], v[48:51], v[100:103], a[68:71]
  ds_read_b64_tr_b16 v[46:47], v17 offset:9472
  v_mfma_f32_16x16x32_bf16 a[72:75], v[48:51], v[104:107], a[72:75]
  buffer_load_dwordx4 v[148:151], v13, s[12:15], s44 offen offset:3072 sc1
  v_mfma_f32_16x16x32_bf16 a[76:79], v[48:51], v[108:111], a[76:79]
  ds_read_b64_tr_b16 v[48:49], v16 offset:8704
  v_mfma_f32_16x16x32_bf16 a[92:95], v[52:55], v[108:111], a[92:95]
  ds_read_b64_tr_b16 v[50:51], v16 offset:9728
  v_mfma_f32_16x16x32_bf16 a[88:91], v[52:55], v[104:107], a[88:91]
  v_mfma_f32_16x16x32_bf16 a[84:87], v[52:55], v[100:103], a[84:87]
  buffer_load_dwordx4 v10, s[8:11], s43 offen offset:2048 lds
  v_mfma_f32_16x16x32_bf16 a[80:83], v[52:55], v[96:99], a[80:83]
  ds_read_b64_tr_b16 v[52:53], v17 offset:8704
  v_mfma_f32_16x16x32_bf16 a[96:99], v[56:59], v[96:99], a[96:99]
  ds_read_b64_tr_b16 v[54:55], v17 offset:9728
  v_mfma_f32_16x16x32_bf16 a[100:103], v[56:59], v[100:103], a[100:103]
  v_mfma_f32_16x16x32_bf16 a[104:107], v[56:59], v[104:107], a[104:107]
  v_mfma_f32_16x16x32_bf16 a[108:111], v[56:59], v[108:111], a[108:111]
  ds_read_b64_tr_b16 v[56:57], v16 offset:8960
  v_mfma_f32_16x16x32_bf16 a[124:127], v[60:63], v[108:111], a[124:127]
  ds_read_b64_tr_b16 v[58:59], v16 offset:9984
  v_mfma_f32_16x16x32_bf16 a[120:123], v[60:63], v[104:107], a[120:123]
  buffer_load_dwordx4 v11, s[8:11], s43 offen offset:3072 lds
  v_mfma_f32_16x16x32_bf16 a[116:119], v[60:63], v[100:103], a[116:119]
  v_mfma_f32_16x16x32_bf16 a[112:115], v[60:63], v[96:99], a[112:115]
  s_waitcnt lgkmcnt(15)
  v_mfma_f32_16x16x32_bf16 v[160:163], v[64:67], v[96:99], v[160:163]
  ds_read_b64_tr_b16 v[60:61], v17 offset:8960
  v_mfma_f32_16x16x32_bf16 v[164:167], v[64:67], v[100:103], v[164:167]
  ds_read_b64_tr_b16 v[62:63], v17 offset:9984
  v_mfma_f32_16x16x32_bf16 v[168:171], v[64:67], v[104:107], v[168:171]
  buffer_load_dwordx4 v[152:155], v14, s[12:15], s44 offen offset:3072 sc1
  v_mfma_f32_16x16x32_bf16 v[172:175], v[64:67], v[108:111], v[172:175]
  ds_read_b64_tr_b16 v[64:65], v16 offset:24576
  v_mfma_f32_16x16x32_bf16 v[188:191], v[68:71], v[108:111], v[188:191]
  ds_read_b64_tr_b16 v[66:67], v16 offset:25600
  v_mfma_f32_16x16x32_bf16 v[184:187], v[68:71], v[104:107], v[184:187]
  s_add_u32 m0, s47, 131072
  s_add_u32 s45, s48, 24576
  v_mfma_f32_16x16x32_bf16 v[180:183], v[68:71], v[100:103], v[180:183]
  buffer_load_dwordx4 v21, s[24:27], s45 offen offset:0 lds
  v_mfma_f32_16x16x32_bf16 v[176:179], v[68:71], v[96:99], v[176:179]
  ds_read_b64_tr_b16 v[68:69], v17 offset:24576
  v_mfma_f32_16x16x32_bf16 v[192:195], v[72:75], v[96:99], v[192:195]
  ds_read_b64_tr_b16 v[70:71], v17 offset:25600
  v_mfma_f32_16x16x32_bf16 v[196:199], v[72:75], v[100:103], v[196:199]
  v_mfma_f32_16x16x32_bf16 v[200:203], v[72:75], v[104:107], v[200:203]
  v_mfma_f32_16x16x32_bf16 v[204:207], v[72:75], v[108:111], v[204:207]
  ds_read_b64_tr_b16 v[72:73], v16 offset:24832
  v_mfma_f32_16x16x32_bf16 v[220:223], v[76:79], v[108:111], v[220:223]
  ds_read_b64_tr_b16 v[74:75], v16 offset:25856
  v_mfma_f32_16x16x32_bf16 v[216:219], v[76:79], v[104:107], v[216:219]
  buffer_load_dwordx4 v22, s[24:27], s45 offen offset:2048 lds
  v_mfma_f32_16x16x32_bf16 v[212:215], v[76:79], v[100:103], v[212:215]
  v_mfma_f32_16x16x32_bf16 v[208:211], v[76:79], v[96:99], v[208:211]
  s_waitcnt lgkmcnt(15)
  v_mfma_f32_16x16x32_bf16 v[224:227], v[80:83], v[96:99], v[224:227]
  ds_read_b64_tr_b16 v[76:77], v17 offset:24832
  v_mfma_f32_16x16x32_bf16 v[228:231], v[80:83], v[100:103], v[228:231]
  ds_read_b64_tr_b16 v[78:79], v17 offset:25856
  v_mfma_f32_16x16x32_bf16 v[232:235], v[80:83], v[104:107], v[232:235]
  buffer_load_dwordx4 v[156:159], v15, s[12:15], s44 offen offset:3072 sc1
  v_mfma_f32_16x16x32_bf16 v[236:239], v[80:83], v[108:111], v[236:239]
  ds_read_b64_tr_b16 v[80:81], v16 offset:25088
  v_mfma_f32_16x16x32_bf16 a[132:135], v[84:87], v[108:111], a[132:135]
  ds_read_b64_tr_b16 v[82:83], v16 offset:26112
  v_mfma_f32_16x16x32_bf16 a[128:131], v[84:87], v[104:107], a[128:131]
  s_add_u32 s84, s90, 6291456
  v_mfma_f32_16x16x32_bf16 v[244:247], v[84:87], v[100:103], v[244:247]
  buffer_load_dword a252, v24, s[4:7], s84 offen
  v_mfma_f32_16x16x32_bf16 v[240:243], v[84:87], v[96:99], v[240:243]
  ds_read_b64_tr_b16 v[84:85], v17 offset:25088
  v_mfma_f32_16x16x32_bf16 a[136:139], v[88:91], v[96:99], a[136:139]
  ds_read_b64_tr_b16 v[86:87], v17 offset:26112
  v_mfma_f32_16x16x32_bf16 a[140:143], v[88:91], v[100:103], a[140:143]
  ds_read_b64_tr_b16 v[88:89], v16 offset:25344
  v_mfma_f32_16x16x32_bf16 a[148:151], v[92:95], v[100:103], a[148:151]
  ds_read_b64_tr_b16 v[90:91], v16 offset:26368
  v_mfma_f32_16x16x32_bf16 a[144:147], v[92:95], v[96:99], a[144:147]
  s_waitcnt vmcnt(20) lgkmcnt(15)
  v_mfma_f32_16x16x32_bf16 a[0:3], v[32:35], v[112:115], a[0:3]
  ds_read_b64_tr_b16 v[92:93], v17 offset:25344
  v_mfma_f32_16x16x32_bf16 a[4:7], v[32:35], v[116:119], a[4:7]
  ds_read_b64_tr_b16 v[94:95], v17 offset:26368
  v_mfma_f32_16x16x32_bf16 a[8:11], v[32:35], v[120:123], a[8:11]
  s_mov_b32 s44, 16384
  buffer_load_dwordx4 v[96:99], v12, s[12:15], s44 offen offset:0 sc1
  v_mfma_f32_16x16x32_bf16 a[12:15], v[32:35], v[124:127], a[12:15]
  v_mfma_f32_16x16x32_bf16 a[28:31], v[36:39], v[124:127], a[28:31]
  v_mfma_f32_16x16x32_bf16 a[24:27], v[36:39], v[120:123], a[24:27]
  v_mfma_f32_16x16x32_bf16 a[20:23], v[36:39], v[116:119], a[20:23]
  v_mfma_f32_16x16x32_bf16 a[16:19], v[36:39], v[112:115], a[16:19]
  v_mfma_f32_16x16x32_bf16 a[32:35], v[40:43], v[112:115], a[32:35]
  buffer_load_dwordx4 v[100:103], v13, s[12:15], s44 offen offset:0 sc1
  v_mfma_f32_16x16x32_bf16 a[36:39], v[40:43], v[116:119], a[36:39]
  v_mfma_f32_16x16x32_bf16 a[40:43], v[40:43], v[120:123], a[40:43]
  v_mfma_f32_16x16x32_bf16 a[44:47], v[40:43], v[124:127], a[44:47]
  v_mfma_f32_16x16x32_bf16 a[60:63], v[44:47], v[124:127], a[60:63]
  v_mfma_f32_16x16x32_bf16 a[56:59], v[44:47], v[120:123], a[56:59]
  v_mfma_f32_16x16x32_bf16 a[52:55], v[44:47], v[116:119], a[52:55]
  v_mfma_f32_16x16x32_bf16 a[48:51], v[44:47], v[112:115], a[48:51]
  s_waitcnt vmcnt(24) lgkmcnt(0)
  s_barrier
  s_waitcnt lgkmcnt(15)
  v_mfma_f32_16x16x32_bf16 a[64:67], v[48:51], v[112:115], a[64:67]
  ds_read_b64_tr_b16 v[32:33], v16 offset:32768
  ds_read_b64_tr_b16 v[34:35], v16 offset:33792
  v_mfma_f32_16x16x32_bf16 a[68:71], v[48:51], v[116:119], a[68:71]
  ds_read_b64_tr_b16 v[36:37], v17 offset:32768
  ds_read_b64_tr_b16 v[38:39], v17 offset:33792
  v_mfma_f32_16x16x32_bf16 a[72:75], v[48:51], v[120:123], a[72:75]
  ds_read_b64_tr_b16 v[40:41], v16 offset:33024
  ds_read_b64_tr_b16 v[42:43], v16 offset:34048
  v_mfma_f32_16x16x32_bf16 a[76:79], v[48:51], v[124:127], a[76:79]
  ds_read_b64_tr_b16 v[44:45], v17 offset:33024
  ds_read_b64_tr_b16 v[46:47], v17 offset:34048
  v_mfma_f32_16x16x32_bf16 a[92:95], v[52:55], v[124:127], a[92:95]
  ds_read_b64_tr_b16 v[48:49], v16 offset:33280
  ds_read_b64_tr_b16 v[50:51], v16 offset:34304
  v_mfma_f32_16x16x32_bf16 a[88:91], v[52:55], v[120:123], a[88:91]
  s_add_u32 m0, s46, 0
  s_mov_b32 s42, 4718592
  v_mfma_f32_16x16x32_bf16 a[84:87], v[52:55], v[116:119], a[84:87]
  buffer_load_dwordx4 v4, s[4:7], s42 offen offset:0 lds
  v_mfma_f32_16x16x32_bf16 a[80:83], v[52:55], v[112:115], a[80:83]
  ds_read_b64_tr_b16 v[52:53], v17 offset:33280
  v_mfma_f32_16x16x32_bf16 a[96:99], v[56:59], v[112:115], a[96:99]
  ds_read_b64_tr_b16 v[54:55], v17 offset:34304
  v_mfma_f32_16x16x32_bf16 a[100:103], v[56:59], v[116:119], a[100:103]
  buffer_load_dwordx4 v[104:107], v14, s[12:15], s44 offen offset:0 sc1
  v_mfma_f32_16x16x32_bf16 a[104:107], v[56:59], v[120:123], a[104:107]
  v_mfma_f32_16x16x32_bf16 a[108:111], v[56:59], v[124:127], a[108:111]
  ds_read_b64_tr_b16 v[56:57], v16 offset:33536
  v_mfma_f32_16x16x32_bf16 a[124:127], v[60:63], v[124:127], a[124:127]
  ds_read_b64_tr_b16 v[58:59], v16 offset:34560
  v_mfma_f32_16x16x32_bf16 a[120:123], v[60:63], v[120:123], a[120:123]
  v_mfma_f32_16x16x32_bf16 a[116:119], v[60:63], v[116:119], a[116:119]
  v_mfma_f32_16x16x32_bf16 a[112:115], v[60:63], v[112:115], a[112:115]
  s_waitcnt lgkmcnt(15)
  v_mfma_f32_16x16x32_bf16 v[160:163], v[64:67], v[112:115], v[160:163]
  ds_read_b64_tr_b16 v[60:61], v17 offset:33536
  v_mfma_f32_16x16x32_bf16 v[164:167], v[64:67], v[116:119], v[164:167]
  ds_read_b64_tr_b16 v[62:63], v17 offset:34560
  v_mfma_f32_16x16x32_bf16 v[168:171], v[64:67], v[120:123], v[168:171]
  buffer_load_dwordx4 v5, s[4:7], s42 offen offset:1024 lds
  v_mfma_f32_16x16x32_bf16 v[172:175], v[64:67], v[124:127], v[172:175]
  ds_read_b64_tr_b16 v[64:65], v16 offset:49152
  v_mfma_f32_16x16x32_bf16 v[188:191], v[68:71], v[124:127], v[188:191]
  ds_read_b64_tr_b16 v[66:67], v16 offset:50176
  v_mfma_f32_16x16x32_bf16 v[184:187], v[68:71], v[120:123], v[184:187]
  buffer_load_dwordx4 v6, s[4:7], s42 offen offset:2048 lds
  v_mfma_f32_16x16x32_bf16 v[180:183], v[68:71], v[116:119], v[180:183]
  v_mfma_f32_16x16x32_bf16 v[176:179], v[68:71], v[112:115], v[176:179]
  ds_read_b64_tr_b16 v[68:69], v17 offset:49152
  v_mfma_f32_16x16x32_bf16 v[192:195], v[72:75], v[112:115], v[192:195]
  ds_read_b64_tr_b16 v[70:71], v17 offset:50176
  v_mfma_f32_16x16x32_bf16 v[196:199], v[72:75], v[116:119], v[196:199]
  v_mfma_f32_16x16x32_bf16 v[200:203], v[72:75], v[120:123], v[200:203]
  buffer_load_dwordx4 v[108:111], v15, s[12:15], s44 offen offset:0 sc1
  v_mfma_f32_16x16x32_bf16 v[204:207], v[72:75], v[124:127], v[204:207]
  ds_read_b64_tr_b16 v[72:73], v16 offset:49408
  v_mfma_f32_16x16x32_bf16 v[220:223], v[76:79], v[124:127], v[220:223]
  ds_read_b64_tr_b16 v[74:75], v16 offset:50432
  v_mfma_f32_16x16x32_bf16 v[216:219], v[76:79], v[120:123], v[216:219]
  v_mfma_f32_16x16x32_bf16 v[212:215], v[76:79], v[116:119], v[212:215]
  v_mfma_f32_16x16x32_bf16 v[208:211], v[76:79], v[112:115], v[208:211]
  s_waitcnt lgkmcnt(15)
  v_mfma_f32_16x16x32_bf16 v[224:227], v[80:83], v[112:115], v[224:227]
  ds_read_b64_tr_b16 v[76:77], v17 offset:49408
  v_mfma_f32_16x16x32_bf16 v[228:231], v[80:83], v[116:119], v[228:231]
  ds_read_b64_tr_b16 v[78:79], v17 offset:50432
  v_mfma_f32_16x16x32_bf16 v[232:235], v[80:83], v[120:123], v[232:235]
  buffer_load_dwordx4 v7, s[4:7], s42 offen offset:3072 lds
  v_mfma_f32_16x16x32_bf16 v[236:239], v[80:83], v[124:127], v[236:239]
  ds_read_b64_tr_b16 v[80:81], v16 offset:49664
  v_mfma_f32_16x16x32_bf16 a[132:135], v[84:87], v[124:127], a[132:135]
  ds_read_b64_tr_b16 v[82:83], v16 offset:50688
  v_mfma_f32_16x16x32_bf16 a[128:131], v[84:87], v[120:123], a[128:131]
  s_add_u32 s84, s91, 5505024
  v_mfma_f32_16x16x32_bf16 v[244:247], v[84:87], v[116:119], v[244:247]
  buffer_load_dword a253, v24, s[8:11], s84 offen
  v_mfma_f32_16x16x32_bf16 v[240:243], v[84:87], v[112:115], v[240:243]
  ds_read_b64_tr_b16 v[84:85], v17 offset:49664
  v_mfma_f32_16x16x32_bf16 a[136:139], v[88:91], v[112:115], a[136:139]
  ds_read_b64_tr_b16 v[86:87], v17 offset:50688
  v_mfma_f32_16x16x32_bf16 a[140:143], v[88:91], v[116:119], a[140:143]
  ds_read_b64_tr_b16 v[88:89], v16 offset:49920
  v_mfma_f32_16x16x32_bf16 a[148:151], v[92:95], v[116:119], a[148:151]
  ds_read_b64_tr_b16 v[90:91], v16 offset:50944
  v_mfma_f32_16x16x32_bf16 a[144:147], v[92:95], v[112:115], a[144:147]
  s_waitcnt vmcnt(21) lgkmcnt(15)
  v_mfma_f32_16x16x32_bf16 a[0:3], v[32:35], v[128:131], a[0:3]
  ds_read_b64_tr_b16 v[92:93], v17 offset:49920
  v_mfma_f32_16x16x32_bf16 a[4:7], v[32:35], v[132:135], a[4:7]
  ds_read_b64_tr_b16 v[94:95], v17 offset:50944
  v_mfma_f32_16x16x32_bf16 a[8:11], v[32:35], v[136:139], a[8:11]
  buffer_load_dwordx4 v[112:115], v12, s[12:15], s44 offen offset:1024 sc1
  v_mfma_f32_16x16x32_bf16 a[12:15], v[32:35], v[140:143], a[12:15]
  ds_read_b64_tr_b16 v[32:33], v16 offset:40960
  v_mfma_f32_16x16x32_bf16 a[28:31], v[36:39], v[140:143], a[28:31]
  ds_read_b64_tr_b16 v[34:35], v16 offset:41984
  v_mfma_f32_16x16x32_bf16 a[24:27], v[36:39], v[136:139], a[24:27]
  s_add_u32 m0, s46, 16384
  s_mov_b32 s43, 4128768
  v_mfma_f32_16x16x32_bf16 a[20:23], v[36:39], v[132:135], a[20:23]
  buffer_load_dwordx4 v8, s[8:11], s43 offen offset:0 lds
  v_mfma_f32_16x16x32_bf16 a[16:19], v[36:39], v[128:131], a[16:19]
  ds_read_b64_tr_b16 v[36:37], v17 offset:40960
  v_mfma_f32_16x16x32_bf16 a[32:35], v[40:43], v[128:131], a[32:35]
  ds_read_b64_tr_b16 v[38:39], v17 offset:41984
  v_mfma_f32_16x16x32_bf16 a[36:39], v[40:43], v[132:135], a[36:39]
  v_mfma_f32_16x16x32_bf16 a[40:43], v[40:43], v[136:139], a[40:43]
  v_mfma_f32_16x16x32_bf16 a[44:47], v[40:43], v[140:143], a[44:47]
  ds_read_b64_tr_b16 v[40:41], v16 offset:41216
  v_mfma_f32_16x16x32_bf16 a[60:63], v[44:47], v[140:143], a[60:63]
  ds_read_b64_tr_b16 v[42:43], v16 offset:42240
  v_mfma_f32_16x16x32_bf16 a[56:59], v[44:47], v[136:139], a[56:59]
  buffer_load_dwordx4 v9, s[8:11], s43 offen offset:1024 lds
  v_mfma_f32_16x16x32_bf16 a[52:55], v[44:47], v[132:135], a[52:55]
  v_mfma_f32_16x16x32_bf16 a[48:51], v[44:47], v[128:131], a[48:51]
  s_waitcnt lgkmcnt(15)
  v_mfma_f32_16x16x32_bf16 a[64:67], v[48:51], v[128:131], a[64:67]
  ds_read_b64_tr_b16 v[44:45], v17 offset:41216
  v_mfma_f32_16x16x32_bf16 a[68:71], v[48:51], v[132:135], a[68:71]
  ds_read_b64_tr_b16 v[46:47], v17 offset:42240
  v_mfma_f32_16x16x32_bf16 a[72:75], v[48:51], v[136:139], a[72:75]
  buffer_load_dwordx4 v[116:119], v13, s[12:15], s44 offen offset:1024 sc1
  v_mfma_f32_16x16x32_bf16 a[76:79], v[48:51], v[140:143], a[76:79]
  ds_read_b64_tr_b16 v[48:49], v16 offset:41472
  v_mfma_f32_16x16x32_bf16 a[92:95], v[52:55], v[140:143], a[92:95]
  ds_read_b64_tr_b16 v[50:51], v16 offset:42496
  v_mfma_f32_16x16x32_bf16 a[88:91], v[52:55], v[136:139], a[88:91]
  v_mfma_f32_16x16x32_bf16 a[84:87], v[52:55], v[132:135], a[84:87]
  v_mfma_f32_16x16x32_bf16 a[80:83], v[52:55], v[128:131], a[80:83]
  ds_read_b64_tr_b16 v[52:53], v17 offset:41472
  v_mfma_f32_16x16x32_bf16 a[96:99], v[56:59], v[128:131], a[96:99]
  ds_read_b64_tr_b16 v[54:55], v17 offset:42496
  v_mfma_f32_16x16x32_bf16 a[100:103], v[56:59], v[132:135], a[100:103]
  buffer_load_dwordx4 v10, s[8:11], s43 offen offset:2048 lds
  v_mfma_f32_16x16x32_bf16 a[104:107], v[56:59], v[136:139], a[104:107]
  v_mfma_f32_16x16x32_bf16 a[108:111], v[56:59], v[140:143], a[108:111]
  ds_read_b64_tr_b16 v[56:57], v16 offset:41728
  v_mfma_f32_16x16x32_bf16 a[124:127], v[60:63], v[140:143], a[124:127]
  ds_read_b64_tr_b16 v[58:59], v16 offset:42752
  v_mfma_f32_16x16x32_bf16 a[120:123], v[60:63], v[136:139], a[120:123]
  v_mfma_f32_16x16x32_bf16 a[116:119], v[60:63], v[132:135], a[116:119]
  buffer_load_dwordx4 v[120:123], v14, s[12:15], s44 offen offset:1024 sc1
  v_mfma_f32_16x16x32_bf16 a[112:115], v[60:63], v[128:131], a[112:115]
  s_waitcnt lgkmcnt(15)
  v_mfma_f32_16x16x32_bf16 v[160:163], v[64:67], v[128:131], v[160:163]
  ds_read_b64_tr_b16 v[60:61], v17 offset:41728
  v_mfma_f32_16x16x32_bf16 v[164:167], v[64:67], v[132:135], v[164:167]
  ds_read_b64_tr_b16 v[62:63], v17 offset:42752
  v_mfma_f32_16x16x32_bf16 v[168:171], v[64:67], v[136:139], v[168:171]
  v_mfma_f32_16x16x32_bf16 v[172:175], v[64:67], v[140:143], v[172:175]
  ds_read_b64_tr_b16 v[64:65], v16 offset:57344
  v_mfma_f32_16x16x32_bf16 v[188:191], v[68:71], v[140:143], v[188:191]
  ds_read_b64_tr_b16 v[66:67], v16 offset:58368
  v_mfma_f32_16x16x32_bf16 v[184:187], v[68:71], v[136:139], v[184:187]
  buffer_load_dwordx4 v11, s[8:11], s43 offen offset:3072 lds
  v_mfma_f32_16x16x32_bf16 v[180:183], v[68:71], v[132:135], v[180:183]
  v_mfma_f32_16x16x32_bf16 v[176:179], v[68:71], v[128:131], v[176:179]
  ds_read_b64_tr_b16 v[68:69], v17 offset:57344
  v_mfma_f32_16x16x32_bf16 v[192:195], v[72:75], v[128:131], v[192:195]
  ds_read_b64_tr_b16 v[70:71], v17 offset:58368
  v_mfma_f32_16x16x32_bf16 v[196:199], v[72:75], v[132:135], v[196:199]
  s_add_u32 m0, s49, 139264
  s_add_u32 s45, s48, 8192
  v_mfma_f32_16x16x32_bf16 v[200:203], v[72:75], v[136:139], v[200:203]
  buffer_load_dwordx4 v28, s[28:31], s45 offen offset:0 lds
  v_mfma_f32_16x16x32_bf16 v[204:207], v[72:75], v[140:143], v[204:207]
  ds_read_b64_tr_b16 v[72:73], v16 offset:57600
  v_mfma_f32_16x16x32_bf16 v[220:223], v[76:79], v[140:143], v[220:223]
  ds_read_b64_tr_b16 v[74:75], v16 offset:58624
  v_mfma_f32_16x16x32_bf16 v[216:219], v[76:79], v[136:139], v[216:219]
  v_mfma_f32_16x16x32_bf16 v[212:215], v[76:79], v[132:135], v[212:215]
  v_mfma_f32_16x16x32_bf16 v[208:211], v[76:79], v[128:131], v[208:211]
  s_waitcnt lgkmcnt(15)
  v_mfma_f32_16x16x32_bf16 v[224:227], v[80:83], v[128:131], v[224:227]
  ds_read_b64_tr_b16 v[76:77], v17 offset:57600
  v_mfma_f32_16x16x32_bf16 v[228:231], v[80:83], v[132:135], v[228:231]
  ds_read_b64_tr_b16 v[78:79], v17 offset:58624
  v_mfma_f32_16x16x32_bf16 v[232:235], v[80:83], v[136:139], v[232:235]
  buffer_load_dwordx4 v[124:127], v15, s[12:15], s44 offen offset:1024 sc1
  v_mfma_f32_16x16x32_bf16 v[236:239], v[80:83], v[140:143], v[236:239]
  ds_read_b64_tr_b16 v[80:81], v16 offset:57856
  v_mfma_f32_16x16x32_bf16 a[132:135], v[84:87], v[140:143], a[132:135]
  ds_read_b64_tr_b16 v[82:83], v16 offset:58880
  v_mfma_f32_16x16x32_bf16 a[128:131], v[84:87], v[136:139], a[128:131]
  buffer_load_dwordx4 v29, s[28:31], s45 offen offset:1024 lds
  v_mfma_f32_16x16x32_bf16 v[244:247], v[84:87], v[132:135], v[244:247]
  v_mfma_f32_16x16x32_bf16 v[240:243], v[84:87], v[128:131], v[240:243]
  ds_read_b64_tr_b16 v[84:85], v17 offset:57856
  v_mfma_f32_16x16x32_bf16 a[136:139], v[88:91], v[128:131], a[136:139]
  ds_read_b64_tr_b16 v[86:87], v17 offset:58880
  v_mfma_f32_16x16x32_bf16 a[140:143], v[88:91], v[132:135], a[140:143]
  ds_read_b64_tr_b16 v[88:89], v16 offset:58112
  v_mfma_f32_16x16x32_bf16 a[148:151], v[92:95], v[132:135], a[148:151]
  ds_read_b64_tr_b16 v[90:91], v16 offset:59136
  v_mfma_f32_16x16x32_bf16 a[144:147], v[92:95], v[128:131], a[144:147]
  s_waitcnt vmcnt(20) lgkmcnt(15)
  v_mfma_f32_16x16x32_bf16 a[0:3], v[32:35], v[144:147], a[0:3]
  ds_read_b64_tr_b16 v[92:93], v17 offset:58112
  v_mfma_f32_16x16x32_bf16 a[4:7], v[32:35], v[148:151], a[4:7]
  ds_read_b64_tr_b16 v[94:95], v17 offset:59136
  v_mfma_f32_16x16x32_bf16 a[8:11], v[32:35], v[152:155], a[8:11]
  buffer_load_dwordx4 v[128:131], v12, s[12:15], s44 offen offset:2048 sc1
  v_mfma_f32_16x16x32_bf16 a[12:15], v[32:35], v[156:159], a[12:15]
  v_mfma_f32_16x16x32_bf16 a[28:31], v[36:39], v[156:159], a[28:31]
  v_mfma_f32_16x16x32_bf16 a[24:27], v[36:39], v[152:155], a[24:27]
  v_mfma_f32_16x16x32_bf16 a[20:23], v[36:39], v[148:151], a[20:23]
  v_mfma_f32_16x16x32_bf16 a[16:19], v[36:39], v[144:147], a[16:19]
  v_mfma_f32_16x16x32_bf16 a[32:35], v[40:43], v[144:147], a[32:35]
  buffer_load_dwordx4 v[132:135], v13, s[12:15], s44 offen offset:2048 sc1
  v_mfma_f32_16x16x32_bf16 a[36:39], v[40:43], v[148:151], a[36:39]
  v_mfma_f32_16x16x32_bf16 a[40:43], v[40:43], v[152:155], a[40:43]
  v_mfma_f32_16x16x32_bf16 a[44:47], v[40:43], v[156:159], a[44:47]
  v_mfma_f32_16x16x32_bf16 a[60:63], v[44:47], v[156:159], a[60:63]
  v_mfma_f32_16x16x32_bf16 a[56:59], v[44:47], v[152:155], a[56:59]
  v_mfma_f32_16x16x32_bf16 a[52:55], v[44:47], v[148:151], a[52:55]
  v_mfma_f32_16x16x32_bf16 a[48:51], v[44:47], v[144:147], a[48:51]
  s_waitcnt vmcnt(26) lgkmcnt(0)
  s_barrier
  s_waitcnt lgkmcnt(15)
  v_mfma_f32_16x16x32_bf16 a[64:67], v[48:51], v[144:147], a[64:67]
  ds_read_b64_tr_b16 v[32:33], v18 offset:0
  ds_read_b64_tr_b16 v[34:35], v18 offset:1024
  v_mfma_f32_16x16x32_bf16 a[68:71], v[48:51], v[148:151], a[68:71]
  ds_read_b64_tr_b16 v[36:37], v19 offset:0
  ds_read_b64_tr_b16 v[38:39], v19 offset:1024
  v_mfma_f32_16x16x32_bf16 a[72:75], v[48:51], v[152:155], a[72:75]
  ds_read_b64_tr_b16 v[40:41], v18 offset:256
  ds_read_b64_tr_b16 v[42:43], v18 offset:1280
  v_mfma_f32_16x16x32_bf16 a[76:79], v[48:51], v[156:159], a[76:79]
  ds_read_b64_tr_b16 v[44:45], v19 offset:256
  ds_read_b64_tr_b16 v[46:47], v19 offset:1280
  v_mfma_f32_16x16x32_bf16 a[92:95], v[52:55], v[156:159], a[92:95]
  ds_read_b64_tr_b16 v[48:49], v18 offset:512
  ds_read_b64_tr_b16 v[50:51], v18 offset:1536
  v_mfma_f32_16x16x32_bf16 a[88:91], v[52:55], v[152:155], a[88:91]
  s_add_u32 m0, s46, 32768
  s_mov_b32 s42, 5242880
  v_mfma_f32_16x16x32_bf16 a[84:87], v[52:55], v[148:151], a[84:87]
  buffer_load_dwordx4 v4, s[4:7], s42 offen offset:0 lds
  v_mfma_f32_16x16x32_bf16 a[80:83], v[52:55], v[144:147], a[80:83]
  ds_read_b64_tr_b16 v[52:53], v19 offset:512
  v_mfma_f32_16x16x32_bf16 a[96:99], v[56:59], v[144:147], a[96:99]
  ds_read_b64_tr_b16 v[54:55], v19 offset:1536
  v_mfma_f32_16x16x32_bf16 a[100:103], v[56:59], v[148:151], a[100:103]
  v_mfma_f32_16x16x32_bf16 a[104:107], v[56:59], v[152:155], a[104:107]
  buffer_load_dwordx4 v[136:139], v14, s[12:15], s44 offen offset:2048 sc1
  v_mfma_f32_16x16x32_bf16 a[108:111], v[56:59], v[156:159], a[108:111]
  ds_read_b64_tr_b16 v[56:57], v18 offset:768
  v_mfma_f32_16x16x32_bf16 a[124:127], v[60:63], v[156:159], a[124:127]
  ds_read_b64_tr_b16 v[58:59], v18 offset:1792
  v_mfma_f32_16x16x32_bf16 a[120:123], v[60:63], v[152:155], a[120:123]
  v_mfma_f32_16x16x32_bf16 a[116:119], v[60:63], v[148:151], a[116:119]
  v_mfma_f32_16x16x32_bf16 a[112:115], v[60:63], v[144:147], a[112:115]
  s_waitcnt lgkmcnt(15)
  v_mfma_f32_16x16x32_bf16 v[160:163], v[64:67], v[144:147], v[160:163]
  ds_read_b64_tr_b16 v[60:61], v19 offset:768
  v_mfma_f32_16x16x32_bf16 v[164:167], v[64:67], v[148:151], v[164:167]
  ds_read_b64_tr_b16 v[62:63], v19 offset:1792
  v_mfma_f32_16x16x32_bf16 v[168:171], v[64:67], v[152:155], v[168:171]
  buffer_load_dwordx4 v5, s[4:7], s42 offen offset:1024 lds
  v_mfma_f32_16x16x32_bf16 v[172:175], v[64:67], v[156:159], v[172:175]
  ds_read_b64_tr_b16 v[64:65], v18 offset:16384
  v_mfma_f32_16x16x32_bf16 v[188:191], v[68:71], v[156:159], v[188:191]
  ds_read_b64_tr_b16 v[66:67], v18 offset:17408
  v_mfma_f32_16x16x32_bf16 v[184:187], v[68:71], v[152:155], v[184:187]
  v_mfma_f32_16x16x32_bf16 v[180:183], v[68:71], v[148:151], v[180:183]
  v_mfma_f32_16x16x32_bf16 v[176:179], v[68:71], v[144:147], v[176:179]
  ds_read_b64_tr_b16 v[68:69], v19 offset:16384
  v_mfma_f32_16x16x32_bf16 v[192:195], v[72:75], v[144:147], v[192:195]
  ds_read_b64_tr_b16 v[70:71], v19 offset:17408
  v_mfma_f32_16x16x32_bf16 v[196:199], v[72:75], v[148:151], v[196:199]
  buffer_load_dwordx4 v6, s[4:7], s42 offen offset:2048 lds
  v_mfma_f32_16x16x32_bf16 v[200:203], v[72:75], v[152:155], v[200:203]
  v_mfma_f32_16x16x32_bf16 v[204:207], v[72:75], v[156:159], v[204:207]
  ds_read_b64_tr_b16 v[72:73], v18 offset:16640
  v_mfma_f32_16x16x32_bf16 v[220:223], v[76:79], v[156:159], v[220:223]
  ds_read_b64_tr_b16 v[74:75], v18 offset:17664
  v_mfma_f32_16x16x32_bf16 v[216:219], v[76:79], v[152:155], v[216:219]
  v_mfma_f32_16x16x32_bf16 v[212:215], v[76:79], v[148:151], v[212:215]
  buffer_load_dwordx4 v[140:143], v15, s[12:15], s44 offen offset:2048 sc1
  v_mfma_f32_16x16x32_bf16 v[208:211], v[76:79], v[144:147], v[208:211]
  s_waitcnt lgkmcnt(15)
  v_mfma_f32_16x16x32_bf16 v[224:227], v[80:83], v[144:147], v[224:227]
  ds_read_b64_tr_b16 v[76:77], v19 offset:16640
  v_mfma_f32_16x16x32_bf16 v[228:231], v[80:83], v[148:151], v[228:231]
  ds_read_b64_tr_b16 v[78:79], v19 offset:17664
  v_mfma_f32_16x16x32_bf16 v[232:235], v[80:83], v[152:155], v[232:235]
  v_mfma_f32_16x16x32_bf16 v[236:239], v[80:83], v[156:159], v[236:239]
  ds_read_b64_tr_b16 v[80:81], v18 offset:16896
  v_mfma_f32_16x16x32_bf16 a[132:135], v[84:87], v[156:159], a[132:135]
  ds_read_b64_tr_b16 v[82:83], v18 offset:17920
  v_mfma_f32_16x16x32_bf16 a[128:131], v[84:87], v[152:155], a[128:131]
  buffer_load_dwordx4 v7, s[4:7], s42 offen offset:3072 lds
  v_mfma_f32_16x16x32_bf16 v[244:247], v[84:87], v[148:151], v[244:247]
  v_mfma_f32_16x16x32_bf16 v[240:243], v[84:87], v[144:147], v[240:243]
  ds_read_b64_tr_b16 v[84:85], v19 offset:16896
  v_mfma_f32_16x16x32_bf16 a[136:139], v[88:91], v[144:147], a[136:139]
  ds_read_b64_tr_b16 v[86:87], v19 offset:17920
  v_mfma_f32_16x16x32_bf16 a[140:143], v[88:91], v[148:151], a[140:143]
  ds_read_b64_tr_b16 v[88:89], v18 offset:17152
  v_mfma_f32_16x16x32_bf16 a[148:151], v[92:95], v[148:151], a[148:151]
  ds_read_b64_tr_b16 v[90:91], v18 offset:18176
  v_mfma_f32_16x16x32_bf16 a[144:147], v[92:95], v[144:147], a[144:147]
  s_waitcnt vmcnt(20) lgkmcnt(15)
  v_mfma_f32_16x16x32_bf16 a[0:3], v[32:35], v[96:99], a[0:3]
  ds_read_b64_tr_b16 v[92:93], v19 offset:17152
  v_mfma_f32_16x16x32_bf16 a[4:7], v[32:35], v[100:103], a[4:7]
  ds_read_b64_tr_b16 v[94:95], v19 offset:18176
  v_mfma_f32_16x16x32_bf16 a[8:11], v[32:35], v[104:107], a[8:11]
  buffer_load_dwordx4 v[144:147], v12, s[12:15], s44 offen offset:3072 sc1
  v_mfma_f32_16x16x32_bf16 a[12:15], v[32:35], v[108:111], a[12:15]
  ds_read_b64_tr_b16 v[32:33], v18 offset:8192
  v_mfma_f32_16x16x32_bf16 a[28:31], v[36:39], v[108:111], a[28:31]
  ds_read_b64_tr_b16 v[34:35], v18 offset:9216
  v_mfma_f32_16x16x32_bf16 a[24:27], v[36:39], v[104:107], a[24:27]
  s_add_u32 m0, s46, 49152
  s_mov_b32 s43, 4587520
  v_mfma_f32_16x16x32_bf16 a[20:23], v[36:39], v[100:103], a[20:23]
  buffer_load_dwordx4 v8, s[8:11], s43 offen offset:0 lds
  v_mfma_f32_16x16x32_bf16 a[16:19], v[36:39], v[96:99], a[16:19]
  ds_read_b64_tr_b16 v[36:37], v19 offset:8192
  v_mfma_f32_16x16x32_bf16 a[32:35], v[40:43], v[96:99], a[32:35]
  ds_read_b64_tr_b16 v[38:39], v19 offset:9216
  v_mfma_f32_16x16x32_bf16 a[36:39], v[40:43], v[100:103], a[36:39]
  v_mfma_f32_16x16x32_bf16 a[40:43], v[40:43], v[104:107], a[40:43]
  v_mfma_f32_16x16x32_bf16 a[44:47], v[40:43], v[108:111], a[44:47]
  ds_read_b64_tr_b16 v[40:41], v18 offset:8448
  v_mfma_f32_16x16x32_bf16 a[60:63], v[44:47], v[108:111], a[60:63]
  ds_read_b64_tr_b16 v[42:43], v18 offset:9472
  v_mfma_f32_16x16x32_bf16 a[56:59], v[44:47], v[104:107], a[56:59]
  buffer_load_dwordx4 v9, s[8:11], s43 offen offset:1024 lds
  v_mfma_f32_16x16x32_bf16 a[52:55], v[44:47], v[100:103], a[52:55]
  v_mfma_f32_16x16x32_bf16 a[48:51], v[44:47], v[96:99], a[48:51]
  s_waitcnt lgkmcnt(15)
  v_mfma_f32_16x16x32_bf16 a[64:67], v[48:51], v[96:99], a[64:67]
  ds_read_b64_tr_b16 v[44:45], v19 offset:8448
  v_mfma_f32_16x16x32_bf16 a[68:71], v[48:51], v[100:103], a[68:71]
  ds_read_b64_tr_b16 v[46:47], v19 offset:9472
  v_mfma_f32_16x16x32_bf16 a[72:75], v[48:51], v[104:107], a[72:75]
  buffer_load_dwordx4 v[148:151], v13, s[12:15], s44 offen offset:3072 sc1
  v_mfma_f32_16x16x32_bf16 a[76:79], v[48:51], v[108:111], a[76:79]
  ds_read_b64_tr_b16 v[48:49], v18 offset:8704
  v_mfma_f32_16x16x32_bf16 a[92:95], v[52:55], v[108:111], a[92:95]
  ds_read_b64_tr_b16 v[50:51], v18 offset:9728
  v_mfma_f32_16x16x32_bf16 a[88:91], v[52:55], v[104:107], a[88:91]
  v_mfma_f32_16x16x32_bf16 a[84:87], v[52:55], v[100:103], a[84:87]
  buffer_load_dwordx4 v10, s[8:11], s43 offen offset:2048 lds
  v_mfma_f32_16x16x32_bf16 a[80:83], v[52:55], v[96:99], a[80:83]
  ds_read_b64_tr_b16 v[52:53], v19 offset:8704
  v_mfma_f32_16x16x32_bf16 a[96:99], v[56:59], v[96:99], a[96:99]
  ds_read_b64_tr_b16 v[54:55], v19 offset:9728
  v_mfma_f32_16x16x32_bf16 a[100:103], v[56:59], v[100:103], a[100:103]
  v_mfma_f32_16x16x32_bf16 a[104:107], v[56:59], v[104:107], a[104:107]
  v_mfma_f32_16x16x32_bf16 a[108:111], v[56:59], v[108:111], a[108:111]
  ds_read_b64_tr_b16 v[56:57], v18 offset:8960
  v_mfma_f32_16x16x32_bf16 a[124:127], v[60:63], v[108:111], a[124:127]
  ds_read_b64_tr_b16 v[58:59], v18 offset:9984
  v_mfma_f32_16x16x32_bf16 a[120:123], v[60:63], v[104:107], a[120:123]
  buffer_load_dwordx4 v11, s[8:11], s43 offen offset:3072 lds
  v_mfma_f32_16x16x32_bf16 a[116:119], v[60:63], v[100:103], a[116:119]
  v_mfma_f32_16x16x32_bf16 a[112:115], v[60:63], v[96:99], a[112:115]
  s_waitcnt lgkmcnt(15)
  v_mfma_f32_16x16x32_bf16 v[160:163], v[64:67], v[96:99], v[160:163]
  ds_read_b64_tr_b16 v[60:61], v19 offset:8960
  v_mfma_f32_16x16x32_bf16 v[164:167], v[64:67], v[100:103], v[164:167]
  ds_read_b64_tr_b16 v[62:63], v19 offset:9984
  v_mfma_f32_16x16x32_bf16 v[168:171], v[64:67], v[104:107], v[168:171]
  buffer_load_dwordx4 v[152:155], v14, s[12:15], s44 offen offset:3072 sc1
  v_mfma_f32_16x16x32_bf16 v[172:175], v[64:67], v[108:111], v[172:175]
  ds_read_b64_tr_b16 v[64:65], v18 offset:24576
  v_mfma_f32_16x16x32_bf16 v[188:191], v[68:71], v[108:111], v[188:191]
  ds_read_b64_tr_b16 v[66:67], v18 offset:25600
  v_mfma_f32_16x16x32_bf16 v[184:187], v[68:71], v[104:107], v[184:187]
  s_add_u32 m0, s47, 147456
  s_add_u32 s45, s48, 32768
  v_mfma_f32_16x16x32_bf16 v[180:183], v[68:71], v[100:103], v[180:183]
  buffer_load_dwordx4 v21, s[24:27], s45 offen offset:0 lds
  v_mfma_f32_16x16x32_bf16 v[176:179], v[68:71], v[96:99], v[176:179]
  ds_read_b64_tr_b16 v[68:69], v19 offset:24576
  v_mfma_f32_16x16x32_bf16 v[192:195], v[72:75], v[96:99], v[192:195]
  ds_read_b64_tr_b16 v[70:71], v19 offset:25600
  v_mfma_f32_16x16x32_bf16 v[196:199], v[72:75], v[100:103], v[196:199]
  v_mfma_f32_16x16x32_bf16 v[200:203], v[72:75], v[104:107], v[200:203]
  v_mfma_f32_16x16x32_bf16 v[204:207], v[72:75], v[108:111], v[204:207]
  ds_read_b64_tr_b16 v[72:73], v18 offset:24832
  v_mfma_f32_16x16x32_bf16 v[220:223], v[76:79], v[108:111], v[220:223]
  ds_read_b64_tr_b16 v[74:75], v18 offset:25856
  v_mfma_f32_16x16x32_bf16 v[216:219], v[76:79], v[104:107], v[216:219]
  buffer_load_dwordx4 v22, s[24:27], s45 offen offset:2048 lds
  v_mfma_f32_16x16x32_bf16 v[212:215], v[76:79], v[100:103], v[212:215]
  v_mfma_f32_16x16x32_bf16 v[208:211], v[76:79], v[96:99], v[208:211]
  s_waitcnt lgkmcnt(15)
  v_mfma_f32_16x16x32_bf16 v[224:227], v[80:83], v[96:99], v[224:227]
  ds_read_b64_tr_b16 v[76:77], v19 offset:24832
  v_mfma_f32_16x16x32_bf16 v[228:231], v[80:83], v[100:103], v[228:231]
  ds_read_b64_tr_b16 v[78:79], v19 offset:25856
  v_mfma_f32_16x16x32_bf16 v[232:235], v[80:83], v[104:107], v[232:235]
  buffer_load_dwordx4 v[156:159], v15, s[12:15], s44 offen offset:3072 sc1
  v_mfma_f32_16x16x32_bf16 v[236:239], v[80:83], v[108:111], v[236:239]
  ds_read_b64_tr_b16 v[80:81], v18 offset:25088
  v_mfma_f32_16x16x32_bf16 a[132:135], v[84:87], v[108:111], a[132:135]
  ds_read_b64_tr_b16 v[82:83], v18 offset:26112
  v_mfma_f32_16x16x32_bf16 a[128:131], v[84:87], v[104:107], a[128:131]
  s_add_u32 s84, s90, 7340032
  v_mfma_f32_16x16x32_bf16 v[244:247], v[84:87], v[100:103], v[244:247]
  buffer_load_dword a254, v24, s[4:7], s84 offen
  v_mfma_f32_16x16x32_bf16 v[240:243], v[84:87], v[96:99], v[240:243]
  ds_read_b64_tr_b16 v[84:85], v19 offset:25088
  v_mfma_f32_16x16x32_bf16 a[136:139], v[88:91], v[96:99], a[136:139]
  ds_read_b64_tr_b16 v[86:87], v19 offset:26112
  v_mfma_f32_16x16x32_bf16 a[140:143], v[88:91], v[100:103], a[140:143]
  ds_read_b64_tr_b16 v[88:89], v18 offset:25344
  v_mfma_f32_16x16x32_bf16 a[148:151], v[92:95], v[100:103], a[148:151]
  ds_read_b64_tr_b16 v[90:91], v18 offset:26368
  v_mfma_f32_16x16x32_bf16 a[144:147], v[92:95], v[96:99], a[144:147]
  s_waitcnt vmcnt(20) lgkmcnt(15)
  v_mfma_f32_16x16x32_bf16 a[0:3], v[32:35], v[112:115], a[0:3]
  ds_read_b64_tr_b16 v[92:93], v19 offset:25344
  v_mfma_f32_16x16x32_bf16 a[4:7], v[32:35], v[116:119], a[4:7]
  ds_read_b64_tr_b16 v[94:95], v19 offset:26368
  v_mfma_f32_16x16x32_bf16 a[8:11], v[32:35], v[120:123], a[8:11]
  s_mov_b32 s44, 20480
  buffer_load_dwordx4 v[96:99], v12, s[12:15], s44 offen offset:0 sc1
  v_mfma_f32_16x16x32_bf16 a[12:15], v[32:35], v[124:127], a[12:15]
  v_mfma_f32_16x16x32_bf16 a[28:31], v[36:39], v[124:127], a[28:31]
  v_mfma_f32_16x16x32_bf16 a[24:27], v[36:39], v[120:123], a[24:27]
  v_mfma_f32_16x16x32_bf16 a[20:23], v[36:39], v[116:119], a[20:23]
  v_mfma_f32_16x16x32_bf16 a[16:19], v[36:39], v[112:115], a[16:19]
  v_mfma_f32_16x16x32_bf16 a[32:35], v[40:43], v[112:115], a[32:35]
  buffer_load_dwordx4 v[100:103], v13, s[12:15], s44 offen offset:0 sc1
  v_mfma_f32_16x16x32_bf16 a[36:39], v[40:43], v[116:119], a[36:39]
  v_mfma_f32_16x16x32_bf16 a[40:43], v[40:43], v[120:123], a[40:43]
  v_mfma_f32_16x16x32_bf16 a[44:47], v[40:43], v[124:127], a[44:47]
  v_mfma_f32_16x16x32_bf16 a[60:63], v[44:47], v[124:127], a[60:63]
  v_mfma_f32_16x16x32_bf16 a[56:59], v[44:47], v[120:123], a[56:59]
  v_mfma_f32_16x16x32_bf16 a[52:55], v[44:47], v[116:119], a[52:55]
  v_mfma_f32_16x16x32_bf16 a[48:51], v[44:47], v[112:115], a[48:51]
  s_waitcnt vmcnt(24) lgkmcnt(0)
  s_barrier
  s_waitcnt lgkmcnt(15)
  v_mfma_f32_16x16x32_bf16 a[64:67], v[48:51], v[112:115], a[64:67]
  ds_read_b64_tr_b16 v[32:33], v16 offset:0
  ds_read_b64_tr_b16 v[34:35], v16 offset:1024
  v_mfma_f32_16x16x32_bf16 a[68:71], v[48:51], v[116:119], a[68:71]
  ds_read_b64_tr_b16 v[36:37], v17 offset:0
  ds_read_b64_tr_b16 v[38:39], v17 offset:1024
  v_mfma_f32_16x16x32_bf16 a[72:75], v[48:51], v[120:123], a[72:75]
  ds_read_b64_tr_b16 v[40:41], v16 offset:256
  ds_read_b64_tr_b16 v[42:43], v16 offset:1280
  v_mfma_f32_16x16x32_bf16 a[76:79], v[48:51], v[124:127], a[76:79]
  ds_read_b64_tr_b16 v[44:45], v17 offset:256
  ds_read_b64_tr_b16 v[46:47], v17 offset:1280
  v_mfma_f32_16x16x32_bf16 a[92:95], v[52:55], v[124:127], a[92:95]
  ds_read_b64_tr_b16 v[48:49], v16 offset:512
  ds_read_b64_tr_b16 v[50:51], v16 offset:1536
  v_mfma_f32_16x16x32_bf16 a[88:91], v[52:55], v[120:123], a[88:91]
  s_add_u32 m0, s46, 65536
  s_mov_b32 s42, 5767168
  v_mfma_f32_16x16x32_bf16 a[84:87], v[52:55], v[116:119], a[84:87]
  buffer_load_dwordx4 v4, s[4:7], s42 offen offset:0 lds
  v_mfma_f32_16x16x32_bf16 a[80:83], v[52:55], v[112:115], a[80:83]
  ds_read_b64_tr_b16 v[52:53], v17 offset:512
  v_mfma_f32_16x16x32_bf16 a[96:99], v[56:59], v[112:115], a[96:99]
  ds_read_b64_tr_b16 v[54:55], v17 offset:1536
  v_mfma_f32_16x16x32_bf16 a[100:103], v[56:59], v[116:119], a[100:103]
  buffer_load_dwordx4 v[104:107], v14, s[12:15], s44 offen offset:0 sc1
  v_mfma_f32_16x16x32_bf16 a[104:107], v[56:59], v[120:123], a[104:107]
  v_mfma_f32_16x16x32_bf16 a[108:111], v[56:59], v[124:127], a[108:111]
  ds_read_b64_tr_b16 v[56:57], v16 offset:768
  v_mfma_f32_16x16x32_bf16 a[124:127], v[60:63], v[124:127], a[124:127]
  ds_read_b64_tr_b16 v[58:59], v16 offset:1792
  v_mfma_f32_16x16x32_bf16 a[120:123], v[60:63], v[120:123], a[120:123]
  v_mfma_f32_16x16x32_bf16 a[116:119], v[60:63], v[116:119], a[116:119]
  v_mfma_f32_16x16x32_bf16 a[112:115], v[60:63], v[112:115], a[112:115]
  s_waitcnt lgkmcnt(15)
  v_mfma_f32_16x16x32_bf16 v[160:163], v[64:67], v[112:115], v[160:163]
  ds_read_b64_tr_b16 v[60:61], v17 offset:768
  v_mfma_f32_16x16x32_bf16 v[164:167], v[64:67], v[116:119], v[164:167]
  ds_read_b64_tr_b16 v[62:63], v17 offset:1792
  v_mfma_f32_16x16x32_bf16 v[168:171], v[64:67], v[120:123], v[168:171]
  buffer_load_dwordx4 v5, s[4:7], s42 offen offset:1024 lds
  v_mfma_f32_16x16x32_bf16 v[172:175], v[64:67], v[124:127], v[172:175]
  ds_read_b64_tr_b16 v[64:65], v16 offset:16384
  v_mfma_f32_16x16x32_bf16 v[188:191], v[68:71], v[124:127], v[188:191]
  ds_read_b64_tr_b16 v[66:67], v16 offset:17408
  v_mfma_f32_16x16x32_bf16 v[184:187], v[68:71], v[120:123], v[184:187]
  buffer_load_dwordx4 v6, s[4:7], s42 offen offset:2048 lds
  v_mfma_f32_16x16x32_bf16 v[180:183], v[68:71], v[116:119], v[180:183]
  v_mfma_f32_16x16x32_bf16 v[176:179], v[68:71], v[112:115], v[176:179]
  ds_read_b64_tr_b16 v[68:69], v17 offset:16384
  v_mfma_f32_16x16x32_bf16 v[192:195], v[72:75], v[112:115], v[192:195]
  ds_read_b64_tr_b16 v[70:71], v17 offset:17408
  v_mfma_f32_16x16x32_bf16 v[196:199], v[72:75], v[116:119], v[196:199]
  v_mfma_f32_16x16x32_bf16 v[200:203], v[72:75], v[120:123], v[200:203]
  buffer_load_dwordx4 v[108:111], v15, s[12:15], s44 offen offset:0 sc1
  v_mfma_f32_16x16x32_bf16 v[204:207], v[72:75], v[124:127], v[204:207]
  ds_read_b64_tr_b16 v[72:73], v16 offset:16640
  v_mfma_f32_16x16x32_bf16 v[220:223], v[76:79], v[124:127], v[220:223]
  ds_read_b64_tr_b16 v[74:75], v16 offset:17664
  v_mfma_f32_16x16x32_bf16 v[216:219], v[76:79], v[120:123], v[216:219]
  v_mfma_f32_16x16x32_bf16 v[212:215], v[76:79], v[116:119], v[212:215]
  v_mfma_f32_16x16x32_bf16 v[208:211], v[76:79], v[112:115], v[208:211]
  s_waitcnt lgkmcnt(15)
  v_mfma_f32_16x16x32_bf16 v[224:227], v[80:83], v[112:115], v[224:227]
  ds_read_b64_tr_b16 v[76:77], v17 offset:16640
  v_mfma_f32_16x16x32_bf16 v[228:231], v[80:83], v[116:119], v[228:231]
  ds_read_b64_tr_b16 v[78:79], v17 offset:17664
  v_mfma_f32_16x16x32_bf16 v[232:235], v[80:83], v[120:123], v[232:235]
  buffer_load_dwordx4 v7, s[4:7], s42 offen offset:3072 lds
  v_mfma_f32_16x16x32_bf16 v[236:239], v[80:83], v[124:127], v[236:239]
  ds_read_b64_tr_b16 v[80:81], v16 offset:16896
  v_mfma_f32_16x16x32_bf16 a[132:135], v[84:87], v[124:127], a[132:135]
  ds_read_b64_tr_b16 v[82:83], v16 offset:17920
  v_mfma_f32_16x16x32_bf16 a[128:131], v[84:87], v[120:123], a[128:131]
  s_add_u32 s84, s91, 6422528
  v_mfma_f32_16x16x32_bf16 v[244:247], v[84:87], v[116:119], v[244:247]
  buffer_load_dword a255, v24, s[8:11], s84 offen
  v_mfma_f32_16x16x32_bf16 v[240:243], v[84:87], v[112:115], v[240:243]
  ds_read_b64_tr_b16 v[84:85], v17 offset:16896
  v_mfma_f32_16x16x32_bf16 a[136:139], v[88:91], v[112:115], a[136:139]
  ds_read_b64_tr_b16 v[86:87], v17 offset:17920
  v_mfma_f32_16x16x32_bf16 a[140:143], v[88:91], v[116:119], a[140:143]
  ds_read_b64_tr_b16 v[88:89], v16 offset:17152
  v_mfma_f32_16x16x32_bf16 a[148:151], v[92:95], v[116:119], a[148:151]
  ds_read_b64_tr_b16 v[90:91], v16 offset:18176
  v_mfma_f32_16x16x32_bf16 a[144:147], v[92:95], v[112:115], a[144:147]
  s_waitcnt vmcnt(21) lgkmcnt(15)
  v_mfma_f32_16x16x32_bf16 a[0:3], v[32:35], v[128:131], a[0:3]
  ds_read_b64_tr_b16 v[92:93], v17 offset:17152
  v_mfma_f32_16x16x32_bf16 a[4:7], v[32:35], v[132:135], a[4:7]
  ds_read_b64_tr_b16 v[94:95], v17 offset:18176
  v_mfma_f32_16x16x32_bf16 a[8:11], v[32:35], v[136:139], a[8:11]
  buffer_load_dwordx4 v[112:115], v12, s[12:15], s44 offen offset:1024 sc1
  v_mfma_f32_16x16x32_bf16 a[12:15], v[32:35], v[140:143], a[12:15]
  ds_read_b64_tr_b16 v[32:33], v16 offset:8192
  v_mfma_f32_16x16x32_bf16 a[28:31], v[36:39], v[140:143], a[28:31]
  ds_read_b64_tr_b16 v[34:35], v16 offset:9216
  v_mfma_f32_16x16x32_bf16 a[24:27], v[36:39], v[136:139], a[24:27]
  s_add_u32 m0, s46, 81920
  s_mov_b32 s43, 5046272
  v_mfma_f32_16x16x32_bf16 a[20:23], v[36:39], v[132:135], a[20:23]
  buffer_load_dwordx4 v8, s[8:11], s43 offen offset:0 lds
  v_mfma_f32_16x16x32_bf16 a[16:19], v[36:39], v[128:131], a[16:19]
  ds_read_b64_tr_b16 v[36:37], v17 offset:8192
  v_mfma_f32_16x16x32_bf16 a[32:35], v[40:43], v[128:131], a[32:35]
  ds_read_b64_tr_b16 v[38:39], v17 offset:9216
  v_mfma_f32_16x16x32_bf16 a[36:39], v[40:43], v[132:135], a[36:39]
  v_mfma_f32_16x16x32_bf16 a[40:43], v[40:43], v[136:139], a[40:43]
  v_mfma_f32_16x16x32_bf16 a[44:47], v[40:43], v[140:143], a[44:47]
  ds_read_b64_tr_b16 v[40:41], v16 offset:8448
  v_mfma_f32_16x16x32_bf16 a[60:63], v[44:47], v[140:143], a[60:63]
  ds_read_b64_tr_b16 v[42:43], v16 offset:9472
  v_mfma_f32_16x16x32_bf16 a[56:59], v[44:47], v[136:139], a[56:59]
  buffer_load_dwordx4 v9, s[8:11], s43 offen offset:1024 lds
  v_mfma_f32_16x16x32_bf16 a[52:55], v[44:47], v[132:135], a[52:55]
  v_mfma_f32_16x16x32_bf16 a[48:51], v[44:47], v[128:131], a[48:51]
  s_waitcnt lgkmcnt(15)
  v_mfma_f32_16x16x32_bf16 a[64:67], v[48:51], v[128:131], a[64:67]
  ds_read_b64_tr_b16 v[44:45], v17 offset:8448
  v_mfma_f32_16x16x32_bf16 a[68:71], v[48:51], v[132:135], a[68:71]
  ds_read_b64_tr_b16 v[46:47], v17 offset:9472
  v_mfma_f32_16x16x32_bf16 a[72:75], v[48:51], v[136:139], a[72:75]
  buffer_load_dwordx4 v[116:119], v13, s[12:15], s44 offen offset:1024 sc1
  v_mfma_f32_16x16x32_bf16 a[76:79], v[48:51], v[140:143], a[76:79]
  ds_read_b64_tr_b16 v[48:49], v16 offset:8704
  v_mfma_f32_16x16x32_bf16 a[92:95], v[52:55], v[140:143], a[92:95]
  ds_read_b64_tr_b16 v[50:51], v16 offset:9728
  v_mfma_f32_16x16x32_bf16 a[88:91], v[52:55], v[136:139], a[88:91]
  v_mfma_f32_16x16x32_bf16 a[84:87], v[52:55], v[132:135], a[84:87]
  v_mfma_f32_16x16x32_bf16 a[80:83], v[52:55], v[128:131], a[80:83]
  ds_read_b64_tr_b16 v[52:53], v17 offset:8704
  v_mfma_f32_16x16x32_bf16 a[96:99], v[56:59], v[128:131], a[96:99]
  ds_read_b64_tr_b16 v[54:55], v17 offset:9728
  v_mfma_f32_16x16x32_bf16 a[100:103], v[56:59], v[132:135], a[100:103]
  buffer_load_dwordx4 v10, s[8:11], s43 offen offset:2048 lds
  v_mfma_f32_16x16x32_bf16 a[104:107], v[56:59], v[136:139], a[104:107]
  v_mfma_f32_16x16x32_bf16 a[108:111], v[56:59], v[140:143], a[108:111]
  ds_read_b64_tr_b16 v[56:57], v16 offset:8960
  v_mfma_f32_16x16x32_bf16 a[124:127], v[60:63], v[140:143], a[124:127]
  ds_read_b64_tr_b16 v[58:59], v16 offset:9984
  v_mfma_f32_16x16x32_bf16 a[120:123], v[60:63], v[136:139], a[120:123]
  v_mfma_f32_16x16x32_bf16 a[116:119], v[60:63], v[132:135], a[116:119]
  buffer_load_dwordx4 v[120:123], v14, s[12:15], s44 offen offset:1024 sc1
  v_mfma_f32_16x16x32_bf16 a[112:115], v[60:63], v[128:131], a[112:115]
  s_waitcnt lgkmcnt(15)
  v_mfma_f32_16x16x32_bf16 v[160:163], v[64:67], v[128:131], v[160:163]
  ds_read_b64_tr_b16 v[60:61], v17 offset:8960
  v_mfma_f32_16x16x32_bf16 v[164:167], v[64:67], v[132:135], v[164:167]
  ds_read_b64_tr_b16 v[62:63], v17 offset:9984
  v_mfma_f32_16x16x32_bf16 v[168:171], v[64:67], v[136:139], v[168:171]
  v_mfma_f32_16x16x32_bf16 v[172:175], v[64:67], v[140:143], v[172:175]
  ds_read_b64_tr_b16 v[64:65], v16 offset:24576
  v_mfma_f32_16x16x32_bf16 v[188:191], v[68:71], v[140:143], v[188:191]
  ds_read_b64_tr_b16 v[66:67], v16 offset:25600
  v_mfma_f32_16x16x32_bf16 v[184:187], v[68:71], v[136:139], v[184:187]
  buffer_load_dwordx4 v11, s[8:11], s43 offen offset:3072 lds
  v_mfma_f32_16x16x32_bf16 v[180:183], v[68:71], v[132:135], v[180:183]
  v_mfma_f32_16x16x32_bf16 v[176:179], v[68:71], v[128:131], v[176:179]
  ds_read_b64_tr_b16 v[68:69], v17 offset:24576
  v_mfma_f32_16x16x32_bf16 v[192:195], v[72:75], v[128:131], v[192:195]
  ds_read_b64_tr_b16 v[70:71], v17 offset:25600
  v_mfma_f32_16x16x32_bf16 v[196:199], v[72:75], v[132:135], v[196:199]
  s_add_u32 m0, s49, 155648
  s_add_u32 s45, s48, 16384
  v_mfma_f32_16x16x32_bf16 v[200:203], v[72:75], v[136:139], v[200:203]
  buffer_load_dwordx4 v28, s[28:31], s45 offen offset:0 lds
  v_mfma_f32_16x16x32_bf16 v[204:207], v[72:75], v[140:143], v[204:207]
  ds_read_b64_tr_b16 v[72:73], v16 offset:24832
  v_mfma_f32_16x16x32_bf16 v[220:223], v[76:79], v[140:143], v[220:223]
  ds_read_b64_tr_b16 v[74:75], v16 offset:25856
  v_mfma_f32_16x16x32_bf16 v[216:219], v[76:79], v[136:139], v[216:219]
  v_mfma_f32_16x16x32_bf16 v[212:215], v[76:79], v[132:135], v[212:215]
  v_mfma_f32_16x16x32_bf16 v[208:211], v[76:79], v[128:131], v[208:211]
  s_waitcnt lgkmcnt(15)
  v_mfma_f32_16x16x32_bf16 v[224:227], v[80:83], v[128:131], v[224:227]
  ds_read_b64_tr_b16 v[76:77], v17 offset:24832
  v_mfma_f32_16x16x32_bf16 v[228:231], v[80:83], v[132:135], v[228:231]
  ds_read_b64_tr_b16 v[78:79], v17 offset:25856
  v_mfma_f32_16x16x32_bf16 v[232:235], v[80:83], v[136:139], v[232:235]
  buffer_load_dwordx4 v[124:127], v15, s[12:15], s44 offen offset:1024 sc1
  v_mfma_f32_16x16x32_bf16 v[236:239], v[80:83], v[140:143], v[236:239]
  ds_read_b64_tr_b16 v[80:81], v16 offset:25088
  v_mfma_f32_16x16x32_bf16 a[132:135], v[84:87], v[140:143], a[132:135]
  ds_read_b64_tr_b16 v[82:83], v16 offset:26112
  v_mfma_f32_16x16x32_bf16 a[128:131], v[84:87], v[136:139], a[128:131]
  buffer_load_dwordx4 v29, s[28:31], s45 offen offset:1024 lds
  v_mfma_f32_16x16x32_bf16 v[244:247], v[84:87], v[132:135], v[244:247]
  v_mfma_f32_16x16x32_bf16 v[240:243], v[84:87], v[128:131], v[240:243]
  ds_read_b64_tr_b16 v[84:85], v17 offset:25088
  v_mfma_f32_16x16x32_bf16 a[136:139], v[88:91], v[128:131], a[136:139]
  ds_read_b64_tr_b16 v[86:87], v17 offset:26112
  v_mfma_f32_16x16x32_bf16 a[140:143], v[88:91], v[132:135], a[140:143]
  ds_read_b64_tr_b16 v[88:89], v16 offset:25344
  v_mfma_f32_16x16x32_bf16 a[148:151], v[92:95], v[132:135], a[148:151]
  ds_read_b64_tr_b16 v[90:91], v16 offset:26368
  v_mfma_f32_16x16x32_bf16 a[144:147], v[92:95], v[128:131], a[144:147]
  s_waitcnt vmcnt(20) lgkmcnt(15)
  v_mfma_f32_16x16x32_bf16 a[0:3], v[32:35], v[144:147], a[0:3]
  ds_read_b64_tr_b16 v[92:93], v17 offset:25344
  v_mfma_f32_16x16x32_bf16 a[4:7], v[32:35], v[148:151], a[4:7]
  ds_read_b64_tr_b16 v[94:95], v17 offset:26368
  v_mfma_f32_16x16x32_bf16 a[8:11], v[32:35], v[152:155], a[8:11]
  buffer_load_dwordx4 v[128:131], v12, s[12:15], s44 offen offset:2048 sc1
  v_mfma_f32_16x16x32_bf16 a[12:15], v[32:35], v[156:159], a[12:15]
  v_mfma_f32_16x16x32_bf16 a[28:31], v[36:39], v[156:159], a[28:31]
  v_mfma_f32_16x16x32_bf16 a[24:27], v[36:39], v[152:155], a[24:27]
  v_mfma_f32_16x16x32_bf16 a[20:23], v[36:39], v[148:151], a[20:23]
  v_mfma_f32_16x16x32_bf16 a[16:19], v[36:39], v[144:147], a[16:19]
  v_mfma_f32_16x16x32_bf16 a[32:35], v[40:43], v[144:147], a[32:35]
  buffer_load_dwordx4 v[132:135], v13, s[12:15], s44 offen offset:2048 sc1
  v_mfma_f32_16x16x32_bf16 a[36:39], v[40:43], v[148:151], a[36:39]
  v_mfma_f32_16x16x32_bf16 a[40:43], v[40:43], v[152:155], a[40:43]
  v_mfma_f32_16x16x32_bf16 a[44:47], v[40:43], v[156:159], a[44:47]
  v_mfma_f32_16x16x32_bf16 a[60:63], v[44:47], v[156:159], a[60:63]
  v_mfma_f32_16x16x32_bf16 a[56:59], v[44:47], v[152:155], a[56:59]
  v_mfma_f32_16x16x32_bf16 a[52:55], v[44:47], v[148:151], a[52:55]
  v_mfma_f32_16x16x32_bf16 a[48:51], v[44:47], v[144:147], a[48:51]
  s_waitcnt vmcnt(26) lgkmcnt(0)
  s_barrier
  s_waitcnt lgkmcnt(15)
  v_mfma_f32_16x16x32_bf16 a[64:67], v[48:51], v[144:147], a[64:67]
  ds_read_b64_tr_b16 v[32:33], v16 offset:32768
  ds_read_b64_tr_b16 v[34:35], v16 offset:33792
  v_mfma_f32_16x16x32_bf16 a[68:71], v[48:51], v[148:151], a[68:71]
  ds_read_b64_tr_b16 v[36:37], v17 offset:32768
  ds_read_b64_tr_b16 v[38:39], v17 offset:33792
  v_mfma_f32_16x16x32_bf16 a[72:75], v[48:51], v[152:155], a[72:75]
  ds_read_b64_tr_b16 v[40:41], v16 offset:33024
  ds_read_b64_tr_b16 v[42:43], v16 offset:34048
  v_mfma_f32_16x16x32_bf16 a[76:79], v[48:51], v[156:159], a[76:79]
  ds_read_b64_tr_b16 v[44:45], v17 offset:33024
  ds_read_b64_tr_b16 v[46:47], v17 offset:34048
  v_mfma_f32_16x16x32_bf16 a[92:95], v[52:55], v[156:159], a[92:95]
  ds_read_b64_tr_b16 v[48:49], v16 offset:33280
  ds_read_b64_tr_b16 v[50:51], v16 offset:34304
  v_mfma_f32_16x16x32_bf16 a[88:91], v[52:55], v[152:155], a[88:91]
  s_add_u32 m0, s46, 0
  s_mov_b32 s42, 6291456
  v_mfma_f32_16x16x32_bf16 a[84:87], v[52:55], v[148:151], a[84:87]
  buffer_load_dwordx4 v4, s[4:7], s42 offen offset:0 lds
  v_mfma_f32_16x16x32_bf16 a[80:83], v[52:55], v[144:147], a[80:83]
  ds_read_b64_tr_b16 v[52:53], v17 offset:33280
  v_mfma_f32_16x16x32_bf16 a[96:99], v[56:59], v[144:147], a[96:99]
  ds_read_b64_tr_b16 v[54:55], v17 offset:34304
  v_mfma_f32_16x16x32_bf16 a[100:103], v[56:59], v[148:151], a[100:103]
  v_mfma_f32_16x16x32_bf16 a[104:107], v[56:59], v[152:155], a[104:107]
  buffer_load_dwordx4 v[136:139], v14, s[12:15], s44 offen offset:2048 sc1
  v_mfma_f32_16x16x32_bf16 a[108:111], v[56:59], v[156:159], a[108:111]
  ds_read_b64_tr_b16 v[56:57], v16 offset:33536
  v_mfma_f32_16x16x32_bf16 a[124:127], v[60:63], v[156:159], a[124:127]
  ds_read_b64_tr_b16 v[58:59], v16 offset:34560
  v_mfma_f32_16x16x32_bf16 a[120:123], v[60:63], v[152:155], a[120:123]
  v_mfma_f32_16x16x32_bf16 a[116:119], v[60:63], v[148:151], a[116:119]
  v_mfma_f32_16x16x32_bf16 a[112:115], v[60:63], v[144:147], a[112:115]
  s_waitcnt lgkmcnt(15)
  v_mfma_f32_16x16x32_bf16 v[160:163], v[64:67], v[144:147], v[160:163]
  ds_read_b64_tr_b16 v[60:61], v17 offset:33536
  v_mfma_f32_16x16x32_bf16 v[164:167], v[64:67], v[148:151], v[164:167]
  ds_read_b64_tr_b16 v[62:63], v17 offset:34560
  v_mfma_f32_16x16x32_bf16 v[168:171], v[64:67], v[152:155], v[168:171]
  buffer_load_dwordx4 v5, s[4:7], s42 offen offset:1024 lds
  v_mfma_f32_16x16x32_bf16 v[172:175], v[64:67], v[156:159], v[172:175]
  ds_read_b64_tr_b16 v[64:65], v16 offset:49152
  v_mfma_f32_16x16x32_bf16 v[188:191], v[68:71], v[156:159], v[188:191]
  ds_read_b64_tr_b16 v[66:67], v16 offset:50176
  v_mfma_f32_16x16x32_bf16 v[184:187], v[68:71], v[152:155], v[184:187]
  v_mfma_f32_16x16x32_bf16 v[180:183], v[68:71], v[148:151], v[180:183]
  v_mfma_f32_16x16x32_bf16 v[176:179], v[68:71], v[144:147], v[176:179]
  ds_read_b64_tr_b16 v[68:69], v17 offset:49152
  v_mfma_f32_16x16x32_bf16 v[192:195], v[72:75], v[144:147], v[192:195]
  ds_read_b64_tr_b16 v[70:71], v17 offset:50176
  v_mfma_f32_16x16x32_bf16 v[196:199], v[72:75], v[148:151], v[196:199]
  buffer_load_dwordx4 v6, s[4:7], s42 offen offset:2048 lds
  v_mfma_f32_16x16x32_bf16 v[200:203], v[72:75], v[152:155], v[200:203]
  v_mfma_f32_16x16x32_bf16 v[204:207], v[72:75], v[156:159], v[204:207]
  ds_read_b64_tr_b16 v[72:73], v16 offset:49408
  v_mfma_f32_16x16x32_bf16 v[220:223], v[76:79], v[156:159], v[220:223]
  ds_read_b64_tr_b16 v[74:75], v16 offset:50432
  v_mfma_f32_16x16x32_bf16 v[216:219], v[76:79], v[152:155], v[216:219]
  v_mfma_f32_16x16x32_bf16 v[212:215], v[76:79], v[148:151], v[212:215]
  buffer_load_dwordx4 v[140:143], v15, s[12:15], s44 offen offset:2048 sc1
  v_mfma_f32_16x16x32_bf16 v[208:211], v[76:79], v[144:147], v[208:211]
  s_waitcnt lgkmcnt(15)
  v_mfma_f32_16x16x32_bf16 v[224:227], v[80:83], v[144:147], v[224:227]
  ds_read_b64_tr_b16 v[76:77], v17 offset:49408
  v_mfma_f32_16x16x32_bf16 v[228:231], v[80:83], v[148:151], v[228:231]
  ds_read_b64_tr_b16 v[78:79], v17 offset:50432
  v_mfma_f32_16x16x32_bf16 v[232:235], v[80:83], v[152:155], v[232:235]
  v_mfma_f32_16x16x32_bf16 v[236:239], v[80:83], v[156:159], v[236:239]
  ds_read_b64_tr_b16 v[80:81], v16 offset:49664
  v_mfma_f32_16x16x32_bf16 a[132:135], v[84:87], v[156:159], a[132:135]
  ds_read_b64_tr_b16 v[82:83], v16 offset:50688
  v_mfma_f32_16x16x32_bf16 a[128:131], v[84:87], v[152:155], a[128:131]
  buffer_load_dwordx4 v7, s[4:7], s42 offen offset:3072 lds
  v_mfma_f32_16x16x32_bf16 v[244:247], v[84:87], v[148:151], v[244:247]
  v_mfma_f32_16x16x32_bf16 v[240:243], v[84:87], v[144:147], v[240:243]
  ds_read_b64_tr_b16 v[84:85], v17 offset:49664
  v_mfma_f32_16x16x32_bf16 a[136:139], v[88:91], v[144:147], a[136:139]
  ds_read_b64_tr_b16 v[86:87], v17 offset:50688
  v_mfma_f32_16x16x32_bf16 a[140:143], v[88:91], v[148:151], a[140:143]
  ds_read_b64_tr_b16 v[88:89], v16 offset:49920
  v_mfma_f32_16x16x32_bf16 a[148:151], v[92:95], v[148:151], a[148:151]
  ds_read_b64_tr_b16 v[90:91], v16 offset:50944
  v_mfma_f32_16x16x32_bf16 a[144:147], v[92:95], v[144:147], a[144:147]
  s_waitcnt vmcnt(20) lgkmcnt(15)
  v_mfma_f32_16x16x32_bf16 a[0:3], v[32:35], v[96:99], a[0:3]
  ds_read_b64_tr_b16 v[92:93], v17 offset:49920
  v_mfma_f32_16x16x32_bf16 a[4:7], v[32:35], v[100:103], a[4:7]
  ds_read_b64_tr_b16 v[94:95], v17 offset:50944
  v_mfma_f32_16x16x32_bf16 a[8:11], v[32:35], v[104:107], a[8:11]
  buffer_load_dwordx4 v[144:147], v12, s[12:15], s44 offen offset:3072 sc1
  v_mfma_f32_16x16x32_bf16 a[12:15], v[32:35], v[108:111], a[12:15]
  ds_read_b64_tr_b16 v[32:33], v16 offset:40960
  v_mfma_f32_16x16x32_bf16 a[28:31], v[36:39], v[108:111], a[28:31]
  ds_read_b64_tr_b16 v[34:35], v16 offset:41984
  v_mfma_f32_16x16x32_bf16 a[24:27], v[36:39], v[104:107], a[24:27]
  v_mfma_f32_16x16x32_bf16 a[20:23], v[36:39], v[100:103], a[20:23]
  v_mfma_f32_16x16x32_bf16 a[16:19], v[36:39], v[96:99], a[16:19]
  ds_read_b64_tr_b16 v[36:37], v17 offset:40960
  ds_read_b64_tr_b16 v[38:39], v17 offset:41984
  v_mfma_f32_16x16x32_bf16 a[32:35], v[40:43], v[96:99], a[32:35]
  s_add_u32 m0, s46, 16384
  s_mov_b32 s43, 5505024
  v_mfma_f32_16x16x32_bf16 a[36:39], v[40:43], v[100:103], a[36:39]
  buffer_load_dwordx4 v8, s[8:11], s43 offen offset:0 lds
  v_mfma_f32_16x16x32_bf16 a[40:43], v[40:43], v[104:107], a[40:43]
  v_mfma_f32_16x16x32_bf16 a[44:47], v[40:43], v[108:111], a[44:47]
  ds_read_b64_tr_b16 v[40:41], v16 offset:41216
  v_mfma_f32_16x16x32_bf16 a[60:63], v[44:47], v[108:111], a[60:63]
  ds_read_b64_tr_b16 v[42:43], v16 offset:42240
  v_mfma_f32_16x16x32_bf16 a[56:59], v[44:47], v[104:107], a[56:59]
  v_mfma_f32_16x16x32_bf16 a[52:55], v[44:47], v[100:103], a[52:55]
  v_mfma_f32_16x16x32_bf16 a[48:51], v[44:47], v[96:99], a[48:51]
  s_waitcnt lgkmcnt(15)
  v_mfma_f32_16x16x32_bf16 a[64:67], v[48:51], v[96:99], a[64:67]
  ds_read_b64_tr_b16 v[44:45], v17 offset:41216
  v_mfma_f32_16x16x32_bf16 a[68:71], v[48:51], v[100:103], a[68:71]
  ds_read_b64_tr_b16 v[46:47], v17 offset:42240
  v_mfma_f32_16x16x32_bf16 a[72:75], v[48:51], v[104:107], a[72:75]
  buffer_load_dwordx4 v[148:151], v13, s[12:15], s44 offen offset:3072 sc1
  v_mfma_f32_16x16x32_bf16 a[76:79], v[48:51], v[108:111], a[76:79]
  ds_read_b64_tr_b16 v[48:49], v16 offset:41472
  v_mfma_f32_16x16x32_bf16 a[92:95], v[52:55], v[108:111], a[92:95]
  ds_read_b64_tr_b16 v[50:51], v16 offset:42496
  v_mfma_f32_16x16x32_bf16 a[88:91], v[52:55], v[104:107], a[88:91]
  v_mfma_f32_16x16x32_bf16 a[84:87], v[52:55], v[100:103], a[84:87]
  buffer_load_dwordx4 v9, s[8:11], s43 offen offset:1024 lds
  v_mfma_f32_16x16x32_bf16 a[80:83], v[52:55], v[96:99], a[80:83]
  ds_read_b64_tr_b16 v[52:53], v17 offset:41472
  v_mfma_f32_16x16x32_bf16 a[96:99], v[56:59], v[96:99], a[96:99]
  ds_read_b64_tr_b16 v[54:55], v17 offset:42496
  v_mfma_f32_16x16x32_bf16 a[100:103], v[56:59], v[100:103], a[100:103]
  v_mfma_f32_16x16x32_bf16 a[104:107], v[56:59], v[104:107], a[104:107]
  v_mfma_f32_16x16x32_bf16 a[108:111], v[56:59], v[108:111], a[108:111]
  ds_read_b64_tr_b16 v[56:57], v16 offset:41728
  v_mfma_f32_16x16x32_bf16 a[124:127], v[60:63], v[108:111], a[124:127]
  ds_read_b64_tr_b16 v[58:59], v16 offset:42752
  v_mfma_f32_16x16x32_bf16 a[120:123], v[60:63], v[104:107], a[120:123]
  v_mfma_f32_16x16x32_bf16 a[116:119], v[60:63], v[100:103], a[116:119]
  buffer_load_dwordx4 v[152:155], v14, s[12:15], s44 offen offset:3072 sc1
  v_mfma_f32_16x16x32_bf16 a[112:115], v[60:63], v[96:99], a[112:115]
  s_waitcnt lgkmcnt(15)
  v_mfma_f32_16x16x32_bf16 v[160:163], v[64:67], v[96:99], v[160:163]
  ds_read_b64_tr_b16 v[60:61], v17 offset:41728
  v_mfma_f32_16x16x32_bf16 v[164:167], v[64:67], v[100:103], v[164:167]
  ds_read_b64_tr_b16 v[62:63], v17 offset:42752
  v_mfma_f32_16x16x32_bf16 v[168:171], v[64:67], v[104:107], v[168:171]
  v_mfma_f32_16x16x32_bf16 v[172:175], v[64:67], v[108:111], v[172:175]
  ds_read_b64_tr_b16 v[64:65], v16 offset:57344
  v_mfma_f32_16x16x32_bf16 v[188:191], v[68:71], v[108:111], v[188:191]
  ds_read_b64_tr_b16 v[66:67], v16 offset:58368
  v_mfma_f32_16x16x32_bf16 v[184:187], v[68:71], v[104:107], v[184:187]
  buffer_load_dwordx4 v10, s[8:11], s43 offen offset:2048 lds
  v_mfma_f32_16x16x32_bf16 v[180:183], v[68:71], v[100:103], v[180:183]
  v_mfma_f32_16x16x32_bf16 v[176:179], v[68:71], v[96:99], v[176:179]
  ds_read_b64_tr_b16 v[68:69], v17 offset:57344
  v_mfma_f32_16x16x32_bf16 v[192:195], v[72:75], v[96:99], v[192:195]
  ds_read_b64_tr_b16 v[70:71], v17 offset:58368
  v_mfma_f32_16x16x32_bf16 v[196:199], v[72:75], v[100:103], v[196:199]
  v_mfma_f32_16x16x32_bf16 v[200:203], v[72:75], v[104:107], v[200:203]
  v_mfma_f32_16x16x32_bf16 v[204:207], v[72:75], v[108:111], v[204:207]
  ds_read_b64_tr_b16 v[72:73], v16 offset:57600
  v_mfma_f32_16x16x32_bf16 v[220:223], v[76:79], v[108:111], v[220:223]
  ds_read_b64_tr_b16 v[74:75], v16 offset:58624
  v_mfma_f32_16x16x32_bf16 v[216:219], v[76:79], v[104:107], v[216:219]
  buffer_load_dwordx4 v[156:159], v15, s[12:15], s44 offen offset:3072 sc1
  v_mfma_f32_16x16x32_bf16 v[212:215], v[76:79], v[100:103], v[212:215]
  v_mfma_f32_16x16x32_bf16 v[208:211], v[76:79], v[96:99], v[208:211]
  s_waitcnt lgkmcnt(15)
  v_mfma_f32_16x16x32_bf16 v[224:227], v[80:83], v[96:99], v[224:227]
  ds_read_b64_tr_b16 v[76:77], v17 offset:57600
  v_mfma_f32_16x16x32_bf16 v[228:231], v[80:83], v[100:103], v[228:231]
  ds_read_b64_tr_b16 v[78:79], v17 offset:58624
  v_mfma_f32_16x16x32_bf16 v[232:235], v[80:83], v[104:107], v[232:235]
  v_mfma_f32_16x16x32_bf16 v[236:239], v[80:83], v[108:111], v[236:239]
  ds_read_b64_tr_b16 v[80:81], v16 offset:57856
  v_mfma_f32_16x16x32_bf16 a[132:135], v[84:87], v[108:111], a[132:135]
  ds_read_b64_tr_b16 v[82:83], v16 offset:58880
  v_mfma_f32_16x16x32_bf16 a[128:131], v[84:87], v[104:107], a[128:131]
  buffer_load_dwordx4 v11, s[8:11], s43 offen offset:3072 lds
  v_mfma_f32_16x16x32_bf16 v[244:247], v[84:87], v[100:103], v[244:247]
  v_mfma_f32_16x16x32_bf16 v[240:243], v[84:87], v[96:99], v[240:243]
  ds_read_b64_tr_b16 v[84:85], v17 offset:57856
  v_mfma_f32_16x16x32_bf16 a[136:139], v[88:91], v[96:99], a[136:139]
  ds_read_b64_tr_b16 v[86:87], v17 offset:58880
  v_mfma_f32_16x16x32_bf16 a[140:143], v[88:91], v[100:103], a[140:143]
  ds_read_b64_tr_b16 v[88:89], v16 offset:58112
  v_mfma_f32_16x16x32_bf16 a[148:151], v[92:95], v[100:103], a[148:151]
  ds_read_b64_tr_b16 v[90:91], v16 offset:59136
  v_mfma_f32_16x16x32_bf16 a[144:147], v[92:95], v[96:99], a[144:147]
  s_waitcnt vmcnt(17) lgkmcnt(15)
  v_mfma_f32_16x16x32_bf16 a[0:3], v[32:35], v[112:115], a[0:3]
  ds_read_b64_tr_b16 v[92:93], v17 offset:58112
  v_mfma_f32_16x16x32_bf16 a[4:7], v[32:35], v[116:119], a[4:7]
  ds_read_b64_tr_b16 v[94:95], v17 offset:59136
  v_mfma_f32_16x16x32_bf16 a[8:11], v[32:35], v[120:123], a[8:11]
  s_mov_b32 s44, 24576
  buffer_load_dwordx4 v[96:99], v12, s[12:15], s44 offen offset:0 sc1
  v_mfma_f32_16x16x32_bf16 a[12:15], v[32:35], v[124:127], a[12:15]
  v_mfma_f32_16x16x32_bf16 a[28:31], v[36:39], v[124:127], a[28:31]
  v_mfma_f32_16x16x32_bf16 a[24:27], v[36:39], v[120:123], a[24:27]
  v_mfma_f32_16x16x32_bf16 a[20:23], v[36:39], v[116:119], a[20:23]
  v_mfma_f32_16x16x32_bf16 a[16:19], v[36:39], v[112:115], a[16:19]
  v_mfma_f32_16x16x32_bf16 a[32:35], v[40:43], v[112:115], a[32:35]
  buffer_load_dwordx4 v[100:103], v13, s[12:15], s44 offen offset:0 sc1
  v_mfma_f32_16x16x32_bf16 a[36:39], v[40:43], v[116:119], a[36:39]
  v_mfma_f32_16x16x32_bf16 a[40:43], v[40:43], v[120:123], a[40:43]
  v_mfma_f32_16x16x32_bf16 a[44:47], v[40:43], v[124:127], a[44:47]
  v_mfma_f32_16x16x32_bf16 a[60:63], v[44:47], v[124:127], a[60:63]
  v_mfma_f32_16x16x32_bf16 a[56:59], v[44:47], v[120:123], a[56:59]
  v_mfma_f32_16x16x32_bf16 a[52:55], v[44:47], v[116:119], a[52:55]
  v_mfma_f32_16x16x32_bf16 a[48:51], v[44:47], v[112:115], a[48:51]
  s_waitcnt vmcnt(21) lgkmcnt(0)
  s_barrier
  s_waitcnt lgkmcnt(15)
  v_mfma_f32_16x16x32_bf16 a[64:67], v[48:51], v[112:115], a[64:67]
  ds_read_b64_tr_b16 v[32:33], v18 offset:0
  ds_read_b64_tr_b16 v[34:35], v18 offset:1024
  v_mfma_f32_16x16x32_bf16 a[68:71], v[48:51], v[116:119], a[68:71]
  ds_read_b64_tr_b16 v[36:37], v19 offset:0
  ds_read_b64_tr_b16 v[38:39], v19 offset:1024
  v_mfma_f32_16x16x32_bf16 a[72:75], v[48:51], v[120:123], a[72:75]
  ds_read_b64_tr_b16 v[40:41], v18 offset:256
  ds_read_b64_tr_b16 v[42:43], v18 offset:1280
  v_mfma_f32_16x16x32_bf16 a[76:79], v[48:51], v[124:127], a[76:79]
  ds_read_b64_tr_b16 v[44:45], v19 offset:256
  ds_read_b64_tr_b16 v[46:47], v19 offset:1280
  v_mfma_f32_16x16x32_bf16 a[92:95], v[52:55], v[124:127], a[92:95]
  ds_read_b64_tr_b16 v[48:49], v18 offset:512
  ds_read_b64_tr_b16 v[50:51], v18 offset:1536
  v_mfma_f32_16x16x32_bf16 a[88:91], v[52:55], v[120:123], a[88:91]
  s_add_u32 m0, s46, 32768
  s_mov_b32 s42, 6815744
  v_mfma_f32_16x16x32_bf16 a[84:87], v[52:55], v[116:119], a[84:87]
  buffer_load_dwordx4 v4, s[4:7], s42 offen offset:0 lds
  v_mfma_f32_16x16x32_bf16 a[80:83], v[52:55], v[112:115], a[80:83]
  ds_read_b64_tr_b16 v[52:53], v19 offset:512
  v_mfma_f32_16x16x32_bf16 a[96:99], v[56:59], v[112:115], a[96:99]
  ds_read_b64_tr_b16 v[54:55], v19 offset:1536
  v_mfma_f32_16x16x32_bf16 a[100:103], v[56:59], v[116:119], a[100:103]
  v_mfma_f32_16x16x32_bf16 a[104:107], v[56:59], v[120:123], a[104:107]
  buffer_load_dwordx4 v[104:107], v14, s[12:15], s44 offen offset:0 sc1
  v_mfma_f32_16x16x32_bf16 a[108:111], v[56:59], v[124:127], a[108:111]
  ds_read_b64_tr_b16 v[56:57], v18 offset:768
  v_mfma_f32_16x16x32_bf16 a[124:127], v[60:63], v[124:127], a[124:127]
  ds_read_b64_tr_b16 v[58:59], v18 offset:1792
  v_mfma_f32_16x16x32_bf16 a[120:123], v[60:63], v[120:123], a[120:123]
  v_mfma_f32_16x16x32_bf16 a[116:119], v[60:63], v[116:119], a[116:119]
  v_mfma_f32_16x16x32_bf16 a[112:115], v[60:63], v[112:115], a[112:115]
  s_waitcnt lgkmcnt(15)
  v_mfma_f32_16x16x32_bf16 v[160:163], v[64:67], v[112:115], v[160:163]
  ds_read_b64_tr_b16 v[60:61], v19 offset:768
  v_mfma_f32_16x16x32_bf16 v[164:167], v[64:67], v[116:119], v[164:167]
  ds_read_b64_tr_b16 v[62:63], v19 offset:1792
  v_mfma_f32_16x16x32_bf16 v[168:171], v[64:67], v[120:123], v[168:171]
  buffer_load_dwordx4 v5, s[4:7], s42 offen offset:1024 lds
  v_mfma_f32_16x16x32_bf16 v[172:175], v[64:67], v[124:127], v[172:175]
  ds_read_b64_tr_b16 v[64:65], v18 offset:16384
  v_mfma_f32_16x16x32_bf16 v[188:191], v[68:71], v[124:127], v[188:191]
  ds_read_b64_tr_b16 v[66:67], v18 offset:17408
  v_mfma_f32_16x16x32_bf16 v[184:187], v[68:71], v[120:123], v[184:187]
  v_mfma_f32_16x16x32_bf16 v[180:183], v[68:71], v[116:119], v[180:183]
  v_mfma_f32_16x16x32_bf16 v[176:179], v[68:71], v[112:115], v[176:179]
  ds_read_b64_tr_b16 v[68:69], v19 offset:16384
  v_mfma_f32_16x16x32_bf16 v[192:195], v[72:75], v[112:115], v[192:195]
  ds_read_b64_tr_b16 v[70:71], v19 offset:17408
  v_mfma_f32_16x16x32_bf16 v[196:199], v[72:75], v[116:119], v[196:199]
  buffer_load_dwordx4 v6, s[4:7], s42 offen offset:2048 lds
  v_mfma_f32_16x16x32_bf16 v[200:203], v[72:75], v[120:123], v[200:203]
  v_mfma_f32_16x16x32_bf16 v[204:207], v[72:75], v[124:127], v[204:207]
  ds_read_b64_tr_b16 v[72:73], v18 offset:16640
  v_mfma_f32_16x16x32_bf16 v[220:223], v[76:79], v[124:127], v[220:223]
  ds_read_b64_tr_b16 v[74:75], v18 offset:17664
  v_mfma_f32_16x16x32_bf16 v[216:219], v[76:79], v[120:123], v[216:219]
  v_mfma_f32_16x16x32_bf16 v[212:215], v[76:79], v[116:119], v[212:215]
  buffer_load_dwordx4 v[108:111], v15, s[12:15], s44 offen offset:0 sc1
  v_mfma_f32_16x16x32_bf16 v[208:211], v[76:79], v[112:115], v[208:211]
  s_waitcnt lgkmcnt(15)
  v_mfma_f32_16x16x32_bf16 v[224:227], v[80:83], v[112:115], v[224:227]
  ds_read_b64_tr_b16 v[76:77], v19 offset:16640
  v_mfma_f32_16x16x32_bf16 v[228:231], v[80:83], v[116:119], v[228:231]
  ds_read_b64_tr_b16 v[78:79], v19 offset:17664
  v_mfma_f32_16x16x32_bf16 v[232:235], v[80:83], v[120:123], v[232:235]
  v_mfma_f32_16x16x32_bf16 v[236:239], v[80:83], v[124:127], v[236:239]
  ds_read_b64_tr_b16 v[80:81], v18 offset:16896
  v_mfma_f32_16x16x32_bf16 a[132:135], v[84:87], v[124:127], a[132:135]
  ds_read_b64_tr_b16 v[82:83], v18 offset:17920
  v_mfma_f32_16x16x32_bf16 a[128:131], v[84:87], v[120:123], a[128:131]
  buffer_load_dwordx4 v7, s[4:7], s42 offen offset:3072 lds
  v_mfma_f32_16x16x32_bf16 v[244:247], v[84:87], v[116:119], v[244:247]
  v_mfma_f32_16x16x32_bf16 v[240:243], v[84:87], v[112:115], v[240:243]
  ds_read_b64_tr_b16 v[84:85], v19 offset:16896
  v_mfma_f32_16x16x32_bf16 a[136:139], v[88:91], v[112:115], a[136:139]
  ds_read_b64_tr_b16 v[86:87], v19 offset:17920
  v_mfma_f32_16x16x32_bf16 a[140:143], v[88:91], v[116:119], a[140:143]
  ds_read_b64_tr_b16 v[88:89], v18 offset:17152
  v_mfma_f32_16x16x32_bf16 a[148:151], v[92:95], v[116:119], a[148:151]
  ds_read_b64_tr_b16 v[90:91], v18 offset:18176
  v_mfma_f32_16x16x32_bf16 a[144:147], v[92:95], v[112:115], a[144:147]
  s_waitcnt vmcnt(17) lgkmcnt(15)
  v_mfma_f32_16x16x32_bf16 a[0:3], v[32:35], v[128:131], a[0:3]
  ds_read_b64_tr_b16 v[92:93], v19 offset:17152
  v_mfma_f32_16x16x32_bf16 a[4:7], v[32:35], v[132:135], a[4:7]
  ds_read_b64_tr_b16 v[94:95], v19 offset:18176
  v_mfma_f32_16x16x32_bf16 a[8:11], v[32:35], v[136:139], a[8:11]
  buffer_load_dwordx4 v[112:115], v12, s[12:15], s44 offen offset:1024 sc1
  v_mfma_f32_16x16x32_bf16 a[12:15], v[32:35], v[140:143], a[12:15]
  ds_read_b64_tr_b16 v[32:33], v18 offset:8192
  v_mfma_f32_16x16x32_bf16 a[28:31], v[36:39], v[140:143], a[28:31]
  ds_read_b64_tr_b16 v[34:35], v18 offset:9216
  v_mfma_f32_16x16x32_bf16 a[24:27], v[36:39], v[136:139], a[24:27]
  v_mfma_f32_16x16x32_bf16 a[20:23], v[36:39], v[132:135], a[20:23]
  v_mfma_f32_16x16x32_bf16 a[16:19], v[36:39], v[128:131], a[16:19]
  ds_read_b64_tr_b16 v[36:37], v19 offset:8192
  ds_read_b64_tr_b16 v[38:39], v19 offset:9216
  v_mfma_f32_16x16x32_bf16 a[32:35], v[40:43], v[128:131], a[32:35]
  s_add_u32 m0, s46, 49152
  s_mov_b32 s43, 5963776
  v_mfma_f32_16x16x32_bf16 a[36:39], v[40:43], v[132:135], a[36:39]
  buffer_load_dwordx4 v8, s[8:11], s43 offen offset:0 lds
  v_mfma_f32_16x16x32_bf16 a[40:43], v[40:43], v[136:139], a[40:43]
  v_mfma_f32_16x16x32_bf16 a[44:47], v[40:43], v[140:143], a[44:47]
  ds_read_b64_tr_b16 v[40:41], v18 offset:8448
  v_mfma_f32_16x16x32_bf16 a[60:63], v[44:47], v[140:143], a[60:63]
  ds_read_b64_tr_b16 v[42:43], v18 offset:9472
  v_mfma_f32_16x16x32_bf16 a[56:59], v[44:47], v[136:139], a[56:59]
  v_mfma_f32_16x16x32_bf16 a[52:55], v[44:47], v[132:135], a[52:55]
  v_mfma_f32_16x16x32_bf16 a[48:51], v[44:47], v[128:131], a[48:51]
  s_waitcnt lgkmcnt(15)
  v_mfma_f32_16x16x32_bf16 a[64:67], v[48:51], v[128:131], a[64:67]
  ds_read_b64_tr_b16 v[44:45], v19 offset:8448
  v_mfma_f32_16x16x32_bf16 a[68:71], v[48:51], v[132:135], a[68:71]
  ds_read_b64_tr_b16 v[46:47], v19 offset:9472
  v_mfma_f32_16x16x32_bf16 a[72:75], v[48:51], v[136:139], a[72:75]
  buffer_load_dwordx4 v[116:119], v13, s[12:15], s44 offen offset:1024 sc1
  v_mfma_f32_16x16x32_bf16 a[76:79], v[48:51], v[140:143], a[76:79]
  ds_read_b64_tr_b16 v[48:49], v18 offset:8704
  v_mfma_f32_16x16x32_bf16 a[92:95], v[52:55], v[140:143], a[92:95]
  ds_read_b64_tr_b16 v[50:51], v18 offset:9728
  v_mfma_f32_16x16x32_bf16 a[88:91], v[52:55], v[136:139], a[88:91]
  v_mfma_f32_16x16x32_bf16 a[84:87], v[52:55], v[132:135], a[84:87]
  buffer_load_dwordx4 v9, s[8:11], s43 offen offset:1024 lds
  v_mfma_f32_16x16x32_bf16 a[80:83], v[52:55], v[128:131], a[80:83]
  ds_read_b64_tr_b16 v[52:53], v19 offset:8704
  v_mfma_f32_16x16x32_bf16 a[96:99], v[56:59], v[128:131], a[96:99]
  ds_read_b64_tr_b16 v[54:55], v19 offset:9728
  v_mfma_f32_16x16x32_bf16 a[100:103], v[56:59], v[132:135], a[100:103]
  v_mfma_f32_16x16x32_bf16 a[104:107], v[56:59], v[136:139], a[104:107]
  v_mfma_f32_16x16x32_bf16 a[108:111], v[56:59], v[140:143], a[108:111]
  ds_read_b64_tr_b16 v[56:57], v18 offset:8960
  v_mfma_f32_16x16x32_bf16 a[124:127], v[60:63], v[140:143], a[124:127]
  ds_read_b64_tr_b16 v[58:59], v18 offset:9984
  v_mfma_f32_16x16x32_bf16 a[120:123], v[60:63], v[136:139], a[120:123]
  v_mfma_f32_16x16x32_bf16 a[116:119], v[60:63], v[132:135], a[116:119]
  buffer_load_dwordx4 v[120:123], v14, s[12:15], s44 offen offset:1024 sc1
  v_mfma_f32_16x16x32_bf16 a[112:115], v[60:63], v[128:131], a[112:115]
  s_waitcnt lgkmcnt(15)
  v_mfma_f32_16x16x32_bf16 v[160:163], v[64:67], v[128:131], v[160:163]
  ds_read_b64_tr_b16 v[60:61], v19 offset:8960
  v_mfma_f32_16x16x32_bf16 v[164:167], v[64:67], v[132:135], v[164:167]
  ds_read_b64_tr_b16 v[62:63], v19 offset:9984
  v_mfma_f32_16x16x32_bf16 v[168:171], v[64:67], v[136:139], v[168:171]
  v_mfma_f32_16x16x32_bf16 v[172:175], v[64:67], v[140:143], v[172:175]
  ds_read_b64_tr_b16 v[64:65], v18 offset:24576
  v_mfma_f32_16x16x32_bf16 v[188:191], v[68:71], v[140:143], v[188:191]
  ds_read_b64_tr_b16 v[66:67], v18 offset:25600
  v_mfma_f32_16x16x32_bf16 v[184:187], v[68:71], v[136:139], v[184:187]
  buffer_load_dwordx4 v10, s[8:11], s43 offen offset:2048 lds
  v_mfma_f32_16x16x32_bf16 v[180:183], v[68:71], v[132:135], v[180:183]
  v_mfma_f32_16x16x32_bf16 v[176:179], v[68:71], v[128:131], v[176:179]
  ds_read_b64_tr_b16 v[68:69], v19 offset:24576
  v_mfma_f32_16x16x32_bf16 v[192:195], v[72:75], v[128:131], v[192:195]
  ds_read_b64_tr_b16 v[70:71], v19 offset:25600
  v_mfma_f32_16x16x32_bf16 v[196:199], v[72:75], v[132:135], v[196:199]
  v_mfma_f32_16x16x32_bf16 v[200:203], v[72:75], v[136:139], v[200:203]
  v_mfma_f32_16x16x32_bf16 v[204:207], v[72:75], v[140:143], v[204:207]
  ds_read_b64_tr_b16 v[72:73], v18 offset:24832
  v_mfma_f32_16x16x32_bf16 v[220:223], v[76:79], v[140:143], v[220:223]
  ds_read_b64_tr_b16 v[74:75], v18 offset:25856
  v_mfma_f32_16x16x32_bf16 v[216:219], v[76:79], v[136:139], v[216:219]
  buffer_load_dwordx4 v[124:127], v15, s[12:15], s44 offen offset:1024 sc1
  v_mfma_f32_16x16x32_bf16 v[212:215], v[76:79], v[132:135], v[212:215]
  v_mfma_f32_16x16x32_bf16 v[208:211], v[76:79], v[128:131], v[208:211]
  s_waitcnt lgkmcnt(15)
  v_mfma_f32_16x16x32_bf16 v[224:227], v[80:83], v[128:131], v[224:227]
  ds_read_b64_tr_b16 v[76:77], v19 offset:24832
  v_mfma_f32_16x16x32_bf16 v[228:231], v[80:83], v[132:135], v[228:231]
  ds_read_b64_tr_b16 v[78:79], v19 offset:25856
  v_mfma_f32_16x16x32_bf16 v[232:235], v[80:83], v[136:139], v[232:235]
  v_mfma_f32_16x16x32_bf16 v[236:239], v[80:83], v[140:143], v[236:239]
  ds_read_b64_tr_b16 v[80:81], v18 offset:25088
  v_mfma_f32_16x16x32_bf16 a[132:135], v[84:87], v[140:143], a[132:135]
  ds_read_b64_tr_b16 v[82:83], v18 offset:26112
  v_mfma_f32_16x16x32_bf16 a[128:131], v[84:87], v[136:139], a[128:131]
  buffer_load_dwordx4 v11, s[8:11], s43 offen offset:3072 lds
  v_mfma_f32_16x16x32_bf16 v[244:247], v[84:87], v[132:135], v[244:247]
  v_mfma_f32_16x16x32_bf16 v[240:243], v[84:87], v[128:131], v[240:243]
  ds_read_b64_tr_b16 v[84:85], v19 offset:25088
  v_mfma_f32_16x16x32_bf16 a[136:139], v[88:91], v[128:131], a[136:139]
  ds_read_b64_tr_b16 v[86:87], v19 offset:26112
  v_mfma_f32_16x16x32_bf16 a[140:143], v[88:91], v[132:135], a[140:143]
  ds_read_b64_tr_b16 v[88:89], v18 offset:25344
  v_mfma_f32_16x16x32_bf16 a[148:151], v[92:95], v[132:135], a[148:151]
  ds_read_b64_tr_b16 v[90:91], v18 offset:26368
  v_mfma_f32_16x16x32_bf16 a[144:147], v[92:95], v[128:131], a[144:147]
  s_waitcnt vmcnt(17) lgkmcnt(15)
  v_mfma_f32_16x16x32_bf16 a[0:3], v[32:35], v[144:147], a[0:3]
  ds_read_b64_tr_b16 v[92:93], v19 offset:25344
  v_mfma_f32_16x16x32_bf16 a[4:7], v[32:35], v[148:151], a[4:7]
  ds_read_b64_tr_b16 v[94:95], v19 offset:26368
  v_mfma_f32_16x16x32_bf16 a[8:11], v[32:35], v[152:155], a[8:11]
  buffer_load_dwordx4 v[128:131], v12, s[12:15], s44 offen offset:2048 sc1
  v_mfma_f32_16x16x32_bf16 a[12:15], v[32:35], v[156:159], a[12:15]
  v_mfma_f32_16x16x32_bf16 a[28:31], v[36:39], v[156:159], a[28:31]
  v_mfma_f32_16x16x32_bf16 a[24:27], v[36:39], v[152:155], a[24:27]
  v_mfma_f32_16x16x32_bf16 a[20:23], v[36:39], v[148:151], a[20:23]
  v_mfma_f32_16x16x32_bf16 a[16:19], v[36:39], v[144:147], a[16:19]
  v_mfma_f32_16x16x32_bf16 a[32:35], v[40:43], v[144:147], a[32:35]
  buffer_load_dwordx4 v[132:135], v13, s[12:15], s44 offen offset:2048 sc1
  v_mfma_f32_16x16x32_bf16 a[36:39], v[40:43], v[148:151], a[36:39]
  v_mfma_f32_16x16x32_bf16 a[40:43], v[40:43], v[152:155], a[40:43]
  v_mfma_f32_16x16x32_bf16 a[44:47], v[40:43], v[156:159], a[44:47]
  v_mfma_f32_16x16x32_bf16 a[60:63], v[44:47], v[156:159], a[60:63]
  v_mfma_f32_16x16x32_bf16 a[56:59], v[44:47], v[152:155], a[56:59]
  v_mfma_f32_16x16x32_bf16 a[52:55], v[44:47], v[148:151], a[52:55]
  v_mfma_f32_16x16x32_bf16 a[48:51], v[44:47], v[144:147], a[48:51]
  s_waitcnt vmcnt(18) lgkmcnt(0)
  s_barrier
  s_waitcnt lgkmcnt(15)
  v_mfma_f32_16x16x32_bf16 a[64:67], v[48:51], v[144:147], a[64:67]
  ds_read_b64_tr_b16 v[32:33], v16 offset:0
  ds_read_b64_tr_b16 v[34:35], v16 offset:1024
  v_mfma_f32_16x16x32_bf16 a[68:71], v[48:51], v[148:151], a[68:71]
  ds_read_b64_tr_b16 v[36:37], v17 offset:0
  ds_read_b64_tr_b16 v[38:39], v17 offset:1024
  v_mfma_f32_16x16x32_bf16 a[72:75], v[48:51], v[152:155], a[72:75]
  ds_read_b64_tr_b16 v[40:41], v16 offset:256
  ds_read_b64_tr_b16 v[42:43], v16 offset:1280
  v_mfma_f32_16x16x32_bf16 a[76:79], v[48:51], v[156:159], a[76:79]
  ds_read_b64_tr_b16 v[44:45], v17 offset:256
  ds_read_b64_tr_b16 v[46:47], v17 offset:1280
  v_mfma_f32_16x16x32_bf16 a[92:95], v[52:55], v[156:159], a[92:95]
  ds_read_b64_tr_b16 v[48:49], v16 offset:512
  ds_read_b64_tr_b16 v[50:51], v16 offset:1536
  v_mfma_f32_16x16x32_bf16 a[88:91], v[52:55], v[152:155], a[88:91]
  s_add_u32 m0, s46, 65536
  s_mov_b32 s42, 7340032
  v_mfma_f32_16x16x32_bf16 a[84:87], v[52:55], v[148:151], a[84:87]
  buffer_load_dwordx4 v4, s[4:7], s42 offen offset:0 lds
  v_mfma_f32_16x16x32_bf16 a[80:83], v[52:55], v[144:147], a[80:83]
  ds_read_b64_tr_b16 v[52:53], v17 offset:512
  v_mfma_f32_16x16x32_bf16 a[96:99], v[56:59], v[144:147], a[96:99]
  ds_read_b64_tr_b16 v[54:55], v17 offset:1536
  v_mfma_f32_16x16x32_bf16 a[100:103], v[56:59], v[148:151], a[100:103]
  v_mfma_f32_16x16x32_bf16 a[104:107], v[56:59], v[152:155], a[104:107]
  buffer_load_dwordx4 v[136:139], v14, s[12:15], s44 offen offset:2048 sc1
  v_mfma_f32_16x16x32_bf16 a[108:111], v[56:59], v[156:159], a[108:111]
  ds_read_b64_tr_b16 v[56:57], v16 offset:768
  v_mfma_f32_16x16x32_bf16 a[124:127], v[60:63], v[156:159], a[124:127]
  ds_read_b64_tr_b16 v[58:59], v16 offset:1792
  v_mfma_f32_16x16x32_bf16 a[120:123], v[60:63], v[152:155], a[120:123]
  v_mfma_f32_16x16x32_bf16 a[116:119], v[60:63], v[148:151], a[116:119]
  v_mfma_f32_16x16x32_bf16 a[112:115], v[60:63], v[144:147], a[112:115]
  s_waitcnt lgkmcnt(15)
  v_mfma_f32_16x16x32_bf16 v[160:163], v[64:67], v[144:147], v[160:163]
  ds_read_b64_tr_b16 v[60:61], v17 offset:768
  v_mfma_f32_16x16x32_bf16 v[164:167], v[64:67], v[148:151], v[164:167]
  ds_read_b64_tr_b16 v[62:63], v17 offset:1792
  v_mfma_f32_16x16x32_bf16 v[168:171], v[64:67], v[152:155], v[168:171]
  buffer_load_dwordx4 v5, s[4:7], s42 offen offset:1024 lds
  v_mfma_f32_16x16x32_bf16 v[172:175], v[64:67], v[156:159], v[172:175]
  ds_read_b64_tr_b16 v[64:65], v16 offset:16384
  v_mfma_f32_16x16x32_bf16 v[188:191], v[68:71], v[156:159], v[188:191]
  ds_read_b64_tr_b16 v[66:67], v16 offset:17408
  v_mfma_f32_16x16x32_bf16 v[184:187], v[68:71], v[152:155], v[184:187]
  v_mfma_f32_16x16x32_bf16 v[180:183], v[68:71], v[148:151], v[180:183]
  v_mfma_f32_16x16x32_bf16 v[176:179], v[68:71], v[144:147], v[176:179]
  ds_read_b64_tr_b16 v[68:69], v17 offset:16384
  v_mfma_f32_16x16x32_bf16 v[192:195], v[72:75], v[144:147], v[192:195]
  ds_read_b64_tr_b16 v[70:71], v17 offset:17408
  v_mfma_f32_16x16x32_bf16 v[196:199], v[72:75], v[148:151], v[196:199]
  buffer_load_dwordx4 v6, s[4:7], s42 offen offset:2048 lds
  v_mfma_f32_16x16x32_bf16 v[200:203], v[72:75], v[152:155], v[200:203]
  v_mfma_f32_16x16x32_bf16 v[204:207], v[72:75], v[156:159], v[204:207]
  ds_read_b64_tr_b16 v[72:73], v16 offset:16640
  v_mfma_f32_16x16x32_bf16 v[220:223], v[76:79], v[156:159], v[220:223]
  ds_read_b64_tr_b16 v[74:75], v16 offset:17664
  v_mfma_f32_16x16x32_bf16 v[216:219], v[76:79], v[152:155], v[216:219]
  v_mfma_f32_16x16x32_bf16 v[212:215], v[76:79], v[148:151], v[212:215]
  buffer_load_dwordx4 v[140:143], v15, s[12:15], s44 offen offset:2048 sc1
  v_mfma_f32_16x16x32_bf16 v[208:211], v[76:79], v[144:147], v[208:211]
  s_waitcnt lgkmcnt(15)
  v_mfma_f32_16x16x32_bf16 v[224:227], v[80:83], v[144:147], v[224:227]
  ds_read_b64_tr_b16 v[76:77], v17 offset:16640
  v_mfma_f32_16x16x32_bf16 v[228:231], v[80:83], v[148:151], v[228:231]
  ds_read_b64_tr_b16 v[78:79], v17 offset:17664
  v_mfma_f32_16x16x32_bf16 v[232:235], v[80:83], v[152:155], v[232:235]
  v_mfma_f32_16x16x32_bf16 v[236:239], v[80:83], v[156:159], v[236:239]
  ds_read_b64_tr_b16 v[80:81], v16 offset:16896
  v_mfma_f32_16x16x32_bf16 a[132:135], v[84:87], v[156:159], a[132:135]
  ds_read_b64_tr_b16 v[82:83], v16 offset:17920
  v_mfma_f32_16x16x32_bf16 a[128:131], v[84:87], v[152:155], a[128:131]
  buffer_load_dwordx4 v7, s[4:7], s42 offen offset:3072 lds
  v_mfma_f32_16x16x32_bf16 v[244:247], v[84:87], v[148:151], v[244:247]
  v_mfma_f32_16x16x32_bf16 v[240:243], v[84:87], v[144:147], v[240:243]
  ds_read_b64_tr_b16 v[84:85], v17 offset:16896
  v_mfma_f32_16x16x32_bf16 a[136:139], v[88:91], v[144:147], a[136:139]
  ds_read_b64_tr_b16 v[86:87], v17 offset:17920
  v_mfma_f32_16x16x32_bf16 a[140:143], v[88:91], v[148:151], a[140:143]
  ds_read_b64_tr_b16 v[88:89], v16 offset:17152
  v_mfma_f32_16x16x32_bf16 a[148:151], v[92:95], v[148:151], a[148:151]
  ds_read_b64_tr_b16 v[90:91], v16 offset:18176
  v_mfma_f32_16x16x32_bf16 a[144:147], v[92:95], v[144:147], a[144:147]
  s_waitcnt vmcnt(17) lgkmcnt(15)
  v_mfma_f32_16x16x32_bf16 a[0:3], v[32:35], v[96:99], a[0:3]
  ds_read_b64_tr_b16 v[92:93], v17 offset:17152
  v_mfma_f32_16x16x32_bf16 a[4:7], v[32:35], v[100:103], a[4:7]
  ds_read_b64_tr_b16 v[94:95], v17 offset:18176
  v_mfma_f32_16x16x32_bf16 a[8:11], v[32:35], v[104:107], a[8:11]
  buffer_load_dwordx4 v[144:147], v12, s[12:15], s44 offen offset:3072 sc1
  v_mfma_f32_16x16x32_bf16 a[12:15], v[32:35], v[108:111], a[12:15]
  ds_read_b64_tr_b16 v[32:33], v16 offset:8192
  v_mfma_f32_16x16x32_bf16 a[28:31], v[36:39], v[108:111], a[28:31]
  ds_read_b64_tr_b16 v[34:35], v16 offset:9216
  v_mfma_f32_16x16x32_bf16 a[24:27], v[36:39], v[104:107], a[24:27]
  v_mfma_f32_16x16x32_bf16 a[20:23], v[36:39], v[100:103], a[20:23]
  v_mfma_f32_16x16x32_bf16 a[16:19], v[36:39], v[96:99], a[16:19]
  ds_read_b64_tr_b16 v[36:37], v17 offset:8192
  ds_read_b64_tr_b16 v[38:39], v17 offset:9216
  v_mfma_f32_16x16x32_bf16 a[32:35], v[40:43], v[96:99], a[32:35]
  s_add_u32 m0, s46, 81920
  s_mov_b32 s43, 6422528
  v_mfma_f32_16x16x32_bf16 a[36:39], v[40:43], v[100:103], a[36:39]
  buffer_load_dwordx4 v8, s[8:11], s43 offen offset:0 lds
  v_mfma_f32_16x16x32_bf16 a[40:43], v[40:43], v[104:107], a[40:43]
  v_mfma_f32_16x16x32_bf16 a[44:47], v[40:43], v[108:111], a[44:47]
  ds_read_b64_tr_b16 v[40:41], v16 offset:8448
  v_mfma_f32_16x16x32_bf16 a[60:63], v[44:47], v[108:111], a[60:63]
  ds_read_b64_tr_b16 v[42:43], v16 offset:9472
  v_mfma_f32_16x16x32_bf16 a[56:59], v[44:47], v[104:107], a[56:59]
  v_mfma_f32_16x16x32_bf16 a[52:55], v[44:47], v[100:103], a[52:55]
  v_mfma_f32_16x16x32_bf16 a[48:51], v[44:47], v[96:99], a[48:51]
  s_waitcnt lgkmcnt(15)
  v_mfma_f32_16x16x32_bf16 a[64:67], v[48:51], v[96:99], a[64:67]
  ds_read_b64_tr_b16 v[44:45], v17 offset:8448
  v_mfma_f32_16x16x32_bf16 a[68:71], v[48:51], v[100:103], a[68:71]
  ds_read_b64_tr_b16 v[46:47], v17 offset:9472
  v_mfma_f32_16x16x32_bf16 a[72:75], v[48:51], v[104:107], a[72:75]
  buffer_load_dwordx4 v[148:151], v13, s[12:15], s44 offen offset:3072 sc1
  v_mfma_f32_16x16x32_bf16 a[76:79], v[48:51], v[108:111], a[76:79]
  ds_read_b64_tr_b16 v[48:49], v16 offset:8704
  v_mfma_f32_16x16x32_bf16 a[92:95], v[52:55], v[108:111], a[92:95]
  ds_read_b64_tr_b16 v[50:51], v16 offset:9728
  v_mfma_f32_16x16x32_bf16 a[88:91], v[52:55], v[104:107], a[88:91]
  v_mfma_f32_16x16x32_bf16 a[84:87], v[52:55], v[100:103], a[84:87]
  buffer_load_dwordx4 v9, s[8:11], s43 offen offset:1024 lds
  v_mfma_f32_16x16x32_bf16 a[80:83], v[52:55], v[96:99], a[80:83]
  ds_read_b64_tr_b16 v[52:53], v17 offset:8704
  v_mfma_f32_16x16x32_bf16 a[96:99], v[56:59], v[96:99], a[96:99]
  ds_read_b64_tr_b16 v[54:55], v17 offset:9728
  v_mfma_f32_16x16x32_bf16 a[100:103], v[56:59], v[100:103], a[100:103]
  v_mfma_f32_16x16x32_bf16 a[104:107], v[56:59], v[104:107], a[104:107]
  v_mfma_f32_16x16x32_bf16 a[108:111], v[56:59], v[108:111], a[108:111]
  ds_read_b64_tr_b16 v[56:57], v16 offset:8960
  v_mfma_f32_16x16x32_bf16 a[124:127], v[60:63], v[108:111], a[124:127]
  ds_read_b64_tr_b16 v[58:59], v16 offset:9984
  v_mfma_f32_16x16x32_bf16 a[120:123], v[60:63], v[104:107], a[120:123]
  v_mfma_f32_16x16x32_bf16 a[116:119], v[60:63], v[100:103], a[116:119]
  buffer_load_dwordx4 v[152:155], v14, s[12:15], s44 offen offset:3072 sc1
  v_mfma_f32_16x16x32_bf16 a[112:115], v[60:63], v[96:99], a[112:115]
  s_waitcnt lgkmcnt(15)
  v_mfma_f32_16x16x32_bf16 v[160:163], v[64:67], v[96:99], v[160:163]
  ds_read_b64_tr_b16 v[60:61], v17 offset:8960
  v_mfma_f32_16x16x32_bf16 v[164:167], v[64:67], v[100:103], v[164:167]
  ds_read_b64_tr_b16 v[62:63], v17 offset:9984
  v_mfma_f32_16x16x32_bf16 v[168:171], v[64:67], v[104:107], v[168:171]
  v_mfma_f32_16x16x32_bf16 v[172:175], v[64:67], v[108:111], v[172:175]
  ds_read_b64_tr_b16 v[64:65], v16 offset:24576
  v_mfma_f32_16x16x32_bf16 v[188:191], v[68:71], v[108:111], v[188:191]
  ds_read_b64_tr_b16 v[66:67], v16 offset:25600
  v_mfma_f32_16x16x32_bf16 v[184:187], v[68:71], v[104:107], v[184:187]
  buffer_load_dwordx4 v10, s[8:11], s43 offen offset:2048 lds
  v_mfma_f32_16x16x32_bf16 v[180:183], v[68:71], v[100:103], v[180:183]
  v_mfma_f32_16x16x32_bf16 v[176:179], v[68:71], v[96:99], v[176:179]
  ds_read_b64_tr_b16 v[68:69], v17 offset:24576
  v_mfma_f32_16x16x32_bf16 v[192:195], v[72:75], v[96:99], v[192:195]
  ds_read_b64_tr_b16 v[70:71], v17 offset:25600
  v_mfma_f32_16x16x32_bf16 v[196:199], v[72:75], v[100:103], v[196:199]
  v_mfma_f32_16x16x32_bf16 v[200:203], v[72:75], v[104:107], v[200:203]
  v_mfma_f32_16x16x32_bf16 v[204:207], v[72:75], v[108:111], v[204:207]
  ds_read_b64_tr_b16 v[72:73], v16 offset:24832
  v_mfma_f32_16x16x32_bf16 v[220:223], v[76:79], v[108:111], v[220:223]
  ds_read_b64_tr_b16 v[74:75], v16 offset:25856
  v_mfma_f32_16x16x32_bf16 v[216:219], v[76:79], v[104:107], v[216:219]
  buffer_load_dwordx4 v[156:159], v15, s[12:15], s44 offen offset:3072 sc1
  v_mfma_f32_16x16x32_bf16 v[212:215], v[76:79], v[100:103], v[212:215]
  v_mfma_f32_16x16x32_bf16 v[208:211], v[76:79], v[96:99], v[208:211]
  s_waitcnt lgkmcnt(15)
  v_mfma_f32_16x16x32_bf16 v[224:227], v[80:83], v[96:99], v[224:227]
  ds_read_b64_tr_b16 v[76:77], v17 offset:24832
  v_mfma_f32_16x16x32_bf16 v[228:231], v[80:83], v[100:103], v[228:231]
  ds_read_b64_tr_b16 v[78:79], v17 offset:25856
  v_mfma_f32_16x16x32_bf16 v[232:235], v[80:83], v[104:107], v[232:235]
  v_mfma_f32_16x16x32_bf16 v[236:239], v[80:83], v[108:111], v[236:239]
  ds_read_b64_tr_b16 v[80:81], v16 offset:25088
  v_mfma_f32_16x16x32_bf16 a[132:135], v[84:87], v[108:111], a[132:135]
  ds_read_b64_tr_b16 v[82:83], v16 offset:26112
  v_mfma_f32_16x16x32_bf16 a[128:131], v[84:87], v[104:107], a[128:131]
  buffer_load_dwordx4 v11, s[8:11], s43 offen offset:3072 lds
  v_mfma_f32_16x16x32_bf16 v[244:247], v[84:87], v[100:103], v[244:247]
  v_mfma_f32_16x16x32_bf16 v[240:243], v[84:87], v[96:99], v[240:243]
  ds_read_b64_tr_b16 v[84:85], v17 offset:25088
  v_mfma_f32_16x16x32_bf16 a[136:139], v[88:91], v[96:99], a[136:139]
  ds_read_b64_tr_b16 v[86:87], v17 offset:26112
  v_mfma_f32_16x16x32_bf16 a[140:143], v[88:91], v[100:103], a[140:143]
  ds_read_b64_tr_b16 v[88:89], v16 offset:25344
  v_mfma_f32_16x16x32_bf16 a[148:151], v[92:95], v[100:103], a[148:151]
  ds_read_b64_tr_b16 v[90:91], v16 offset:26368
  v_mfma_f32_16x16x32_bf16 a[144:147], v[92:95], v[96:99], a[144:147]
  s_waitcnt vmcnt(17) lgkmcnt(15)
  v_mfma_f32_16x16x32_bf16 a[0:3], v[32:35], v[112:115], a[0:3]
  ds_read_b64_tr_b16 v[92:93], v17 offset:25344
  v_mfma_f32_16x16x32_bf16 a[4:7], v[32:35], v[116:119], a[4:7]
  ds_read_b64_tr_b16 v[94:95], v17 offset:26368
  v_mfma_f32_16x16x32_bf16 a[8:11], v[32:35], v[120:123], a[8:11]
  s_mov_b32 s44, 28672
  buffer_load_dwordx4 v[96:99], v12, s[12:15], s44 offen offset:0 sc1
  v_mfma_f32_16x16x32_bf16 a[12:15], v[32:35], v[124:127], a[12:15]
  v_mfma_f32_16x16x32_bf16 a[28:31], v[36:39], v[124:127], a[28:31]
  v_mfma_f32_16x16x32_bf16 a[24:27], v[36:39], v[120:123], a[24:27]
  v_mfma_f32_16x16x32_bf16 a[20:23], v[36:39], v[116:119], a[20:23]
  v_mfma_f32_16x16x32_bf16 a[16:19], v[36:39], v[112:115], a[16:19]
  v_mfma_f32_16x16x32_bf16 a[32:35], v[40:43], v[112:115], a[32:35]
  buffer_load_dwordx4 v[100:103], v13, s[12:15], s44 offen offset:0 sc1
  v_mfma_f32_16x16x32_bf16 a[36:39], v[40:43], v[116:119], a[36:39]
  v_mfma_f32_16x16x32_bf16 a[40:43], v[40:43], v[120:123], a[40:43]
  v_mfma_f32_16x16x32_bf16 a[44:47], v[40:43], v[124:127], a[44:47]
  v_mfma_f32_16x16x32_bf16 a[60:63], v[44:47], v[124:127], a[60:63]
  v_mfma_f32_16x16x32_bf16 a[56:59], v[44:47], v[120:123], a[56:59]
  v_mfma_f32_16x16x32_bf16 a[52:55], v[44:47], v[116:119], a[52:55]
  v_mfma_f32_16x16x32_bf16 a[48:51], v[44:47], v[112:115], a[48:51]
  s_waitcnt vmcnt(18) lgkmcnt(0)
  s_barrier
  s_waitcnt lgkmcnt(15)
  v_mfma_f32_16x16x32_bf16 a[64:67], v[48:51], v[112:115], a[64:67]
  ds_read_b64_tr_b16 v[32:33], v16 offset:32768
  ds_read_b64_tr_b16 v[34:35], v16 offset:33792
  v_mfma_f32_16x16x32_bf16 a[68:71], v[48:51], v[116:119], a[68:71]
  ds_read_b64_tr_b16 v[36:37], v17 offset:32768
  ds_read_b64_tr_b16 v[38:39], v17 offset:33792
  v_mfma_f32_16x16x32_bf16 a[72:75], v[48:51], v[120:123], a[72:75]
  ds_read_b64_tr_b16 v[40:41], v16 offset:33024
  ds_read_b64_tr_b16 v[42:43], v16 offset:34048
  v_mfma_f32_16x16x32_bf16 a[76:79], v[48:51], v[124:127], a[76:79]
  ds_read_b64_tr_b16 v[44:45], v17 offset:33024
  ds_read_b64_tr_b16 v[46:47], v17 offset:34048
  v_mfma_f32_16x16x32_bf16 a[92:95], v[52:55], v[124:127], a[92:95]
  ds_read_b64_tr_b16 v[48:49], v16 offset:33280
  ds_read_b64_tr_b16 v[50:51], v16 offset:34304
  v_mfma_f32_16x16x32_bf16 a[88:91], v[52:55], v[120:123], a[88:91]
  s_add_u32 m0, s46, 0
  s_mov_b32 s42, 7864320
  v_mfma_f32_16x16x32_bf16 a[84:87], v[52:55], v[116:119], a[84:87]
  buffer_load_dwordx4 v4, s[4:7], s42 offen offset:0 lds
  v_mfma_f32_16x16x32_bf16 a[80:83], v[52:55], v[112:115], a[80:83]
  ds_read_b64_tr_b16 v[52:53], v17 offset:33280
  v_mfma_f32_16x16x32_bf16 a[96:99], v[56:59], v[112:115], a[96:99]
  ds_read_b64_tr_b16 v[54:55], v17 offset:34304
  v_mfma_f32_16x16x32_bf16 a[100:103], v[56:59], v[116:119], a[100:103]
  v_mfma_f32_16x16x32_bf16 a[104:107], v[56:59], v[120:123], a[104:107]
  buffer_load_dwordx4 v[104:107], v14, s[12:15], s44 offen offset:0 sc1
  v_mfma_f32_16x16x32_bf16 a[108:111], v[56:59], v[124:127], a[108:111]
  ds_read_b64_tr_b16 v[56:57], v16 offset:33536
  v_mfma_f32_16x16x32_bf16 a[124:127], v[60:63], v[124:127], a[124:127]
  ds_read_b64_tr_b16 v[58:59], v16 offset:34560
  v_mfma_f32_16x16x32_bf16 a[120:123], v[60:63], v[120:123], a[120:123]
  v_mfma_f32_16x16x32_bf16 a[116:119], v[60:63], v[116:119], a[116:119]
  v_mfma_f32_16x16x32_bf16 a[112:115], v[60:63], v[112:115], a[112:115]
  s_waitcnt lgkmcnt(15)
  v_mfma_f32_16x16x32_bf16 v[160:163], v[64:67], v[112:115], v[160:163]
  ds_read_b64_tr_b16 v[60:61], v17 offset:33536
  v_mfma_f32_16x16x32_bf16 v[164:167], v[64:67], v[116:119], v[164:167]
  ds_read_b64_tr_b16 v[62:63], v17 offset:34560
  v_mfma_f32_16x16x32_bf16 v[168:171], v[64:67], v[120:123], v[168:171]
  buffer_load_dwordx4 v5, s[4:7], s42 offen offset:1024 lds
  v_mfma_f32_16x16x32_bf16 v[172:175], v[64:67], v[124:127], v[172:175]
  ds_read_b64_tr_b16 v[64:65], v16 offset:49152
  v_mfma_f32_16x16x32_bf16 v[188:191], v[68:71], v[124:127], v[188:191]
  ds_read_b64_tr_b16 v[66:67], v16 offset:50176
  v_mfma_f32_16x16x32_bf16 v[184:187], v[68:71], v[120:123], v[184:187]
  v_mfma_f32_16x16x32_bf16 v[180:183], v[68:71], v[116:119], v[180:183]
  v_mfma_f32_16x16x32_bf16 v[176:179], v[68:71], v[112:115], v[176:179]
  ds_read_b64_tr_b16 v[68:69], v17 offset:49152
  v_mfma_f32_16x16x32_bf16 v[192:195], v[72:75], v[112:115], v[192:195]
  ds_read_b64_tr_b16 v[70:71], v17 offset:50176
  v_mfma_f32_16x16x32_bf16 v[196:199], v[72:75], v[116:119], v[196:199]
  buffer_load_dwordx4 v6, s[4:7], s42 offen offset:2048 lds
  v_mfma_f32_16x16x32_bf16 v[200:203], v[72:75], v[120:123], v[200:203]
  v_mfma_f32_16x16x32_bf16 v[204:207], v[72:75], v[124:127], v[204:207]
  ds_read_b64_tr_b16 v[72:73], v16 offset:49408
  v_mfma_f32_16x16x32_bf16 v[220:223], v[76:79], v[124:127], v[220:223]
  ds_read_b64_tr_b16 v[74:75], v16 offset:50432
  v_mfma_f32_16x16x32_bf16 v[216:219], v[76:79], v[120:123], v[216:219]
  v_mfma_f32_16x16x32_bf16 v[212:215], v[76:79], v[116:119], v[212:215]
  buffer_load_dwordx4 v[108:111], v15, s[12:15], s44 offen offset:0 sc1
  v_mfma_f32_16x16x32_bf16 v[208:211], v[76:79], v[112:115], v[208:211]
  s_waitcnt lgkmcnt(15)
  v_mfma_f32_16x16x32_bf16 v[224:227], v[80:83], v[112:115], v[224:227]
  ds_read_b64_tr_b16 v[76:77], v17 offset:49408
  v_mfma_f32_16x16x32_bf16 v[228:231], v[80:83], v[116:119], v[228:231]
  ds_read_b64_tr_b16 v[78:79], v17 offset:50432
  v_mfma_f32_16x16x32_bf16 v[232:235], v[80:83], v[120:123], v[232:235]
  v_mfma_f32_16x16x32_bf16 v[236:239], v[80:83], v[124:127], v[236:239]
  ds_read_b64_tr_b16 v[80:81], v16 offset:49664
  v_mfma_f32_16x16x32_bf16 a[132:135], v[84:87], v[124:127], a[132:135]
  ds_read_b64_tr_b16 v[82:83], v16 offset:50688
  v_mfma_f32_16x16x32_bf16 a[128:131], v[84:87], v[120:123], a[128:131]
  buffer_load_dwordx4 v7, s[4:7], s42 offen offset:3072 lds
  v_mfma_f32_16x16x32_bf16 v[244:247], v[84:87], v[116:119], v[244:247]
  v_mfma_f32_16x16x32_bf16 v[240:243], v[84:87], v[112:115], v[240:243]
  ds_read_b64_tr_b16 v[84:85], v17 offset:49664
  v_mfma_f32_16x16x32_bf16 a[136:139], v[88:91], v[112:115], a[136:139]
  ds_read_b64_tr_b16 v[86:87], v17 offset:50688
  v_mfma_f32_16x16x32_bf16 a[140:143], v[88:91], v[116:119], a[140:143]
  ds_read_b64_tr_b16 v[88:89], v16 offset:49920
  v_mfma_f32_16x16x32_bf16 a[148:151], v[92:95], v[116:119], a[148:151]
  ds_read_b64_tr_b16 v[90:91], v16 offset:50944
  v_mfma_f32_16x16x32_bf16 a[144:147], v[92:95], v[112:115], a[144:147]
  s_waitcnt vmcnt(17) lgkmcnt(15)
  v_mfma_f32_16x16x32_bf16 a[0:3], v[32:35], v[128:131], a[0:3]
  ds_read_b64_tr_b16 v[92:93], v17 offset:49920
  v_mfma_f32_16x16x32_bf16 a[4:7], v[32:35], v[132:135], a[4:7]
  ds_read_b64_tr_b16 v[94:95], v17 offset:50944
  v_mfma_f32_16x16x32_bf16 a[8:11], v[32:35], v[136:139], a[8:11]
  buffer_load_dwordx4 v[112:115], v12, s[12:15], s44 offen offset:1024 sc1
  v_mfma_f32_16x16x32_bf16 a[12:15], v[32:35], v[140:143], a[12:15]
  ds_read_b64_tr_b16 v[32:33], v16 offset:40960
  v_mfma_f32_16x16x32_bf16 a[28:31], v[36:39], v[140:143], a[28:31]
  ds_read_b64_tr_b16 v[34:35], v16 offset:41984
  v_mfma_f32_16x16x32_bf16 a[24:27], v[36:39], v[136:139], a[24:27]
  v_mfma_f32_16x16x32_bf16 a[20:23], v[36:39], v[132:135], a[20:23]
  v_mfma_f32_16x16x32_bf16 a[16:19], v[36:39], v[128:131], a[16:19]
  ds_read_b64_tr_b16 v[36:37], v17 offset:40960
  ds_read_b64_tr_b16 v[38:39], v17 offset:41984
  v_mfma_f32_16x16x32_bf16 a[32:35], v[40:43], v[128:131], a[32:35]
  s_add_u32 m0, s46, 16384
  s_mov_b32 s43, 6881280
  v_mfma_f32_16x16x32_bf16 a[36:39], v[40:43], v[132:135], a[36:39]
  buffer_load_dwordx4 v8, s[8:11], s43 offen offset:0 lds
  v_mfma_f32_16x16x32_bf16 a[40:43], v[40:43], v[136:139], a[40:43]
  v_mfma_f32_16x16x32_bf16 a[44:47], v[40:43], v[140:143], a[44:47]
  ds_read_b64_tr_b16 v[40:41], v16 offset:41216
  v_mfma_f32_16x16x32_bf16 a[60:63], v[44:47], v[140:143], a[60:63]
  ds_read_b64_tr_b16 v[42:43], v16 offset:42240
  v_mfma_f32_16x16x32_bf16 a[56:59], v[44:47], v[136:139], a[56:59]
  v_mfma_f32_16x16x32_bf16 a[52:55], v[44:47], v[132:135], a[52:55]
  v_mfma_f32_16x16x32_bf16 a[48:51], v[44:47], v[128:131], a[48:51]
  s_waitcnt lgkmcnt(15)
  v_mfma_f32_16x16x32_bf16 a[64:67], v[48:51], v[128:131], a[64:67]
  ds_read_b64_tr_b16 v[44:45], v17 offset:41216
  v_mfma_f32_16x16x32_bf16 a[68:71], v[48:51], v[132:135], a[68:71]
  ds_read_b64_tr_b16 v[46:47], v17 offset:42240
  v_mfma_f32_16x16x32_bf16 a[72:75], v[48:51], v[136:139], a[72:75]
  buffer_load_dwordx4 v[116:119], v13, s[12:15], s44 offen offset:1024 sc1
  v_mfma_f32_16x16x32_bf16 a[76:79], v[48:51], v[140:143], a[76:79]
  ds_read_b64_tr_b16 v[48:49], v16 offset:41472
  v_mfma_f32_16x16x32_bf16 a[92:95], v[52:55], v[140:143], a[92:95]
  ds_read_b64_tr_b16 v[50:51], v16 offset:42496
  v_mfma_f32_16x16x32_bf16 a[88:91], v[52:55], v[136:139], a[88:91]
  v_mfma_f32_16x16x32_bf16 a[84:87], v[52:55], v[132:135], a[84:87]
  buffer_load_dwordx4 v9, s[8:11], s43 offen offset:1024 lds
  v_mfma_f32_16x16x32_bf16 a[80:83], v[52:55], v[128:131], a[80:83]
  ds_read_b64_tr_b16 v[52:53], v17 offset:41472
  v_mfma_f32_16x16x32_bf16 a[96:99], v[56:59], v[128:131], a[96:99]
  ds_read_b64_tr_b16 v[54:55], v17 offset:42496
  v_mfma_f32_16x16x32_bf16 a[100:103], v[56:59], v[132:135], a[100:103]
  v_mfma_f32_16x16x32_bf16 a[104:107], v[56:59], v[136:139], a[104:107]
  v_mfma_f32_16x16x32_bf16 a[108:111], v[56:59], v[140:143], a[108:111]
  ds_read_b64_tr_b16 v[56:57], v16 offset:41728
  v_mfma_f32_16x16x32_bf16 a[124:127], v[60:63], v[140:143], a[124:127]
  ds_read_b64_tr_b16 v[58:59], v16 offset:42752
  v_mfma_f32_16x16x32_bf16 a[120:123], v[60:63], v[136:139], a[120:123]
  v_mfma_f32_16x16x32_bf16 a[116:119], v[60:63], v[132:135], a[116:119]
  buffer_load_dwordx4 v[120:123], v14, s[12:15], s44 offen offset:1024 sc1
  v_mfma_f32_16x16x32_bf16 a[112:115], v[60:63], v[128:131], a[112:115]
  s_waitcnt lgkmcnt(15)
  v_mfma_f32_16x16x32_bf16 v[160:163], v[64:67], v[128:131], v[160:163]
  ds_read_b64_tr_b16 v[60:61], v17 offset:41728
  v_mfma_f32_16x16x32_bf16 v[164:167], v[64:67], v[132:135], v[164:167]
  ds_read_b64_tr_b16 v[62:63], v17 offset:42752
  v_mfma_f32_16x16x32_bf16 v[168:171], v[64:67], v[136:139], v[168:171]
  v_mfma_f32_16x16x32_bf16 v[172:175], v[64:67], v[140:143], v[172:175]
  ds_read_b64_tr_b16 v[64:65], v16 offset:57344
  v_mfma_f32_16x16x32_bf16 v[188:191], v[68:71], v[140:143], v[188:191]
  ds_read_b64_tr_b16 v[66:67], v16 offset:58368
  v_mfma_f32_16x16x32_bf16 v[184:187], v[68:71], v[136:139], v[184:187]
  buffer_load_dwordx4 v10, s[8:11], s43 offen offset:2048 lds
  v_mfma_f32_16x16x32_bf16 v[180:183], v[68:71], v[132:135], v[180:183]
  v_mfma_f32_16x16x32_bf16 v[176:179], v[68:71], v[128:131], v[176:179]
  ds_read_b64_tr_b16 v[68:69], v17 offset:57344
  v_mfma_f32_16x16x32_bf16 v[192:195], v[72:75], v[128:131], v[192:195]
  ds_read_b64_tr_b16 v[70:71], v17 offset:58368
  v_mfma_f32_16x16x32_bf16 v[196:199], v[72:75], v[132:135], v[196:199]
  v_mfma_f32_16x16x32_bf16 v[200:203], v[72:75], v[136:139], v[200:203]
  v_mfma_f32_16x16x32_bf16 v[204:207], v[72:75], v[140:143], v[204:207]
  ds_read_b64_tr_b16 v[72:73], v16 offset:57600
  v_mfma_f32_16x16x32_bf16 v[220:223], v[76:79], v[140:143], v[220:223]
  ds_read_b64_tr_b16 v[74:75], v16 offset:58624
  v_mfma_f32_16x16x32_bf16 v[216:219], v[76:79], v[136:139], v[216:219]
  buffer_load_dwordx4 v[124:127], v15, s[12:15], s44 offen offset:1024 sc1
  v_mfma_f32_16x16x32_bf16 v[212:215], v[76:79], v[132:135], v[212:215]
  v_mfma_f32_16x16x32_bf16 v[208:211], v[76:79], v[128:131], v[208:211]
  s_waitcnt lgkmcnt(15)
  v_mfma_f32_16x16x32_bf16 v[224:227], v[80:83], v[128:131], v[224:227]
  ds_read_b64_tr_b16 v[76:77], v17 offset:57600
  v_mfma_f32_16x16x32_bf16 v[228:231], v[80:83], v[132:135], v[228:231]
  ds_read_b64_tr_b16 v[78:79], v17 offset:58624
  v_mfma_f32_16x16x32_bf16 v[232:235], v[80:83], v[136:139], v[232:235]
  v_mfma_f32_16x16x32_bf16 v[236:239], v[80:83], v[140:143], v[236:239]
  ds_read_b64_tr_b16 v[80:81], v16 offset:57856
  v_mfma_f32_16x16x32_bf16 a[132:135], v[84:87], v[140:143], a[132:135]
  ds_read_b64_tr_b16 v[82:83], v16 offset:58880
  v_mfma_f32_16x16x32_bf16 a[128:131], v[84:87], v[136:139], a[128:131]
  buffer_load_dwordx4 v11, s[8:11], s43 offen offset:3072 lds
  v_mfma_f32_16x16x32_bf16 v[244:247], v[84:87], v[132:135], v[244:247]
  v_mfma_f32_16x16x32_bf16 v[240:243], v[84:87], v[128:131], v[240:243]
  ds_read_b64_tr_b16 v[84:85], v17 offset:57856
  v_mfma_f32_16x16x32_bf16 a[136:139], v[88:91], v[128:131], a[136:139]
  ds_read_b64_tr_b16 v[86:87], v17 offset:58880
  v_mfma_f32_16x16x32_bf16 a[140:143], v[88:91], v[132:135], a[140:143]
  ds_read_b64_tr_b16 v[88:89], v16 offset:58112
  v_mfma_f32_16x16x32_bf16 a[148:151], v[92:95], v[132:135], a[148:151]
  ds_read_b64_tr_b16 v[90:91], v16 offset:59136
  v_mfma_f32_16x16x32_bf16 a[144:147], v[92:95], v[128:131], a[144:147]
  s_waitcnt vmcnt(17) lgkmcnt(15)
  v_mfma_f32_16x16x32_bf16 a[0:3], v[32:35], v[144:147], a[0:3]
  ds_read_b64_tr_b16 v[92:93], v17 offset:58112
  v_mfma_f32_16x16x32_bf16 a[4:7], v[32:35], v[148:151], a[4:7]
  ds_read_b64_tr_b16 v[94:95], v17 offset:59136
  v_mfma_f32_16x16x32_bf16 a[8:11], v[32:35], v[152:155], a[8:11]
  buffer_load_dwordx4 v[128:131], v12, s[12:15], s44 offen offset:2048 sc1
  v_mfma_f32_16x16x32_bf16 a[12:15], v[32:35], v[156:159], a[12:15]
  v_mfma_f32_16x16x32_bf16 a[28:31], v[36:39], v[156:159], a[28:31]
  v_mfma_f32_16x16x32_bf16 a[24:27], v[36:39], v[152:155], a[24:27]
  v_mfma_f32_16x16x32_bf16 a[20:23], v[36:39], v[148:151], a[20:23]
  v_mfma_f32_16x16x32_bf16 a[16:19], v[36:39], v[144:147], a[16:19]
  v_mfma_f32_16x16x32_bf16 a[32:35], v[40:43], v[144:147], a[32:35]
  buffer_load_dwordx4 v[132:135], v13, s[12:15], s44 offen offset:2048 sc1
  v_mfma_f32_16x16x32_bf16 a[36:39], v[40:43], v[148:151], a[36:39]
  v_mfma_f32_16x16x32_bf16 a[40:43], v[40:43], v[152:155], a[40:43]
  v_mfma_f32_16x16x32_bf16 a[44:47], v[40:43], v[156:159], a[44:47]
  v_mfma_f32_16x16x32_bf16 a[60:63], v[44:47], v[156:159], a[60:63]
  v_mfma_f32_16x16x32_bf16 a[56:59], v[44:47], v[152:155], a[56:59]
  v_mfma_f32_16x16x32_bf16 a[52:55], v[44:47], v[148:151], a[52:55]
  v_mfma_f32_16x16x32_bf16 a[48:51], v[44:47], v[144:147], a[48:51]
  s_waitcnt vmcnt(18) lgkmcnt(0)
  s_barrier
  s_waitcnt lgkmcnt(15)
  v_mfma_f32_16x16x32_bf16 a[64:67], v[48:51], v[144:147], a[64:67]
  ds_read_b64_tr_b16 v[32:33], v18 offset:0
  ds_read_b64_tr_b16 v[34:35], v18 offset:1024
  v_mfma_f32_16x16x32_bf16 a[68:71], v[48:51], v[148:151], a[68:71]
  ds_read_b64_tr_b16 v[36:37], v19 offset:0
  ds_read_b64_tr_b16 v[38:39], v19 offset:1024
  v_mfma_f32_16x16x32_bf16 a[72:75], v[48:51], v[152:155], a[72:75]
  ds_read_b64_tr_b16 v[40:41], v18 offset:256
  ds_read_b64_tr_b16 v[42:43], v18 offset:1280
  v_mfma_f32_16x16x32_bf16 a[76:79], v[48:51], v[156:159], a[76:79]
  ds_read_b64_tr_b16 v[44:45], v19 offset:256
  ds_read_b64_tr_b16 v[46:47], v19 offset:1280
  v_mfma_f32_16x16x32_bf16 a[92:95], v[52:55], v[156:159], a[92:95]
  ds_read_b64_tr_b16 v[48:49], v18 offset:512
  ds_read_b64_tr_b16 v[50:51], v18 offset:1536
  v_mfma_f32_16x16x32_bf16 a[88:91], v[52:55], v[152:155], a[88:91]
  s_add_u32 m0, s47, 32768
  s_add_u32 s45, s48, 40960
  v_mfma_f32_16x16x32_bf16 a[84:87], v[52:55], v[148:151], a[84:87]
  buffer_load_dwordx4 v21, s[24:27], s45 offen offset:0 lds
  v_mfma_f32_16x16x32_bf16 a[80:83], v[52:55], v[144:147], a[80:83]
  ds_read_b64_tr_b16 v[52:53], v19 offset:512
  v_mfma_f32_16x16x32_bf16 a[96:99], v[56:59], v[144:147], a[96:99]
  ds_read_b64_tr_b16 v[54:55], v19 offset:1536
  v_mfma_f32_16x16x32_bf16 a[100:103], v[56:59], v[148:151], a[100:103]
  v_mfma_f32_16x16x32_bf16 a[104:107], v[56:59], v[152:155], a[104:107]
  buffer_load_dwordx4 v[136:139], v14, s[12:15], s44 offen offset:2048 sc1
  v_mfma_f32_16x16x32_bf16 a[108:111], v[56:59], v[156:159], a[108:111]
  ds_read_b64_tr_b16 v[56:57], v18 offset:768
  v_mfma_f32_16x16x32_bf16 a[124:127], v[60:63], v[156:159], a[124:127]
  ds_read_b64_tr_b16 v[58:59], v18 offset:1792
  v_mfma_f32_16x16x32_bf16 a[120:123], v[60:63], v[152:155], a[120:123]
  v_mfma_f32_16x16x32_bf16 a[116:119], v[60:63], v[148:151], a[116:119]
  v_mfma_f32_16x16x32_bf16 a[112:115], v[60:63], v[144:147], a[112:115]
  s_waitcnt lgkmcnt(15)
  v_mfma_f32_16x16x32_bf16 v[160:163], v[64:67], v[144:147], v[160:163]
  ds_read_b64_tr_b16 v[60:61], v19 offset:768
  v_mfma_f32_16x16x32_bf16 v[164:167], v[64:67], v[148:151], v[164:167]
  ds_read_b64_tr_b16 v[62:63], v19 offset:1792
  v_mfma_f32_16x16x32_bf16 v[168:171], v[64:67], v[152:155], v[168:171]
  buffer_load_dwordx4 v22, s[24:27], s45 offen offset:2048 lds
  v_mfma_f32_16x16x32_bf16 v[172:175], v[64:67], v[156:159], v[172:175]
  ds_read_b64_tr_b16 v[64:65], v18 offset:16384
  v_mfma_f32_16x16x32_bf16 v[188:191], v[68:71], v[156:159], v[188:191]
  ds_read_b64_tr_b16 v[66:67], v18 offset:17408
  v_mfma_f32_16x16x32_bf16 v[184:187], v[68:71], v[152:155], v[184:187]
  v_mfma_f32_16x16x32_bf16 v[180:183], v[68:71], v[148:151], v[180:183]
  v_mfma_f32_16x16x32_bf16 v[176:179], v[68:71], v[144:147], v[176:179]
  ds_read_b64_tr_b16 v[68:69], v19 offset:16384
  ds_read_b64_tr_b16 v[70:71], v19 offset:17408
  v_mfma_f32_16x16x32_bf16 v[192:195], v[72:75], v[144:147], v[192:195]
  s_add_u32 m0, s49, 40960
  s_add_u32 s45, s48, 24576
  v_mfma_f32_16x16x32_bf16 v[196:199], v[72:75], v[148:151], v[196:199]
  buffer_load_dwordx4 v28, s[28:31], s45 offen offset:0 lds
  v_mfma_f32_16x16x32_bf16 v[200:203], v[72:75], v[152:155], v[200:203]
  v_mfma_f32_16x16x32_bf16 v[204:207], v[72:75], v[156:159], v[204:207]
  ds_read_b64_tr_b16 v[72:73], v18 offset:16640
  v_mfma_f32_16x16x32_bf16 v[220:223], v[76:79], v[156:159], v[220:223]
  ds_read_b64_tr_b16 v[74:75], v18 offset:17664
  v_mfma_f32_16x16x32_bf16 v[216:219], v[76:79], v[152:155], v[216:219]
  v_mfma_f32_16x16x32_bf16 v[212:215], v[76:79], v[148:151], v[212:215]
  buffer_load_dwordx4 v[140:143], v15, s[12:15], s44 offen offset:2048 sc1
  v_mfma_f32_16x16x32_bf16 v[208:211], v[76:79], v[144:147], v[208:211]
  s_waitcnt lgkmcnt(15)
  v_mfma_f32_16x16x32_bf16 v[224:227], v[80:83], v[144:147], v[224:227]
  ds_read_b64_tr_b16 v[76:77], v19 offset:16640
  v_mfma_f32_16x16x32_bf16 v[228:231], v[80:83], v[148:151], v[228:231]
  ds_read_b64_tr_b16 v[78:79], v19 offset:17664
  v_mfma_f32_16x16x32_bf16 v[232:235], v[80:83], v[152:155], v[232:235]
  v_mfma_f32_16x16x32_bf16 v[236:239], v[80:83], v[156:159], v[236:239]
  ds_read_b64_tr_b16 v[80:81], v18 offset:16896
  v_mfma_f32_16x16x32_bf16 a[132:135], v[84:87], v[156:159], a[132:135]
  ds_read_b64_tr_b16 v[82:83], v18 offset:17920
  v_mfma_f32_16x16x32_bf16 a[128:131], v[84:87], v[152:155], a[128:131]
  buffer_load_dwordx4 v29, s[28:31], s45 offen offset:1024 lds
  v_mfma_f32_16x16x32_bf16 v[244:247], v[84:87], v[148:151], v[244:247]
  v_mfma_f32_16x16x32_bf16 v[240:243], v[84:87], v[144:147], v[240:243]
  ds_read_b64_tr_b16 v[84:85], v19 offset:16896
  v_mfma_f32_16x16x32_bf16 a[136:139], v[88:91], v[144:147], a[136:139]
  ds_read_b64_tr_b16 v[86:87], v19 offset:17920
  v_mfma_f32_16x16x32_bf16 a[140:143], v[88:91], v[148:151], a[140:143]
  ds_read_b64_tr_b16 v[88:89], v18 offset:17152
  v_mfma_f32_16x16x32_bf16 a[148:151], v[92:95], v[148:151], a[148:151]
  ds_read_b64_tr_b16 v[90:91], v18 offset:18176
  v_mfma_f32_16x16x32_bf16 a[144:147], v[92:95], v[144:147], a[144:147]
  s_waitcnt vmcnt(17) lgkmcnt(15)
  v_mfma_f32_16x16x32_bf16 a[0:3], v[32:35], v[96:99], a[0:3]
  ds_read_b64_tr_b16 v[92:93], v19 offset:17152
  v_mfma_f32_16x16x32_bf16 a[4:7], v[32:35], v[100:103], a[4:7]
  ds_read_b64_tr_b16 v[94:95], v19 offset:18176
  v_mfma_f32_16x16x32_bf16 a[8:11], v[32:35], v[104:107], a[8:11]
  buffer_load_dwordx4 v[144:147], v12, s[12:15], s44 offen offset:3072 sc1
  v_mfma_f32_16x16x32_bf16 a[12:15], v[32:35], v[108:111], a[12:15]
  ds_read_b64_tr_b16 v[32:33], v18 offset:8192
  v_mfma_f32_16x16x32_bf16 a[28:31], v[36:39], v[108:111], a[28:31]
  ds_read_b64_tr_b16 v[34:35], v18 offset:9216
  v_mfma_f32_16x16x32_bf16 a[24:27], v[36:39], v[104:107], a[24:27]
  v_mfma_f32_16x16x32_bf16 a[20:23], v[36:39], v[100:103], a[20:23]
  v_mfma_f32_16x16x32_bf16 a[16:19], v[36:39], v[96:99], a[16:19]
  ds_read_b64_tr_b16 v[36:37], v19 offset:8192
  ds_read_b64_tr_b16 v[38:39], v19 offset:9216
  v_mfma_f32_16x16x32_bf16 a[32:35], v[40:43], v[96:99], a[32:35]
  s_add_u32 m0, s47, 49152
  s_add_u32 s45, s48, 49152
  v_mfma_f32_16x16x32_bf16 a[36:39], v[40:43], v[100:103], a[36:39]
  buffer_load_dwordx4 v21, s[24:27], s45 offen offset:0 lds
  v_mfma_f32_16x16x32_bf16 a[40:43], v[40:43], v[104:107], a[40:43]
  v_mfma_f32_16x16x32_bf16 a[44:47], v[40:43], v[108:111], a[44:47]
  ds_read_b64_tr_b16 v[40:41], v18 offset:8448
  v_mfma_f32_16x16x32_bf16 a[60:63], v[44:47], v[108:111], a[60:63]
  ds_read_b64_tr_b16 v[42:43], v18 offset:9472
  v_mfma_f32_16x16x32_bf16 a[56:59], v[44:47], v[104:107], a[56:59]
  v_mfma_f32_16x16x32_bf16 a[52:55], v[44:47], v[100:103], a[52:55]
  v_mfma_f32_16x16x32_bf16 a[48:51], v[44:47], v[96:99], a[48:51]
  s_waitcnt lgkmcnt(15)
  v_mfma_f32_16x16x32_bf16 a[64:67], v[48:51], v[96:99], a[64:67]
  ds_read_b64_tr_b16 v[44:45], v19 offset:8448
  v_mfma_f32_16x16x32_bf16 a[68:71], v[48:51], v[100:103], a[68:71]
  ds_read_b64_tr_b16 v[46:47], v19 offset:9472
  v_mfma_f32_16x16x32_bf16 a[72:75], v[48:51], v[104:107], a[72:75]
  buffer_load_dwordx4 v[148:151], v13, s[12:15], s44 offen offset:3072 sc1
  v_mfma_f32_16x16x32_bf16 a[76:79], v[48:51], v[108:111], a[76:79]
  ds_read_b64_tr_b16 v[48:49], v18 offset:8704
  v_mfma_f32_16x16x32_bf16 a[92:95], v[52:55], v[108:111], a[92:95]
  ds_read_b64_tr_b16 v[50:51], v18 offset:9728
  v_mfma_f32_16x16x32_bf16 a[88:91], v[52:55], v[104:107], a[88:91]
  v_mfma_f32_16x16x32_bf16 a[84:87], v[52:55], v[100:103], a[84:87]
  buffer_load_dwordx4 v22, s[24:27], s45 offen offset:2048 lds
  v_mfma_f32_16x16x32_bf16 a[80:83], v[52:55], v[96:99], a[80:83]
  ds_read_b64_tr_b16 v[52:53], v19 offset:8704
  v_mfma_f32_16x16x32_bf16 a[96:99], v[56:59], v[96:99], a[96:99]
  ds_read_b64_tr_b16 v[54:55], v19 offset:9728
  v_mfma_f32_16x16x32_bf16 a[100:103], v[56:59], v[100:103], a[100:103]
  v_mfma_f32_16x16x32_bf16 a[104:107], v[56:59], v[104:107], a[104:107]
  v_mfma_f32_16x16x32_bf16 a[108:111], v[56:59], v[108:111], a[108:111]
  ds_read_b64_tr_b16 v[56:57], v18 offset:8960
  v_mfma_f32_16x16x32_bf16 a[124:127], v[60:63], v[108:111], a[124:127]
  ds_read_b64_tr_b16 v[58:59], v18 offset:9984
  v_mfma_f32_16x16x32_bf16 a[120:123], v[60:63], v[104:107], a[120:123]
  v_mfma_f32_16x16x32_bf16 a[116:119], v[60:63], v[100:103], a[116:119]
  buffer_load_dwordx4 v[152:155], v14, s[12:15], s44 offen offset:3072 sc1
  v_mfma_f32_16x16x32_bf16 a[112:115], v[60:63], v[96:99], a[112:115]
  s_waitcnt lgkmcnt(15)
  v_mfma_f32_16x16x32_bf16 v[160:163], v[64:67], v[96:99], v[160:163]
  ds_read_b64_tr_b16 v[60:61], v19 offset:8960
  v_mfma_f32_16x16x32_bf16 v[164:167], v[64:67], v[100:103], v[164:167]
  ds_read_b64_tr_b16 v[62:63], v19 offset:9984
  v_mfma_f32_16x16x32_bf16 v[168:171], v[64:67], v[104:107], v[168:171]
  v_mfma_f32_16x16x32_bf16 v[172:175], v[64:67], v[108:111], v[172:175]
  ds_read_b64_tr_b16 v[64:65], v18 offset:24576
  v_mfma_f32_16x16x32_bf16 v[188:191], v[68:71], v[108:111], v[188:191]
  ds_read_b64_tr_b16 v[66:67], v18 offset:25600
  v_mfma_f32_16x16x32_bf16 v[184:187], v[68:71], v[104:107], v[184:187]
  s_add_u32 m0, s49, 57344
  s_add_u32 s45, s48, 32768
  v_mfma_f32_16x16x32_bf16 v[180:183], v[68:71], v[100:103], v[180:183]
  buffer_load_dwordx4 v28, s[28:31], s45 offen offset:0 lds
  v_mfma_f32_16x16x32_bf16 v[176:179], v[68:71], v[96:99], v[176:179]
  ds_read_b64_tr_b16 v[68:69], v19 offset:24576
  v_mfma_f32_16x16x32_bf16 v[192:195], v[72:75], v[96:99], v[192:195]
  ds_read_b64_tr_b16 v[70:71], v19 offset:25600
  v_mfma_f32_16x16x32_bf16 v[196:199], v[72:75], v[100:103], v[196:199]
  v_mfma_f32_16x16x32_bf16 v[200:203], v[72:75], v[104:107], v[200:203]
  v_mfma_f32_16x16x32_bf16 v[204:207], v[72:75], v[108:111], v[204:207]
  ds_read_b64_tr_b16 v[72:73], v18 offset:24832
  v_mfma_f32_16x16x32_bf16 v[220:223], v[76:79], v[108:111], v[220:223]
  ds_read_b64_tr_b16 v[74:75], v18 offset:25856
  v_mfma_f32_16x16x32_bf16 v[216:219], v[76:79], v[104:107], v[216:219]
  buffer_load_dwordx4 v[156:159], v15, s[12:15], s44 offen offset:3072 sc1
  v_mfma_f32_16x16x32_bf16 v[212:215], v[76:79], v[100:103], v[212:215]
  v_mfma_f32_16x16x32_bf16 v[208:211], v[76:79], v[96:99], v[208:211]
  s_waitcnt lgkmcnt(15)
  v_mfma_f32_16x16x32_bf16 v[224:227], v[80:83], v[96:99], v[224:227]
  ds_read_b64_tr_b16 v[76:77], v19 offset:24832
  v_mfma_f32_16x16x32_bf16 v[228:231], v[80:83], v[100:103], v[228:231]
  ds_read_b64_tr_b16 v[78:79], v19 offset:25856
  v_mfma_f32_16x16x32_bf16 v[232:235], v[80:83], v[104:107], v[232:235]
  v_mfma_f32_16x16x32_bf16 v[236:239], v[80:83], v[108:111], v[236:239]
  ds_read_b64_tr_b16 v[80:81], v18 offset:25088
  v_mfma_f32_16x16x32_bf16 a[132:135], v[84:87], v[108:111], a[132:135]
  ds_read_b64_tr_b16 v[82:83], v18 offset:26112
  v_mfma_f32_16x16x32_bf16 a[128:131], v[84:87], v[104:107], a[128:131]
  buffer_load_dwordx4 v29, s[28:31], s45 offen offset:1024 lds
  v_mfma_f32_16x16x32_bf16 v[244:247], v[84:87], v[100:103], v[244:247]
  v_mfma_f32_16x16x32_bf16 v[240:243], v[84:87], v[96:99], v[240:243]
  ds_read_b64_tr_b16 v[84:85], v19 offset:25088
  v_mfma_f32_16x16x32_bf16 a[136:139], v[88:91], v[96:99], a[136:139]
  ds_read_b64_tr_b16 v[86:87], v19 offset:26112
  v_mfma_f32_16x16x32_bf16 a[140:143], v[88:91], v[100:103], a[140:143]
  ds_read_b64_tr_b16 v[88:89], v18 offset:25344
  v_mfma_f32_16x16x32_bf16 a[148:151], v[92:95], v[100:103], a[148:151]
  ds_read_b64_tr_b16 v[90:91], v18 offset:26368
  v_mfma_f32_16x16x32_bf16 a[144:147], v[92:95], v[96:99], a[144:147]
  s_waitcnt vmcnt(17) lgkmcnt(15)
  v_mfma_f32_16x16x32_bf16 a[0:3], v[32:35], v[112:115], a[0:3]
  ds_read_b64_tr_b16 v[92:93], v19 offset:25344
  v_mfma_f32_16x16x32_bf16 a[4:7], v[32:35], v[116:119], a[4:7]
  ds_read_b64_tr_b16 v[94:95], v19 offset:26368
  v_mfma_f32_16x16x32_bf16 a[8:11], v[32:35], v[120:123], a[8:11]
  v_mfma_f32_16x16x32_bf16 a[12:15], v[32:35], v[124:127], a[12:15]
  v_mfma_f32_16x16x32_bf16 a[28:31], v[36:39], v[124:127], a[28:31]
  v_mfma_f32_16x16x32_bf16 a[24:27], v[36:39], v[120:123], a[24:27]
  v_mfma_f32_16x16x32_bf16 a[20:23], v[36:39], v[116:119], a[20:23]
  v_mfma_f32_16x16x32_bf16 a[16:19], v[36:39], v[112:115], a[16:19]
  v_mfma_f32_16x16x32_bf16 a[32:35], v[40:43], v[112:115], a[32:35]
  v_mfma_f32_16x16x32_bf16 a[36:39], v[40:43], v[116:119], a[36:39]
  v_mfma_f32_16x16x32_bf16 a[40:43], v[40:43], v[120:123], a[40:43]
  v_mfma_f32_16x16x32_bf16 a[44:47], v[40:43], v[124:127], a[44:47]
  v_mfma_f32_16x16x32_bf16 a[60:63], v[44:47], v[124:127], a[60:63]
  v_mfma_f32_16x16x32_bf16 a[56:59], v[44:47], v[120:123], a[56:59]
  v_mfma_f32_16x16x32_bf16 a[52:55], v[44:47], v[116:119], a[52:55]
  v_mfma_f32_16x16x32_bf16 a[48:51], v[44:47], v[112:115], a[48:51]
  s_waitcnt vmcnt(16) lgkmcnt(0)
  s_barrier
  s_waitcnt lgkmcnt(15)
  v_mfma_f32_16x16x32_bf16 a[64:67], v[48:51], v[112:115], a[64:67]
  ds_read_b64_tr_b16 v[32:33], v16 offset:0
  ds_read_b64_tr_b16 v[34:35], v16 offset:1024
  v_mfma_f32_16x16x32_bf16 a[68:71], v[48:51], v[116:119], a[68:71]
  ds_read_b64_tr_b16 v[36:37], v17 offset:0
  ds_read_b64_tr_b16 v[38:39], v17 offset:1024
  v_mfma_f32_16x16x32_bf16 a[72:75], v[48:51], v[120:123], a[72:75]
  ds_read_b64_tr_b16 v[40:41], v16 offset:256
  ds_read_b64_tr_b16 v[42:43], v16 offset:1280
  v_mfma_f32_16x16x32_bf16 a[76:79], v[48:51], v[124:127], a[76:79]
  ds_read_b64_tr_b16 v[44:45], v17 offset:256
  ds_read_b64_tr_b16 v[46:47], v17 offset:1280
  v_mfma_f32_16x16x32_bf16 a[92:95], v[52:55], v[124:127], a[92:95]
  ds_read_b64_tr_b16 v[48:49], v16 offset:512
  ds_read_b64_tr_b16 v[50:51], v16 offset:1536
  v_mfma_f32_16x16x32_bf16 a[88:91], v[52:55], v[120:123], a[88:91]
  s_add_u32 m0, s47, 65536
  s_add_u32 s45, s48, 57344
  v_mfma_f32_16x16x32_bf16 a[84:87], v[52:55], v[116:119], a[84:87]
  buffer_load_dwordx4 v21, s[24:27], s45 offen offset:0 lds
  v_mfma_f32_16x16x32_bf16 a[80:83], v[52:55], v[112:115], a[80:83]
  ds_read_b64_tr_b16 v[52:53], v17 offset:512
  v_mfma_f32_16x16x32_bf16 a[96:99], v[56:59], v[112:115], a[96:99]
  ds_read_b64_tr_b16 v[54:55], v17 offset:1536
  v_mfma_f32_16x16x32_bf16 a[100:103], v[56:59], v[116:119], a[100:103]
  v_mfma_f32_16x16x32_bf16 a[104:107], v[56:59], v[120:123], a[104:107]
  v_mfma_f32_16x16x32_bf16 a[108:111], v[56:59], v[124:127], a[108:111]
  ds_read_b64_tr_b16 v[56:57], v16 offset:768
  v_mfma_f32_16x16x32_bf16 a[124:127], v[60:63], v[124:127], a[124:127]
  ds_read_b64_tr_b16 v[58:59], v16 offset:1792
  v_mfma_f32_16x16x32_bf16 a[120:123], v[60:63], v[120:123], a[120:123]
  v_mfma_f32_16x16x32_bf16 a[116:119], v[60:63], v[116:119], a[116:119]
  buffer_load_dwordx4 v22, s[24:27], s45 offen offset:2048 lds
  v_mfma_f32_16x16x32_bf16 a[112:115], v[60:63], v[112:115], a[112:115]
  s_waitcnt lgkmcnt(15)
  v_mfma_f32_16x16x32_bf16 v[160:163], v[64:67], v[112:115], v[160:163]
  ds_read_b64_tr_b16 v[60:61], v17 offset:768
  v_mfma_f32_16x16x32_bf16 v[164:167], v[64:67], v[116:119], v[164:167]
  ds_read_b64_tr_b16 v[62:63], v17 offset:1792
  v_mfma_f32_16x16x32_bf16 v[168:171], v[64:67], v[120:123], v[168:171]
  v_mfma_f32_16x16x32_bf16 v[172:175], v[64:67], v[124:127], v[172:175]
  ds_read_b64_tr_b16 v[64:65], v16 offset:16384
  v_mfma_f32_16x16x32_bf16 v[188:191], v[68:71], v[124:127], v[188:191]
  ds_read_b64_tr_b16 v[66:67], v16 offset:17408
  v_mfma_f32_16x16x32_bf16 v[184:187], v[68:71], v[120:123], v[184:187]
  v_mfma_f32_16x16x32_bf16 v[180:183], v[68:71], v[116:119], v[180:183]
  v_mfma_f32_16x16x32_bf16 v[176:179], v[68:71], v[112:115], v[176:179]
  ds_read_b64_tr_b16 v[68:69], v17 offset:16384
  ds_read_b64_tr_b16 v[70:71], v17 offset:17408
  v_mfma_f32_16x16x32_bf16 v[192:195], v[72:75], v[112:115], v[192:195]
  s_add_u32 m0, s49, 73728
  s_add_u32 s45, s48, 40960
  v_mfma_f32_16x16x32_bf16 v[196:199], v[72:75], v[116:119], v[196:199]
  buffer_load_dwordx4 v28, s[28:31], s45 offen offset:0 lds
  v_mfma_f32_16x16x32_bf16 v[200:203], v[72:75], v[120:123], v[200:203]
  v_mfma_f32_16x16x32_bf16 v[204:207], v[72:75], v[124:127], v[204:207]
  ds_read_b64_tr_b16 v[72:73], v16 offset:16640
  v_mfma_f32_16x16x32_bf16 v[220:223], v[76:79], v[124:127], v[220:223]
  ds_read_b64_tr_b16 v[74:75], v16 offset:17664
  v_mfma_f32_16x16x32_bf16 v[216:219], v[76:79], v[120:123], v[216:219]
  v_mfma_f32_16x16x32_bf16 v[212:215], v[76:79], v[116:119], v[212:215]
  v_mfma_f32_16x16x32_bf16 v[208:211], v[76:79], v[112:115], v[208:211]
  s_waitcnt lgkmcnt(15)
  v_mfma_f32_16x16x32_bf16 v[224:227], v[80:83], v[112:115], v[224:227]
  ds_read_b64_tr_b16 v[76:77], v17 offset:16640
  v_mfma_f32_16x16x32_bf16 v[228:231], v[80:83], v[116:119], v[228:231]
  ds_read_b64_tr_b16 v[78:79], v17 offset:17664
  v_mfma_f32_16x16x32_bf16 v[232:235], v[80:83], v[120:123], v[232:235]
  buffer_load_dwordx4 v29, s[28:31], s45 offen offset:1024 lds
  v_mfma_f32_16x16x32_bf16 v[236:239], v[80:83], v[124:127], v[236:239]
  ds_read_b64_tr_b16 v[80:81], v16 offset:16896
  v_mfma_f32_16x16x32_bf16 a[132:135], v[84:87], v[124:127], a[132:135]
  ds_read_b64_tr_b16 v[82:83], v16 offset:17920
  v_mfma_f32_16x16x32_bf16 a[128:131], v[84:87], v[120:123], a[128:131]
  v_mfma_f32_16x16x32_bf16 v[244:247], v[84:87], v[116:119], v[244:247]
  v_mfma_f32_16x16x32_bf16 v[240:243], v[84:87], v[112:115], v[240:243]
  ds_read_b64_tr_b16 v[84:85], v17 offset:16896
  v_mfma_f32_16x16x32_bf16 a[136:139], v[88:91], v[112:115], a[136:139]
  ds_read_b64_tr_b16 v[86:87], v17 offset:17920
  v_mfma_f32_16x16x32_bf16 a[140:143], v[88:91], v[116:119], a[140:143]
  ds_read_b64_tr_b16 v[88:89], v16 offset:17152
  v_mfma_f32_16x16x32_bf16 a[148:151], v[92:95], v[116:119], a[148:151]
  ds_read_b64_tr_b16 v[90:91], v16 offset:18176
  v_mfma_f32_16x16x32_bf16 a[144:147], v[92:95], v[112:115], a[144:147]
  s_waitcnt vmcnt(13) lgkmcnt(15)
  v_mfma_f32_16x16x32_bf16 a[0:3], v[32:35], v[128:131], a[0:3]
  ds_read_b64_tr_b16 v[92:93], v17 offset:17152
  v_mfma_f32_16x16x32_bf16 a[4:7], v[32:35], v[132:135], a[4:7]
  ds_read_b64_tr_b16 v[94:95], v17 offset:18176
  v_mfma_f32_16x16x32_bf16 a[8:11], v[32:35], v[136:139], a[8:11]
  s_add_u32 m0, s47, 81920
  s_add_u32 s45, s48, 65536
  v_mfma_f32_16x16x32_bf16 a[12:15], v[32:35], v[140:143], a[12:15]
  ds_read_b64_tr_b16 v[32:33], v16 offset:8192
  v_mfma_f32_16x16x32_bf16 a[28:31], v[36:39], v[140:143], a[28:31]
  ds_read_b64_tr_b16 v[34:35], v16 offset:9216
  v_mfma_f32_16x16x32_bf16 a[24:27], v[36:39], v[136:139], a[24:27]
  buffer_load_dwordx4 v21, s[24:27], s45 offen offset:0 lds
  v_mfma_f32_16x16x32_bf16 a[20:23], v[36:39], v[132:135], a[20:23]
  v_mfma_f32_16x16x32_bf16 a[16:19], v[36:39], v[128:131], a[16:19]
  ds_read_b64_tr_b16 v[36:37], v17 offset:8192
  v_mfma_f32_16x16x32_bf16 a[32:35], v[40:43], v[128:131], a[32:35]
  ds_read_b64_tr_b16 v[38:39], v17 offset:9216
  v_mfma_f32_16x16x32_bf16 a[36:39], v[40:43], v[132:135], a[36:39]
  v_mfma_f32_16x16x32_bf16 a[40:43], v[40:43], v[136:139], a[40:43]
  v_mfma_f32_16x16x32_bf16 a[44:47], v[40:43], v[140:143], a[44:47]
  ds_read_b64_tr_b16 v[40:41], v16 offset:8448
  v_mfma_f32_16x16x32_bf16 a[60:63], v[44:47], v[140:143], a[60:63]
  ds_read_b64_tr_b16 v[42:43], v16 offset:9472
  v_mfma_f32_16x16x32_bf16 a[56:59], v[44:47], v[136:139], a[56:59]
  v_mfma_f32_16x16x32_bf16 a[52:55], v[44:47], v[132:135], a[52:55]
  v_mfma_f32_16x16x32_bf16 a[48:51], v[44:47], v[128:131], a[48:51]
  s_waitcnt lgkmcnt(15)
  v_mfma_f32_16x16x32_bf16 a[64:67], v[48:51], v[128:131], a[64:67]
  ds_read_b64_tr_b16 v[44:45], v17 offset:8448
  v_mfma_f32_16x16x32_bf16 a[68:71], v[48:51], v[132:135], a[68:71]
  ds_read_b64_tr_b16 v[46:47], v17 offset:9472
  v_mfma_f32_16x16x32_bf16 a[72:75], v[48:51], v[136:139], a[72:75]
  buffer_load_dwordx4 v22, s[24:27], s45 offen offset:2048 lds
  v_mfma_f32_16x16x32_bf16 a[76:79], v[48:51], v[140:143], a[76:79]
  ds_read_b64_tr_b16 v[48:49], v16 offset:8704
  v_mfma_f32_16x16x32_bf16 a[92:95], v[52:55], v[140:143], a[92:95]
  ds_read_b64_tr_b16 v[50:51], v16 offset:9728
  v_mfma_f32_16x16x32_bf16 a[88:91], v[52:55], v[136:139], a[88:91]
  v_mfma_f32_16x16x32_bf16 a[84:87], v[52:55], v[132:135], a[84:87]
  v_mfma_f32_16x16x32_bf16 a[80:83], v[52:55], v[128:131], a[80:83]
  ds_read_b64_tr_b16 v[52:53], v17 offset:8704
  v_mfma_f32_16x16x32_bf16 a[96:99], v[56:59], v[128:131], a[96:99]
  ds_read_b64_tr_b16 v[54:55], v17 offset:9728
  v_mfma_f32_16x16x32_bf16 a[100:103], v[56:59], v[132:135], a[100:103]
  v_mfma_f32_16x16x32_bf16 a[104:107], v[56:59], v[136:139], a[104:107]
  v_mfma_f32_16x16x32_bf16 a[108:111], v[56:59], v[140:143], a[108:111]
  ds_read_b64_tr_b16 v[56:57], v16 offset:8960
  v_mfma_f32_16x16x32_bf16 a[124:127], v[60:63], v[140:143], a[124:127]
  ds_read_b64_tr_b16 v[58:59], v16 offset:9984
  v_mfma_f32_16x16x32_bf16 a[120:123], v[60:63], v[136:139], a[120:123]
  s_add_u32 m0, s49, 90112
  s_add_u32 s45, s48, 49152
  v_mfma_f32_16x16x32_bf16 a[116:119], v[60:63], v[132:135], a[116:119]
  buffer_load_dwordx4 v28, s[28:31], s45 offen offset:0 lds
  v_mfma_f32_16x16x32_bf16 a[112:115], v[60:63], v[128:131], a[112:115]
  s_waitcnt lgkmcnt(15)
  v_mfma_f32_16x16x32_bf16 v[160:163], v[64:67], v[128:131], v[160:163]
  ds_read_b64_tr_b16 v[60:61], v17 offset:8960
  v_mfma_f32_16x16x32_bf16 v[164:167], v[64:67], v[132:135], v[164:167]
  ds_read_b64_tr_b16 v[62:63], v17 offset:9984
  v_mfma_f32_16x16x32_bf16 v[168:171], v[64:67], v[136:139], v[168:171]
  v_mfma_f32_16x16x32_bf16 v[172:175], v[64:67], v[140:143], v[172:175]
  ds_read_b64_tr_b16 v[64:65], v16 offset:24576
  v_mfma_f32_16x16x32_bf16 v[188:191], v[68:71], v[140:143], v[188:191]
  ds_read_b64_tr_b16 v[66:67], v16 offset:25600
  v_mfma_f32_16x16x32_bf16 v[184:187], v[68:71], v[136:139], v[184:187]
  v_mfma_f32_16x16x32_bf16 v[180:183], v[68:71], v[132:135], v[180:183]
  v_mfma_f32_16x16x32_bf16 v[176:179], v[68:71], v[128:131], v[176:179]
  ds_read_b64_tr_b16 v[68:69], v17 offset:24576
  v_mfma_f32_16x16x32_bf16 v[192:195], v[72:75], v[128:131], v[192:195]
  ds_read_b64_tr_b16 v[70:71], v17 offset:25600
  v_mfma_f32_16x16x32_bf16 v[196:199], v[72:75], v[132:135], v[196:199]
  v_mfma_f32_16x16x32_bf16 v[200:203], v[72:75], v[136:139], v[200:203]
  v_mfma_f32_16x16x32_bf16 v[204:207], v[72:75], v[140:143], v[204:207]
  ds_read_b64_tr_b16 v[72:73], v16 offset:24832
  v_mfma_f32_16x16x32_bf16 v[220:223], v[76:79], v[140:143], v[220:223]
  ds_read_b64_tr_b16 v[74:75], v16 offset:25856
  v_mfma_f32_16x16x32_bf16 v[216:219], v[76:79], v[136:139], v[216:219]
  buffer_load_dwordx4 v29, s[28:31], s45 offen offset:1024 lds
  v_mfma_f32_16x16x32_bf16 v[212:215], v[76:79], v[132:135], v[212:215]
  v_mfma_f32_16x16x32_bf16 v[208:211], v[76:79], v[128:131], v[208:211]
  s_waitcnt lgkmcnt(15)
  v_mfma_f32_16x16x32_bf16 v[224:227], v[80:83], v[128:131], v[224:227]
  ds_read_b64_tr_b16 v[76:77], v17 offset:24832
  v_mfma_f32_16x16x32_bf16 v[228:231], v[80:83], v[132:135], v[228:231]
  ds_read_b64_tr_b16 v[78:79], v17 offset:25856
  v_mfma_f32_16x16x32_bf16 v[232:235], v[80:83], v[136:139], v[232:235]
  v_mfma_f32_16x16x32_bf16 v[236:239], v[80:83], v[140:143], v[236:239]
  ds_read_b64_tr_b16 v[80:81], v16 offset:25088
  v_mfma_f32_16x16x32_bf16 a[132:135], v[84:87], v[140:143], a[132:135]
  ds_read_b64_tr_b16 v[82:83], v16 offset:26112
  v_mfma_f32_16x16x32_bf16 a[128:131], v[84:87], v[136:139], a[128:131]
  v_mfma_f32_16x16x32_bf16 v[244:247], v[84:87], v[132:135], v[244:247]
  v_mfma_f32_16x16x32_bf16 v[240:243], v[84:87], v[128:131], v[240:243]
  ds_read_b64_tr_b16 v[84:85], v17 offset:25088
  v_mfma_f32_16x16x32_bf16 a[136:139], v[88:91], v[128:131], a[136:139]
  ds_read_b64_tr_b16 v[86:87], v17 offset:26112
  v_mfma_f32_16x16x32_bf16 a[140:143], v[88:91], v[132:135], a[140:143]
  ds_read_b64_tr_b16 v[88:89], v16 offset:25344
  v_mfma_f32_16x16x32_bf16 a[148:151], v[92:95], v[132:135], a[148:151]
  ds_read_b64_tr_b16 v[90:91], v16 offset:26368
  v_mfma_f32_16x16x32_bf16 a[144:147], v[92:95], v[128:131], a[144:147]
  s_waitcnt vmcnt(9) lgkmcnt(15)
  v_mfma_f32_16x16x32_bf16 a[0:3], v[32:35], v[144:147], a[0:3]
  ds_read_b64_tr_b16 v[92:93], v17 offset:25344
  v_mfma_f32_16x16x32_bf16 a[4:7], v[32:35], v[148:151], a[4:7]
  ds_read_b64_tr_b16 v[94:95], v17 offset:26368
  v_mfma_f32_16x16x32_bf16 a[8:11], v[32:35], v[152:155], a[8:11]
  v_xor_b32 v255, s62, v1
  v_mfma_f32_16x16x32_bf16 a[12:15], v[32:35], v[156:159], a[12:15]
  v_lshlrev_b32 v252, 11, v2
  v_mfma_f32_16x16x32_bf16 a[28:31], v[36:39], v[156:159], a[28:31]
  v_lshl_add_u32 v252, v255, 6, v252
  v_mfma_f32_16x16x32_bf16 a[24:27], v[36:39], v[152:155], a[24:27]
  s_lshl_b32 s89, s36, 16
  v_mfma_f32_16x16x32_bf16 a[20:23], v[36:39], v[148:151], a[20:23]
  s_add_u32 s89, s89, s81
  v_mfma_f32_16x16x32_bf16 a[16:19], v[36:39], v[144:147], a[16:19]
  v_add_u32 v252, s89, v252
  v_mfma_f32_16x16x32_bf16 a[32:35], v[40:43], v[144:147], a[32:35]
  v_lshlrev_b32 v253, 4, v3
  v_mfma_f32_16x16x32_bf16 a[36:39], v[40:43], v[148:151], a[36:39]
  v_xor_b32 v254, 32, v253
  v_mfma_f32_16x16x32_bf16 a[40:43], v[40:43], v[152:155], a[40:43]
  v_add_u32 v4, v252, v253
  v_mfma_f32_16x16x32_bf16 a[44:47], v[40:43], v[156:159], a[44:47]
  v_add_u32 v5, v252, v254
  v_mfma_f32_16x16x32_bf16 a[60:63], v[44:47], v[156:159], a[60:63]
  v_add_u32 v5, 7168, v5
  v_mfma_f32_16x16x32_bf16 a[56:59], v[44:47], v[152:155], a[56:59]
  v_add_u32 v6, 14336, v4
  v_mfma_f32_16x16x32_bf16 a[52:55], v[44:47], v[148:151], a[52:55]
  v_add_u32 v7, 14336, v5
  v_mfma_f32_16x16x32_bf16 a[48:51], v[44:47], v[144:147], a[48:51]
  s_waitcnt lgkmcnt(0)
  s_barrier
  s_waitcnt lgkmcnt(15)
  v_mfma_f32_16x16x32_bf16 a[64:67], v[48:51], v[144:147], a[64:67]
  v_lshlrev_b32 v252, 10, v1
  v_mfma_f32_16x16x32_bf16 a[68:71], v[48:51], v[148:151], a[68:71]
  v_lshl_add_u32 v252, v2, 6, v252
  v_mfma_f32_16x16x32_bf16 a[72:75], v[48:51], v[152:155], a[72:75]
  v_lshl_add_u32 v252, v3, 3, v252
  v_mfma_f32_16x16x32_bf16 a[76:79], v[48:51], v[156:159], a[76:79]
  v_and_b32 v253, 1, v1
  v_mfma_f32_16x16x32_bf16 a[92:95], v[52:55], v[156:159], a[92:95]
  s_add_u32 m0, s47, 0
  s_add_u32 s45, s48, 73728
  v_mfma_f32_16x16x32_bf16 a[88:91], v[52:55], v[152:155], a[88:91]
  buffer_load_dwordx4 v21, s[24:27], s45 offen offset:0 lds
  v_lshl_add_u32 v8, v253, 5, v252
  v_mfma_f32_16x16x32_bf16 a[84:87], v[52:55], v[148:151], a[84:87]
  v_xor_b32 v9, 32, v8
  v_mfma_f32_16x16x32_bf16 a[80:83], v[52:55], v[144:147], a[80:83]
  v_add_u32 v10, 0x10000, v8
  v_mfma_f32_16x16x32_bf16 a[96:99], v[56:59], v[144:147], a[96:99]
  v_add_u32 v11, 0x10000, v9
  v_mfma_f32_16x16x32_bf16 a[100:103], v[56:59], v[148:151], a[100:103]
  v_add_u32 v12, 0x10000, v10
  v_mfma_f32_16x16x32_bf16 a[104:107], v[56:59], v[152:155], a[104:107]
  v_add_u32 v13, 0x10000, v11
  v_mfma_f32_16x16x32_bf16 a[108:111], v[56:59], v[156:159], a[108:111]
  v_and_b32 v252, 15, v0
  v_mfma_f32_16x16x32_bf16 a[124:127], v[60:63], v[156:159], a[124:127]
  v_lshlrev_b32 v254, 11, v252
  v_mfma_f32_16x16x32_bf16 a[120:123], v[60:63], v[152:155], a[120:123]
  v_lshl_add_u32 v254, v253, 5, v254
  v_mfma_f32_16x16x32_bf16 a[116:119], v[60:63], v[148:151], a[116:119]
  buffer_load_dwordx4 v22, s[24:27], s45 offen offset:2048 lds
  v_lshrrev_b32 v255, 1, v1
  v_mfma_f32_16x16x32_bf16 a[112:115], v[60:63], v[144:147], a[112:115]
  s_waitcnt lgkmcnt(8)
  v_mfma_f32_16x16x32_bf16 v[160:163], v[64:67], v[144:147], v[160:163]
  v_lshl_add_u32 v254, v255, 4, v254
  v_mov_b32 v14, v254
  v_mfma_f32_16x16x32_bf16 v[164:167], v[64:67], v[148:151], v[164:167]
  v_lshrrev_b32 v14, 2, v0
  v_mfma_f32_16x16x32_bf16 v[168:171], v[64:67], v[152:155], v[168:171]
  v_lshlrev_b32 v14, 11, v14
  v_mfma_f32_16x16x32_bf16 v[172:175], v[64:67], v[156:159], v[172:175]
  v_lshl_add_u32 v14, v3, 4, v14
  v_mfma_f32_16x16x32_bf16 v[188:191], v[68:71], v[156:159], v[188:191]
  v_lshl_add_u32 v253, v253, 1, v255
  v_mfma_f32_16x16x32_bf16 v[184:187], v[68:71], v[152:155], v[184:187]
  v_lshrrev_b32 v254, 1, v2
  v_mfma_f32_16x16x32_bf16 v[180:183], v[68:71], v[148:151], v[180:183]
  v_xor_b32 v254, v2, v254
  v_mfma_f32_16x16x32_bf16 v[176:179], v[68:71], v[144:147], v[176:179]
  s_add_u32 m0, s49, 8192
  s_add_u32 s45, s48, 57344
  v_mfma_f32_16x16x32_bf16 v[192:195], v[72:75], v[144:147], v[192:195]
  buffer_load_dwordx4 v28, s[28:31], s45 offen offset:0 lds
  v_xor_b32 v253, v253, v254
  v_mfma_f32_16x16x32_bf16 v[196:199], v[72:75], v[148:151], v[196:199]
  v_lshlrev_b32 v252, 6, v252
  v_lshl_add_u32 v16, v253, 4, v252
  v_mfma_f32_16x16x32_bf16 v[200:203], v[72:75], v[152:155], v[200:203]
  v_add_u32 v17, 0x10000, v16
  v_mfma_f32_16x16x32_bf16 v[204:207], v[72:75], v[156:159], v[204:207]
  v_add_u32 v18, 0x20000, v16
  v_mfma_f32_16x16x32_bf16 v[220:223], v[76:79], v[156:159], v[220:223]
  v_mfma_f32_16x16x32_bf16 v[216:219], v[76:79], v[152:155], v[216:219]
  v_mfma_f32_16x16x32_bf16 v[212:215], v[76:79], v[148:151], v[212:215]
  v_mfma_f32_16x16x32_bf16 v[208:211], v[76:79], v[144:147], v[208:211]
  s_waitcnt lgkmcnt(0)
  v_mfma_f32_16x16x32_bf16 v[224:227], v[80:83], v[144:147], v[224:227]
  v_mfma_f32_16x16x32_bf16 v[228:231], v[80:83], v[148:151], v[228:231]
  v_mfma_f32_16x16x32_bf16 v[232:235], v[80:83], v[152:155], v[232:235]
  buffer_load_dwordx4 v29, s[28:31], s45 offen offset:1024 lds
  v_mfma_f32_16x16x32_bf16 v[236:239], v[80:83], v[156:159], v[236:239]
  v_mfma_f32_16x16x32_bf16 a[132:135], v[84:87], v[156:159], a[132:135]
  v_mfma_f32_16x16x32_bf16 a[128:131], v[84:87], v[152:155], a[128:131]
  v_mfma_f32_16x16x32_bf16 v[244:247], v[84:87], v[148:151], v[244:247]
  v_mfma_f32_16x16x32_bf16 v[240:243], v[84:87], v[144:147], v[240:243]
  v_mfma_f32_16x16x32_bf16 a[136:139], v[88:91], v[144:147], a[136:139]
  v_mfma_f32_16x16x32_bf16 a[140:143], v[88:91], v[148:151], a[140:143]
  v_mfma_f32_16x16x32_bf16 a[148:151], v[92:95], v[148:151], a[148:151]
  v_mfma_f32_16x16x32_bf16 a[144:147], v[92:95], v[144:147], a[144:147]
  s_add_u32 m0, s47, 16384
  s_add_u32 s45, s48, 81920
  buffer_load_dwordx4 v21, s[24:27], s45 offen offset:0 lds
  buffer_load_dwordx4 v22, s[24:27], s45 offen offset:2048 lds
  s_add_u32 m0, s49, 24576
  s_add_u32 s45, s48, 65536
  buffer_load_dwordx4 v28, s[28:31], s45 offen offset:0 lds
  buffer_load_dwordx4 v29, s[28:31], s45 offen offset:1024 lds
  buffer_load_dword v251, v24, s[32:35], s3 offen
  s_load_dwordx2 s[4:5], s[0:1], 56
  s_load_dwordx2 s[8:9], s[0:1], 32
  s_load_dwordx2 s[12:13], s[0:1], 72
  s_mov_b32 s92, 0xbfb8aa3b
  s_mov_b32 s93, 0xbfb8aa3b
  s_mov_b32 s94, 1.0
  s_mov_b32 s95, 1.0
  s_mov_b32 s96, 0x3e0293ee
  s_mov_b32 s97, 0x3e0293ee
  v_pk_mul_f32 v[40:41], v[160:161], s[92:93]
  v_pk_mul_f32 v[42:43], v[162:163], s[92:93]
  v_pk_mul_f32 v[44:45], v[176:177], s[92:93]
  v_pk_mul_f32 v[46:47], v[178:179], s[92:93]
  v_exp_f32 v40, v40
  v_exp_f32 v41, v41
  v_exp_f32 v42, v42
  v_exp_f32 v43, v43
  v_exp_f32 v44, v44
  v_exp_f32 v45, v45
  v_exp_f32 v46, v46
  v_exp_f32 v47, v47
  v_pk_add_f32 v[40:41], v[40:41], s[94:95]
  v_pk_add_f32 v[42:43], v[42:43], s[94:95]
  v_pk_add_f32 v[44:45], v[44:45], s[94:95]
  v_pk_add_f32 v[46:47], v[46:47], s[94:95]
  v_rcp_f32 v40, v40
  v_rcp_f32 v41, v41
  v_rcp_f32 v42, v42
  v_rcp_f32 v43, v43
  v_rcp_f32 v44, v44
  v_rcp_f32 v45, v45
  v_rcp_f32 v46, v46
  v_rcp_f32 v47, v47
  v_pk_mul_f32 v[40:41], v[160:161], v[40:41]
  v_pk_mul_f32 v[42:43], v[162:163], v[42:43]
  v_pk_mul_f32 v[44:45], v[176:177], v[44:45]
  v_pk_mul_f32 v[46:47], v[178:179], v[46:47]
  v_cvt_pk_bf16_f32 v48, v40, v41
  v_cvt_pk_bf16_f32 v49, v42, v43
  v_cvt_pk_bf16_f32 v50, v44, v45
  v_cvt_pk_bf16_f32 v51, v46, v47
  buffer_store_dwordx4 v[48:51], v20, s[16:19], s50 offen offset:0 sc1
  v_accvgpr_read_b32 v56, a0
  v_accvgpr_read_b32 v57, a1
  v_accvgpr_read_b32 v58, a2
  v_accvgpr_read_b32 v59, a3
  v_accvgpr_read_b32 v60, a16
  v_accvgpr_read_b32 v61, a17
  v_accvgpr_read_b32 v62, a18
  v_accvgpr_read_b32 v63, a19
  v_pk_mul_f32 v[56:57], v[56:57], s[96:97]
  v_pk_mul_f32 v[58:59], v[58:59], s[96:97]
  v_pk_mul_f32 v[60:61], v[60:61], s[96:97]
  v_pk_mul_f32 v[62:63], v[62:63], s[96:97]
  v_cvt_pk_bf16_f32 v128, v56, v57
  v_cvt_pk_bf16_f32 v129, v58, v59
  v_cvt_pk_bf16_f32 v130, v60, v61
  v_cvt_pk_bf16_f32 v131, v62, v63
  v_pk_mul_f32 v[40:41], v[164:165], s[92:93]
  v_pk_mul_f32 v[42:43], v[166:167], s[92:93]
  v_pk_mul_f32 v[44:45], v[180:181], s[92:93]
  v_pk_mul_f32 v[46:47], v[182:183], s[92:93]
  v_exp_f32 v40, v40
  v_exp_f32 v41, v41
  v_exp_f32 v42, v42
  v_exp_f32 v43, v43
  v_exp_f32 v44, v44
  v_exp_f32 v45, v45
  v_exp_f32 v46, v46
  v_exp_f32 v47, v47
  v_pk_add_f32 v[40:41], v[40:41], s[94:95]
  v_pk_add_f32 v[42:43], v[42:43], s[94:95]
  v_pk_add_f32 v[44:45], v[44:45], s[94:95]
  v_pk_add_f32 v[46:47], v[46:47], s[94:95]
  v_rcp_f32 v40, v40
  v_rcp_f32 v41, v41
  v_rcp_f32 v42, v42
  v_rcp_f32 v43, v43
  v_rcp_f32 v44, v44
  v_rcp_f32 v45, v45
  v_rcp_f32 v46, v46
  v_rcp_f32 v47, v47
  v_pk_mul_f32 v[40:41], v[164:165], v[40:41]
  v_pk_mul_f32 v[42:43], v[166:167], v[42:43]
  v_pk_mul_f32 v[44:45], v[180:181], v[44:45]
  v_pk_mul_f32 v[46:47], v[182:183], v[46:47]
  v_cvt_pk_bf16_f32 v48, v40, v41
  v_cvt_pk_bf16_f32 v49, v42, v43
  v_cvt_pk_bf16_f32 v50, v44, v45
  v_cvt_pk_bf16_f32 v51, v46, v47
  buffer_store_dwordx4 v[48:51], v20, s[16:19], s51 offen offset:0 sc1
  v_accvgpr_read_b32 v56, a32
  v_accvgpr_read_b32 v57, a33
  v_accvgpr_read_b32 v58, a34
  v_accvgpr_read_b32 v59, a35
  v_accvgpr_read_b32 v60, a48
  v_accvgpr_read_b32 v61, a49
  v_accvgpr_read_b32 v62, a50
  v_accvgpr_read_b32 v63, a51
  v_permlane16_swap_b32 v128, v130
  v_permlane16_swap_b32 v129, v131
  v_pk_mul_f32 v[56:57], v[56:57], s[96:97]
  v_pk_mul_f32 v[58:59], v[58:59], s[96:97]
  v_pk_mul_f32 v[60:61], v[60:61], s[96:97]
  v_pk_mul_f32 v[62:63], v[62:63], s[96:97]
  v_cvt_pk_bf16_f32 v132, v56, v57
  v_cvt_pk_bf16_f32 v133, v58, v59
  v_cvt_pk_bf16_f32 v134, v60, v61
  v_cvt_pk_bf16_f32 v135, v62, v63
  v_pk_mul_f32 v[40:41], v[168:169], s[92:93]
  v_pk_mul_f32 v[42:43], v[170:171], s[92:93]
  v_pk_mul_f32 v[44:45], v[184:185], s[92:93]
  v_pk_mul_f32 v[46:47], v[186:187], s[92:93]
  v_exp_f32 v40, v40
  v_exp_f32 v41, v41
  v_exp_f32 v42, v42
  v_exp_f32 v43, v43
  v_exp_f32 v44, v44
  v_exp_f32 v45, v45
  v_exp_f32 v46, v46
  v_exp_f32 v47, v47
  v_pk_add_f32 v[40:41], v[40:41], s[94:95]
  v_pk_add_f32 v[42:43], v[42:43], s[94:95]
  v_pk_add_f32 v[44:45], v[44:45], s[94:95]
  v_pk_add_f32 v[46:47], v[46:47], s[94:95]
  v_rcp_f32 v40, v40
  v_rcp_f32 v41, v41
  v_rcp_f32 v42, v42
  v_rcp_f32 v43, v43
  v_rcp_f32 v44, v44
  v_rcp_f32 v45, v45
  v_rcp_f32 v46, v46
  v_rcp_f32 v47, v47
  v_pk_mul_f32 v[40:41], v[168:169], v[40:41]
  v_pk_mul_f32 v[42:43], v[170:171], v[42:43]
  v_pk_mul_f32 v[44:45], v[184:185], v[44:45]
  v_pk_mul_f32 v[46:47], v[186:187], v[46:47]
  v_cvt_pk_bf16_f32 v48, v40, v41
  v_cvt_pk_bf16_f32 v49, v42, v43
  v_cvt_pk_bf16_f32 v50, v44, v45
  v_cvt_pk_bf16_f32 v51, v46, v47
  buffer_store_dwordx4 v[48:51], v20, s[16:19], s52 offen offset:0 sc1
  v_accvgpr_read_b32 v56, a64
  v_accvgpr_read_b32 v57, a65
  v_accvgpr_read_b32 v58, a66
  v_accvgpr_read_b32 v59, a67
  v_accvgpr_read_b32 v60, a80
  v_accvgpr_read_b32 v61, a81
  v_accvgpr_read_b32 v62, a82
  v_accvgpr_read_b32 v63, a83
  v_permlane16_swap_b32 v132, v134
  v_permlane16_swap_b32 v133, v135
  v_pk_mul_f32 v[56:57], v[56:57], s[96:97]
  v_pk_mul_f32 v[58:59], v[58:59], s[96:97]
  v_pk_mul_f32 v[60:61], v[60:61], s[96:97]
  v_pk_mul_f32 v[62:63], v[62:63], s[96:97]
  v_cvt_pk_bf16_f32 v136, v56, v57
  v_cvt_pk_bf16_f32 v137, v58, v59
  v_cvt_pk_bf16_f32 v138, v60, v61
  v_cvt_pk_bf16_f32 v139, v62, v63
  v_pk_mul_f32 v[40:41], v[172:173], s[92:93]
  v_pk_mul_f32 v[42:43], v[174:175], s[92:93]
  v_pk_mul_f32 v[44:45], v[188:189], s[92:93]
  v_pk_mul_f32 v[46:47], v[190:191], s[92:93]
  v_exp_f32 v40, v40
  v_exp_f32 v41, v41
  v_exp_f32 v42, v42
  v_exp_f32 v43, v43
  v_exp_f32 v44, v44
  v_exp_f32 v45, v45
  v_exp_f32 v46, v46
  v_exp_f32 v47, v47
  v_pk_add_f32 v[40:41], v[40:41], s[94:95]
  v_pk_add_f32 v[42:43], v[42:43], s[94:95]
  v_pk_add_f32 v[44:45], v[44:45], s[94:95]
  v_pk_add_f32 v[46:47], v[46:47], s[94:95]
  v_rcp_f32 v40, v40
  v_rcp_f32 v41, v41
  v_rcp_f32 v42, v42
  v_rcp_f32 v43, v43
  v_rcp_f32 v44, v44
  v_rcp_f32 v45, v45
  v_rcp_f32 v46, v46
  v_rcp_f32 v47, v47
  v_pk_mul_f32 v[40:41], v[172:173], v[40:41]
  v_pk_mul_f32 v[42:43], v[174:175], v[42:43]
  v_pk_mul_f32 v[44:45], v[188:189], v[44:45]
  v_pk_mul_f32 v[46:47], v[190:191], v[46:47]
  v_cvt_pk_bf16_f32 v48, v40, v41
  v_cvt_pk_bf16_f32 v49, v42, v43
  v_cvt_pk_bf16_f32 v50, v44, v45
  v_cvt_pk_bf16_f32 v51, v46, v47
  buffer_store_dwordx4 v[48:51], v20, s[16:19], s53 offen offset:0 sc1
  v_accvgpr_read_b32 v56, a96
  v_accvgpr_read_b32 v57, a97
  v_accvgpr_read_b32 v58, a98
  v_accvgpr_read_b32 v59, a99
  v_accvgpr_read_b32 v60, a112
  v_accvgpr_read_b32 v61, a113
  v_accvgpr_read_b32 v62, a114
  v_accvgpr_read_b32 v63, a115
  v_permlane16_swap_b32 v136, v138
  v_permlane16_swap_b32 v137, v139
  v_pk_mul_f32 v[56:57], v[56:57], s[96:97]
  v_pk_mul_f32 v[58:59], v[58:59], s[96:97]
  v_pk_mul_f32 v[60:61], v[60:61], s[96:97]
  v_pk_mul_f32 v[62:63], v[62:63], s[96:97]
  v_cvt_pk_bf16_f32 v140, v56, v57
  v_cvt_pk_bf16_f32 v141, v58, v59
  v_cvt_pk_bf16_f32 v142, v60, v61
  v_cvt_pk_bf16_f32 v143, v62, v63
  v_accvgpr_read_b32 v36, a128
  v_accvgpr_read_b32 v37, a129
  v_accvgpr_read_b32 v38, a130
  v_accvgpr_read_b32 v39, a131
  v_pk_mul_f32 v[40:41], v[232:233], s[92:93]
  v_pk_mul_f32 v[42:43], v[234:235], s[92:93]
  v_pk_mul_f32 v[44:45], v[36:37], s[92:93]
  v_pk_mul_f32 v[46:47], v[38:39], s[92:93]
  v_exp_f32 v40, v40
  v_exp_f32 v41, v41
  v_exp_f32 v42, v42
  v_exp_f32 v43, v43
  v_exp_f32 v44, v44
  v_exp_f32 v45, v45
  v_exp_f32 v46, v46
  v_exp_f32 v47, v47
  v_pk_add_f32 v[40:41], v[40:41], s[94:95]
  v_pk_add_f32 v[42:43], v[42:43], s[94:95]
  v_pk_add_f32 v[44:45], v[44:45], s[94:95]
  v_pk_add_f32 v[46:47], v[46:47], s[94:95]
  v_rcp_f32 v40, v40
  v_rcp_f32 v41, v41
  v_rcp_f32 v42, v42
  v_rcp_f32 v43, v43
  v_rcp_f32 v44, v44
  v_rcp_f32 v45, v45
  v_rcp_f32 v46, v46
  v_rcp_f32 v47, v47
  v_pk_mul_f32 v[40:41], v[232:233], v[40:41]
  v_pk_mul_f32 v[42:43], v[234:235], v[42:43]
  v_pk_mul_f32 v[44:45], v[36:37], v[44:45]
  v_pk_mul_f32 v[46:47], v[38:39], v[46:47]
  v_cvt_pk_bf16_f32 v48, v40, v41
  v_cvt_pk_bf16_f32 v49, v42, v43
  v_cvt_pk_bf16_f32 v50, v44, v45
  v_cvt_pk_bf16_f32 v51, v46, v47
  buffer_store_dwordx4 v[48:51], v20, s[16:19], s52 offen offset:2048 sc1
  v_accvgpr_read_b32 v56, a4
  v_accvgpr_read_b32 v57, a5
  v_accvgpr_read_b32 v58, a6
  v_accvgpr_read_b32 v59, a7
  v_accvgpr_read_b32 v60, a20
  v_accvgpr_read_b32 v61, a21
  v_accvgpr_read_b32 v62, a22
  v_accvgpr_read_b32 v63, a23
  v_permlane16_swap_b32 v140, v142
  v_permlane16_swap_b32 v141, v143
  v_pk_mul_f32 v[56:57], v[56:57], s[96:97]
  v_pk_mul_f32 v[58:59], v[58:59], s[96:97]
  v_pk_mul_f32 v[60:61], v[60:61], s[96:97]
  v_pk_mul_f32 v[62:63], v[62:63], s[96:97]
  v_cvt_pk_bf16_f32 v144, v56, v57
  v_cvt_pk_bf16_f32 v145, v58, v59
  v_cvt_pk_bf16_f32 v146, v60, v61
  v_cvt_pk_bf16_f32 v147, v62, v63
  v_accvgpr_read_b32 v36, a132
  v_accvgpr_read_b32 v37, a133
  v_accvgpr_read_b32 v38, a134
  v_accvgpr_read_b32 v39, a135
  v_pk_mul_f32 v[40:41], v[236:237], s[92:93]
  v_pk_mul_f32 v[42:43], v[238:239], s[92:93]
  v_pk_mul_f32 v[44:45], v[36:37], s[92:93]
  v_pk_mul_f32 v[46:47], v[38:39], s[92:93]
  v_exp_f32 v40, v40
  v_exp_f32 v41, v41
  v_exp_f32 v42, v42
  v_exp_f32 v43, v43
  v_exp_f32 v44, v44
  v_exp_f32 v45, v45
  v_exp_f32 v46, v46
  v_exp_f32 v47, v47
  v_pk_add_f32 v[40:41], v[40:41], s[94:95]
  v_pk_add_f32 v[42:43], v[42:43], s[94:95]
  v_pk_add_f32 v[44:45], v[44:45], s[94:95]
  v_pk_add_f32 v[46:47], v[46:47], s[94:95]
  v_rcp_f32 v40, v40
  v_rcp_f32 v41, v41
  v_rcp_f32 v42, v42
  v_rcp_f32 v43, v43
  v_rcp_f32 v44, v44
  v_rcp_f32 v45, v45
  v_rcp_f32 v46, v46
  v_rcp_f32 v47, v47
  v_pk_mul_f32 v[40:41], v[236:237], v[40:41]
  v_pk_mul_f32 v[42:43], v[238:239], v[42:43]
  v_pk_mul_f32 v[44:45], v[36:37], v[44:45]
  v_pk_mul_f32 v[46:47], v[38:39], v[46:47]
  v_cvt_pk_bf16_f32 v48, v40, v41
  v_cvt_pk_bf16_f32 v49, v42, v43
  v_cvt_pk_bf16_f32 v50, v44, v45
  v_cvt_pk_bf16_f32 v51, v46, v47
  buffer_store_dwordx4 v[48:51], v20, s[16:19], s53 offen offset:2048 sc1
  v_accvgpr_read_b32 v56, a36
  v_accvgpr_read_b32 v57, a37
  v_accvgpr_read_b32 v58, a38
  v_accvgpr_read_b32 v59, a39
  v_accvgpr_read_b32 v60, a52
  v_accvgpr_read_b32 v61, a53
  v_accvgpr_read_b32 v62, a54
  v_accvgpr_read_b32 v63, a55
  v_permlane16_swap_b32 v144, v146
  v_permlane16_swap_b32 v145, v147
  v_pk_mul_f32 v[56:57], v[56:57], s[96:97]
  v_pk_mul_f32 v[58:59], v[58:59], s[96:97]
  v_pk_mul_f32 v[60:61], v[60:61], s[96:97]
  v_pk_mul_f32 v[62:63], v[62:63], s[96:97]
  v_cvt_pk_bf16_f32 v148, v56, v57
  v_cvt_pk_bf16_f32 v149, v58, v59
  v_cvt_pk_bf16_f32 v150, v60, v61
  v_cvt_pk_bf16_f32 v151, v62, v63
  v_accvgpr_read_b32 v32, a136
  v_accvgpr_read_b32 v33, a137
  v_accvgpr_read_b32 v34, a138
  v_accvgpr_read_b32 v35, a139
  v_accvgpr_read_b32 v36, a144
  v_accvgpr_read_b32 v37, a145
  v_accvgpr_read_b32 v38, a146
  v_accvgpr_read_b32 v39, a147
  v_pk_mul_f32 v[40:41], v[32:33], s[92:93]
  v_pk_mul_f32 v[42:43], v[34:35], s[92:93]
  v_pk_mul_f32 v[44:45], v[36:37], s[92:93]
  v_pk_mul_f32 v[46:47], v[38:39], s[92:93]
  v_exp_f32 v40, v40
  v_exp_f32 v41, v41
  v_exp_f32 v42, v42
  v_exp_f32 v43, v43
  v_exp_f32 v44, v44
  v_exp_f32 v45, v45
  v_exp_f32 v46, v46
  v_exp_f32 v47, v47
  v_pk_add_f32 v[40:41], v[40:41], s[94:95]
  v_pk_add_f32 v[42:43], v[42:43], s[94:95]
  v_pk_add_f32 v[44:45], v[44:45], s[94:95]
  v_pk_add_f32 v[46:47], v[46:47], s[94:95]
  v_rcp_f32 v40, v40
  v_rcp_f32 v41, v41
  v_rcp_f32 v42, v42
  v_rcp_f32 v43, v43
  v_rcp_f32 v44, v44
  v_rcp_f32 v45, v45
  v_rcp_f32 v46, v46
  v_rcp_f32 v47, v47
  v_pk_mul_f32 v[40:41], v[32:33], v[40:41]
  v_pk_mul_f32 v[42:43], v[34:35], v[42:43]
  v_pk_mul_f32 v[44:45], v[36:37], v[44:45]
  v_pk_mul_f32 v[46:47], v[38:39], v[46:47]
  v_cvt_pk_bf16_f32 v48, v40, v41
  v_cvt_pk_bf16_f32 v49, v42, v43
  v_cvt_pk_bf16_f32 v50, v44, v45
  v_cvt_pk_bf16_f32 v51, v46, v47
  buffer_store_dwordx4 v[48:51], v20, s[16:19], s54 offen offset:0 sc1
  v_accvgpr_read_b32 v56, a68
  v_accvgpr_read_b32 v57, a69
  v_accvgpr_read_b32 v58, a70
  v_accvgpr_read_b32 v59, a71
  v_accvgpr_read_b32 v60, a84
  v_accvgpr_read_b32 v61, a85
  v_accvgpr_read_b32 v62, a86
  v_accvgpr_read_b32 v63, a87
  v_permlane16_swap_b32 v148, v150
  v_permlane16_swap_b32 v149, v151
  v_pk_mul_f32 v[56:57], v[56:57], s[96:97]
  v_pk_mul_f32 v[58:59], v[58:59], s[96:97]
  v_pk_mul_f32 v[60:61], v[60:61], s[96:97]
  v_pk_mul_f32 v[62:63], v[62:63], s[96:97]
  v_cvt_pk_bf16_f32 v152, v56, v57
  v_cvt_pk_bf16_f32 v153, v58, v59
  v_cvt_pk_bf16_f32 v154, v60, v61
  v_cvt_pk_bf16_f32 v155, v62, v63
  v_accvgpr_read_b32 v32, a140
  v_accvgpr_read_b32 v33, a141
  v_accvgpr_read_b32 v34, a142
  v_accvgpr_read_b32 v35, a143
  v_accvgpr_read_b32 v36, a148
  v_accvgpr_read_b32 v37, a149
  v_accvgpr_read_b32 v38, a150
  v_accvgpr_read_b32 v39, a151
  v_pk_mul_f32 v[40:41], v[32:33], s[92:93]
  v_pk_mul_f32 v[42:43], v[34:35], s[92:93]
  v_pk_mul_f32 v[44:45], v[36:37], s[92:93]
  v_pk_mul_f32 v[46:47], v[38:39], s[92:93]
  v_exp_f32 v40, v40
  v_exp_f32 v41, v41
  v_exp_f32 v42, v42
  v_exp_f32 v43, v43
  v_exp_f32 v44, v44
  v_exp_f32 v45, v45
  v_exp_f32 v46, v46
  v_exp_f32 v47, v47
  v_pk_add_f32 v[40:41], v[40:41], s[94:95]
  v_pk_add_f32 v[42:43], v[42:43], s[94:95]
  v_pk_add_f32 v[44:45], v[44:45], s[94:95]
  v_pk_add_f32 v[46:47], v[46:47], s[94:95]
  v_rcp_f32 v40, v40
  v_rcp_f32 v41, v41
  v_rcp_f32 v42, v42
  v_rcp_f32 v43, v43
  v_rcp_f32 v44, v44
  v_rcp_f32 v45, v45
  v_rcp_f32 v46, v46
  v_rcp_f32 v47, v47
  v_pk_mul_f32 v[40:41], v[32:33], v[40:41]
  v_pk_mul_f32 v[42:43], v[34:35], v[42:43]
  v_pk_mul_f32 v[44:45], v[36:37], v[44:45]
  v_pk_mul_f32 v[46:47], v[38:39], v[46:47]
  v_cvt_pk_bf16_f32 v48, v40, v41
  v_cvt_pk_bf16_f32 v49, v42, v43
  v_cvt_pk_bf16_f32 v50, v44, v45
  v_cvt_pk_bf16_f32 v51, v46, v47
  buffer_store_dwordx4 v[48:51], v20, s[16:19], s55 offen offset:0 sc1
  v_accvgpr_read_b32 v56, a100
  v_accvgpr_read_b32 v57, a101
  v_accvgpr_read_b32 v58, a102
  v_accvgpr_read_b32 v59, a103
  v_accvgpr_read_b32 v60, a116
  v_accvgpr_read_b32 v61, a117
  v_accvgpr_read_b32 v62, a118
  v_accvgpr_read_b32 v63, a119
  v_permlane16_swap_b32 v152, v154
  v_permlane16_swap_b32 v153, v155
  v_pk_mul_f32 v[56:57], v[56:57], s[96:97]
  v_pk_mul_f32 v[58:59], v[58:59], s[96:97]
  v_pk_mul_f32 v[60:61], v[60:61], s[96:97]
  v_pk_mul_f32 v[62:63], v[62:63], s[96:97]
  v_cvt_pk_bf16_f32 v156, v56, v57
  v_cvt_pk_bf16_f32 v157, v58, v59
  v_cvt_pk_bf16_f32 v158, v60, v61
  v_cvt_pk_bf16_f32 v159, v62, v63
  v_pk_mul_f32 v[40:41], v[192:193], s[92:93]
  v_pk_mul_f32 v[42:43], v[194:195], s[92:93]
  v_pk_mul_f32 v[44:45], v[208:209], s[92:93]
  v_pk_mul_f32 v[46:47], v[210:211], s[92:93]
  v_exp_f32 v40, v40
  v_exp_f32 v41, v41
  v_exp_f32 v42, v42
  v_exp_f32 v43, v43
  v_exp_f32 v44, v44
  v_exp_f32 v45, v45
  v_exp_f32 v46, v46
  v_exp_f32 v47, v47
  v_pk_add_f32 v[40:41], v[40:41], s[94:95]
  v_pk_add_f32 v[42:43], v[42:43], s[94:95]
  v_pk_add_f32 v[44:45], v[44:45], s[94:95]
  v_pk_add_f32 v[46:47], v[46:47], s[94:95]
  v_rcp_f32 v40, v40
  v_rcp_f32 v41, v41
  v_rcp_f32 v42, v42
  v_rcp_f32 v43, v43
  v_rcp_f32 v44, v44
  v_rcp_f32 v45, v45
  v_rcp_f32 v46, v46
  v_rcp_f32 v47, v47
  v_pk_mul_f32 v[40:41], v[192:193], v[40:41]
  v_pk_mul_f32 v[42:43], v[194:195], v[42:43]
  v_pk_mul_f32 v[44:45], v[208:209], v[44:45]
  v_pk_mul_f32 v[46:47], v[210:211], v[46:47]
  v_cvt_pk_bf16_f32 v48, v40, v41
  v_cvt_pk_bf16_f32 v49, v42, v43
  v_cvt_pk_bf16_f32 v50, v44, v45
  v_cvt_pk_bf16_f32 v51, v46, v47
  buffer_store_dwordx4 v[48:51], v20, s[16:19], s50 offen offset:1024 sc1
  v_accvgpr_read_b32 v56, a8
  v_accvgpr_read_b32 v57, a9
  v_accvgpr_read_b32 v58, a10
  v_accvgpr_read_b32 v59, a11
  v_accvgpr_read_b32 v60, a24
  v_accvgpr_read_b32 v61, a25
  v_accvgpr_read_b32 v62, a26
  v_accvgpr_read_b32 v63, a27
  v_permlane16_swap_b32 v156, v158
  v_permlane16_swap_b32 v157, v159
  v_pk_mul_f32 v[56:57], v[56:57], s[96:97]
  v_pk_mul_f32 v[58:59], v[58:59], s[96:97]
  v_pk_mul_f32 v[60:61], v[60:61], s[96:97]
  v_pk_mul_f32 v[62:63], v[62:63], s[96:97]
  v_cvt_pk_bf16_f32 v160, v56, v57
  v_cvt_pk_bf16_f32 v161, v58, v59
  v_cvt_pk_bf16_f32 v162, v60, v61
  v_cvt_pk_bf16_f32 v163, v62, v63
  v_pk_mul_f32 v[40:41], v[196:197], s[92:93]
  v_pk_mul_f32 v[42:43], v[198:199], s[92:93]
  v_pk_mul_f32 v[44:45], v[212:213], s[92:93]
  v_pk_mul_f32 v[46:47], v[214:215], s[92:93]
  v_exp_f32 v40, v40
  v_exp_f32 v41, v41
  v_exp_f32 v42, v42
  v_exp_f32 v43, v43
  v_exp_f32 v44, v44
  v_exp_f32 v45, v45
  v_exp_f32 v46, v46
  v_exp_f32 v47, v47
  v_pk_add_f32 v[40:41], v[40:41], s[94:95]
  v_pk_add_f32 v[42:43], v[42:43], s[94:95]
  v_pk_add_f32 v[44:45], v[44:45], s[94:95]
  v_pk_add_f32 v[46:47], v[46:47], s[94:95]
  v_rcp_f32 v40, v40
  v_rcp_f32 v41, v41
  v_rcp_f32 v42, v42
  v_rcp_f32 v43, v43
  v_rcp_f32 v44, v44
  v_rcp_f32 v45, v45
  v_rcp_f32 v46, v46
  v_rcp_f32 v47, v47
  v_pk_mul_f32 v[40:41], v[196:197], v[40:41]
  v_pk_mul_f32 v[42:43], v[198:199], v[42:43]
  v_pk_mul_f32 v[44:45], v[212:213], v[44:45]
  v_pk_mul_f32 v[46:47], v[214:215], v[46:47]
  v_cvt_pk_bf16_f32 v48, v40, v41
  v_cvt_pk_bf16_f32 v49, v42, v43
  v_cvt_pk_bf16_f32 v50, v44, v45
  v_cvt_pk_bf16_f32 v51, v46, v47
  buffer_store_dwordx4 v[48:51], v20, s[16:19], s51 offen offset:1024 sc1
  v_accvgpr_read_b32 v56, a40
  v_accvgpr_read_b32 v57, a41
  v_accvgpr_read_b32 v58, a42
  v_accvgpr_read_b32 v59, a43
  v_accvgpr_read_b32 v60, a56
  v_accvgpr_read_b32 v61, a57
  v_accvgpr_read_b32 v62, a58
  v_accvgpr_read_b32 v63, a59
  v_permlane16_swap_b32 v160, v162
  v_permlane16_swap_b32 v161, v163
  v_pk_mul_f32 v[56:57], v[56:57], s[96:97]
  v_pk_mul_f32 v[58:59], v[58:59], s[96:97]
  v_pk_mul_f32 v[60:61], v[60:61], s[96:97]
  v_pk_mul_f32 v[62:63], v[62:63], s[96:97]
  v_cvt_pk_bf16_f32 v164, v56, v57
  v_cvt_pk_bf16_f32 v165, v58, v59
  v_cvt_pk_bf16_f32 v166, v60, v61
  v_cvt_pk_bf16_f32 v167, v62, v63
  v_pk_mul_f32 v[40:41], v[200:201], s[92:93]
  v_pk_mul_f32 v[42:43], v[202:203], s[92:93]
  v_pk_mul_f32 v[44:45], v[216:217], s[92:93]
  v_pk_mul_f32 v[46:47], v[218:219], s[92:93]
  v_exp_f32 v40, v40
  v_exp_f32 v41, v41
  v_exp_f32 v42, v42
  v_exp_f32 v43, v43
  v_exp_f32 v44, v44
  v_exp_f32 v45, v45
  v_exp_f32 v46, v46
  v_exp_f32 v47, v47
  v_pk_add_f32 v[40:41], v[40:41], s[94:95]
  v_pk_add_f32 v[42:43], v[42:43], s[94:95]
  v_pk_add_f32 v[44:45], v[44:45], s[94:95]
  v_pk_add_f32 v[46:47], v[46:47], s[94:95]
  v_rcp_f32 v40, v40
  v_rcp_f32 v41, v41
  v_rcp_f32 v42, v42
  v_rcp_f32 v43, v43
  v_rcp_f32 v44, v44
  v_rcp_f32 v45, v45
  v_rcp_f32 v46, v46
  v_rcp_f32 v47, v47
  v_pk_mul_f32 v[40:41], v[200:201], v[40:41]
  v_pk_mul_f32 v[42:43], v[202:203], v[42:43]
  v_pk_mul_f32 v[44:45], v[216:217], v[44:45]
  v_pk_mul_f32 v[46:47], v[218:219], v[46:47]
  v_cvt_pk_bf16_f32 v48, v40, v41
  v_cvt_pk_bf16_f32 v49, v42, v43
  v_cvt_pk_bf16_f32 v50, v44, v45
  v_cvt_pk_bf16_f32 v51, v46, v47
  buffer_store_dwordx4 v[48:51], v20, s[16:19], s52 offen offset:1024 sc1
  v_accvgpr_read_b32 v56, a72
  v_accvgpr_read_b32 v57, a73
  v_accvgpr_read_b32 v58, a74
  v_accvgpr_read_b32 v59, a75
  v_accvgpr_read_b32 v60, a88
  v_accvgpr_read_b32 v61, a89
  v_accvgpr_read_b32 v62, a90
  v_accvgpr_read_b32 v63, a91
  v_permlane16_swap_b32 v164, v166
  v_permlane16_swap_b32 v165, v167
  v_pk_mul_f32 v[56:57], v[56:57], s[96:97]
  v_pk_mul_f32 v[58:59], v[58:59], s[96:97]
  v_pk_mul_f32 v[60:61], v[60:61], s[96:97]
  v_pk_mul_f32 v[62:63], v[62:63], s[96:97]
  v_cvt_pk_bf16_f32 v168, v56, v57
  v_cvt_pk_bf16_f32 v169, v58, v59
  v_cvt_pk_bf16_f32 v170, v60, v61
  v_cvt_pk_bf16_f32 v171, v62, v63
  v_pk_mul_f32 v[40:41], v[204:205], s[92:93]
  v_pk_mul_f32 v[42:43], v[206:207], s[92:93]
  v_pk_mul_f32 v[44:45], v[220:221], s[92:93]
  v_pk_mul_f32 v[46:47], v[222:223], s[92:93]
  v_exp_f32 v40, v40
  v_exp_f32 v41, v41
  v_exp_f32 v42, v42
  v_exp_f32 v43, v43
  v_exp_f32 v44, v44
  v_exp_f32 v45, v45
  v_exp_f32 v46, v46
  v_exp_f32 v47, v47
  v_pk_add_f32 v[40:41], v[40:41], s[94:95]
  v_pk_add_f32 v[42:43], v[42:43], s[94:95]
  v_pk_add_f32 v[44:45], v[44:45], s[94:95]
  v_pk_add_f32 v[46:47], v[46:47], s[94:95]
  v_rcp_f32 v40, v40
  v_rcp_f32 v41, v41
  v_rcp_f32 v42, v42
  v_rcp_f32 v43, v43
  v_rcp_f32 v44, v44
  v_rcp_f32 v45, v45
  v_rcp_f32 v46, v46
  v_rcp_f32 v47, v47
  v_pk_mul_f32 v[40:41], v[204:205], v[40:41]
  v_pk_mul_f32 v[42:43], v[206:207], v[42:43]
  v_pk_mul_f32 v[44:45], v[220:221], v[44:45]
  v_pk_mul_f32 v[46:47], v[222:223], v[46:47]
  v_cvt_pk_bf16_f32 v48, v40, v41
  v_cvt_pk_bf16_f32 v49, v42, v43
  v_cvt_pk_bf16_f32 v50, v44, v45
  v_cvt_pk_bf16_f32 v51, v46, v47
  buffer_store_dwordx4 v[48:51], v20, s[16:19], s53 offen offset:1024 sc1
  v_accvgpr_read_b32 v56, a104
  v_accvgpr_read_b32 v57, a105
  v_accvgpr_read_b32 v58, a106
  v_accvgpr_read_b32 v59, a107
  v_accvgpr_read_b32 v60, a120
  v_accvgpr_read_b32 v61, a121
  v_accvgpr_read_b32 v62, a122
  v_accvgpr_read_b32 v63, a123
  v_permlane16_swap_b32 v168, v170
  v_permlane16_swap_b32 v169, v171
  v_pk_mul_f32 v[56:57], v[56:57], s[96:97]
  v_pk_mul_f32 v[58:59], v[58:59], s[96:97]
  v_pk_mul_f32 v[60:61], v[60:61], s[96:97]
  v_pk_mul_f32 v[62:63], v[62:63], s[96:97]
  v_cvt_pk_bf16_f32 v172, v56, v57
  v_cvt_pk_bf16_f32 v173, v58, v59
  v_cvt_pk_bf16_f32 v174, v60, v61
  v_cvt_pk_bf16_f32 v175, v62, v63
  v_pk_mul_f32 v[40:41], v[224:225], s[92:93]
  v_pk_mul_f32 v[42:43], v[226:227], s[92:93]
  v_pk_mul_f32 v[44:45], v[240:241], s[92:93]
  v_pk_mul_f32 v[46:47], v[242:243], s[92:93]
  v_exp_f32 v40, v40
  v_exp_f32 v41, v41
  v_exp_f32 v42, v42
  v_exp_f32 v43, v43
  v_exp_f32 v44, v44
  v_exp_f32 v45, v45
  v_exp_f32 v46, v46
  v_exp_f32 v47, v47
  v_pk_add_f32 v[40:41], v[40:41], s[94:95]
  v_pk_add_f32 v[42:43], v[42:43], s[94:95]
  v_pk_add_f32 v[44:45], v[44:45], s[94:95]
  v_pk_add_f32 v[46:47], v[46:47], s[94:95]
  v_rcp_f32 v40, v40
  v_rcp_f32 v41, v41
  v_rcp_f32 v42, v42
  v_rcp_f32 v43, v43
  v_rcp_f32 v44, v44
  v_rcp_f32 v45, v45
  v_rcp_f32 v46, v46
  v_rcp_f32 v47, v47
  v_pk_mul_f32 v[40:41], v[224:225], v[40:41]
  v_pk_mul_f32 v[42:43], v[226:227], v[42:43]
  v_pk_mul_f32 v[44:45], v[240:241], v[44:45]
  v_pk_mul_f32 v[46:47], v[242:243], v[46:47]
  v_cvt_pk_bf16_f32 v48, v40, v41
  v_cvt_pk_bf16_f32 v49, v42, v43
  v_cvt_pk_bf16_f32 v50, v44, v45
  v_cvt_pk_bf16_f32 v51, v46, v47
  buffer_store_dwordx4 v[48:51], v20, s[16:19], s50 offen offset:2048 sc1
  v_accvgpr_read_b32 v56, a12
  v_accvgpr_read_b32 v57, a13
  v_accvgpr_read_b32 v58, a14
  v_accvgpr_read_b32 v59, a15
  v_accvgpr_read_b32 v60, a28
  v_accvgpr_read_b32 v61, a29
  v_accvgpr_read_b32 v62, a30
  v_accvgpr_read_b32 v63, a31
  v_permlane16_swap_b32 v172, v174
  v_permlane16_swap_b32 v173, v175
  v_pk_mul_f32 v[56:57], v[56:57], s[96:97]
  v_pk_mul_f32 v[58:59], v[58:59], s[96:97]
  v_pk_mul_f32 v[60:61], v[60:61], s[96:97]
  v_pk_mul_f32 v[62:63], v[62:63], s[96:97]
  v_cvt_pk_bf16_f32 v176, v56, v57
  v_cvt_pk_bf16_f32 v177, v58, v59
  v_cvt_pk_bf16_f32 v178, v60, v61
  v_cvt_pk_bf16_f32 v179, v62, v63
  v_pk_mul_f32 v[40:41], v[228:229], s[92:93]
  v_pk_mul_f32 v[42:43], v[230:231], s[92:93]
  v_pk_mul_f32 v[44:45], v[244:245], s[92:93]
  v_pk_mul_f32 v[46:47], v[246:247], s[92:93]
  v_exp_f32 v40, v40
  v_exp_f32 v41, v41
  v_exp_f32 v42, v42
  v_exp_f32 v43, v43
  v_exp_f32 v44, v44
  v_exp_f32 v45, v45
  v_exp_f32 v46, v46
  v_exp_f32 v47, v47
  v_pk_add_f32 v[40:41], v[40:41], s[94:95]
  v_pk_add_f32 v[42:43], v[42:43], s[94:95]
  v_pk_add_f32 v[44:45], v[44:45], s[94:95]
  v_pk_add_f32 v[46:47], v[46:47], s[94:95]
  v_rcp_f32 v40, v40
  v_rcp_f32 v41, v41
  v_rcp_f32 v42, v42
  v_rcp_f32 v43, v43
  v_rcp_f32 v44, v44
  v_rcp_f32 v45, v45
  v_rcp_f32 v46, v46
  v_rcp_f32 v47, v47
  v_pk_mul_f32 v[40:41], v[228:229], v[40:41]
  v_pk_mul_f32 v[42:43], v[230:231], v[42:43]
  v_pk_mul_f32 v[44:45], v[244:245], v[44:45]
  v_pk_mul_f32 v[46:47], v[246:247], v[46:47]
  v_cvt_pk_bf16_f32 v48, v40, v41
  v_cvt_pk_bf16_f32 v49, v42, v43
  v_cvt_pk_bf16_f32 v50, v44, v45
  v_cvt_pk_bf16_f32 v51, v46, v47
  buffer_store_dwordx4 v[48:51], v20, s[16:19], s51 offen offset:2048 sc1
  v_accvgpr_read_b32 v56, a44
  v_accvgpr_read_b32 v57, a45
  v_accvgpr_read_b32 v58, a46
  v_accvgpr_read_b32 v59, a47
  v_accvgpr_read_b32 v60, a60
  v_accvgpr_read_b32 v61, a61
  v_accvgpr_read_b32 v62, a62
  v_accvgpr_read_b32 v63, a63
  v_permlane16_swap_b32 v176, v178
  v_permlane16_swap_b32 v177, v179
  v_pk_mul_f32 v[56:57], v[56:57], s[96:97]
  v_pk_mul_f32 v[58:59], v[58:59], s[96:97]
  v_pk_mul_f32 v[60:61], v[60:61], s[96:97]
  v_pk_mul_f32 v[62:63], v[62:63], s[96:97]
  v_cvt_pk_bf16_f32 v180, v56, v57
  v_cvt_pk_bf16_f32 v181, v58, v59
  v_cvt_pk_bf16_f32 v182, v60, v61
  v_cvt_pk_bf16_f32 v183, v62, v63
  s_waitcnt lgkmcnt(0)
  ds_read_b128 a[128:131], v17 offset:32768
  ds_read_b128 a[144:147], v17 offset:33792
  ds_read_b128 a[132:135], v17 offset:34816
  ds_read_b128 a[148:151], v17 offset:35840
  ds_read_b128 a[136:139], v17 offset:36864
  ds_read_b128 a[152:155], v17 offset:37888
  ds_read_b128 a[140:143], v17 offset:38912
  ds_read_b128 a[156:159], v17 offset:39936
  s_waitcnt lgkmcnt(4)
  ds_read_b64_tr_b16 a[160:161], v10 offset:57344
  ds_read_b64_tr_b16 a[162:163], v10 offset:61440
  ds_read_b64_tr_b16 a[164:165], v11 offset:57344
  ds_read_b64_tr_b16 a[166:167], v11 offset:61440
  ds_read_b64_tr_b16 a[168:169], v10 offset:57600
  ds_read_b64_tr_b16 a[170:171], v10 offset:61696
  ds_read_b64_tr_b16 a[172:173], v11 offset:57600
  ds_read_b64_tr_b16 a[174:175], v11 offset:61696
  ds_read_b64_tr_b16 a[176:177], v10 offset:57856
  ds_read_b64_tr_b16 a[178:179], v10 offset:61952
  ds_read_b64_tr_b16 a[180:181], v11 offset:57856
  ds_read_b64_tr_b16 a[182:183], v11 offset:61952
  ds_read_b64_tr_b16 a[184:185], v10 offset:58112
  ds_read_b64_tr_b16 a[186:187], v10 offset:62208
  ds_read_b64_tr_b16 a[188:189], v11 offset:58112
  ds_read_b64_tr_b16 a[190:191], v11 offset:62208
  v_accvgpr_read_b32 v56, a76
  v_accvgpr_read_b32 v57, a77
  v_accvgpr_read_b32 v58, a78
  v_accvgpr_read_b32 v59, a79
  v_accvgpr_read_b32 v60, a92
  v_accvgpr_read_b32 v61, a93
  v_accvgpr_read_b32 v62, a94
  v_accvgpr_read_b32 v63, a95
  v_permlane16_swap_b32 v180, v182
  v_permlane16_swap_b32 v181, v183
  v_pk_mul_f32 v[56:57], v[56:57], s[96:97]
  v_pk_mul_f32 v[58:59], v[58:59], s[96:97]
  v_pk_mul_f32 v[60:61], v[60:61], s[96:97]
  v_pk_mul_f32 v[62:63], v[62:63], s[96:97]
  v_cvt_pk_bf16_f32 v184, v56, v57
  v_cvt_pk_bf16_f32 v185, v58, v59
  v_cvt_pk_bf16_f32 v186, v60, v61
  v_cvt_pk_bf16_f32 v187, v62, v63
  v_accvgpr_read_b32 v56, a108
  v_accvgpr_read_b32 v57, a109
  v_accvgpr_read_b32 v58, a110
  v_accvgpr_read_b32 v59, a111
  v_accvgpr_read_b32 v60, a124
  v_accvgpr_read_b32 v61, a125
  v_accvgpr_read_b32 v62, a126
  v_accvgpr_read_b32 v63, a127
  v_permlane16_swap_b32 v184, v186
  v_permlane16_swap_b32 v185, v187
  v_pk_mul_f32 v[56:57], v[56:57], s[96:97]
  v_pk_mul_f32 v[58:59], v[58:59], s[96:97]
  v_pk_mul_f32 v[60:61], v[60:61], s[96:97]
  v_pk_mul_f32 v[62:63], v[62:63], s[96:97]
  v_cvt_pk_bf16_f32 v188, v56, v57
  v_cvt_pk_bf16_f32 v189, v58, v59
  v_cvt_pk_bf16_f32 v190, v60, v61
  v_cvt_pk_bf16_f32 v191, v62, v63
  s_mov_b32 s6, 7340032
  s_mov_b32 s7, 0x00020000
  s_mov_b32 s10, 8388608
  s_mov_b32 s11, 0x00020000
  s_mov_b32 s14, 256
  s_mov_b32 s15, 0x00020000
  v_mov_b32 v208, 0x3f803f80
  v_mov_b32 v209, 0x3f803f80
  v_mov_b32 v210, 0x3f803f80
  v_mov_b32 v211, 0x3f803f80
  v_permlane16_swap_b32 v188, v190
  v_permlane16_swap_b32 v189, v191
  s_waitcnt lgkmcnt(15)
  v_mfma_f32_16x16x32_bf16 v[32:35], a[128:131], v[128:131], 0
  v_mfma_f32_16x16x32_bf16 v[36:39], a[128:131], v[144:147], 0
  v_mfma_f32_16x16x32_bf16 v[40:43], a[128:131], v[160:163], 0
  v_mfma_f32_16x16x32_bf16 v[44:47], a[128:131], v[176:179], 0
  ds_read_b128 a[128:131], v17 offset:40960
  v_mfma_f32_16x16x32_bf16 v[60:63], a[144:147], v[176:179], 0
  v_mfma_f32_16x16x32_bf16 v[56:59], a[144:147], v[160:163], 0
  v_mfma_f32_16x16x32_bf16 v[52:55], a[144:147], v[144:147], 0
  v_mfma_f32_16x16x32_bf16 v[48:51], a[144:147], v[128:131], 0
  ds_read_b128 a[144:147], v17 offset:41984
  v_mfma_f32_16x16x32_bf16 v[32:35], a[132:135], v[132:135], v[32:35]
  v_mfma_f32_16x16x32_bf16 v[36:39], a[132:135], v[148:151], v[36:39]
  v_mfma_f32_16x16x32_bf16 v[40:43], a[132:135], v[164:167], v[40:43]
  v_mfma_f32_16x16x32_bf16 v[44:47], a[132:135], v[180:183], v[44:47]
  ds_read_b128 a[132:135], v17 offset:43008
  v_mfma_f32_16x16x32_bf16 v[60:63], a[148:151], v[180:183], v[60:63]
  v_mfma_f32_16x16x32_bf16 v[56:59], a[148:151], v[164:167], v[56:59]
  v_mfma_f32_16x16x32_bf16 v[52:55], a[148:151], v[148:151], v[52:55]
  v_mfma_f32_16x16x32_bf16 v[48:51], a[148:151], v[132:135], v[48:51]
  ds_read_b128 a[148:151], v17 offset:44032
  s_waitcnt lgkmcnt(15)
  v_mfma_f32_16x16x32_bf16 v[32:35], a[136:139], v[136:139], v[32:35]
  v_mfma_f32_16x16x32_bf16 v[36:39], a[136:139], v[152:155], v[36:39]
  v_mfma_f32_16x16x32_bf16 v[40:43], a[136:139], v[168:171], v[40:43]
  v_mfma_f32_16x16x32_bf16 v[44:47], a[136:139], v[184:187], v[44:47]
  ds_read_b128 a[136:139], v17 offset:45056
  v_mfma_f32_16x16x32_bf16 v[60:63], a[152:155], v[184:187], v[60:63]
  v_mfma_f32_16x16x32_bf16 v[56:59], a[152:155], v[168:171], v[56:59]
  v_mfma_f32_16x16x32_bf16 v[52:55], a[152:155], v[152:155], v[52:55]
  v_mfma_f32_16x16x32_bf16 v[48:51], a[152:155], v[136:139], v[48:51]
  ds_read_b128 a[152:155], v17 offset:46080
  v_mfma_f32_16x16x32_bf16 v[32:35], a[140:143], v[140:143], v[32:35]
  v_mfma_f32_16x16x32_bf16 v[36:39], a[140:143], v[156:159], v[36:39]
  v_mfma_f32_16x16x32_bf16 v[40:43], a[140:143], v[172:175], v[40:43]
  v_mfma_f32_16x16x32_bf16 v[44:47], a[140:143], v[188:191], v[44:47]
  ds_read_b128 a[140:143], v17 offset:47104
  v_mfma_f32_16x16x32_bf16 v[60:63], a[156:159], v[188:191], v[60:63]
  v_mfma_f32_16x16x32_bf16 v[56:59], a[156:159], v[172:175], v[56:59]
  v_mfma_f32_16x16x32_bf16 v[52:55], a[156:159], v[156:159], v[52:55]
  v_mfma_f32_16x16x32_bf16 v[48:51], a[156:159], v[140:143], v[48:51]
  ds_read_b128 a[156:159], v17 offset:48128
  s_nop 7
  v_max3_f32 v228, v32, v33, v34
  v_max3_f32 v228, v228, v35, v48
  v_max3_f32 v228, v228, v49, v50
  v_max_f32 v228, v228, v51
  v_max3_f32 v229, v36, v37, v38
  v_max3_f32 v229, v229, v39, v52
  v_max3_f32 v229, v229, v53, v54
  v_max_f32 v229, v229, v55
  v_max3_f32 v230, v40, v41, v42
  v_max3_f32 v230, v230, v43, v56
  v_max3_f32 v230, v230, v57, v58
  v_max_f32 v230, v230, v59
  v_max3_f32 v231, v44, v45, v46
  v_max3_f32 v231, v231, v47, v60
  v_max3_f32 v231, v231, v61, v62
  v_max_f32 v231, v231, v63
  v_mov_b32 v232, v228
  v_mov_b32 v233, v229
  v_mov_b32 v234, v230
  v_mov_b32 v235, v231
  s_nop 0
  v_permlane16_swap_b32 v228, v232
  v_permlane16_swap_b32 v229, v233
  v_permlane16_swap_b32 v230, v234
  v_permlane16_swap_b32 v231, v235
  v_max_f32 v228, v228, v232
  v_max_f32 v229, v229, v233
  v_max_f32 v230, v230, v234
  v_max_f32 v231, v231, v235
  v_mov_b32 v232, v228
  v_mov_b32 v233, v229
  v_mov_b32 v234, v230
  v_mov_b32 v235, v231
  s_nop 0
  v_permlane32_swap_b32 v228, v232
  v_permlane32_swap_b32 v229, v233
  v_permlane32_swap_b32 v230, v234
  v_permlane32_swap_b32 v231, v235
  v_max_f32 v228, v228, v232
  v_max_f32 v229, v229, v233
  v_max_f32 v230, v230, v234
  v_max_f32 v231, v231, v235
  v_sub_f32 v192, 0xc2480000, v228
  v_sub_f32 v193, 0xc2480000, v228
  v_sub_f32 v194, 0xc2480000, v228
  v_sub_f32 v195, 0xc2480000, v228
  v_sub_f32 v196, 0xc2480000, v229
  v_sub_f32 v197, 0xc2480000, v229
  v_sub_f32 v198, 0xc2480000, v229
  v_sub_f32 v199, 0xc2480000, v229
  v_sub_f32 v200, 0xc2480000, v230
  v_sub_f32 v201, 0xc2480000, v230
  v_sub_f32 v202, 0xc2480000, v230
  v_sub_f32 v203, 0xc2480000, v230
  v_sub_f32 v204, 0xc2480000, v231
  v_sub_f32 v205, 0xc2480000, v231
  v_sub_f32 v206, 0xc2480000, v231
  v_sub_f32 v207, 0xc2480000, v231
  s_nop 1
  s_waitcnt lgkmcnt(4)
  v_mfma_f32_16x16x32_bf16 v[64:67], a[128:131], v[128:131], v[192:195]
  v_add_f32 v32, v32, v192
  v_add_f32 v33, v33, v192
  v_mfma_f32_16x16x32_bf16 v[68:71], a[128:131], v[144:147], v[196:199]
  v_exp_f32 v32, v32
  v_mfma_f32_16x16x32_bf16 v[72:75], a[128:131], v[160:163], v[200:203]
  v_exp_f32 v33, v33
  v_mfma_f32_16x16x32_bf16 v[76:79], a[128:131], v[176:179], v[204:207]
  ds_read_b128 a[128:131], v17 offset:49152
  v_add_f32 v34, v34, v192
  v_mfma_f32_16x16x32_bf16 v[92:95], a[144:147], v[176:179], v[204:207]
  v_add_f32 v35, v35, v192
  v_mfma_f32_16x16x32_bf16 v[88:91], a[144:147], v[160:163], v[200:203]
  v_exp_f32 v34, v34
  v_exp_f32 v35, v35
  v_mfma_f32_16x16x32_bf16 v[84:87], a[144:147], v[144:147], v[196:199]
  v_cvt_pk_bf16_f32 v96, v32, v33
  v_add_f32 v48, v48, v192
  v_add_f32 v49, v49, v192
  v_exp_f32 v48, v48
  v_mfma_f32_16x16x32_bf16 v[80:83], a[144:147], v[128:131], v[192:195]
  ds_read_b128 a[144:147], v17 offset:50176
  v_exp_f32 v49, v49
  v_mfma_f32_16x16x32_bf16 v[64:67], a[132:135], v[132:135], v[64:67]
  v_cvt_pk_bf16_f32 v97, v34, v35
  v_add_f32 v50, v50, v192
  v_add_f32 v51, v51, v192
  v_exp_f32 v50, v50
  v_mfma_f32_16x16x32_bf16 v[68:71], a[132:135], v[148:151], v[68:71]
  v_exp_f32 v51, v51
  v_cvt_pk_bf16_f32 v98, v48, v49
  v_mfma_f32_16x16x32_bf16 v[72:75], a[132:135], v[164:167], v[72:75]
  v_add_f32 v36, v36, v196
  v_add_f32 v37, v37, v196
  v_exp_f32 v36, v36
  v_mfma_f32_16x16x32_bf16 v[76:79], a[132:135], v[180:183], v[76:79]
  ds_read_b128 a[132:135], v17 offset:51200
  v_exp_f32 v37, v37
  v_cvt_pk_bf16_f32 v99, v50, v51
  v_mfma_f32_16x16x32_bf16 v[92:95], a[148:151], v[180:183], v[92:95]
  v_add_f32 v38, v38, v196
  v_add_f32 v39, v39, v196
  v_exp_f32 v38, v38
  v_mfma_f32_16x16x32_bf16 v[88:91], a[148:151], v[164:167], v[88:91]
  v_exp_f32 v39, v39
  v_cvt_pk_bf16_f32 v100, v36, v37
  v_add_f32 v52, v52, v196
  v_mfma_f32_16x16x32_bf16 v[84:87], a[148:151], v[148:151], v[84:87]
  v_add_f32 v53, v53, v196
  v_exp_f32 v52, v52
  v_exp_f32 v53, v53
  v_mfma_f32_16x16x32_bf16 v[80:83], a[148:151], v[132:135], v[80:83]
  ds_read_b128 a[148:151], v17 offset:52224
  v_cvt_pk_bf16_f32 v101, v38, v39
  v_add_f32 v54, v54, v196
  s_waitcnt lgkmcnt(4)
  v_mfma_f32_16x16x32_bf16 v[64:67], a[136:139], v[136:139], v[64:67]
  v_add_f32 v55, v55, v196
  v_exp_f32 v54, v54
  v_exp_f32 v55, v55
  v_mfma_f32_16x16x32_bf16 v[68:71], a[136:139], v[152:155], v[68:71]
  v_cvt_pk_bf16_f32 v102, v52, v53
  v_add_f32 v40, v40, v200
  v_add_f32 v41, v41, v200
  v_mfma_f32_16x16x32_bf16 v[72:75], a[136:139], v[168:171], v[72:75]
  v_exp_f32 v40, v40
  v_exp_f32 v41, v41
  v_mfma_f32_16x16x32_bf16 v[76:79], a[136:139], v[184:187], v[76:79]
  ds_read_b128 a[136:139], v17 offset:53248
  v_cvt_pk_bf16_f32 v103, v54, v55
  v_add_f32 v42, v42, v200
  v_add_f32 v43, v43, v200
  v_exp_f32 v42, v42
  v_mfma_f32_16x16x32_bf16 v[92:95], a[152:155], v[184:187], v[92:95]
  v_exp_f32 v43, v43
  v_mfma_f32_16x16x32_bf16 v[88:91], a[152:155], v[168:171], v[88:91]
  v_cvt_pk_bf16_f32 v104, v40, v41
  v_add_f32 v56, v56, v200
  v_add_f32 v57, v57, v200
  v_exp_f32 v56, v56
  v_mfma_f32_16x16x32_bf16 v[84:87], a[152:155], v[152:155], v[84:87]
  v_exp_f32 v57, v57
  v_cvt_pk_bf16_f32 v105, v42, v43
  v_mfma_f32_16x16x32_bf16 v[80:83], a[152:155], v[136:139], v[80:83]
  ds_read_b128 a[152:155], v17 offset:54272
  v_add_f32 v58, v58, v200
  v_add_f32 v59, v59, v200
  v_exp_f32 v58, v58
  v_mfma_f32_16x16x32_bf16 v[64:67], a[140:143], v[140:143], v[64:67]
  v_exp_f32 v59, v59
  v_cvt_pk_bf16_f32 v106, v56, v57
  v_mfma_f32_16x16x32_bf16 v[68:71], a[140:143], v[156:159], v[68:71]
  v_add_f32 v44, v44, v204
  v_add_f32 v45, v45, v204
  v_exp_f32 v44, v44
  v_mfma_f32_16x16x32_bf16 v[72:75], a[140:143], v[172:175], v[72:75]
  v_exp_f32 v45, v45
  v_cvt_pk_bf16_f32 v107, v58, v59
  v_add_f32 v46, v46, v204
  v_mfma_f32_16x16x32_bf16 v[76:79], a[140:143], v[188:191], v[76:79]
  ds_read_b128 a[140:143], v17 offset:55296
  v_add_f32 v47, v47, v204
  v_exp_f32 v46, v46
  v_exp_f32 v47, v47
  v_mfma_f32_16x16x32_bf16 v[92:95], a[156:159], v[188:191], v[92:95]
  v_cvt_pk_bf16_f32 v108, v44, v45
  v_add_f32 v60, v60, v204
  v_mfma_f32_16x16x32_bf16 v[88:91], a[156:159], v[172:175], v[88:91]
  v_add_f32 v61, v61, v204
  v_exp_f32 v60, v60
  v_exp_f32 v61, v61
  v_mfma_f32_16x16x32_bf16 v[84:87], a[156:159], v[156:159], v[84:87]
  v_cvt_pk_bf16_f32 v109, v46, v47
  v_add_f32 v62, v62, v204
  v_add_f32 v63, v63, v204
  v_mfma_f32_16x16x32_bf16 v[80:83], a[156:159], v[140:143], v[80:83]
  ds_read_b128 a[156:159], v17 offset:56320
  v_exp_f32 v62, v62
  v_exp_f32 v63, v63
  v_cvt_pk_bf16_f32 v110, v60, v61
  s_nop 0
  v_cvt_pk_bf16_f32 v111, v62, v63
  s_waitcnt lgkmcnt(4)
  v_mfma_f32_16x16x32_bf16 v[32:35], a[128:131], v[128:131], v[192:195]
  v_exp_f32 v64, v64
  v_mfma_f32_16x16x32_bf16 v[36:39], a[128:131], v[144:147], v[196:199]
  v_exp_f32 v65, v65
  v_mfma_f32_16x16x32_bf16 v[40:43], a[128:131], v[160:163], v[200:203]
  v_mfma_f32_16x16x32_bf16 v[44:47], a[128:131], v[176:179], v[204:207]
  ds_read_b128 a[128:131], v18 offset:0
  v_mfma_f32_16x16x32_bf16 v[60:63], a[144:147], v[176:179], v[204:207]
  v_exp_f32 v66, v66
  v_mfma_f32_16x16x32_bf16 v[56:59], a[144:147], v[160:163], v[200:203]
  v_exp_f32 v67, v67
  v_mfma_f32_16x16x32_bf16 v[52:55], a[144:147], v[144:147], v[196:199]
  v_cvt_pk_bf16_f32 v112, v64, v65
  v_mfma_f32_16x16x32_bf16 v[48:51], a[144:147], v[128:131], v[192:195]
  ds_read_b128 a[144:147], v18 offset:1024
  v_mfma_f32_16x16x32_bf16 v[32:35], a[132:135], v[132:135], v[32:35]
  v_exp_f32 v80, v80
  v_mfma_f32_16x16x32_bf16 v[36:39], a[132:135], v[148:151], v[36:39]
  v_exp_f32 v81, v81
  v_mfma_f32_16x16x32_bf16 v[40:43], a[132:135], v[164:167], v[40:43]
  v_cvt_pk_bf16_f32 v113, v66, v67
  v_mfma_f32_16x16x32_bf16 v[44:47], a[132:135], v[180:183], v[44:47]
  ds_read_b128 a[132:135], v18 offset:2048
  v_mfma_f32_16x16x32_bf16 v[60:63], a[148:151], v[180:183], v[60:63]
  v_exp_f32 v82, v82
  v_mfma_f32_16x16x32_bf16 v[56:59], a[148:151], v[164:167], v[56:59]
  v_exp_f32 v83, v83
  v_mfma_f32_16x16x32_bf16 v[52:55], a[148:151], v[148:151], v[52:55]
  v_cvt_pk_bf16_f32 v114, v80, v81
  v_mfma_f32_16x16x32_bf16 v[48:51], a[148:151], v[132:135], v[48:51]
  ds_read_b128 a[148:151], v18 offset:3072
  s_waitcnt lgkmcnt(4)
  v_mfma_f32_16x16x32_bf16 v[32:35], a[136:139], v[136:139], v[32:35]
  v_exp_f32 v68, v68
  v_mfma_f32_16x16x32_bf16 v[36:39], a[136:139], v[152:155], v[36:39]
  v_exp_f32 v69, v69
  v_mfma_f32_16x16x32_bf16 v[40:43], a[136:139], v[168:171], v[40:43]
  v_cvt_pk_bf16_f32 v115, v82, v83
  v_mfma_f32_16x16x32_bf16 v[44:47], a[136:139], v[184:187], v[44:47]
  ds_read_b128 a[136:139], v18 offset:4096
  v_mfma_f32_16x16x32_bf16 v[60:63], a[152:155], v[184:187], v[60:63]
  v_exp_f32 v70, v70
  v_mfma_f32_16x16x32_bf16 v[56:59], a[152:155], v[168:171], v[56:59]
  v_exp_f32 v71, v71
  v_mfma_f32_16x16x32_bf16 v[52:55], a[152:155], v[152:155], v[52:55]
  v_cvt_pk_bf16_f32 v116, v68, v69
  v_mfma_f32_16x16x32_bf16 v[48:51], a[152:155], v[136:139], v[48:51]
  ds_read_b128 a[152:155], v18 offset:5120
  v_mfma_f32_16x16x32_bf16 v[32:35], a[140:143], v[140:143], v[32:35]
  v_exp_f32 v84, v84
  v_mfma_f32_16x16x32_bf16 v[36:39], a[140:143], v[156:159], v[36:39]
  v_exp_f32 v85, v85
  v_mfma_f32_16x16x32_bf16 v[40:43], a[140:143], v[172:175], v[40:43]
  v_cvt_pk_bf16_f32 v117, v70, v71
  v_mfma_f32_16x16x32_bf16 v[44:47], a[140:143], v[188:191], v[44:47]
  ds_read_b128 a[140:143], v18 offset:6144
  v_mfma_f32_16x16x32_bf16 v[60:63], a[156:159], v[188:191], v[60:63]
  v_exp_f32 v86, v86
  v_mfma_f32_16x16x32_bf16 v[56:59], a[156:159], v[172:175], v[56:59]
  v_exp_f32 v87, v87
  v_mfma_f32_16x16x32_bf16 v[52:55], a[156:159], v[156:159], v[52:55]
  v_cvt_pk_bf16_f32 v118, v84, v85
  v_mfma_f32_16x16x32_bf16 v[48:51], a[156:159], v[140:143], v[48:51]
  ds_read_b128 a[156:159], v18 offset:7168
  s_waitcnt lgkmcnt(15)
  v_mfma_f32_16x16x32_bf16 a[0:3], a[160:163], v[96:99], 0
  v_exp_f32 v72, v72
  v_mfma_f32_16x16x32_bf16 a[4:7], a[160:163], v[100:103], 0
  v_exp_f32 v73, v73
  v_mfma_f32_16x16x32_bf16 a[8:11], a[160:163], v[104:107], 0
  v_mfma_f32_16x16x32_bf16 a[12:15], a[160:163], v[108:111], 0
  ds_read_b64_tr_b16 a[160:161], v12 offset:8192
  v_cvt_pk_bf16_f32 v119, v86, v87
  v_mfma_f32_16x16x32_bf16 a[28:31], a[164:167], v[108:111], 0
  ds_read_b64_tr_b16 a[162:163], v12 offset:12288
  v_mfma_f32_16x16x32_bf16 a[24:27], a[164:167], v[104:107], 0
  v_exp_f32 v74, v74
  v_mfma_f32_16x16x32_bf16 a[20:23], a[164:167], v[100:103], 0
  v_exp_f32 v75, v75
  v_mfma_f32_16x16x32_bf16 a[16:19], a[164:167], v[96:99], 0
  ds_read_b64_tr_b16 a[164:165], v13 offset:8192
  v_cvt_pk_bf16_f32 v120, v72, v73
  v_mfma_f32_16x16x32_bf16 a[32:35], a[168:171], v[96:99], 0
  ds_read_b64_tr_b16 a[166:167], v13 offset:12288
  v_mfma_f32_16x16x32_bf16 a[36:39], a[168:171], v[100:103], 0
  v_exp_f32 v88, v88
  v_mfma_f32_16x16x32_bf16 a[40:43], a[168:171], v[104:107], 0
  v_exp_f32 v89, v89
  v_mfma_f32_16x16x32_bf16 a[44:47], a[168:171], v[108:111], 0
  ds_read_b64_tr_b16 a[168:169], v12 offset:8448
  v_cvt_pk_bf16_f32 v121, v74, v75
  v_mfma_f32_16x16x32_bf16 a[60:63], a[172:175], v[108:111], 0
  ds_read_b64_tr_b16 a[170:171], v12 offset:12544
  v_mfma_f32_16x16x32_bf16 a[56:59], a[172:175], v[104:107], 0
  v_exp_f32 v90, v90
  v_mfma_f32_16x16x32_bf16 a[52:55], a[172:175], v[100:103], 0
  v_exp_f32 v91, v91
  v_mfma_f32_16x16x32_bf16 a[48:51], a[172:175], v[96:99], 0
  ds_read_b64_tr_b16 a[172:173], v13 offset:8448
  s_waitcnt lgkmcnt(15)
  v_mfma_f32_16x16x32_bf16 a[64:67], a[176:179], v[96:99], 0
  ds_read_b64_tr_b16 a[174:175], v13 offset:12544
  v_cvt_pk_bf16_f32 v122, v88, v89
  v_mfma_f32_16x16x32_bf16 a[68:71], a[176:179], v[100:103], 0
  v_exp_f32 v76, v76
  v_mfma_f32_16x16x32_bf16 a[72:75], a[176:179], v[104:107], 0
  v_exp_f32 v77, v77
  v_mfma_f32_16x16x32_bf16 a[76:79], a[176:179], v[108:111], 0
  ds_read_b64_tr_b16 a[176:177], v12 offset:8704
  v_cvt_pk_bf16_f32 v123, v90, v91
  v_mfma_f32_16x16x32_bf16 a[92:95], a[180:183], v[108:111], 0
  ds_read_b64_tr_b16 a[178:179], v12 offset:12800
  v_mfma_f32_16x16x32_bf16 a[88:91], a[180:183], v[104:107], 0
  v_exp_f32 v78, v78
  v_mfma_f32_16x16x32_bf16 a[84:87], a[180:183], v[100:103], 0
  v_exp_f32 v79, v79
  v_mfma_f32_16x16x32_bf16 a[80:83], a[180:183], v[96:99], 0
  ds_read_b64_tr_b16 a[180:181], v13 offset:8704
  v_cvt_pk_bf16_f32 v124, v76, v77
  v_mfma_f32_16x16x32_bf16 a[96:99], a[184:187], v[96:99], 0
  ds_read_b64_tr_b16 a[182:183], v13 offset:12800
  v_mfma_f32_16x16x32_bf16 a[100:103], a[184:187], v[100:103], 0
  v_exp_f32 v92, v92
  v_mfma_f32_16x16x32_bf16 a[104:107], a[184:187], v[104:107], 0
  v_exp_f32 v93, v93
  v_mfma_f32_16x16x32_bf16 a[108:111], a[184:187], v[108:111], 0
  ds_read_b64_tr_b16 a[184:185], v12 offset:8960
  v_cvt_pk_bf16_f32 v125, v78, v79
  v_mfma_f32_16x16x32_bf16 a[124:127], a[188:191], v[108:111], 0
  ds_read_b64_tr_b16 a[186:187], v12 offset:13056
  v_mfma_f32_16x16x32_bf16 a[120:123], a[188:191], v[104:107], 0
  v_exp_f32 v94, v94
  v_mfma_f32_16x16x32_bf16 a[116:119], a[188:191], v[100:103], 0
  v_exp_f32 v95, v95
  v_mfma_f32_16x16x32_bf16 a[112:115], a[188:191], v[96:99], 0
  ds_read_b64_tr_b16 a[188:189], v13 offset:8960
  v_mfma_f32_16x16x32_bf16 v[212:215], v[208:211], v[96:99], 0
  ds_read_b64_tr_b16 a[190:191], v13 offset:13056
  v_cvt_pk_bf16_f32 v126, v92, v93
  v_mfma_f32_16x16x32_bf16 v[216:219], v[208:211], v[100:103], 0
  s_nop 0
  v_cvt_pk_bf16_f32 v127, v94, v95
  v_mfma_f32_16x16x32_bf16 v[220:223], v[208:211], v[104:107], 0
  v_mfma_f32_16x16x32_bf16 v[224:227], v[208:211], v[108:111], 0
  s_waitcnt lgkmcnt(15)
  v_mfma_f32_16x16x32_bf16 v[64:67], a[128:131], v[128:131], v[192:195]
  v_exp_f32 v32, v32
  v_mfma_f32_16x16x32_bf16 v[68:71], a[128:131], v[144:147], v[196:199]
  v_exp_f32 v33, v33
  v_mfma_f32_16x16x32_bf16 v[72:75], a[128:131], v[160:163], v[200:203]
  v_mfma_f32_16x16x32_bf16 v[76:79], a[128:131], v[176:179], v[204:207]
  ds_read_b128 a[128:131], v18 offset:16384
  v_mfma_f32_16x16x32_bf16 v[92:95], a[144:147], v[176:179], v[204:207]
  v_exp_f32 v34, v34
  v_mfma_f32_16x16x32_bf16 v[88:91], a[144:147], v[160:163], v[200:203]
  v_exp_f32 v35, v35
  v_mfma_f32_16x16x32_bf16 v[84:87], a[144:147], v[144:147], v[196:199]
  v_cvt_pk_bf16_f32 v96, v32, v33
  v_mfma_f32_16x16x32_bf16 v[80:83], a[144:147], v[128:131], v[192:195]
  ds_read_b128 a[144:147], v18 offset:17408
  v_mfma_f32_16x16x32_bf16 v[64:67], a[132:135], v[132:135], v[64:67]
  v_exp_f32 v48, v48
  v_mfma_f32_16x16x32_bf16 v[68:71], a[132:135], v[148:151], v[68:71]
  v_exp_f32 v49, v49
  v_mfma_f32_16x16x32_bf16 v[72:75], a[132:135], v[164:167], v[72:75]
  v_cvt_pk_bf16_f32 v97, v34, v35
  v_mfma_f32_16x16x32_bf16 v[76:79], a[132:135], v[180:183], v[76:79]
  ds_read_b128 a[132:135], v18 offset:18432
  v_mfma_f32_16x16x32_bf16 v[92:95], a[148:151], v[180:183], v[92:95]
  v_exp_f32 v50, v50
  v_mfma_f32_16x16x32_bf16 v[88:91], a[148:151], v[164:167], v[88:91]
  v_exp_f32 v51, v51
  v_mfma_f32_16x16x32_bf16 v[84:87], a[148:151], v[148:151], v[84:87]
  v_cvt_pk_bf16_f32 v98, v48, v49
  v_mfma_f32_16x16x32_bf16 v[80:83], a[148:151], v[132:135], v[80:83]
  ds_read_b128 a[148:151], v18 offset:19456
  s_waitcnt lgkmcnt(15)
  v_mfma_f32_16x16x32_bf16 v[64:67], a[136:139], v[136:139], v[64:67]
  v_exp_f32 v36, v36
  v_mfma_f32_16x16x32_bf16 v[68:71], a[136:139], v[152:155], v[68:71]
  v_exp_f32 v37, v37
  v_mfma_f32_16x16x32_bf16 v[72:75], a[136:139], v[168:171], v[72:75]
  v_cvt_pk_bf16_f32 v99, v50, v51
  v_mfma_f32_16x16x32_bf16 v[76:79], a[136:139], v[184:187], v[76:79]
  ds_read_b128 a[136:139], v18 offset:20480
  v_mfma_f32_16x16x32_bf16 v[92:95], a[152:155], v[184:187], v[92:95]
  v_exp_f32 v38, v38
  v_mfma_f32_16x16x32_bf16 v[88:91], a[152:155], v[168:171], v[88:91]
  v_exp_f32 v39, v39
  v_mfma_f32_16x16x32_bf16 v[84:87], a[152:155], v[152:155], v[84:87]
  v_cvt_pk_bf16_f32 v100, v36, v37
  v_mfma_f32_16x16x32_bf16 v[80:83], a[152:155], v[136:139], v[80:83]
  ds_read_b128 a[152:155], v18 offset:21504
  v_mfma_f32_16x16x32_bf16 v[64:67], a[140:143], v[140:143], v[64:67]
  v_exp_f32 v52, v52
  v_mfma_f32_16x16x32_bf16 v[68:71], a[140:143], v[156:159], v[68:71]
  v_exp_f32 v53, v53
  v_mfma_f32_16x16x32_bf16 v[72:75], a[140:143], v[172:175], v[72:75]
  v_cvt_pk_bf16_f32 v101, v38, v39
  v_mfma_f32_16x16x32_bf16 v[76:79], a[140:143], v[188:191], v[76:79]
  ds_read_b128 a[140:143], v18 offset:22528
  v_mfma_f32_16x16x32_bf16 v[92:95], a[156:159], v[188:191], v[92:95]
  v_exp_f32 v54, v54
  v_mfma_f32_16x16x32_bf16 v[88:91], a[156:159], v[172:175], v[88:91]
  v_exp_f32 v55, v55
  v_mfma_f32_16x16x32_bf16 v[84:87], a[156:159], v[156:159], v[84:87]
  v_cvt_pk_bf16_f32 v102, v52, v53
  v_mfma_f32_16x16x32_bf16 v[80:83], a[156:159], v[140:143], v[80:83]
  ds_read_b128 a[156:159], v18 offset:23552
  s_waitcnt lgkmcnt(15)
  v_mfma_f32_16x16x32_bf16 a[0:3], a[160:163], v[112:115], a[0:3]
  v_exp_f32 v40, v40
  v_mfma_f32_16x16x32_bf16 a[4:7], a[160:163], v[116:119], a[4:7]
  v_exp_f32 v41, v41
  v_mfma_f32_16x16x32_bf16 a[8:11], a[160:163], v[120:123], a[8:11]
  v_mfma_f32_16x16x32_bf16 a[12:15], a[160:163], v[124:127], a[12:15]
  ds_read_b64_tr_b16 a[160:161], v12 offset:24576
  v_cvt_pk_bf16_f32 v103, v54, v55
  v_mfma_f32_16x16x32_bf16 a[28:31], a[164:167], v[124:127], a[28:31]
  ds_read_b64_tr_b16 a[162:163], v12 offset:28672
  v_mfma_f32_16x16x32_bf16 a[24:27], a[164:167], v[120:123], a[24:27]
  v_exp_f32 v42, v42
  v_mfma_f32_16x16x32_bf16 a[20:23], a[164:167], v[116:119], a[20:23]
  v_exp_f32 v43, v43
  v_mfma_f32_16x16x32_bf16 a[16:19], a[164:167], v[112:115], a[16:19]
  ds_read_b64_tr_b16 a[164:165], v13 offset:24576
  v_cvt_pk_bf16_f32 v104, v40, v41
  v_mfma_f32_16x16x32_bf16 a[32:35], a[168:171], v[112:115], a[32:35]
  ds_read_b64_tr_b16 a[166:167], v13 offset:28672
  v_mfma_f32_16x16x32_bf16 a[36:39], a[168:171], v[116:119], a[36:39]
  v_exp_f32 v56, v56
  v_mfma_f32_16x16x32_bf16 a[40:43], a[168:171], v[120:123], a[40:43]
  v_exp_f32 v57, v57
  v_mfma_f32_16x16x32_bf16 a[44:47], a[168:171], v[124:127], a[44:47]
  ds_read_b64_tr_b16 a[168:169], v12 offset:24832
  v_cvt_pk_bf16_f32 v105, v42, v43
  v_mfma_f32_16x16x32_bf16 a[60:63], a[172:175], v[124:127], a[60:63]
  ds_read_b64_tr_b16 a[170:171], v12 offset:28928
  v_mfma_f32_16x16x32_bf16 a[56:59], a[172:175], v[120:123], a[56:59]
  v_exp_f32 v58, v58
  v_mfma_f32_16x16x32_bf16 a[52:55], a[172:175], v[116:119], a[52:55]
  v_exp_f32 v59, v59
  v_mfma_f32_16x16x32_bf16 a[48:51], a[172:175], v[112:115], a[48:51]
  ds_read_b64_tr_b16 a[172:173], v13 offset:24832
  s_waitcnt lgkmcnt(15)
  v_mfma_f32_16x16x32_bf16 a[64:67], a[176:179], v[112:115], a[64:67]
  ds_read_b64_tr_b16 a[174:175], v13 offset:28928
  v_cvt_pk_bf16_f32 v106, v56, v57
  v_mfma_f32_16x16x32_bf16 a[68:71], a[176:179], v[116:119], a[68:71]
  v_exp_f32 v44, v44
  v_mfma_f32_16x16x32_bf16 a[72:75], a[176:179], v[120:123], a[72:75]
  v_exp_f32 v45, v45
  v_mfma_f32_16x16x32_bf16 a[76:79], a[176:179], v[124:127], a[76:79]
  ds_read_b64_tr_b16 a[176:177], v12 offset:25088
  v_cvt_pk_bf16_f32 v107, v58, v59
  v_mfma_f32_16x16x32_bf16 a[92:95], a[180:183], v[124:127], a[92:95]
  ds_read_b64_tr_b16 a[178:179], v12 offset:29184
  v_mfma_f32_16x16x32_bf16 a[88:91], a[180:183], v[120:123], a[88:91]
  v_exp_f32 v46, v46
  v_mfma_f32_16x16x32_bf16 a[84:87], a[180:183], v[116:119], a[84:87]
  v_exp_f32 v47, v47
  v_mfma_f32_16x16x32_bf16 a[80:83], a[180:183], v[112:115], a[80:83]
  ds_read_b64_tr_b16 a[180:181], v13 offset:25088
  v_cvt_pk_bf16_f32 v108, v44, v45
  v_mfma_f32_16x16x32_bf16 a[96:99], a[184:187], v[112:115], a[96:99]
  ds_read_b64_tr_b16 a[182:183], v13 offset:29184
  v_mfma_f32_16x16x32_bf16 a[100:103], a[184:187], v[116:119], a[100:103]
  v_exp_f32 v60, v60
  v_mfma_f32_16x16x32_bf16 a[104:107], a[184:187], v[120:123], a[104:107]
  v_exp_f32 v61, v61
  v_mfma_f32_16x16x32_bf16 a[108:111], a[184:187], v[124:127], a[108:111]
  ds_read_b64_tr_b16 a[184:185], v12 offset:25344
  v_cvt_pk_bf16_f32 v109, v46, v47
  v_mfma_f32_16x16x32_bf16 a[124:127], a[188:191], v[124:127], a[124:127]
  ds_read_b64_tr_b16 a[186:187], v12 offset:29440
  v_mfma_f32_16x16x32_bf16 a[120:123], a[188:191], v[120:123], a[120:123]
  v_exp_f32 v62, v62
  v_mfma_f32_16x16x32_bf16 a[116:119], a[188:191], v[116:119], a[116:119]
  v_exp_f32 v63, v63
  v_mfma_f32_16x16x32_bf16 a[112:115], a[188:191], v[112:115], a[112:115]
  ds_read_b64_tr_b16 a[188:189], v13 offset:25344
  v_mfma_f32_16x16x32_bf16 v[212:215], v[208:211], v[112:115], v[212:215]
  ds_read_b64_tr_b16 a[190:191], v13 offset:29440
  v_cvt_pk_bf16_f32 v110, v60, v61
  v_mfma_f32_16x16x32_bf16 v[216:219], v[208:211], v[116:119], v[216:219]
  s_nop 0
  v_cvt_pk_bf16_f32 v111, v62, v63
  v_mfma_f32_16x16x32_bf16 v[220:223], v[208:211], v[120:123], v[220:223]
  v_mfma_f32_16x16x32_bf16 v[224:227], v[208:211], v[124:127], v[224:227]
  s_waitcnt lgkmcnt(15)
  v_mfma_f32_16x16x32_bf16 v[32:35], a[128:131], v[128:131], v[192:195]
  v_exp_f32 v64, v64
  v_mfma_f32_16x16x32_bf16 v[36:39], a[128:131], v[144:147], v[196:199]
  v_exp_f32 v65, v65
  v_mfma_f32_16x16x32_bf16 v[40:43], a[128:131], v[160:163], v[200:203]
  v_mfma_f32_16x16x32_bf16 v[44:47], a[128:131], v[176:179], v[204:207]
  v_exp_f32 v66, v66
  v_mfma_f32_16x16x32_bf16 v[60:63], a[144:147], v[176:179], v[204:207]
  v_exp_f32 v67, v67
  v_mfma_f32_16x16x32_bf16 v[56:59], a[144:147], v[160:163], v[200:203]
  v_mfma_f32_16x16x32_bf16 v[52:55], a[144:147], v[144:147], v[196:199]
  v_cvt_pk_bf16_f32 v112, v64, v65
  v_mfma_f32_16x16x32_bf16 v[48:51], a[144:147], v[128:131], v[192:195]
  v_exp_f32 v80, v80
  v_mfma_f32_16x16x32_bf16 v[32:35], a[132:135], v[132:135], v[32:35]
  v_exp_f32 v81, v81
  v_mfma_f32_16x16x32_bf16 v[36:39], a[132:135], v[148:151], v[36:39]
  v_mfma_f32_16x16x32_bf16 v[40:43], a[132:135], v[164:167], v[40:43]
  v_cvt_pk_bf16_f32 v113, v66, v67
  v_mfma_f32_16x16x32_bf16 v[44:47], a[132:135], v[180:183], v[44:47]
  s_waitcnt vmcnt(31) lgkmcnt(0)
  s_barrier
  v_mfma_f32_16x16x32_bf16 v[60:63], a[148:151], v[180:183], v[60:63]
  ds_read_b128 a[128:131], v16 offset:32768
  ds_read_b128 a[144:147], v16 offset:33792
  v_mfma_f32_16x16x32_bf16 v[56:59], a[148:151], v[164:167], v[56:59]
  ds_read_b128 a[132:135], v16 offset:34816
  v_mfma_f32_16x16x32_bf16 v[52:55], a[148:151], v[148:151], v[52:55]
  v_exp_f32 v82, v82
  v_mfma_f32_16x16x32_bf16 v[48:51], a[148:151], v[132:135], v[48:51]
  ds_read_b128 a[148:151], v16 offset:35840
  s_waitcnt lgkmcnt(15)
  v_mfma_f32_16x16x32_bf16 v[32:35], a[136:139], v[136:139], v[32:35]
  s_add_u32 m0, s47, 98304
  s_add_u32 s45, s48, 90112
  v_exp_f32 v83, v83
  v_mfma_f32_16x16x32_bf16 v[36:39], a[136:139], v[152:155], v[36:39]
  buffer_load_dwordx4 v21, s[24:27], s45 offen offset:0 lds
  v_cvt_pk_bf16_f32 v114, v80, v81
  v_mfma_f32_16x16x32_bf16 v[40:43], a[136:139], v[168:171], v[40:43]
  buffer_load_dwordx4 v22, s[24:27], s45 offen offset:2048 lds
  v_exp_f32 v68, v68
  v_mfma_f32_16x16x32_bf16 v[44:47], a[136:139], v[184:187], v[44:47]
  ds_read_b128 a[136:139], v16 offset:36864
  v_mfma_f32_16x16x32_bf16 v[60:63], a[152:155], v[184:187], v[60:63]
  s_add_u32 m0, s49, 106496
  s_add_u32 s45, s48, 73728
  v_exp_f32 v69, v69
  v_mfma_f32_16x16x32_bf16 v[56:59], a[152:155], v[168:171], v[56:59]
  buffer_load_dwordx4 v28, s[28:31], s45 offen offset:0 lds
  v_cvt_pk_bf16_f32 v115, v82, v83
  v_mfma_f32_16x16x32_bf16 v[52:55], a[152:155], v[152:155], v[52:55]
  v_exp_f32 v70, v70
  v_mfma_f32_16x16x32_bf16 v[48:51], a[152:155], v[136:139], v[48:51]
  ds_read_b128 a[152:155], v16 offset:37888
  v_mfma_f32_16x16x32_bf16 v[32:35], a[140:143], v[140:143], v[32:35]
  buffer_load_dwordx4 v29, s[28:31], s45 offen offset:1024 lds
  v_exp_f32 v71, v71
  v_mfma_f32_16x16x32_bf16 v[36:39], a[140:143], v[156:159], v[36:39]
  v_cvt_pk_bf16_f32 v116, v68, v69
  v_mfma_f32_16x16x32_bf16 v[40:43], a[140:143], v[172:175], v[40:43]
  v_exp_f32 v84, v84
  v_mfma_f32_16x16x32_bf16 v[44:47], a[140:143], v[188:191], v[44:47]
  ds_read_b128 a[140:143], v16 offset:38912
  v_mfma_f32_16x16x32_bf16 v[60:63], a[156:159], v[188:191], v[60:63]
  s_add_u32 m0, s47, 114688
  s_add_u32 s45, s48, 98304
  v_exp_f32 v85, v85
  v_mfma_f32_16x16x32_bf16 v[56:59], a[156:159], v[172:175], v[56:59]
  buffer_load_dwordx4 v21, s[24:27], s45 offen offset:0 lds
  v_cvt_pk_bf16_f32 v117, v70, v71
  v_mfma_f32_16x16x32_bf16 v[52:55], a[156:159], v[156:159], v[52:55]
  v_exp_f32 v86, v86
  v_mfma_f32_16x16x32_bf16 v[48:51], a[156:159], v[140:143], v[48:51]
  ds_read_b128 a[156:159], v16 offset:39936
  s_waitcnt lgkmcnt(15)
  v_mfma_f32_16x16x32_bf16 a[0:3], a[160:163], v[96:99], a[0:3]
  buffer_load_dwordx4 v22, s[24:27], s45 offen offset:2048 lds
  v_exp_f32 v87, v87
  v_mfma_f32_16x16x32_bf16 a[4:7], a[160:163], v[100:103], a[4:7]
  s_add_u32 m0, s49, 122880
  s_add_u32 s45, s48, 81920
  v_cvt_pk_bf16_f32 v118, v84, v85
  v_mfma_f32_16x16x32_bf16 a[8:11], a[160:163], v[104:107], a[8:11]
  buffer_load_dwordx4 v28, s[28:31], s45 offen offset:0 lds
  v_exp_f32 v72, v72
  v_mfma_f32_16x16x32_bf16 a[12:15], a[160:163], v[108:111], a[12:15]
  ds_read_b64_tr_b16 a[160:161], v8 offset:40960
  ds_read_b64_tr_b16 a[162:163], v8 offset:45056
  v_mfma_f32_16x16x32_bf16 a[28:31], a[164:167], v[108:111], a[28:31]
  v_exp_f32 v73, v73
  v_mfma_f32_16x16x32_bf16 a[24:27], a[164:167], v[104:107], a[24:27]
  buffer_load_dwordx4 v29, s[28:31], s45 offen offset:1024 lds
  v_cvt_pk_bf16_f32 v119, v86, v87
  v_mfma_f32_16x16x32_bf16 a[20:23], a[164:167], v[100:103], a[20:23]
  v_exp_f32 v74, v74
  v_mfma_f32_16x16x32_bf16 a[16:19], a[164:167], v[96:99], a[16:19]
  ds_read_b64_tr_b16 a[164:165], v9 offset:40960
  ds_read_b64_tr_b16 a[166:167], v9 offset:45056
  v_mfma_f32_16x16x32_bf16 a[32:35], a[168:171], v[96:99], a[32:35]
  s_add_u32 m0, s47, 131072
  s_add_u32 s45, s48, 106496
  v_exp_f32 v75, v75
  v_mfma_f32_16x16x32_bf16 a[36:39], a[168:171], v[100:103], a[36:39]
  buffer_load_dwordx4 v21, s[24:27], s45 offen offset:0 lds
  v_cvt_pk_bf16_f32 v120, v72, v73
  v_mfma_f32_16x16x32_bf16 a[40:43], a[168:171], v[104:107], a[40:43]
  v_exp_f32 v88, v88
  v_mfma_f32_16x16x32_bf16 a[44:47], a[168:171], v[108:111], a[44:47]
  ds_read_b64_tr_b16 a[168:169], v8 offset:41216
  ds_read_b64_tr_b16 a[170:171], v8 offset:45312
  v_mfma_f32_16x16x32_bf16 a[60:63], a[172:175], v[108:111], a[60:63]
  buffer_load_dwordx4 v22, s[24:27], s45 offen offset:2048 lds
  v_exp_f32 v89, v89
  v_mfma_f32_16x16x32_bf16 a[56:59], a[172:175], v[104:107], a[56:59]
  v_cvt_pk_bf16_f32 v121, v74, v75
  v_mfma_f32_16x16x32_bf16 a[52:55], a[172:175], v[100:103], a[52:55]
  s_add_u32 m0, s49, 139264
  s_add_u32 s45, s48, 90112
  v_mfma_f32_16x16x32_bf16 a[48:51], a[172:175], v[96:99], a[48:51]
  ds_read_b64_tr_b16 a[172:173], v9 offset:41216
  v_exp_f32 v90, v90
  s_waitcnt lgkmcnt(15)
  v_mfma_f32_16x16x32_bf16 a[64:67], a[176:179], v[96:99], a[64:67]
  ds_read_b64_tr_b16 a[174:175], v9 offset:45312
  buffer_load_dwordx4 v28, s[28:31], s45 offen offset:0 lds
  v_exp_f32 v91, v91
  v_mfma_f32_16x16x32_bf16 a[68:71], a[176:179], v[100:103], a[68:71]
  v_cvt_pk_bf16_f32 v122, v88, v89
  v_mfma_f32_16x16x32_bf16 a[72:75], a[176:179], v[104:107], a[72:75]
  buffer_load_dwordx4 v29, s[28:31], s45 offen offset:1024 lds
  v_mfma_f32_16x16x32_bf16 a[76:79], a[176:179], v[108:111], a[76:79]
  ds_read_b64_tr_b16 a[176:177], v8 offset:41472
  v_exp_f32 v76, v76
  v_mfma_f32_16x16x32_bf16 a[92:95], a[180:183], v[108:111], a[92:95]
  ds_read_b64_tr_b16 a[178:179], v8 offset:45568
  v_exp_f32 v77, v77
  v_mfma_f32_16x16x32_bf16 a[88:91], a[180:183], v[104:107], a[88:91]
  s_add_u32 m0, s47, 147456
  s_add_u32 s45, s48, 114688
  v_mfma_f32_16x16x32_bf16 a[84:87], a[180:183], v[100:103], a[84:87]
  buffer_load_dwordx4 v21, s[24:27], s45 offen offset:0 lds
  v_cvt_pk_bf16_f32 v123, v90, v91
  v_mfma_f32_16x16x32_bf16 a[80:83], a[180:183], v[96:99], a[80:83]
  ds_read_b64_tr_b16 a[180:181], v9 offset:41472
  v_exp_f32 v78, v78
  v_mfma_f32_16x16x32_bf16 a[96:99], a[184:187], v[96:99], a[96:99]
  ds_read_b64_tr_b16 a[182:183], v9 offset:45568
  v_exp_f32 v79, v79
  v_mfma_f32_16x16x32_bf16 a[100:103], a[184:187], v[100:103], a[100:103]
  buffer_load_dwordx4 v22, s[24:27], s45 offen offset:2048 lds
  v_cvt_pk_bf16_f32 v124, v76, v77
  v_mfma_f32_16x16x32_bf16 a[104:107], a[184:187], v[104:107], a[104:107]
  v_exp_f32 v92, v92
  v_mfma_f32_16x16x32_bf16 a[108:111], a[184:187], v[108:111], a[108:111]
  ds_read_b64_tr_b16 a[184:185], v8 offset:41728
  ds_read_b64_tr_b16 a[186:187], v8 offset:45824
  v_mfma_f32_16x16x32_bf16 a[124:127], a[188:191], v[108:111], a[124:127]
  s_add_u32 m0, s49, 155648
  s_add_u32 s45, s48, 98304
  v_exp_f32 v93, v93
  v_mfma_f32_16x16x32_bf16 a[120:123], a[188:191], v[104:107], a[120:123]
  buffer_load_dwordx4 v28, s[28:31], s45 offen offset:0 lds
  v_cvt_pk_bf16_f32 v125, v78, v79
  v_mfma_f32_16x16x32_bf16 a[116:119], a[188:191], v[100:103], a[116:119]
  v_exp_f32 v94, v94
  v_mfma_f32_16x16x32_bf16 a[112:115], a[188:191], v[96:99], a[112:115]
  ds_read_b64_tr_b16 a[188:189], v9 offset:41728
  v_mfma_f32_16x16x32_bf16 v[212:215], v[208:211], v[96:99], v[212:215]
  ds_read_b64_tr_b16 a[190:191], v9 offset:45824
  buffer_load_dwordx4 v29, s[28:31], s45 offen offset:1024 lds
  v_exp_f32 v95, v95
  v_mfma_f32_16x16x32_bf16 v[216:219], v[208:211], v[100:103], v[216:219]
  v_cvt_pk_bf16_f32 v126, v92, v93
  s_nop 0
  v_mfma_f32_16x16x32_bf16 v[220:223], v[208:211], v[104:107], v[220:223]
  v_cvt_pk_bf16_f32 v127, v94, v95
  v_mfma_f32_16x16x32_bf16 v[224:227], v[208:211], v[108:111], v[224:227]
  s_waitcnt lgkmcnt(15)
  v_mfma_f32_16x16x32_bf16 v[64:67], a[128:131], v[128:131], v[192:195]
  v_exp_f32 v32, v32
  v_mfma_f32_16x16x32_bf16 v[68:71], a[128:131], v[144:147], v[196:199]
  v_exp_f32 v33, v33
  v_mfma_f32_16x16x32_bf16 v[72:75], a[128:131], v[160:163], v[200:203]
  v_mfma_f32_16x16x32_bf16 v[76:79], a[128:131], v[176:179], v[204:207]
  ds_read_b128 a[128:131], v16 offset:49152
  s_cmp_eq_u32 s36, 0
  s_cselect_b32 s85, 0, 0x1000
  v_mov_b32 v19, 1
  buffer_atomic_add v19, v23, s[12:15], s85 offen sc0 sc1
  v_mfma_f32_16x16x32_bf16 v[92:95], a[144:147], v[176:179], v[204:207]
  v_exp_f32 v34, v34
  v_mfma_f32_16x16x32_bf16 v[88:91], a[144:147], v[160:163], v[200:203]
  v_exp_f32 v35, v35
  v_mfma_f32_16x16x32_bf16 v[84:87], a[144:147], v[144:147], v[196:199]
  v_cvt_pk_bf16_f32 v96, v32, v33
  v_mfma_f32_16x16x32_bf16 v[80:83], a[144:147], v[128:131], v[192:195]
  ds_read_b128 a[144:147], v16 offset:50176
  v_mfma_f32_16x16x32_bf16 v[64:67], a[132:135], v[132:135], v[64:67]
  v_exp_f32 v48, v48
  v_mfma_f32_16x16x32_bf16 v[68:71], a[132:135], v[148:151], v[68:71]
  v_exp_f32 v49, v49
  v_mfma_f32_16x16x32_bf16 v[72:75], a[132:135], v[164:167], v[72:75]
  v_cvt_pk_bf16_f32 v97, v34, v35
  v_mfma_f32_16x16x32_bf16 v[76:79], a[132:135], v[180:183], v[76:79]
  ds_read_b128 a[132:135], v16 offset:51200
  v_mfma_f32_16x16x32_bf16 v[92:95], a[148:151], v[180:183], v[92:95]
  v_exp_f32 v50, v50
  v_mfma_f32_16x16x32_bf16 v[88:91], a[148:151], v[164:167], v[88:91]
  v_exp_f32 v51, v51
  v_mfma_f32_16x16x32_bf16 v[84:87], a[148:151], v[148:151], v[84:87]
  v_cvt_pk_bf16_f32 v98, v48, v49
  v_mfma_f32_16x16x32_bf16 v[80:83], a[148:151], v[132:135], v[80:83]
  ds_read_b128 a[148:151], v16 offset:52224
  s_waitcnt lgkmcnt(15)
  v_mfma_f32_16x16x32_bf16 v[64:67], a[136:139], v[136:139], v[64:67]
  buffer_load_dword a240, v24, s[4:7], s60 offen offset:0
  v_mfma_f32_16x16x32_bf16 v[68:71], a[136:139], v[152:155], v[68:71]
  v_exp_f32 v36, v36
  v_mfma_f32_16x16x32_bf16 v[72:75], a[136:139], v[168:171], v[72:75]
  v_exp_f32 v37, v37
  v_mfma_f32_16x16x32_bf16 v[76:79], a[136:139], v[184:187], v[76:79]
  ds_read_b128 a[136:139], v16 offset:53248
  v_cvt_pk_bf16_f32 v99, v50, v51
  v_mfma_f32_16x16x32_bf16 v[92:95], a[152:155], v[184:187], v[92:95]
  v_exp_f32 v38, v38
  v_mfma_f32_16x16x32_bf16 v[88:91], a[152:155], v[168:171], v[88:91]
  v_exp_f32 v39, v39
  v_mfma_f32_16x16x32_bf16 v[84:87], a[152:155], v[152:155], v[84:87]
  v_cvt_pk_bf16_f32 v100, v36, v37
  v_mfma_f32_16x16x32_bf16 v[80:83], a[152:155], v[136:139], v[80:83]
  ds_read_b128 a[152:155], v16 offset:54272
  v_mfma_f32_16x16x32_bf16 v[64:67], a[140:143], v[140:143], v[64:67]
  v_exp_f32 v52, v52
  v_mfma_f32_16x16x32_bf16 v[68:71], a[140:143], v[156:159], v[68:71]
  v_exp_f32 v53, v53
  v_mfma_f32_16x16x32_bf16 v[72:75], a[140:143], v[172:175], v[72:75]
  v_cvt_pk_bf16_f32 v101, v38, v39
  v_mfma_f32_16x16x32_bf16 v[76:79], a[140:143], v[188:191], v[76:79]
  ds_read_b128 a[140:143], v16 offset:55296
  v_mfma_f32_16x16x32_bf16 v[92:95], a[156:159], v[188:191], v[92:95]
  buffer_load_dword a241, v24, s[4:7], s60 offen offset:1024
  v_mfma_f32_16x16x32_bf16 v[88:91], a[156:159], v[172:175], v[88:91]
  v_exp_f32 v54, v54
  v_mfma_f32_16x16x32_bf16 v[84:87], a[156:159], v[156:159], v[84:87]
  v_exp_f32 v55, v55
  v_mfma_f32_16x16x32_bf16 v[80:83], a[156:159], v[140:143], v[80:83]
  ds_read_b128 a[156:159], v16 offset:56320
  s_waitcnt lgkmcnt(15)
  v_mfma_f32_16x16x32_bf16 a[0:3], a[160:163], v[112:115], a[0:3]
  v_cvt_pk_bf16_f32 v102, v52, v53
  v_mfma_f32_16x16x32_bf16 a[4:7], a[160:163], v[116:119], a[4:7]
  v_exp_f32 v40, v40
  v_mfma_f32_16x16x32_bf16 a[8:11], a[160:163], v[120:123], a[8:11]
  v_exp_f32 v41, v41
  v_mfma_f32_16x16x32_bf16 a[12:15], a[160:163], v[124:127], a[12:15]
  ds_read_b64_tr_b16 a[160:161], v8 offset:57344
  v_cvt_pk_bf16_f32 v103, v54, v55
  v_mfma_f32_16x16x32_bf16 a[28:31], a[164:167], v[124:127], a[28:31]
  ds_read_b64_tr_b16 a[162:163], v8 offset:61440
  v_mfma_f32_16x16x32_bf16 a[24:27], a[164:167], v[120:123], a[24:27]
  v_exp_f32 v42, v42
  v_mfma_f32_16x16x32_bf16 a[20:23], a[164:167], v[116:119], a[20:23]
  v_exp_f32 v43, v43
  v_mfma_f32_16x16x32_bf16 a[16:19], a[164:167], v[112:115], a[16:19]
  ds_read_b64_tr_b16 a[164:165], v9 offset:57344
  v_cvt_pk_bf16_f32 v104, v40, v41
  v_mfma_f32_16x16x32_bf16 a[32:35], a[168:171], v[112:115], a[32:35]
  ds_read_b64_tr_b16 a[166:167], v9 offset:61440
  buffer_load_dword a242, v24, s[4:7], s60 offen offset:2048
  v_mfma_f32_16x16x32_bf16 a[36:39], a[168:171], v[116:119], a[36:39]
  v_exp_f32 v56, v56
  v_mfma_f32_16x16x32_bf16 a[40:43], a[168:171], v[120:123], a[40:43]
  v_exp_f32 v57, v57
  v_mfma_f32_16x16x32_bf16 a[44:47], a[168:171], v[124:127], a[44:47]
  ds_read_b64_tr_b16 a[168:169], v8 offset:57600
  v_cvt_pk_bf16_f32 v105, v42, v43
  v_mfma_f32_16x16x32_bf16 a[60:63], a[172:175], v[124:127], a[60:63]
  ds_read_b64_tr_b16 a[170:171], v8 offset:61696
  v_mfma_f32_16x16x32_bf16 a[56:59], a[172:175], v[120:123], a[56:59]
  v_exp_f32 v58, v58
  v_mfma_f32_16x16x32_bf16 a[52:55], a[172:175], v[116:119], a[52:55]
  v_exp_f32 v59, v59
  v_mfma_f32_16x16x32_bf16 a[48:51], a[172:175], v[112:115], a[48:51]
  ds_read_b64_tr_b16 a[172:173], v9 offset:57600
  s_waitcnt lgkmcnt(15)
  v_mfma_f32_16x16x32_bf16 a[64:67], a[176:179], v[112:115], a[64:67]
  ds_read_b64_tr_b16 a[174:175], v9 offset:61696
  v_cvt_pk_bf16_f32 v106, v56, v57
  v_mfma_f32_16x16x32_bf16 a[68:71], a[176:179], v[116:119], a[68:71]
  v_exp_f32 v44, v44
  v_mfma_f32_16x16x32_bf16 a[72:75], a[176:179], v[120:123], a[72:75]
  v_exp_f32 v45, v45
  v_mfma_f32_16x16x32_bf16 a[76:79], a[176:179], v[124:127], a[76:79]
  ds_read_b64_tr_b16 a[176:177], v8 offset:57856
  v_cvt_pk_bf16_f32 v107, v58, v59
  v_mfma_f32_16x16x32_bf16 a[92:95], a[180:183], v[124:127], a[92:95]
  ds_read_b64_tr_b16 a[178:179], v8 offset:61952
  v_mfma_f32_16x16x32_bf16 a[88:91], a[180:183], v[120:123], a[88:91]
  buffer_load_dword a243, v24, s[4:7], s60 offen offset:3072
  v_mfma_f32_16x16x32_bf16 a[84:87], a[180:183], v[116:119], a[84:87]
  v_exp_f32 v46, v46
  v_mfma_f32_16x16x32_bf16 a[80:83], a[180:183], v[112:115], a[80:83]
  ds_read_b64_tr_b16 a[180:181], v9 offset:57856
  ds_read_b64_tr_b16 a[182:183], v9 offset:61952
  v_mfma_f32_16x16x32_bf16 a[96:99], a[184:187], v[112:115], a[96:99]
  v_exp_f32 v47, v47
  v_mfma_f32_16x16x32_bf16 a[100:103], a[184:187], v[116:119], a[100:103]
  v_cvt_pk_bf16_f32 v108, v44, v45
  v_mfma_f32_16x16x32_bf16 a[104:107], a[184:187], v[120:123], a[104:107]
  v_exp_f32 v60, v60
  v_mfma_f32_16x16x32_bf16 a[108:111], a[184:187], v[124:127], a[108:111]
  ds_read_b64_tr_b16 a[184:185], v8 offset:58112
  ds_read_b64_tr_b16 a[186:187], v8 offset:62208
  v_mfma_f32_16x16x32_bf16 a[124:127], a[188:191], v[124:127], a[124:127]
  v_exp_f32 v61, v61
  v_mfma_f32_16x16x32_bf16 a[120:123], a[188:191], v[120:123], a[120:123]
  v_cvt_pk_bf16_f32 v109, v46, v47
  v_mfma_f32_16x16x32_bf16 a[116:119], a[188:191], v[116:119], a[116:119]
  v_exp_f32 v62, v62
  v_mfma_f32_16x16x32_bf16 a[112:115], a[188:191], v[112:115], a[112:115]
  ds_read_b64_tr_b16 a[188:189], v9 offset:58112
  v_mfma_f32_16x16x32_bf16 v[212:215], v[208:211], v[112:115], v[212:215]
  ds_read_b64_tr_b16 a[190:191], v9 offset:62208
  v_exp_f32 v63, v63
  v_mfma_f32_16x16x32_bf16 v[216:219], v[208:211], v[116:119], v[216:219]
  v_cvt_pk_bf16_f32 v110, v60, v61
  s_nop 0
  v_mfma_f32_16x16x32_bf16 v[220:223], v[208:211], v[120:123], v[220:223]
  v_cvt_pk_bf16_f32 v111, v62, v63
  v_mfma_f32_16x16x32_bf16 v[224:227], v[208:211], v[124:127], v[224:227]
  s_waitcnt lgkmcnt(15)
  v_mfma_f32_16x16x32_bf16 v[32:35], a[128:131], v[128:131], v[192:195]
  v_exp_f32 v64, v64
  v_mfma_f32_16x16x32_bf16 v[36:39], a[128:131], v[144:147], v[196:199]
  v_exp_f32 v65, v65
  v_mfma_f32_16x16x32_bf16 v[40:43], a[128:131], v[160:163], v[200:203]
  v_mfma_f32_16x16x32_bf16 v[44:47], a[128:131], v[176:179], v[204:207]
  v_exp_f32 v66, v66
  v_mfma_f32_16x16x32_bf16 v[60:63], a[144:147], v[176:179], v[204:207]
  v_exp_f32 v67, v67
  v_mfma_f32_16x16x32_bf16 v[56:59], a[144:147], v[160:163], v[200:203]
  v_mfma_f32_16x16x32_bf16 v[52:55], a[144:147], v[144:147], v[196:199]
  v_cvt_pk_bf16_f32 v112, v64, v65
  v_mfma_f32_16x16x32_bf16 v[48:51], a[144:147], v[128:131], v[192:195]
  v_exp_f32 v80, v80
  v_mfma_f32_16x16x32_bf16 v[32:35], a[132:135], v[132:135], v[32:35]
  v_exp_f32 v81, v81
  v_mfma_f32_16x16x32_bf16 v[36:39], a[132:135], v[148:151], v[36:39]
  v_mfma_f32_16x16x32_bf16 v[40:43], a[132:135], v[164:167], v[40:43]
  v_cvt_pk_bf16_f32 v113, v66, v67
  v_mfma_f32_16x16x32_bf16 v[44:47], a[132:135], v[180:183], v[44:47]
  s_waitcnt vmcnt(44) lgkmcnt(0)
  s_barrier
  v_mfma_f32_16x16x32_bf16 v[60:63], a[148:151], v[180:183], v[60:63]
  ds_read_b128 a[128:131], v17 offset:0
  ds_read_b128 a[144:147], v17 offset:1024
  v_mfma_f32_16x16x32_bf16 v[56:59], a[148:151], v[164:167], v[56:59]
  ds_read_b128 a[132:135], v17 offset:2048
  v_mfma_f32_16x16x32_bf16 v[52:55], a[148:151], v[148:151], v[52:55]
  v_exp_f32 v82, v82
  v_mfma_f32_16x16x32_bf16 v[48:51], a[148:151], v[132:135], v[48:51]
  ds_read_b128 a[148:151], v17 offset:3072
  s_waitcnt lgkmcnt(15)
  v_mfma_f32_16x16x32_bf16 v[32:35], a[136:139], v[136:139], v[32:35]
  s_add_u32 m0, s47, 32768
  s_add_u32 s45, s48, 122880
  v_exp_f32 v83, v83
  v_mfma_f32_16x16x32_bf16 v[36:39], a[136:139], v[152:155], v[36:39]
  buffer_load_dwordx4 v21, s[24:27], s45 offen offset:0 lds
  v_cvt_pk_bf16_f32 v114, v80, v81
  v_mfma_f32_16x16x32_bf16 v[40:43], a[136:139], v[168:171], v[40:43]
  v_exp_f32 v68, v68
  v_mfma_f32_16x16x32_bf16 v[44:47], a[136:139], v[184:187], v[44:47]
  ds_read_b128 a[136:139], v17 offset:4096
  v_mfma_f32_16x16x32_bf16 v[60:63], a[152:155], v[184:187], v[60:63]
  v_exp_f32 v69, v69
  v_mfma_f32_16x16x32_bf16 v[56:59], a[152:155], v[168:171], v[56:59]
  buffer_load_dwordx4 v22, s[24:27], s45 offen offset:2048 lds
  v_cvt_pk_bf16_f32 v115, v82, v83
  v_mfma_f32_16x16x32_bf16 v[52:55], a[152:155], v[152:155], v[52:55]
  v_exp_f32 v70, v70
  v_mfma_f32_16x16x32_bf16 v[48:51], a[152:155], v[136:139], v[48:51]
  ds_read_b128 a[152:155], v17 offset:5120
  v_mfma_f32_16x16x32_bf16 v[32:35], a[140:143], v[140:143], v[32:35]
  v_exp_f32 v71, v71
  v_mfma_f32_16x16x32_bf16 v[36:39], a[140:143], v[156:159], v[36:39]
  v_cvt_pk_bf16_f32 v116, v68, v69
  v_mfma_f32_16x16x32_bf16 v[40:43], a[140:143], v[172:175], v[40:43]
  v_exp_f32 v84, v84
  v_mfma_f32_16x16x32_bf16 v[44:47], a[140:143], v[188:191], v[44:47]
  ds_read_b128 a[140:143], v17 offset:6144
  v_mfma_f32_16x16x32_bf16 v[60:63], a[156:159], v[188:191], v[60:63]
  s_add_u32 m0, s49, 40960
  s_add_u32 s45, s48, 106496
  v_exp_f32 v85, v85
  v_mfma_f32_16x16x32_bf16 v[56:59], a[156:159], v[172:175], v[56:59]
  buffer_load_dwordx4 v28, s[28:31], s45 offen offset:0 lds
  v_cvt_pk_bf16_f32 v117, v70, v71
  v_mfma_f32_16x16x32_bf16 v[52:55], a[156:159], v[156:159], v[52:55]
  v_exp_f32 v86, v86
  v_mfma_f32_16x16x32_bf16 v[48:51], a[156:159], v[140:143], v[48:51]
  ds_read_b128 a[156:159], v17 offset:7168
  s_waitcnt lgkmcnt(15)
  v_mfma_f32_16x16x32_bf16 a[0:3], a[160:163], v[96:99], a[0:3]
  v_exp_f32 v87, v87
  v_mfma_f32_16x16x32_bf16 a[4:7], a[160:163], v[100:103], a[4:7]
  v_cvt_pk_bf16_f32 v118, v84, v85
  v_mfma_f32_16x16x32_bf16 a[8:11], a[160:163], v[104:107], a[8:11]
  buffer_load_dwordx4 v29, s[28:31], s45 offen offset:1024 lds
  v_exp_f32 v72, v72
  v_mfma_f32_16x16x32_bf16 a[12:15], a[160:163], v[108:111], a[12:15]
  ds_read_b64_tr_b16 a[160:161], v10 offset:8192
  ds_read_b64_tr_b16 a[162:163], v10 offset:12288
  v_mfma_f32_16x16x32_bf16 a[28:31], a[164:167], v[108:111], a[28:31]
  v_exp_f32 v73, v73
  v_mfma_f32_16x16x32_bf16 a[24:27], a[164:167], v[104:107], a[24:27]
  v_cvt_pk_bf16_f32 v119, v86, v87
  v_mfma_f32_16x16x32_bf16 a[20:23], a[164:167], v[100:103], a[20:23]
  v_exp_f32 v74, v74
  v_mfma_f32_16x16x32_bf16 a[16:19], a[164:167], v[96:99], a[16:19]
  ds_read_b64_tr_b16 a[164:165], v11 offset:8192
  ds_read_b64_tr_b16 a[166:167], v11 offset:12288
  v_mfma_f32_16x16x32_bf16 a[32:35], a[168:171], v[96:99], a[32:35]
  s_add_u32 m0, s49, 49152
  s_add_u32 s45, s48, 114688
  v_exp_f32 v75, v75
  v_mfma_f32_16x16x32_bf16 a[36:39], a[168:171], v[100:103], a[36:39]
  buffer_load_dwordx4 v28, s[28:31], s45 offen offset:0 lds
  v_cvt_pk_bf16_f32 v120, v72, v73
  v_mfma_f32_16x16x32_bf16 a[40:43], a[168:171], v[104:107], a[40:43]
  v_exp_f32 v88, v88
  v_mfma_f32_16x16x32_bf16 a[44:47], a[168:171], v[108:111], a[44:47]
  ds_read_b64_tr_b16 a[168:169], v10 offset:8448
  ds_read_b64_tr_b16 a[170:171], v10 offset:12544
  v_mfma_f32_16x16x32_bf16 a[60:63], a[172:175], v[108:111], a[60:63]
  v_exp_f32 v89, v89
  v_mfma_f32_16x16x32_bf16 a[56:59], a[172:175], v[104:107], a[56:59]
  v_cvt_pk_bf16_f32 v121, v74, v75
  v_mfma_f32_16x16x32_bf16 a[52:55], a[172:175], v[100:103], a[52:55]
  v_exp_f32 v90, v90
  v_mfma_f32_16x16x32_bf16 a[48:51], a[172:175], v[96:99], a[48:51]
  ds_read_b64_tr_b16 a[172:173], v11 offset:8448
  s_waitcnt lgkmcnt(15)
  v_mfma_f32_16x16x32_bf16 a[64:67], a[176:179], v[96:99], a[64:67]
  ds_read_b64_tr_b16 a[174:175], v11 offset:12544
  buffer_load_dwordx4 v29, s[28:31], s45 offen offset:1024 lds
  v_exp_f32 v91, v91
  v_mfma_f32_16x16x32_bf16 a[68:71], a[176:179], v[100:103], a[68:71]
  v_cvt_pk_bf16_f32 v122, v88, v89
  v_mfma_f32_16x16x32_bf16 a[72:75], a[176:179], v[104:107], a[72:75]
  v_exp_f32 v76, v76
  v_mfma_f32_16x16x32_bf16 a[76:79], a[176:179], v[108:111], a[76:79]
  ds_read_b64_tr_b16 a[176:177], v10 offset:8704
  ds_read_b64_tr_b16 a[178:179], v10 offset:12800
  v_mfma_f32_16x16x32_bf16 a[92:95], a[180:183], v[108:111], a[92:95]
  v_exp_f32 v77, v77
  v_mfma_f32_16x16x32_bf16 a[88:91], a[180:183], v[104:107], a[88:91]
  s_add_u32 m0, s49, 57344
  s_add_u32 s45, s48, 122880
  v_mfma_f32_16x16x32_bf16 a[84:87], a[180:183], v[100:103], a[84:87]
  buffer_load_dwordx4 v28, s[28:31], s45 offen offset:0 lds
  v_cvt_pk_bf16_f32 v123, v90, v91
  v_mfma_f32_16x16x32_bf16 a[80:83], a[180:183], v[96:99], a[80:83]
  ds_read_b64_tr_b16 a[180:181], v11 offset:8704
  v_exp_f32 v78, v78
  v_mfma_f32_16x16x32_bf16 a[96:99], a[184:187], v[96:99], a[96:99]
  ds_read_b64_tr_b16 a[182:183], v11 offset:12800
  v_exp_f32 v79, v79
  v_mfma_f32_16x16x32_bf16 a[100:103], a[184:187], v[100:103], a[100:103]
  v_cvt_pk_bf16_f32 v124, v76, v77
  v_mfma_f32_16x16x32_bf16 a[104:107], a[184:187], v[104:107], a[104:107]
  v_exp_f32 v92, v92
  v_mfma_f32_16x16x32_bf16 a[108:111], a[184:187], v[108:111], a[108:111]
  ds_read_b64_tr_b16 a[184:185], v10 offset:8960
  ds_read_b64_tr_b16 a[186:187], v10 offset:13056
  v_mfma_f32_16x16x32_bf16 a[124:127], a[188:191], v[108:111], a[124:127]
  buffer_load_dwordx4 v29, s[28:31], s45 offen offset:1024 lds
  v_exp_f32 v93, v93
  v_mfma_f32_16x16x32_bf16 a[120:123], a[188:191], v[104:107], a[120:123]
  v_cvt_pk_bf16_f32 v125, v78, v79
  v_mfma_f32_16x16x32_bf16 a[116:119], a[188:191], v[100:103], a[116:119]
  v_exp_f32 v94, v94
  v_mfma_f32_16x16x32_bf16 a[112:115], a[188:191], v[96:99], a[112:115]
  ds_read_b64_tr_b16 a[188:189], v11 offset:8960
  v_mfma_f32_16x16x32_bf16 v[212:215], v[208:211], v[96:99], v[212:215]
  ds_read_b64_tr_b16 a[190:191], v11 offset:13056
  v_exp_f32 v95, v95
  v_mfma_f32_16x16x32_bf16 v[216:219], v[208:211], v[100:103], v[216:219]
  v_cvt_pk_bf16_f32 v126, v92, v93
  s_nop 0
  v_mfma_f32_16x16x32_bf16 v[220:223], v[208:211], v[104:107], v[220:223]
  v_cvt_pk_bf16_f32 v127, v94, v95
  v_mfma_f32_16x16x32_bf16 v[224:227], v[208:211], v[108:111], v[224:227]
  s_waitcnt lgkmcnt(15)
  v_mfma_f32_16x16x32_bf16 v[64:67], a[128:131], v[128:131], v[192:195]
  v_exp_f32 v32, v32
  v_mfma_f32_16x16x32_bf16 v[68:71], a[128:131], v[144:147], v[196:199]
  v_exp_f32 v33, v33
  v_mfma_f32_16x16x32_bf16 v[72:75], a[128:131], v[160:163], v[200:203]
  v_mfma_f32_16x16x32_bf16 v[76:79], a[128:131], v[176:179], v[204:207]
  ds_read_b128 a[128:131], v17 offset:16384
  s_waitcnt vmcnt(29)
  buffer_store_dword v26, v23, s[16:19], s72 offen offset:0 sc1
  v_mfma_f32_16x16x32_bf16 v[92:95], a[144:147], v[176:179], v[204:207]
  v_exp_f32 v34, v34
  v_mfma_f32_16x16x32_bf16 v[88:91], a[144:147], v[160:163], v[200:203]
  v_exp_f32 v35, v35
  v_mfma_f32_16x16x32_bf16 v[84:87], a[144:147], v[144:147], v[196:199]
  v_cvt_pk_bf16_f32 v96, v32, v33
  v_mfma_f32_16x16x32_bf16 v[80:83], a[144:147], v[128:131], v[192:195]
  ds_read_b128 a[144:147], v17 offset:17408
  v_mfma_f32_16x16x32_bf16 v[64:67], a[132:135], v[132:135], v[64:67]
  v_exp_f32 v48, v48
  v_mfma_f32_16x16x32_bf16 v[68:71], a[132:135], v[148:151], v[68:71]
  v_exp_f32 v49, v49
  v_mfma_f32_16x16x32_bf16 v[72:75], a[132:135], v[164:167], v[72:75]
  v_cvt_pk_bf16_f32 v97, v34, v35
  v_mfma_f32_16x16x32_bf16 v[76:79], a[132:135], v[180:183], v[76:79]
  ds_read_b128 a[132:135], v17 offset:18432
  v_mfma_f32_16x16x32_bf16 v[92:95], a[148:151], v[180:183], v[92:95]
  v_exp_f32 v50, v50
  v_mfma_f32_16x16x32_bf16 v[88:91], a[148:151], v[164:167], v[88:91]
  v_exp_f32 v51, v51
  v_mfma_f32_16x16x32_bf16 v[84:87], a[148:151], v[148:151], v[84:87]
  v_cvt_pk_bf16_f32 v98, v48, v49
  v_mfma_f32_16x16x32_bf16 v[80:83], a[148:151], v[132:135], v[80:83]
  ds_read_b128 a[148:151], v17 offset:19456
  s_waitcnt lgkmcnt(15)
  v_mfma_f32_16x16x32_bf16 v[64:67], a[136:139], v[136:139], v[64:67]
  buffer_load_dword a244, v24, s[4:7], s61 offen offset:0
  v_mfma_f32_16x16x32_bf16 v[68:71], a[136:139], v[152:155], v[68:71]
  v_exp_f32 v36, v36
  v_mfma_f32_16x16x32_bf16 v[72:75], a[136:139], v[168:171], v[72:75]
  v_exp_f32 v37, v37
  v_mfma_f32_16x16x32_bf16 v[76:79], a[136:139], v[184:187], v[76:79]
  ds_read_b128 a[136:139], v17 offset:20480
  v_cvt_pk_bf16_f32 v99, v50, v51
  v_mfma_f32_16x16x32_bf16 v[92:95], a[152:155], v[184:187], v[92:95]
  v_exp_f32 v38, v38
  v_mfma_f32_16x16x32_bf16 v[88:91], a[152:155], v[168:171], v[88:91]
  v_exp_f32 v39, v39
  v_mfma_f32_16x16x32_bf16 v[84:87], a[152:155], v[152:155], v[84:87]
  v_cvt_pk_bf16_f32 v100, v36, v37
  v_mfma_f32_16x16x32_bf16 v[80:83], a[152:155], v[136:139], v[80:83]
  ds_read_b128 a[152:155], v17 offset:21504
  v_mfma_f32_16x16x32_bf16 v[64:67], a[140:143], v[140:143], v[64:67]
  v_exp_f32 v52, v52
  v_mfma_f32_16x16x32_bf16 v[68:71], a[140:143], v[156:159], v[68:71]
  v_exp_f32 v53, v53
  v_mfma_f32_16x16x32_bf16 v[72:75], a[140:143], v[172:175], v[72:75]
  v_cvt_pk_bf16_f32 v101, v38, v39
  v_mfma_f32_16x16x32_bf16 v[76:79], a[140:143], v[188:191], v[76:79]
  ds_read_b128 a[140:143], v17 offset:22528
  v_mfma_f32_16x16x32_bf16 v[92:95], a[156:159], v[188:191], v[92:95]
  buffer_load_dword a245, v24, s[4:7], s61 offen offset:1024
  v_mfma_f32_16x16x32_bf16 v[88:91], a[156:159], v[172:175], v[88:91]
  v_exp_f32 v54, v54
  v_mfma_f32_16x16x32_bf16 v[84:87], a[156:159], v[156:159], v[84:87]
  v_exp_f32 v55, v55
  v_mfma_f32_16x16x32_bf16 v[80:83], a[156:159], v[140:143], v[80:83]
  ds_read_b128 a[156:159], v17 offset:23552
  s_waitcnt lgkmcnt(15)
  v_mfma_f32_16x16x32_bf16 a[0:3], a[160:163], v[112:115], a[0:3]
  v_cvt_pk_bf16_f32 v102, v52, v53
  v_mfma_f32_16x16x32_bf16 a[4:7], a[160:163], v[116:119], a[4:7]
  v_exp_f32 v40, v40
  v_mfma_f32_16x16x32_bf16 a[8:11], a[160:163], v[120:123], a[8:11]
  v_exp_f32 v41, v41
  v_mfma_f32_16x16x32_bf16 a[12:15], a[160:163], v[124:127], a[12:15]
  ds_read_b64_tr_b16 a[160:161], v10 offset:24576
  v_cvt_pk_bf16_f32 v103, v54, v55
  v_mfma_f32_16x16x32_bf16 a[28:31], a[164:167], v[124:127], a[28:31]
  ds_read_b64_tr_b16 a[162:163], v10 offset:28672
  v_mfma_f32_16x16x32_bf16 a[24:27], a[164:167], v[120:123], a[24:27]
  v_exp_f32 v42, v42
  v_mfma_f32_16x16x32_bf16 a[20:23], a[164:167], v[116:119], a[20:23]
  v_exp_f32 v43, v43
  v_mfma_f32_16x16x32_bf16 a[16:19], a[164:167], v[112:115], a[16:19]
  ds_read_b64_tr_b16 a[164:165], v11 offset:24576
  v_cvt_pk_bf16_f32 v104, v40, v41
  v_mfma_f32_16x16x32_bf16 a[32:35], a[168:171], v[112:115], a[32:35]
  ds_read_b64_tr_b16 a[166:167], v11 offset:28672
  buffer_load_dword a246, v24, s[4:7], s61 offen offset:2048
  v_mfma_f32_16x16x32_bf16 a[36:39], a[168:171], v[116:119], a[36:39]
  v_exp_f32 v56, v56
  v_mfma_f32_16x16x32_bf16 a[40:43], a[168:171], v[120:123], a[40:43]
  v_exp_f32 v57, v57
  v_mfma_f32_16x16x32_bf16 a[44:47], a[168:171], v[124:127], a[44:47]
  ds_read_b64_tr_b16 a[168:169], v10 offset:24832
  v_cvt_pk_bf16_f32 v105, v42, v43
  v_mfma_f32_16x16x32_bf16 a[60:63], a[172:175], v[124:127], a[60:63]
  ds_read_b64_tr_b16 a[170:171], v10 offset:28928
  v_mfma_f32_16x16x32_bf16 a[56:59], a[172:175], v[120:123], a[56:59]
  v_exp_f32 v58, v58
  v_mfma_f32_16x16x32_bf16 a[52:55], a[172:175], v[116:119], a[52:55]
  v_exp_f32 v59, v59
  v_mfma_f32_16x16x32_bf16 a[48:51], a[172:175], v[112:115], a[48:51]
  ds_read_b64_tr_b16 a[172:173], v11 offset:24832
  s_waitcnt lgkmcnt(15)
  v_mfma_f32_16x16x32_bf16 a[64:67], a[176:179], v[112:115], a[64:67]
  ds_read_b64_tr_b16 a[174:175], v11 offset:28928
  v_cvt_pk_bf16_f32 v106, v56, v57
  v_mfma_f32_16x16x32_bf16 a[68:71], a[176:179], v[116:119], a[68:71]
  v_exp_f32 v44, v44
  v_mfma_f32_16x16x32_bf16 a[72:75], a[176:179], v[120:123], a[72:75]
  v_exp_f32 v45, v45
  v_mfma_f32_16x16x32_bf16 a[76:79], a[176:179], v[124:127], a[76:79]
  ds_read_b64_tr_b16 a[176:177], v10 offset:25088
  v_cvt_pk_bf16_f32 v107, v58, v59
  v_mfma_f32_16x16x32_bf16 a[92:95], a[180:183], v[124:127], a[92:95]
  ds_read_b64_tr_b16 a[178:179], v10 offset:29184
  v_mfma_f32_16x16x32_bf16 a[88:91], a[180:183], v[120:123], a[88:91]
  buffer_load_dword a247, v24, s[4:7], s61 offen offset:3072
  v_mfma_f32_16x16x32_bf16 a[84:87], a[180:183], v[116:119], a[84:87]
  v_exp_f32 v46, v46
  v_mfma_f32_16x16x32_bf16 a[80:83], a[180:183], v[112:115], a[80:83]
  ds_read_b64_tr_b16 a[180:181], v11 offset:25088
  ds_read_b64_tr_b16 a[182:183], v11 offset:29184
  v_mfma_f32_16x16x32_bf16 a[96:99], a[184:187], v[112:115], a[96:99]
  v_exp_f32 v47, v47
  v_mfma_f32_16x16x32_bf16 a[100:103], a[184:187], v[116:119], a[100:103]
  v_cvt_pk_bf16_f32 v108, v44, v45
  v_mfma_f32_16x16x32_bf16 a[104:107], a[184:187], v[120:123], a[104:107]
  v_exp_f32 v60, v60
  v_mfma_f32_16x16x32_bf16 a[108:111], a[184:187], v[124:127], a[108:111]
  ds_read_b64_tr_b16 a[184:185], v10 offset:25344
  ds_read_b64_tr_b16 a[186:187], v10 offset:29440
  v_mfma_f32_16x16x32_bf16 a[124:127], a[188:191], v[124:127], a[124:127]
  v_exp_f32 v61, v61
  v_mfma_f32_16x16x32_bf16 a[120:123], a[188:191], v[120:123], a[120:123]
  v_cvt_pk_bf16_f32 v109, v46, v47
  v_mfma_f32_16x16x32_bf16 a[116:119], a[188:191], v[116:119], a[116:119]
  v_exp_f32 v62, v62
  v_mfma_f32_16x16x32_bf16 a[112:115], a[188:191], v[112:115], a[112:115]
  ds_read_b64_tr_b16 a[188:189], v11 offset:25344
  v_mfma_f32_16x16x32_bf16 v[212:215], v[208:211], v[112:115], v[212:215]
  ds_read_b64_tr_b16 a[190:191], v11 offset:29440
  v_exp_f32 v63, v63
  v_mfma_f32_16x16x32_bf16 v[216:219], v[208:211], v[116:119], v[216:219]
  v_cvt_pk_bf16_f32 v110, v60, v61
  s_nop 0
  v_mfma_f32_16x16x32_bf16 v[220:223], v[208:211], v[120:123], v[220:223]
  v_cvt_pk_bf16_f32 v111, v62, v63
  v_mfma_f32_16x16x32_bf16 v[224:227], v[208:211], v[124:127], v[224:227]
  s_waitcnt lgkmcnt(15)
  v_mfma_f32_16x16x32_bf16 v[32:35], a[128:131], v[128:131], v[192:195]
  v_exp_f32 v64, v64
  v_mfma_f32_16x16x32_bf16 v[36:39], a[128:131], v[144:147], v[196:199]
  v_exp_f32 v65, v65
  v_mfma_f32_16x16x32_bf16 v[40:43], a[128:131], v[160:163], v[200:203]
  v_mfma_f32_16x16x32_bf16 v[44:47], a[128:131], v[176:179], v[204:207]
  v_exp_f32 v66, v66
  v_mfma_f32_16x16x32_bf16 v[60:63], a[144:147], v[176:179], v[204:207]
  v_exp_f32 v67, v67
  v_mfma_f32_16x16x32_bf16 v[56:59], a[144:147], v[160:163], v[200:203]
  v_mfma_f32_16x16x32_bf16 v[52:55], a[144:147], v[144:147], v[196:199]
  v_cvt_pk_bf16_f32 v112, v64, v65
  v_mfma_f32_16x16x32_bf16 v[48:51], a[144:147], v[128:131], v[192:195]
  v_exp_f32 v80, v80
  v_mfma_f32_16x16x32_bf16 v[32:35], a[132:135], v[132:135], v[32:35]
  v_exp_f32 v81, v81
  v_mfma_f32_16x16x32_bf16 v[36:39], a[132:135], v[148:151], v[36:39]
  v_mfma_f32_16x16x32_bf16 v[40:43], a[132:135], v[164:167], v[40:43]
  v_cvt_pk_bf16_f32 v113, v66, v67
  v_mfma_f32_16x16x32_bf16 v[44:47], a[132:135], v[180:183], v[44:47]
  s_waitcnt vmcnt(49) lgkmcnt(0)
  s_barrier
  v_mfma_f32_16x16x32_bf16 v[60:63], a[148:151], v[180:183], v[60:63]
  ds_read_b128 a[128:131], v16 offset:0
  ds_read_b128 a[144:147], v16 offset:1024
  v_mfma_f32_16x16x32_bf16 v[56:59], a[148:151], v[164:167], v[56:59]
  ds_read_b128 a[132:135], v16 offset:2048
  v_mfma_f32_16x16x32_bf16 v[52:55], a[148:151], v[148:151], v[52:55]
  v_exp_f32 v82, v82
  v_mfma_f32_16x16x32_bf16 v[48:51], a[148:151], v[132:135], v[48:51]
  ds_read_b128 a[148:151], v16 offset:3072
  s_waitcnt lgkmcnt(15)
  v_mfma_f32_16x16x32_bf16 v[32:35], a[136:139], v[136:139], v[32:35]
  s_add_u32 m0, s63, 65536
  s_add_u32 s42, s64, 0
  v_exp_f32 v83, v83
  v_mfma_f32_16x16x32_bf16 v[36:39], a[136:139], v[152:155], v[36:39]
  buffer_load_dwordx4 v4, s[4:7], s42 offen offset:0 lds
  v_cvt_pk_bf16_f32 v114, v80, v81
  v_mfma_f32_16x16x32_bf16 v[40:43], a[136:139], v[168:171], v[40:43]
  v_exp_f32 v68, v68
  v_mfma_f32_16x16x32_bf16 v[44:47], a[136:139], v[184:187], v[44:47]
  ds_read_b128 a[136:139], v16 offset:4096
  v_mfma_f32_16x16x32_bf16 v[60:63], a[152:155], v[184:187], v[60:63]
  v_exp_f32 v69, v69
  v_mfma_f32_16x16x32_bf16 v[56:59], a[152:155], v[168:171], v[56:59]
  buffer_load_dwordx4 v5, s[4:7], s42 offen offset:1024 lds
  v_cvt_pk_bf16_f32 v115, v82, v83
  v_mfma_f32_16x16x32_bf16 v[52:55], a[152:155], v[152:155], v[52:55]
  v_exp_f32 v70, v70
  v_mfma_f32_16x16x32_bf16 v[48:51], a[152:155], v[136:139], v[48:51]
  ds_read_b128 a[152:155], v16 offset:5120
  v_mfma_f32_16x16x32_bf16 v[32:35], a[140:143], v[140:143], v[32:35]
  v_exp_f32 v71, v71
  v_mfma_f32_16x16x32_bf16 v[36:39], a[140:143], v[156:159], v[36:39]
  v_cvt_pk_bf16_f32 v116, v68, v69
  v_mfma_f32_16x16x32_bf16 v[40:43], a[140:143], v[172:175], v[40:43]
  v_exp_f32 v84, v84
  v_mfma_f32_16x16x32_bf16 v[44:47], a[140:143], v[188:191], v[44:47]
  ds_read_b128 a[140:143], v16 offset:6144
  v_mfma_f32_16x16x32_bf16 v[60:63], a[156:159], v[188:191], v[60:63]
  buffer_load_dwordx4 v6, s[4:7], s42 offen offset:2048 lds
  v_exp_f32 v85, v85
  v_mfma_f32_16x16x32_bf16 v[56:59], a[156:159], v[172:175], v[56:59]
  v_cvt_pk_bf16_f32 v117, v70, v71
  v_mfma_f32_16x16x32_bf16 v[52:55], a[156:159], v[156:159], v[52:55]
  v_exp_f32 v86, v86
  v_mfma_f32_16x16x32_bf16 v[48:51], a[156:159], v[140:143], v[48:51]
  ds_read_b128 a[156:159], v16 offset:7168
  s_waitcnt lgkmcnt(15)
  v_mfma_f32_16x16x32_bf16 a[0:3], a[160:163], v[96:99], a[0:3]
  v_exp_f32 v87, v87
  v_mfma_f32_16x16x32_bf16 a[4:7], a[160:163], v[100:103], a[4:7]
  v_cvt_pk_bf16_f32 v118, v84, v85
  v_mfma_f32_16x16x32_bf16 a[8:11], a[160:163], v[104:107], a[8:11]
  buffer_load_dwordx4 v7, s[4:7], s42 offen offset:3072 lds
  v_exp_f32 v72, v72
  v_mfma_f32_16x16x32_bf16 a[12:15], a[160:163], v[108:111], a[12:15]
  ds_read_b64_tr_b16 a[160:161], v8 offset:8192
  ds_read_b64_tr_b16 a[162:163], v8 offset:12288
  v_mfma_f32_16x16x32_bf16 a[28:31], a[164:167], v[108:111], a[28:31]
  v_exp_f32 v73, v73
  v_mfma_f32_16x16x32_bf16 a[24:27], a[164:167], v[104:107], a[24:27]
  v_cvt_pk_bf16_f32 v119, v86, v87
  v_mfma_f32_16x16x32_bf16 a[20:23], a[164:167], v[100:103], a[20:23]
  v_exp_f32 v74, v74
  v_mfma_f32_16x16x32_bf16 a[16:19], a[164:167], v[96:99], a[16:19]
  ds_read_b64_tr_b16 a[164:165], v9 offset:8192
  ds_read_b64_tr_b16 a[166:167], v9 offset:12288
  v_mfma_f32_16x16x32_bf16 a[32:35], a[168:171], v[96:99], a[32:35]
  s_add_u32 m0, s63, 69632
  s_add_u32 s43, s64, 32768
  v_exp_f32 v75, v75
  v_mfma_f32_16x16x32_bf16 a[36:39], a[168:171], v[100:103], a[36:39]
  buffer_load_dwordx4 v4, s[4:7], s43 offen offset:0 lds
  v_cvt_pk_bf16_f32 v120, v72, v73
  v_mfma_f32_16x16x32_bf16 a[40:43], a[168:171], v[104:107], a[40:43]
  v_exp_f32 v88, v88
  v_mfma_f32_16x16x32_bf16 a[44:47], a[168:171], v[108:111], a[44:47]
  ds_read_b64_tr_b16 a[168:169], v8 offset:8448
  ds_read_b64_tr_b16 a[170:171], v8 offset:12544
  v_mfma_f32_16x16x32_bf16 a[60:63], a[172:175], v[108:111], a[60:63]
  v_exp_f32 v89, v89
  v_mfma_f32_16x16x32_bf16 a[56:59], a[172:175], v[104:107], a[56:59]
  v_cvt_pk_bf16_f32 v121, v74, v75
  v_mfma_f32_16x16x32_bf16 a[52:55], a[172:175], v[100:103], a[52:55]
  v_exp_f32 v90, v90
  v_mfma_f32_16x16x32_bf16 a[48:51], a[172:175], v[96:99], a[48:51]
  ds_read_b64_tr_b16 a[172:173], v9 offset:8448
  s_waitcnt lgkmcnt(15)
  v_mfma_f32_16x16x32_bf16 a[64:67], a[176:179], v[96:99], a[64:67]
  ds_read_b64_tr_b16 a[174:175], v9 offset:12544
  buffer_load_dwordx4 v5, s[4:7], s43 offen offset:1024 lds
  v_exp_f32 v91, v91
  v_mfma_f32_16x16x32_bf16 a[68:71], a[176:179], v[100:103], a[68:71]
  v_cvt_pk_bf16_f32 v122, v88, v89
  v_mfma_f32_16x16x32_bf16 a[72:75], a[176:179], v[104:107], a[72:75]
  v_exp_f32 v76, v76
  v_mfma_f32_16x16x32_bf16 a[76:79], a[176:179], v[108:111], a[76:79]
  ds_read_b64_tr_b16 a[176:177], v8 offset:8704
  ds_read_b64_tr_b16 a[178:179], v8 offset:12800
  v_mfma_f32_16x16x32_bf16 a[92:95], a[180:183], v[108:111], a[92:95]
  v_exp_f32 v77, v77
  v_mfma_f32_16x16x32_bf16 a[88:91], a[180:183], v[104:107], a[88:91]
  v_cvt_pk_bf16_f32 v123, v90, v91
  v_mfma_f32_16x16x32_bf16 a[84:87], a[180:183], v[100:103], a[84:87]
  buffer_load_dwordx4 v6, s[4:7], s43 offen offset:2048 lds
  v_mfma_f32_16x16x32_bf16 a[80:83], a[180:183], v[96:99], a[80:83]
  ds_read_b64_tr_b16 a[180:181], v9 offset:8704
  v_exp_f32 v78, v78
  v_mfma_f32_16x16x32_bf16 a[96:99], a[184:187], v[96:99], a[96:99]
  ds_read_b64_tr_b16 a[182:183], v9 offset:12800
  v_exp_f32 v79, v79
  v_mfma_f32_16x16x32_bf16 a[100:103], a[184:187], v[100:103], a[100:103]
  v_cvt_pk_bf16_f32 v124, v76, v77
  v_mfma_f32_16x16x32_bf16 a[104:107], a[184:187], v[104:107], a[104:107]
  v_exp_f32 v92, v92
  v_mfma_f32_16x16x32_bf16 a[108:111], a[184:187], v[108:111], a[108:111]
  ds_read_b64_tr_b16 a[184:185], v8 offset:8960
  ds_read_b64_tr_b16 a[186:187], v8 offset:13056
  v_mfma_f32_16x16x32_bf16 a[124:127], a[188:191], v[108:111], a[124:127]
  buffer_load_dwordx4 v7, s[4:7], s43 offen offset:3072 lds
  v_exp_f32 v93, v93
  v_mfma_f32_16x16x32_bf16 a[120:123], a[188:191], v[104:107], a[120:123]
  v_cvt_pk_bf16_f32 v125, v78, v79
  v_mfma_f32_16x16x32_bf16 a[116:119], a[188:191], v[100:103], a[116:119]
  v_exp_f32 v94, v94
  v_mfma_f32_16x16x32_bf16 a[112:115], a[188:191], v[96:99], a[112:115]
  ds_read_b64_tr_b16 a[188:189], v9 offset:8960
  v_mfma_f32_16x16x32_bf16 v[212:215], v[208:211], v[96:99], v[212:215]
  ds_read_b64_tr_b16 a[190:191], v9 offset:13056
  v_exp_f32 v95, v95
  v_mfma_f32_16x16x32_bf16 v[216:219], v[208:211], v[100:103], v[216:219]
  v_cvt_pk_bf16_f32 v126, v92, v93
  s_nop 0
  v_mfma_f32_16x16x32_bf16 v[220:223], v[208:211], v[104:107], v[220:223]
  v_cvt_pk_bf16_f32 v127, v94, v95
  v_mfma_f32_16x16x32_bf16 v[224:227], v[208:211], v[108:111], v[224:227]
  s_waitcnt lgkmcnt(15)
  v_mfma_f32_16x16x32_bf16 v[64:67], a[128:131], v[128:131], v[192:195]
  v_exp_f32 v32, v32
  v_mfma_f32_16x16x32_bf16 v[68:71], a[128:131], v[144:147], v[196:199]
  v_exp_f32 v33, v33
  v_mfma_f32_16x16x32_bf16 v[72:75], a[128:131], v[160:163], v[200:203]
  v_mfma_f32_16x16x32_bf16 v[76:79], a[128:131], v[176:179], v[204:207]
  ds_read_b128 a[128:131], v16 offset:16384
  buffer_load_dword a248, v24, s[8:11], s60 offen offset:0
  v_mfma_f32_16x16x32_bf16 v[92:95], a[144:147], v[176:179], v[204:207]
  v_exp_f32 v34, v34
  v_mfma_f32_16x16x32_bf16 v[88:91], a[144:147], v[160:163], v[200:203]
  v_exp_f32 v35, v35
  v_mfma_f32_16x16x32_bf16 v[84:87], a[144:147], v[144:147], v[196:199]
  v_cvt_pk_bf16_f32 v96, v32, v33
  v_mfma_f32_16x16x32_bf16 v[80:83], a[144:147], v[128:131], v[192:195]
  ds_read_b128 a[144:147], v16 offset:17408
  v_mfma_f32_16x16x32_bf16 v[64:67], a[132:135], v[132:135], v[64:67]
  v_exp_f32 v48, v48
  v_mfma_f32_16x16x32_bf16 v[68:71], a[132:135], v[148:151], v[68:71]
  v_exp_f32 v49, v49
  v_mfma_f32_16x16x32_bf16 v[72:75], a[132:135], v[164:167], v[72:75]
  v_cvt_pk_bf16_f32 v97, v34, v35
  v_mfma_f32_16x16x32_bf16 v[76:79], a[132:135], v[180:183], v[76:79]
  ds_read_b128 a[132:135], v16 offset:18432
  v_mfma_f32_16x16x32_bf16 v[92:95], a[148:151], v[180:183], v[92:95]
  v_exp_f32 v50, v50
  v_mfma_f32_16x16x32_bf16 v[88:91], a[148:151], v[164:167], v[88:91]
  v_exp_f32 v51, v51
  v_mfma_f32_16x16x32_bf16 v[84:87], a[148:151], v[148:151], v[84:87]
  v_cvt_pk_bf16_f32 v98, v48, v49
  v_mfma_f32_16x16x32_bf16 v[80:83], a[148:151], v[132:135], v[80:83]
  ds_read_b128 a[148:151], v16 offset:19456
  s_waitcnt lgkmcnt(15)
  v_mfma_f32_16x16x32_bf16 v[64:67], a[136:139], v[136:139], v[64:67]
  v_exp_f32 v36, v36
  v_mfma_f32_16x16x32_bf16 v[68:71], a[136:139], v[152:155], v[68:71]
  v_exp_f32 v37, v37
  v_mfma_f32_16x16x32_bf16 v[72:75], a[136:139], v[168:171], v[72:75]
  buffer_load_dword a249, v24, s[8:11], s60 offen offset:1024
  v_cvt_pk_bf16_f32 v99, v50, v51
  v_mfma_f32_16x16x32_bf16 v[76:79], a[136:139], v[184:187], v[76:79]
  ds_read_b128 a[136:139], v16 offset:20480
  v_mfma_f32_16x16x32_bf16 v[92:95], a[152:155], v[184:187], v[92:95]
  v_exp_f32 v38, v38
  v_mfma_f32_16x16x32_bf16 v[88:91], a[152:155], v[168:171], v[88:91]
  v_exp_f32 v39, v39
  v_mfma_f32_16x16x32_bf16 v[84:87], a[152:155], v[152:155], v[84:87]
  v_cvt_pk_bf16_f32 v100, v36, v37
  v_mfma_f32_16x16x32_bf16 v[80:83], a[152:155], v[136:139], v[80:83]
  ds_read_b128 a[152:155], v16 offset:21504
  v_mfma_f32_16x16x32_bf16 v[64:67], a[140:143], v[140:143], v[64:67]
  v_exp_f32 v52, v52
  v_mfma_f32_16x16x32_bf16 v[68:71], a[140:143], v[156:159], v[68:71]
  v_exp_f32 v53, v53
  v_mfma_f32_16x16x32_bf16 v[72:75], a[140:143], v[172:175], v[72:75]
  v_cvt_pk_bf16_f32 v101, v38, v39
  v_mfma_f32_16x16x32_bf16 v[76:79], a[140:143], v[188:191], v[76:79]
  ds_read_b128 a[140:143], v16 offset:22528
  v_mfma_f32_16x16x32_bf16 v[92:95], a[156:159], v[188:191], v[92:95]
  v_exp_f32 v54, v54
  v_mfma_f32_16x16x32_bf16 v[88:91], a[156:159], v[172:175], v[88:91]
  v_exp_f32 v55, v55
  v_mfma_f32_16x16x32_bf16 v[84:87], a[156:159], v[156:159], v[84:87]
  v_cvt_pk_bf16_f32 v102, v52, v53
  v_mfma_f32_16x16x32_bf16 v[80:83], a[156:159], v[140:143], v[80:83]
  ds_read_b128 a[156:159], v16 offset:23552
  s_waitcnt lgkmcnt(15)
  v_mfma_f32_16x16x32_bf16 a[0:3], a[160:163], v[112:115], a[0:3]
  v_exp_f32 v40, v40
  v_mfma_f32_16x16x32_bf16 a[4:7], a[160:163], v[116:119], a[4:7]
  v_exp_f32 v41, v41
  v_mfma_f32_16x16x32_bf16 a[8:11], a[160:163], v[120:123], a[8:11]
  buffer_load_dword a250, v24, s[8:11], s60 offen offset:2048
  v_mfma_f32_16x16x32_bf16 a[12:15], a[160:163], v[124:127], a[12:15]
  ds_read_b64_tr_b16 a[160:161], v8 offset:24576
  v_cvt_pk_bf16_f32 v103, v54, v55
  v_mfma_f32_16x16x32_bf16 a[28:31], a[164:167], v[124:127], a[28:31]
  ds_read_b64_tr_b16 a[162:163], v8 offset:28672
  v_mfma_f32_16x16x32_bf16 a[24:27], a[164:167], v[120:123], a[24:27]
  v_exp_f32 v42, v42
  v_mfma_f32_16x16x32_bf16 a[20:23], a[164:167], v[116:119], a[20:23]
  v_exp_f32 v43, v43
  v_mfma_f32_16x16x32_bf16 a[16:19], a[164:167], v[112:115], a[16:19]
  ds_read_b64_tr_b16 a[164:165], v9 offset:24576
  v_cvt_pk_bf16_f32 v104, v40, v41
  v_mfma_f32_16x16x32_bf16 a[32:35], a[168:171], v[112:115], a[32:35]
  ds_read_b64_tr_b16 a[166:167], v9 offset:28672
  v_mfma_f32_16x16x32_bf16 a[36:39], a[168:171], v[116:119], a[36:39]
  v_exp_f32 v56, v56
  v_mfma_f32_16x16x32_bf16 a[40:43], a[168:171], v[120:123], a[40:43]
  v_exp_f32 v57, v57
  v_mfma_f32_16x16x32_bf16 a[44:47], a[168:171], v[124:127], a[44:47]
  ds_read_b64_tr_b16 a[168:169], v8 offset:24832
  v_cvt_pk_bf16_f32 v105, v42, v43
  v_mfma_f32_16x16x32_bf16 a[60:63], a[172:175], v[124:127], a[60:63]
  ds_read_b64_tr_b16 a[170:171], v8 offset:28928
  v_mfma_f32_16x16x32_bf16 a[56:59], a[172:175], v[120:123], a[56:59]
  v_exp_f32 v58, v58
  v_mfma_f32_16x16x32_bf16 a[52:55], a[172:175], v[116:119], a[52:55]
  v_exp_f32 v59, v59
  v_mfma_f32_16x16x32_bf16 a[48:51], a[172:175], v[112:115], a[48:51]
  ds_read_b64_tr_b16 a[172:173], v9 offset:24832
  s_waitcnt lgkmcnt(15)
  v_mfma_f32_16x16x32_bf16 a[64:67], a[176:179], v[112:115], a[64:67]
  ds_read_b64_tr_b16 a[174:175], v9 offset:28928
  v_cvt_pk_bf16_f32 v106, v56, v57
  v_mfma_f32_16x16x32_bf16 a[68:71], a[176:179], v[116:119], a[68:71]
  v_exp_f32 v44, v44
  v_mfma_f32_16x16x32_bf16 a[72:75], a[176:179], v[120:123], a[72:75]
  buffer_load_dword a251, v24, s[8:11], s60 offen offset:3072
  v_mfma_f32_16x16x32_bf16 a[76:79], a[176:179], v[124:127], a[76:79]
  ds_read_b64_tr_b16 a[176:177], v8 offset:25088
  ds_read_b64_tr_b16 a[178:179], v8 offset:29184
  v_mfma_f32_16x16x32_bf16 a[92:95], a[180:183], v[124:127], a[92:95]
  v_exp_f32 v45, v45
  v_mfma_f32_16x16x32_bf16 a[88:91], a[180:183], v[120:123], a[88:91]
  v_cvt_pk_bf16_f32 v107, v58, v59
  v_mfma_f32_16x16x32_bf16 a[84:87], a[180:183], v[116:119], a[84:87]
  v_exp_f32 v46, v46
  v_mfma_f32_16x16x32_bf16 a[80:83], a[180:183], v[112:115], a[80:83]
  ds_read_b64_tr_b16 a[180:181], v9 offset:25088
  ds_read_b64_tr_b16 a[182:183], v9 offset:29184
  v_mfma_f32_16x16x32_bf16 a[96:99], a[184:187], v[112:115], a[96:99]
  v_exp_f32 v47, v47
  v_mfma_f32_16x16x32_bf16 a[100:103], a[184:187], v[116:119], a[100:103]
  v_cvt_pk_bf16_f32 v108, v44, v45
  v_mfma_f32_16x16x32_bf16 a[104:107], a[184:187], v[120:123], a[104:107]
  v_exp_f32 v60, v60
  v_mfma_f32_16x16x32_bf16 a[108:111], a[184:187], v[124:127], a[108:111]
  ds_read_b64_tr_b16 a[184:185], v8 offset:25344
  ds_read_b64_tr_b16 a[186:187], v8 offset:29440
  v_mfma_f32_16x16x32_bf16 a[124:127], a[188:191], v[124:127], a[124:127]
  v_exp_f32 v61, v61
  v_mfma_f32_16x16x32_bf16 a[120:123], a[188:191], v[120:123], a[120:123]
  v_cvt_pk_bf16_f32 v109, v46, v47
  v_mfma_f32_16x16x32_bf16 a[116:119], a[188:191], v[116:119], a[116:119]
  v_exp_f32 v62, v62
  v_mfma_f32_16x16x32_bf16 a[112:115], a[188:191], v[112:115], a[112:115]
  ds_read_b64_tr_b16 a[188:189], v9 offset:25344
  v_mfma_f32_16x16x32_bf16 v[212:215], v[208:211], v[112:115], v[212:215]
  ds_read_b64_tr_b16 a[190:191], v9 offset:29440
  v_exp_f32 v63, v63
  v_mfma_f32_16x16x32_bf16 v[216:219], v[208:211], v[116:119], v[216:219]
  v_cvt_pk_bf16_f32 v110, v60, v61
  s_nop 0
  v_mfma_f32_16x16x32_bf16 v[220:223], v[208:211], v[120:123], v[220:223]
  v_cvt_pk_bf16_f32 v111, v62, v63
  v_mfma_f32_16x16x32_bf16 v[224:227], v[208:211], v[124:127], v[224:227]
  s_waitcnt lgkmcnt(15)
  v_mfma_f32_16x16x32_bf16 v[32:35], a[128:131], v[128:131], v[192:195]
  v_exp_f32 v64, v64
  v_mfma_f32_16x16x32_bf16 v[36:39], a[128:131], v[144:147], v[196:199]
  v_exp_f32 v65, v65
  v_mfma_f32_16x16x32_bf16 v[40:43], a[128:131], v[160:163], v[200:203]
  v_mfma_f32_16x16x32_bf16 v[44:47], a[128:131], v[176:179], v[204:207]
  v_exp_f32 v66, v66
  v_mfma_f32_16x16x32_bf16 v[60:63], a[144:147], v[176:179], v[204:207]
  v_exp_f32 v67, v67
  v_mfma_f32_16x16x32_bf16 v[56:59], a[144:147], v[160:163], v[200:203]
  v_mfma_f32_16x16x32_bf16 v[52:55], a[144:147], v[144:147], v[196:199]
  v_cvt_pk_bf16_f32 v112, v64, v65
  v_mfma_f32_16x16x32_bf16 v[48:51], a[144:147], v[128:131], v[192:195]
  v_exp_f32 v80, v80
  v_mfma_f32_16x16x32_bf16 v[32:35], a[132:135], v[132:135], v[32:35]
  v_exp_f32 v81, v81
  v_mfma_f32_16x16x32_bf16 v[36:39], a[132:135], v[148:151], v[36:39]
  v_mfma_f32_16x16x32_bf16 v[40:43], a[132:135], v[164:167], v[40:43]
  v_cvt_pk_bf16_f32 v113, v66, v67
  v_mfma_f32_16x16x32_bf16 v[44:47], a[132:135], v[180:183], v[44:47]
  s_waitcnt vmcnt(38) lgkmcnt(0)
  s_barrier
  v_mfma_f32_16x16x32_bf16 v[60:63], a[148:151], v[180:183], v[60:63]
  ds_read_b128 a[128:131], v17 offset:32768
  ds_read_b128 a[144:147], v17 offset:33792
  v_mfma_f32_16x16x32_bf16 v[56:59], a[148:151], v[164:167], v[56:59]
  ds_read_b128 a[132:135], v17 offset:34816
  v_mfma_f32_16x16x32_bf16 v[52:55], a[148:151], v[148:151], v[52:55]
  v_exp_f32 v82, v82
  v_mfma_f32_16x16x32_bf16 v[48:51], a[148:151], v[132:135], v[48:51]
  ds_read_b128 a[148:151], v17 offset:35840
  s_waitcnt lgkmcnt(15)
  v_mfma_f32_16x16x32_bf16 v[32:35], a[136:139], v[136:139], v[32:35]
  s_add_u32 m0, s63, 0
  s_add_u32 s42, s64, 262144
  v_exp_f32 v83, v83
  v_mfma_f32_16x16x32_bf16 v[36:39], a[136:139], v[152:155], v[36:39]
  buffer_load_dwordx4 v4, s[4:7], s42 offen offset:0 lds
  v_cvt_pk_bf16_f32 v114, v80, v81
  v_mfma_f32_16x16x32_bf16 v[40:43], a[136:139], v[168:171], v[40:43]
  v_exp_f32 v68, v68
  v_mfma_f32_16x16x32_bf16 v[44:47], a[136:139], v[184:187], v[44:47]
  ds_read_b128 a[136:139], v17 offset:36864
  v_mfma_f32_16x16x32_bf16 v[60:63], a[152:155], v[184:187], v[60:63]
  v_exp_f32 v69, v69
  v_mfma_f32_16x16x32_bf16 v[56:59], a[152:155], v[168:171], v[56:59]
  buffer_load_dwordx4 v5, s[4:7], s42 offen offset:1024 lds
  v_cvt_pk_bf16_f32 v115, v82, v83
  v_mfma_f32_16x16x32_bf16 v[52:55], a[152:155], v[152:155], v[52:55]
  v_exp_f32 v70, v70
  v_mfma_f32_16x16x32_bf16 v[48:51], a[152:155], v[136:139], v[48:51]
  ds_read_b128 a[152:155], v17 offset:37888
  v_mfma_f32_16x16x32_bf16 v[32:35], a[140:143], v[140:143], v[32:35]
  v_exp_f32 v71, v71
  v_mfma_f32_16x16x32_bf16 v[36:39], a[140:143], v[156:159], v[36:39]
  v_cvt_pk_bf16_f32 v116, v68, v69
  v_mfma_f32_16x16x32_bf16 v[40:43], a[140:143], v[172:175], v[40:43]
  v_exp_f32 v84, v84
  v_mfma_f32_16x16x32_bf16 v[44:47], a[140:143], v[188:191], v[44:47]
  ds_read_b128 a[140:143], v17 offset:38912
  v_mfma_f32_16x16x32_bf16 v[60:63], a[156:159], v[188:191], v[60:63]
  buffer_load_dwordx4 v6, s[4:7], s42 offen offset:2048 lds
  v_exp_f32 v85, v85
  v_mfma_f32_16x16x32_bf16 v[56:59], a[156:159], v[172:175], v[56:59]
  v_cvt_pk_bf16_f32 v117, v70, v71
  v_mfma_f32_16x16x32_bf16 v[52:55], a[156:159], v[156:159], v[52:55]
  v_exp_f32 v86, v86
  v_mfma_f32_16x16x32_bf16 v[48:51], a[156:159], v[140:143], v[48:51]
  ds_read_b128 a[156:159], v17 offset:39936
  s_waitcnt lgkmcnt(15)
  v_mfma_f32_16x16x32_bf16 a[0:3], a[160:163], v[96:99], a[0:3]
  v_exp_f32 v87, v87
  v_mfma_f32_16x16x32_bf16 a[4:7], a[160:163], v[100:103], a[4:7]
  v_cvt_pk_bf16_f32 v118, v84, v85
  v_mfma_f32_16x16x32_bf16 a[8:11], a[160:163], v[104:107], a[8:11]
  buffer_load_dwordx4 v7, s[4:7], s42 offen offset:3072 lds
  v_exp_f32 v72, v72
  v_mfma_f32_16x16x32_bf16 a[12:15], a[160:163], v[108:111], a[12:15]
  ds_read_b64_tr_b16 a[160:161], v10 offset:40960
  ds_read_b64_tr_b16 a[162:163], v10 offset:45056
  v_mfma_f32_16x16x32_bf16 a[28:31], a[164:167], v[108:111], a[28:31]
  v_exp_f32 v73, v73
  v_mfma_f32_16x16x32_bf16 a[24:27], a[164:167], v[104:107], a[24:27]
  v_cvt_pk_bf16_f32 v119, v86, v87
  v_mfma_f32_16x16x32_bf16 a[20:23], a[164:167], v[100:103], a[20:23]
  v_exp_f32 v74, v74
  v_mfma_f32_16x16x32_bf16 a[16:19], a[164:167], v[96:99], a[16:19]
  ds_read_b64_tr_b16 a[164:165], v11 offset:40960
  ds_read_b64_tr_b16 a[166:167], v11 offset:45056
  v_mfma_f32_16x16x32_bf16 a[32:35], a[168:171], v[96:99], a[32:35]
  s_add_u32 m0, s63, 4096
  s_add_u32 s43, s64, 294912
  v_exp_f32 v75, v75
  v_mfma_f32_16x16x32_bf16 a[36:39], a[168:171], v[100:103], a[36:39]
  buffer_load_dwordx4 v4, s[4:7], s43 offen offset:0 lds
  v_cvt_pk_bf16_f32 v120, v72, v73
  v_mfma_f32_16x16x32_bf16 a[40:43], a[168:171], v[104:107], a[40:43]
  v_exp_f32 v88, v88
  v_mfma_f32_16x16x32_bf16 a[44:47], a[168:171], v[108:111], a[44:47]
  ds_read_b64_tr_b16 a[168:169], v10 offset:41216
  ds_read_b64_tr_b16 a[170:171], v10 offset:45312
  v_mfma_f32_16x16x32_bf16 a[60:63], a[172:175], v[108:111], a[60:63]
  v_exp_f32 v89, v89
  v_mfma_f32_16x16x32_bf16 a[56:59], a[172:175], v[104:107], a[56:59]
  v_cvt_pk_bf16_f32 v121, v74, v75
  v_mfma_f32_16x16x32_bf16 a[52:55], a[172:175], v[100:103], a[52:55]
  v_exp_f32 v90, v90
  v_mfma_f32_16x16x32_bf16 a[48:51], a[172:175], v[96:99], a[48:51]
  ds_read_b64_tr_b16 a[172:173], v11 offset:41216
  s_waitcnt lgkmcnt(15)
  v_mfma_f32_16x16x32_bf16 a[64:67], a[176:179], v[96:99], a[64:67]
  ds_read_b64_tr_b16 a[174:175], v11 offset:45312
  buffer_load_dwordx4 v5, s[4:7], s43 offen offset:1024 lds
  v_exp_f32 v91, v91
  v_mfma_f32_16x16x32_bf16 a[68:71], a[176:179], v[100:103], a[68:71]
  v_cvt_pk_bf16_f32 v122, v88, v89
  v_mfma_f32_16x16x32_bf16 a[72:75], a[176:179], v[104:107], a[72:75]
  v_exp_f32 v76, v76
  v_mfma_f32_16x16x32_bf16 a[76:79], a[176:179], v[108:111], a[76:79]
  ds_read_b64_tr_b16 a[176:177], v10 offset:41472
  ds_read_b64_tr_b16 a[178:179], v10 offset:45568
  v_mfma_f32_16x16x32_bf16 a[92:95], a[180:183], v[108:111], a[92:95]
  v_exp_f32 v77, v77
  v_mfma_f32_16x16x32_bf16 a[88:91], a[180:183], v[104:107], a[88:91]
  v_cvt_pk_bf16_f32 v123, v90, v91
  v_mfma_f32_16x16x32_bf16 a[84:87], a[180:183], v[100:103], a[84:87]
  buffer_load_dwordx4 v6, s[4:7], s43 offen offset:2048 lds
  v_mfma_f32_16x16x32_bf16 a[80:83], a[180:183], v[96:99], a[80:83]
  ds_read_b64_tr_b16 a[180:181], v11 offset:41472
  v_exp_f32 v78, v78
  v_mfma_f32_16x16x32_bf16 a[96:99], a[184:187], v[96:99], a[96:99]
  ds_read_b64_tr_b16 a[182:183], v11 offset:45568
  v_exp_f32 v79, v79
  v_mfma_f32_16x16x32_bf16 a[100:103], a[184:187], v[100:103], a[100:103]
  v_cvt_pk_bf16_f32 v124, v76, v77
  v_mfma_f32_16x16x32_bf16 a[104:107], a[184:187], v[104:107], a[104:107]
  v_exp_f32 v92, v92
  v_mfma_f32_16x16x32_bf16 a[108:111], a[184:187], v[108:111], a[108:111]
  ds_read_b64_tr_b16 a[184:185], v10 offset:41728
  ds_read_b64_tr_b16 a[186:187], v10 offset:45824
  v_mfma_f32_16x16x32_bf16 a[124:127], a[188:191], v[108:111], a[124:127]
  buffer_load_dwordx4 v7, s[4:7], s43 offen offset:3072 lds
  v_exp_f32 v93, v93
  v_mfma_f32_16x16x32_bf16 a[120:123], a[188:191], v[104:107], a[120:123]
  v_cvt_pk_bf16_f32 v125, v78, v79
  v_mfma_f32_16x16x32_bf16 a[116:119], a[188:191], v[100:103], a[116:119]
  v_exp_f32 v94, v94
  v_mfma_f32_16x16x32_bf16 a[112:115], a[188:191], v[96:99], a[112:115]
  ds_read_b64_tr_b16 a[188:189], v11 offset:41728
  v_mfma_f32_16x16x32_bf16 v[212:215], v[208:211], v[96:99], v[212:215]
  ds_read_b64_tr_b16 a[190:191], v11 offset:45824
  v_exp_f32 v95, v95
  v_mfma_f32_16x16x32_bf16 v[216:219], v[208:211], v[100:103], v[216:219]
  v_cvt_pk_bf16_f32 v126, v92, v93
  s_nop 0
  v_mfma_f32_16x16x32_bf16 v[220:223], v[208:211], v[104:107], v[220:223]
  v_cvt_pk_bf16_f32 v127, v94, v95
  v_mfma_f32_16x16x32_bf16 v[224:227], v[208:211], v[108:111], v[224:227]
  s_waitcnt lgkmcnt(15)
  v_mfma_f32_16x16x32_bf16 v[64:67], a[128:131], v[128:131], v[192:195]
  v_exp_f32 v32, v32
  v_mfma_f32_16x16x32_bf16 v[68:71], a[128:131], v[144:147], v[196:199]
  v_exp_f32 v33, v33
  v_mfma_f32_16x16x32_bf16 v[72:75], a[128:131], v[160:163], v[200:203]
  v_mfma_f32_16x16x32_bf16 v[76:79], a[128:131], v[176:179], v[204:207]
  ds_read_b128 a[128:131], v17 offset:49152
  buffer_load_dword v25, v27, s[16:19], s73 offen offset:0 sc1
  v_mfma_f32_16x16x32_bf16 v[92:95], a[144:147], v[176:179], v[204:207]
  v_exp_f32 v34, v34
  v_mfma_f32_16x16x32_bf16 v[88:91], a[144:147], v[160:163], v[200:203]
  v_exp_f32 v35, v35
  v_mfma_f32_16x16x32_bf16 v[84:87], a[144:147], v[144:147], v[196:199]
  v_cvt_pk_bf16_f32 v96, v32, v33
  v_mfma_f32_16x16x32_bf16 v[80:83], a[144:147], v[128:131], v[192:195]
  ds_read_b128 a[144:147], v17 offset:50176
  v_mfma_f32_16x16x32_bf16 v[64:67], a[132:135], v[132:135], v[64:67]
  v_exp_f32 v48, v48
  v_mfma_f32_16x16x32_bf16 v[68:71], a[132:135], v[148:151], v[68:71]
  v_exp_f32 v49, v49
  v_mfma_f32_16x16x32_bf16 v[72:75], a[132:135], v[164:167], v[72:75]
  v_cvt_pk_bf16_f32 v97, v34, v35
  v_mfma_f32_16x16x32_bf16 v[76:79], a[132:135], v[180:183], v[76:79]
  ds_read_b128 a[132:135], v17 offset:51200
  v_mfma_f32_16x16x32_bf16 v[92:95], a[148:151], v[180:183], v[92:95]
  buffer_load_dword a252, v24, s[8:11], s61 offen offset:0
  v_mfma_f32_16x16x32_bf16 v[88:91], a[148:151], v[164:167], v[88:91]
  v_exp_f32 v50, v50
  v_mfma_f32_16x16x32_bf16 v[84:87], a[148:151], v[148:151], v[84:87]
  v_exp_f32 v51, v51
  v_mfma_f32_16x16x32_bf16 v[80:83], a[148:151], v[132:135], v[80:83]
  ds_read_b128 a[148:151], v17 offset:52224
  s_waitcnt lgkmcnt(15)
  v_mfma_f32_16x16x32_bf16 v[64:67], a[136:139], v[136:139], v[64:67]
  v_cvt_pk_bf16_f32 v98, v48, v49
  v_mfma_f32_16x16x32_bf16 v[68:71], a[136:139], v[152:155], v[68:71]
  v_exp_f32 v36, v36
  v_mfma_f32_16x16x32_bf16 v[72:75], a[136:139], v[168:171], v[72:75]
  v_exp_f32 v37, v37
  v_mfma_f32_16x16x32_bf16 v[76:79], a[136:139], v[184:187], v[76:79]
  ds_read_b128 a[136:139], v17 offset:53248
  v_cvt_pk_bf16_f32 v99, v50, v51
  v_mfma_f32_16x16x32_bf16 v[92:95], a[152:155], v[184:187], v[92:95]
  v_exp_f32 v38, v38
  v_mfma_f32_16x16x32_bf16 v[88:91], a[152:155], v[168:171], v[88:91]
  buffer_load_dword a253, v24, s[8:11], s61 offen offset:1024
  v_mfma_f32_16x16x32_bf16 v[84:87], a[152:155], v[152:155], v[84:87]
  v_exp_f32 v39, v39
  v_mfma_f32_16x16x32_bf16 v[80:83], a[152:155], v[136:139], v[80:83]
  ds_read_b128 a[152:155], v17 offset:54272
  v_cvt_pk_bf16_f32 v100, v36, v37
  v_mfma_f32_16x16x32_bf16 v[64:67], a[140:143], v[140:143], v[64:67]
  v_exp_f32 v52, v52
  v_mfma_f32_16x16x32_bf16 v[68:71], a[140:143], v[156:159], v[68:71]
  v_exp_f32 v53, v53
  v_mfma_f32_16x16x32_bf16 v[72:75], a[140:143], v[172:175], v[72:75]
  v_cvt_pk_bf16_f32 v101, v38, v39
  v_mfma_f32_16x16x32_bf16 v[76:79], a[140:143], v[188:191], v[76:79]
  ds_read_b128 a[140:143], v17 offset:55296
  v_mfma_f32_16x16x32_bf16 v[92:95], a[156:159], v[188:191], v[92:95]
  v_exp_f32 v54, v54
  v_mfma_f32_16x16x32_bf16 v[88:91], a[156:159], v[172:175], v[88:91]
  v_exp_f32 v55, v55
  v_mfma_f32_16x16x32_bf16 v[84:87], a[156:159], v[156:159], v[84:87]
  buffer_load_dword a254, v24, s[8:11], s61 offen offset:2048
  v_cvt_pk_bf16_f32 v102, v52, v53
  v_mfma_f32_16x16x32_bf16 v[80:83], a[156:159], v[140:143], v[80:83]
  ds_read_b128 a[156:159], v17 offset:56320
  s_waitcnt lgkmcnt(15)
  v_mfma_f32_16x16x32_bf16 a[0:3], a[160:163], v[112:115], a[0:3]
  v_exp_f32 v40, v40
  v_mfma_f32_16x16x32_bf16 a[4:7], a[160:163], v[116:119], a[4:7]
  v_exp_f32 v41, v41
  v_mfma_f32_16x16x32_bf16 a[8:11], a[160:163], v[120:123], a[8:11]
  v_mfma_f32_16x16x32_bf16 a[12:15], a[160:163], v[124:127], a[12:15]
  ds_read_b64_tr_b16 a[160:161], v10 offset:57344
  v_cvt_pk_bf16_f32 v103, v54, v55
  v_mfma_f32_16x16x32_bf16 a[28:31], a[164:167], v[124:127], a[28:31]
  ds_read_b64_tr_b16 a[162:163], v10 offset:61440
  v_mfma_f32_16x16x32_bf16 a[24:27], a[164:167], v[120:123], a[24:27]
  v_exp_f32 v42, v42
  v_mfma_f32_16x16x32_bf16 a[20:23], a[164:167], v[116:119], a[20:23]
  v_exp_f32 v43, v43
  v_mfma_f32_16x16x32_bf16 a[16:19], a[164:167], v[112:115], a[16:19]
  ds_read_b64_tr_b16 a[164:165], v11 offset:57344
  buffer_load_dword a255, v24, s[8:11], s61 offen offset:3072
  v_mfma_f32_16x16x32_bf16 a[32:35], a[168:171], v[112:115], a[32:35]
  ds_read_b64_tr_b16 a[166:167], v11 offset:61440
  v_cvt_pk_bf16_f32 v104, v40, v41
  v_mfma_f32_16x16x32_bf16 a[36:39], a[168:171], v[116:119], a[36:39]
  v_exp_f32 v56, v56
  v_mfma_f32_16x16x32_bf16 a[40:43], a[168:171], v[120:123], a[40:43]
  v_exp_f32 v57, v57
  v_mfma_f32_16x16x32_bf16 a[44:47], a[168:171], v[124:127], a[44:47]
  ds_read_b64_tr_b16 a[168:169], v10 offset:57600
  v_cvt_pk_bf16_f32 v105, v42, v43
  v_mfma_f32_16x16x32_bf16 a[60:63], a[172:175], v[124:127], a[60:63]
  ds_read_b64_tr_b16 a[170:171], v10 offset:61696
  v_mfma_f32_16x16x32_bf16 a[56:59], a[172:175], v[120:123], a[56:59]
  v_exp_f32 v58, v58
  v_mfma_f32_16x16x32_bf16 a[52:55], a[172:175], v[116:119], a[52:55]
  v_exp_f32 v59, v59
  v_mfma_f32_16x16x32_bf16 a[48:51], a[172:175], v[112:115], a[48:51]
  ds_read_b64_tr_b16 a[172:173], v11 offset:57600
  s_waitcnt lgkmcnt(15)
  v_mfma_f32_16x16x32_bf16 a[64:67], a[176:179], v[112:115], a[64:67]
  ds_read_b64_tr_b16 a[174:175], v11 offset:61696
  s_waitcnt vmcnt(42)
  v_readfirstlane_b32 s85, v19
  s_and_b32 s85, s85, 255
  s_cmp_eq_u32 s85, 255
  s_cselect_b32 s85, 0, 1
  s_add_u32 s85, s85, s36
  s_cmp_eq_u32 s85, 0
  s_mov_b32 s85, 0x40000000
  s_cselect_b32 s85, 58720256, s85
  v_mov_b32 v19, s79
  buffer_store_dword v19, v23, s[16:19], s85 offen sc1
  v_mfma_f32_16x16x32_bf16 a[68:71], a[176:179], v[116:119], a[68:71]
  v_cvt_pk_bf16_f32 v106, v56, v57
  v_mfma_f32_16x16x32_bf16 a[72:75], a[176:179], v[120:123], a[72:75]
  v_exp_f32 v44, v44
  v_mfma_f32_16x16x32_bf16 a[76:79], a[176:179], v[124:127], a[76:79]
  ds_read_b64_tr_b16 a[176:177], v10 offset:57856
  ds_read_b64_tr_b16 a[178:179], v10 offset:61952
  v_mfma_f32_16x16x32_bf16 a[92:95], a[180:183], v[124:127], a[92:95]
  v_exp_f32 v45, v45
  v_mfma_f32_16x16x32_bf16 a[88:91], a[180:183], v[120:123], a[88:91]
  v_cvt_pk_bf16_f32 v107, v58, v59
  v_mfma_f32_16x16x32_bf16 a[84:87], a[180:183], v[116:119], a[84:87]
  v_exp_f32 v46, v46
  v_mfma_f32_16x16x32_bf16 a[80:83], a[180:183], v[112:115], a[80:83]
  ds_read_b64_tr_b16 a[180:181], v11 offset:57856
  ds_read_b64_tr_b16 a[182:183], v11 offset:61952
  v_mfma_f32_16x16x32_bf16 a[96:99], a[184:187], v[112:115], a[96:99]
  v_exp_f32 v47, v47
  v_mfma_f32_16x16x32_bf16 a[100:103], a[184:187], v[116:119], a[100:103]
  buffer_load_dword v251, v24, s[32:35], s3 offen
  v_cvt_pk_bf16_f32 v108, v44, v45
  v_mfma_f32_16x16x32_bf16 a[104:107], a[184:187], v[120:123], a[104:107]
  v_exp_f32 v60, v60
  v_mfma_f32_16x16x32_bf16 a[108:111], a[184:187], v[124:127], a[108:111]
  ds_read_b64_tr_b16 a[184:185], v10 offset:58112
  ds_read_b64_tr_b16 a[186:187], v10 offset:62208
  v_mfma_f32_16x16x32_bf16 a[124:127], a[188:191], v[124:127], a[124:127]
  v_exp_f32 v61, v61
  v_mfma_f32_16x16x32_bf16 a[120:123], a[188:191], v[120:123], a[120:123]
  v_cvt_pk_bf16_f32 v109, v46, v47
  v_mfma_f32_16x16x32_bf16 a[116:119], a[188:191], v[116:119], a[116:119]
  v_exp_f32 v62, v62
  v_mfma_f32_16x16x32_bf16 a[112:115], a[188:191], v[112:115], a[112:115]
  ds_read_b64_tr_b16 a[188:189], v11 offset:58112
  v_mfma_f32_16x16x32_bf16 v[212:215], v[208:211], v[112:115], v[212:215]
  ds_read_b64_tr_b16 a[190:191], v11 offset:62208
  v_exp_f32 v63, v63
  v_mfma_f32_16x16x32_bf16 v[216:219], v[208:211], v[116:119], v[216:219]
  v_cvt_pk_bf16_f32 v110, v60, v61
  s_nop 0
  v_mfma_f32_16x16x32_bf16 v[220:223], v[208:211], v[120:123], v[220:223]
  v_cvt_pk_bf16_f32 v111, v62, v63
  v_mfma_f32_16x16x32_bf16 v[224:227], v[208:211], v[124:127], v[224:227]
  s_waitcnt lgkmcnt(15)
  v_mfma_f32_16x16x32_bf16 v[32:35], a[128:131], v[128:131], v[192:195]
  v_exp_f32 v64, v64
  v_mfma_f32_16x16x32_bf16 v[36:39], a[128:131], v[144:147], v[196:199]
  v_exp_f32 v65, v65
  v_mfma_f32_16x16x32_bf16 v[40:43], a[128:131], v[160:163], v[200:203]
  v_mfma_f32_16x16x32_bf16 v[44:47], a[128:131], v[176:179], v[204:207]
  v_exp_f32 v66, v66
  v_mfma_f32_16x16x32_bf16 v[60:63], a[144:147], v[176:179], v[204:207]
  v_exp_f32 v67, v67
  v_mfma_f32_16x16x32_bf16 v[56:59], a[144:147], v[160:163], v[200:203]
  v_mfma_f32_16x16x32_bf16 v[52:55], a[144:147], v[144:147], v[196:199]
  v_cvt_pk_bf16_f32 v112, v64, v65
  v_mfma_f32_16x16x32_bf16 v[48:51], a[144:147], v[128:131], v[192:195]
  v_exp_f32 v80, v80
  v_mfma_f32_16x16x32_bf16 v[32:35], a[132:135], v[132:135], v[32:35]
  v_exp_f32 v81, v81
  v_mfma_f32_16x16x32_bf16 v[36:39], a[132:135], v[148:151], v[36:39]
  v_mfma_f32_16x16x32_bf16 v[40:43], a[132:135], v[164:167], v[40:43]
  v_cvt_pk_bf16_f32 v113, v66, v67
  v_mfma_f32_16x16x32_bf16 v[44:47], a[132:135], v[180:183], v[44:47]
  s_waitcnt vmcnt(45) lgkmcnt(0)
  s_barrier
  v_mfma_f32_16x16x32_bf16 v[60:63], a[148:151], v[180:183], v[60:63]
  ds_read_b128 a[128:131], v18 offset:0
  ds_read_b128 a[144:147], v18 offset:1024
  v_mfma_f32_16x16x32_bf16 v[56:59], a[148:151], v[164:167], v[56:59]
  ds_read_b128 a[132:135], v18 offset:2048
  v_mfma_f32_16x16x32_bf16 v[52:55], a[148:151], v[148:151], v[52:55]
  v_exp_f32 v82, v82
  v_mfma_f32_16x16x32_bf16 v[48:51], a[148:151], v[132:135], v[48:51]
  ds_read_b128 a[148:151], v18 offset:3072
  s_waitcnt lgkmcnt(15)
  v_mfma_f32_16x16x32_bf16 v[32:35], a[136:139], v[136:139], v[32:35]
  s_add_u32 m0, s63, 98304
  s_add_u32 s42, s64, 524288
  v_exp_f32 v83, v83
  v_mfma_f32_16x16x32_bf16 v[36:39], a[136:139], v[152:155], v[36:39]
  buffer_load_dwordx4 v4, s[4:7], s42 offen offset:0 lds
  v_cvt_pk_bf16_f32 v114, v80, v81
  v_mfma_f32_16x16x32_bf16 v[40:43], a[136:139], v[168:171], v[40:43]
  v_exp_f32 v68, v68
  v_mfma_f32_16x16x32_bf16 v[44:47], a[136:139], v[184:187], v[44:47]
  ds_read_b128 a[136:139], v18 offset:4096
  v_mfma_f32_16x16x32_bf16 v[60:63], a[152:155], v[184:187], v[60:63]
  v_exp_f32 v69, v69
  v_mfma_f32_16x16x32_bf16 v[56:59], a[152:155], v[168:171], v[56:59]
  buffer_load_dwordx4 v5, s[4:7], s42 offen offset:1024 lds
  v_cvt_pk_bf16_f32 v115, v82, v83
  v_mfma_f32_16x16x32_bf16 v[52:55], a[152:155], v[152:155], v[52:55]
  v_exp_f32 v70, v70
  v_mfma_f32_16x16x32_bf16 v[48:51], a[152:155], v[136:139], v[48:51]
  ds_read_b128 a[152:155], v18 offset:5120
  v_mfma_f32_16x16x32_bf16 v[32:35], a[140:143], v[140:143], v[32:35]
  v_exp_f32 v71, v71
  v_mfma_f32_16x16x32_bf16 v[36:39], a[140:143], v[156:159], v[36:39]
  v_cvt_pk_bf16_f32 v116, v68, v69
  v_mfma_f32_16x16x32_bf16 v[40:43], a[140:143], v[172:175], v[40:43]
  v_exp_f32 v84, v84
  v_mfma_f32_16x16x32_bf16 v[44:47], a[140:143], v[188:191], v[44:47]
  ds_read_b128 a[140:143], v18 offset:6144
  v_mfma_f32_16x16x32_bf16 v[60:63], a[156:159], v[188:191], v[60:63]
  buffer_load_dwordx4 v6, s[4:7], s42 offen offset:2048 lds
  v_exp_f32 v85, v85
  v_mfma_f32_16x16x32_bf16 v[56:59], a[156:159], v[172:175], v[56:59]
  v_cvt_pk_bf16_f32 v117, v70, v71
  v_mfma_f32_16x16x32_bf16 v[52:55], a[156:159], v[156:159], v[52:55]
  v_exp_f32 v86, v86
  v_mfma_f32_16x16x32_bf16 v[48:51], a[156:159], v[140:143], v[48:51]
  ds_read_b128 a[156:159], v18 offset:7168
  s_waitcnt lgkmcnt(15)
  v_mfma_f32_16x16x32_bf16 a[0:3], a[160:163], v[96:99], a[0:3]
  v_exp_f32 v87, v87
  v_mfma_f32_16x16x32_bf16 a[4:7], a[160:163], v[100:103], a[4:7]
  v_cvt_pk_bf16_f32 v118, v84, v85
  v_mfma_f32_16x16x32_bf16 a[8:11], a[160:163], v[104:107], a[8:11]
  buffer_load_dwordx4 v7, s[4:7], s42 offen offset:3072 lds
  v_exp_f32 v72, v72
  v_mfma_f32_16x16x32_bf16 a[12:15], a[160:163], v[108:111], a[12:15]
  ds_read_b64_tr_b16 a[160:161], v12 offset:8192
  ds_read_b64_tr_b16 a[162:163], v12 offset:12288
  v_mfma_f32_16x16x32_bf16 a[28:31], a[164:167], v[108:111], a[28:31]
  v_exp_f32 v73, v73
  v_mfma_f32_16x16x32_bf16 a[24:27], a[164:167], v[104:107], a[24:27]
  v_cvt_pk_bf16_f32 v119, v86, v87
  v_mfma_f32_16x16x32_bf16 a[20:23], a[164:167], v[100:103], a[20:23]
  v_exp_f32 v74, v74
  v_mfma_f32_16x16x32_bf16 a[16:19], a[164:167], v[96:99], a[16:19]
  ds_read_b64_tr_b16 a[164:165], v13 offset:8192
  ds_read_b64_tr_b16 a[166:167], v13 offset:12288
  v_mfma_f32_16x16x32_bf16 a[32:35], a[168:171], v[96:99], a[32:35]
  s_add_u32 m0, s63, 102400
  s_add_u32 s43, s64, 557056
  v_exp_f32 v75, v75
  v_mfma_f32_16x16x32_bf16 a[36:39], a[168:171], v[100:103], a[36:39]
  buffer_load_dwordx4 v4, s[4:7], s43 offen offset:0 lds
  v_cvt_pk_bf16_f32 v120, v72, v73
  v_mfma_f32_16x16x32_bf16 a[40:43], a[168:171], v[104:107], a[40:43]
  v_exp_f32 v88, v88
  v_mfma_f32_16x16x32_bf16 a[44:47], a[168:171], v[108:111], a[44:47]
  ds_read_b64_tr_b16 a[168:169], v12 offset:8448
  ds_read_b64_tr_b16 a[170:171], v12 offset:12544
  v_mfma_f32_16x16x32_bf16 a[60:63], a[172:175], v[108:111], a[60:63]
  v_exp_f32 v89, v89
  v_mfma_f32_16x16x32_bf16 a[56:59], a[172:175], v[104:107], a[56:59]
  v_cvt_pk_bf16_f32 v121, v74, v75
  v_mfma_f32_16x16x32_bf16 a[52:55], a[172:175], v[100:103], a[52:55]
  v_exp_f32 v90, v90
  v_mfma_f32_16x16x32_bf16 a[48:51], a[172:175], v[96:99], a[48:51]
  ds_read_b64_tr_b16 a[172:173], v13 offset:8448
  s_waitcnt lgkmcnt(15)
  v_mfma_f32_16x16x32_bf16 a[64:67], a[176:179], v[96:99], a[64:67]
  ds_read_b64_tr_b16 a[174:175], v13 offset:12544
  buffer_load_dwordx4 v5, s[4:7], s43 offen offset:1024 lds
  v_exp_f32 v91, v91
  v_mfma_f32_16x16x32_bf16 a[68:71], a[176:179], v[100:103], a[68:71]
  v_cvt_pk_bf16_f32 v122, v88, v89
  v_mfma_f32_16x16x32_bf16 a[72:75], a[176:179], v[104:107], a[72:75]
  v_exp_f32 v76, v76
  v_mfma_f32_16x16x32_bf16 a[76:79], a[176:179], v[108:111], a[76:79]
  ds_read_b64_tr_b16 a[176:177], v12 offset:8704
  ds_read_b64_tr_b16 a[178:179], v12 offset:12800
  v_mfma_f32_16x16x32_bf16 a[92:95], a[180:183], v[108:111], a[92:95]
  v_exp_f32 v77, v77
  v_mfma_f32_16x16x32_bf16 a[88:91], a[180:183], v[104:107], a[88:91]
  v_cvt_pk_bf16_f32 v123, v90, v91
  v_mfma_f32_16x16x32_bf16 a[84:87], a[180:183], v[100:103], a[84:87]
  buffer_load_dwordx4 v6, s[4:7], s43 offen offset:2048 lds
  v_mfma_f32_16x16x32_bf16 a[80:83], a[180:183], v[96:99], a[80:83]
  ds_read_b64_tr_b16 a[180:181], v13 offset:8704
  v_exp_f32 v78, v78
  v_mfma_f32_16x16x32_bf16 a[96:99], a[184:187], v[96:99], a[96:99]
  ds_read_b64_tr_b16 a[182:183], v13 offset:12800
  v_exp_f32 v79, v79
  v_mfma_f32_16x16x32_bf16 a[100:103], a[184:187], v[100:103], a[100:103]
  v_cvt_pk_bf16_f32 v124, v76, v77
  v_mfma_f32_16x16x32_bf16 a[104:107], a[184:187], v[104:107], a[104:107]
  v_exp_f32 v92, v92
  v_mfma_f32_16x16x32_bf16 a[108:111], a[184:187], v[108:111], a[108:111]
  ds_read_b64_tr_b16 a[184:185], v12 offset:8960
  ds_read_b64_tr_b16 a[186:187], v12 offset:13056
  v_mfma_f32_16x16x32_bf16 a[124:127], a[188:191], v[108:111], a[124:127]
  buffer_load_dwordx4 v7, s[4:7], s43 offen offset:3072 lds
  v_exp_f32 v93, v93
  v_mfma_f32_16x16x32_bf16 a[120:123], a[188:191], v[104:107], a[120:123]
  v_cvt_pk_bf16_f32 v125, v78, v79
  v_mfma_f32_16x16x32_bf16 a[116:119], a[188:191], v[100:103], a[116:119]
  v_exp_f32 v94, v94
  v_mfma_f32_16x16x32_bf16 a[112:115], a[188:191], v[96:99], a[112:115]
  ds_read_b64_tr_b16 a[188:189], v13 offset:8960
  v_mfma_f32_16x16x32_bf16 v[212:215], v[208:211], v[96:99], v[212:215]
  ds_read_b64_tr_b16 a[190:191], v13 offset:13056
  v_exp_f32 v95, v95
  v_mfma_f32_16x16x32_bf16 v[216:219], v[208:211], v[100:103], v[216:219]
  v_cvt_pk_bf16_f32 v126, v92, v93
  s_nop 0
  v_mfma_f32_16x16x32_bf16 v[220:223], v[208:211], v[104:107], v[220:223]
  v_cvt_pk_bf16_f32 v127, v94, v95
  v_mfma_f32_16x16x32_bf16 v[224:227], v[208:211], v[108:111], v[224:227]
  s_waitcnt vmcnt(14)
  v_cmp_eq_u32 vcc, v26, v25
  s_and_b32 s84, vcc_lo, 0xff
  s_cmp_eq_u32 s84, 0xff
  s_cbranch_scc0 L_main_spin_2
L_main_spin_2_ok:
  s_waitcnt lgkmcnt(15)
  v_mfma_f32_16x16x32_bf16 v[64:67], a[128:131], v[128:131], v[192:195]
  v_exp_f32 v32, v32
  v_mfma_f32_16x16x32_bf16 v[68:71], a[128:131], v[144:147], v[196:199]
  v_exp_f32 v33, v33
  v_mfma_f32_16x16x32_bf16 v[72:75], a[128:131], v[160:163], v[200:203]
  v_mfma_f32_16x16x32_bf16 v[76:79], a[128:131], v[176:179], v[204:207]
  ds_read_b128 a[128:131], v18 offset:16384
  v_mfma_f32_16x16x32_bf16 v[92:95], a[144:147], v[176:179], v[204:207]
  s_add_u32 s68, s66, 0
  v_mfma_f32_16x16x32_bf16 v[88:91], a[144:147], v[160:163], v[200:203]
  buffer_load_dwordx4 a[192:195], v20, s[16:19], s68 offen offset:0 sc1
  v_mfma_f32_16x16x32_bf16 v[84:87], a[144:147], v[144:147], v[196:199]
  v_exp_f32 v34, v34
  v_mfma_f32_16x16x32_bf16 v[80:83], a[144:147], v[128:131], v[192:195]
  ds_read_b128 a[144:147], v18 offset:17408
  v_exp_f32 v35, v35
  v_mfma_f32_16x16x32_bf16 v[64:67], a[132:135], v[132:135], v[64:67]
  v_cvt_pk_bf16_f32 v96, v32, v33
  v_mfma_f32_16x16x32_bf16 v[68:71], a[132:135], v[148:151], v[68:71]
  s_add_u32 s69, s66, 114944
  v_mfma_f32_16x16x32_bf16 v[72:75], a[132:135], v[164:167], v[72:75]
  buffer_load_dwordx4 a[196:199], v20, s[16:19], s69 offen offset:0 sc1
  v_exp_f32 v48, v48
  v_mfma_f32_16x16x32_bf16 v[76:79], a[132:135], v[180:183], v[76:79]
  ds_read_b128 a[132:135], v18 offset:18432
  v_exp_f32 v49, v49
  v_mfma_f32_16x16x32_bf16 v[92:95], a[148:151], v[180:183], v[92:95]
  v_cvt_pk_bf16_f32 v97, v34, v35
  v_mfma_f32_16x16x32_bf16 v[88:91], a[148:151], v[164:167], v[88:91]
  v_exp_f32 v50, v50
  v_mfma_f32_16x16x32_bf16 v[84:87], a[148:151], v[148:151], v[84:87]
  v_exp_f32 v51, v51
  v_mfma_f32_16x16x32_bf16 v[80:83], a[148:151], v[132:135], v[80:83]
  ds_read_b128 a[148:151], v18 offset:19456
  s_waitcnt lgkmcnt(15)
  v_mfma_f32_16x16x32_bf16 v[64:67], a[136:139], v[136:139], v[64:67]
  v_cvt_pk_bf16_f32 v98, v48, v49
  v_mfma_f32_16x16x32_bf16 v[68:71], a[136:139], v[152:155], v[68:71]
  s_add_u32 s70, s66, 229888
  v_mfma_f32_16x16x32_bf16 v[72:75], a[136:139], v[168:171], v[72:75]
  buffer_load_dwordx4 a[200:203], v20, s[16:19], s70 offen offset:0 sc1
  v_exp_f32 v36, v36
  v_mfma_f32_16x16x32_bf16 v[76:79], a[136:139], v[184:187], v[76:79]
  ds_read_b128 a[136:139], v18 offset:20480
  v_mfma_f32_16x16x32_bf16 v[92:95], a[152:155], v[184:187], v[92:95]
  v_exp_f32 v37, v37
  v_mfma_f32_16x16x32_bf16 v[88:91], a[152:155], v[168:171], v[88:91]
  v_cvt_pk_bf16_f32 v99, v50, v51
  v_mfma_f32_16x16x32_bf16 v[84:87], a[152:155], v[152:155], v[84:87]
  v_exp_f32 v38, v38
  v_mfma_f32_16x16x32_bf16 v[80:83], a[152:155], v[136:139], v[80:83]
  ds_read_b128 a[152:155], v18 offset:21504
  v_mfma_f32_16x16x32_bf16 v[64:67], a[140:143], v[140:143], v[64:67]
  v_exp_f32 v39, v39
  v_mfma_f32_16x16x32_bf16 v[68:71], a[140:143], v[156:159], v[68:71]
  s_add_u32 s71, s66, 344832
  v_cvt_pk_bf16_f32 v100, v36, v37
  v_mfma_f32_16x16x32_bf16 v[72:75], a[140:143], v[172:175], v[72:75]
  buffer_load_dwordx4 a[204:207], v20, s[16:19], s71 offen offset:0 sc1
  v_exp_f32 v52, v52
  v_mfma_f32_16x16x32_bf16 v[76:79], a[140:143], v[188:191], v[76:79]
  ds_read_b128 a[140:143], v18 offset:22528
  v_mfma_f32_16x16x32_bf16 v[92:95], a[156:159], v[188:191], v[92:95]
  v_exp_f32 v53, v53
  v_mfma_f32_16x16x32_bf16 v[88:91], a[156:159], v[172:175], v[88:91]
  v_cvt_pk_bf16_f32 v101, v38, v39
  v_mfma_f32_16x16x32_bf16 v[84:87], a[156:159], v[156:159], v[84:87]
  v_exp_f32 v54, v54
  v_mfma_f32_16x16x32_bf16 v[80:83], a[156:159], v[140:143], v[80:83]
  ds_read_b128 a[156:159], v18 offset:23552
  s_waitcnt lgkmcnt(15)
  v_mfma_f32_16x16x32_bf16 a[0:3], a[160:163], v[112:115], a[0:3]
  v_exp_f32 v55, v55
  v_mfma_f32_16x16x32_bf16 a[4:7], a[160:163], v[116:119], a[4:7]
  v_cvt_pk_bf16_f32 v102, v52, v53
  v_mfma_f32_16x16x32_bf16 a[8:11], a[160:163], v[120:123], a[8:11]
  buffer_load_dwordx4 a[208:211], v20, s[16:19], s68 offen offset:1024 sc1
  v_exp_f32 v40, v40
  v_mfma_f32_16x16x32_bf16 a[12:15], a[160:163], v[124:127], a[12:15]
  ds_read_b64_tr_b16 a[160:161], v12 offset:24576
  ds_read_b64_tr_b16 a[162:163], v12 offset:28672
  v_mfma_f32_16x16x32_bf16 a[28:31], a[164:167], v[124:127], a[28:31]
  v_exp_f32 v41, v41
  v_mfma_f32_16x16x32_bf16 a[24:27], a[164:167], v[120:123], a[24:27]
  v_cvt_pk_bf16_f32 v103, v54, v55
  v_mfma_f32_16x16x32_bf16 a[20:23], a[164:167], v[116:119], a[20:23]
  v_exp_f32 v42, v42
  v_mfma_f32_16x16x32_bf16 a[16:19], a[164:167], v[112:115], a[16:19]
  ds_read_b64_tr_b16 a[164:165], v13 offset:24576
  ds_read_b64_tr_b16 a[166:167], v13 offset:28672
  v_mfma_f32_16x16x32_bf16 a[32:35], a[168:171], v[112:115], a[32:35]
  v_exp_f32 v43, v43
  v_mfma_f32_16x16x32_bf16 a[36:39], a[168:171], v[116:119], a[36:39]
  v_cvt_pk_bf16_f32 v104, v40, v41
  v_mfma_f32_16x16x32_bf16 a[40:43], a[168:171], v[120:123], a[40:43]
  buffer_load_dwordx4 a[212:215], v20, s[16:19], s69 offen offset:1024 sc1
  v_exp_f32 v56, v56
  v_mfma_f32_16x16x32_bf16 a[44:47], a[168:171], v[124:127], a[44:47]
  ds_read_b64_tr_b16 a[168:169], v12 offset:24832
  ds_read_b64_tr_b16 a[170:171], v12 offset:28928
  v_mfma_f32_16x16x32_bf16 a[60:63], a[172:175], v[124:127], a[60:63]
  v_exp_f32 v57, v57
  v_mfma_f32_16x16x32_bf16 a[56:59], a[172:175], v[120:123], a[56:59]
  v_cvt_pk_bf16_f32 v105, v42, v43
  v_mfma_f32_16x16x32_bf16 a[52:55], a[172:175], v[116:119], a[52:55]
  v_exp_f32 v58, v58
  v_mfma_f32_16x16x32_bf16 a[48:51], a[172:175], v[112:115], a[48:51]
  ds_read_b64_tr_b16 a[172:173], v13 offset:24832
  s_waitcnt lgkmcnt(15)
  v_mfma_f32_16x16x32_bf16 a[64:67], a[176:179], v[112:115], a[64:67]
  ds_read_b64_tr_b16 a[174:175], v13 offset:28928
  v_exp_f32 v59, v59
  v_mfma_f32_16x16x32_bf16 a[68:71], a[176:179], v[116:119], a[68:71]
  v_cvt_pk_bf16_f32 v106, v56, v57
  v_mfma_f32_16x16x32_bf16 a[72:75], a[176:179], v[120:123], a[72:75]
  buffer_load_dwordx4 a[216:219], v20, s[16:19], s70 offen offset:1024 sc1
  v_mfma_f32_16x16x32_bf16 a[76:79], a[176:179], v[124:127], a[76:79]
  ds_read_b64_tr_b16 a[176:177], v12 offset:25088
  v_exp_f32 v44, v44
  v_mfma_f32_16x16x32_bf16 a[92:95], a[180:183], v[124:127], a[92:95]
  ds_read_b64_tr_b16 a[178:179], v12 offset:29184
  v_exp_f32 v45, v45
  v_mfma_f32_16x16x32_bf16 a[88:91], a[180:183], v[120:123], a[88:91]
  v_cvt_pk_bf16_f32 v107, v58, v59
  v_mfma_f32_16x16x32_bf16 a[84:87], a[180:183], v[116:119], a[84:87]
  v_exp_f32 v46, v46
  v_mfma_f32_16x16x32_bf16 a[80:83], a[180:183], v[112:115], a[80:83]
  ds_read_b64_tr_b16 a[180:181], v13 offset:25088
  ds_read_b64_tr_b16 a[182:183], v13 offset:29184
  v_mfma_f32_16x16x32_bf16 a[96:99], a[184:187], v[112:115], a[96:99]
  v_exp_f32 v47, v47
  v_mfma_f32_16x16x32_bf16 a[100:103], a[184:187], v[116:119], a[100:103]
  v_cvt_pk_bf16_f32 v108, v44, v45
  v_mfma_f32_16x16x32_bf16 a[104:107], a[184:187], v[120:123], a[104:107]
  buffer_load_dwordx4 a[220:223], v20, s[16:19], s71 offen offset:1024 sc1
  v_mfma_f32_16x16x32_bf16 a[108:111], a[184:187], v[124:127], a[108:111]
  ds_read_b64_tr_b16 a[184:185], v12 offset:25344
  v_exp_f32 v60, v60
  v_mfma_f32_16x16x32_bf16 a[124:127], a[188:191], v[124:127], a[124:127]
  ds_read_b64_tr_b16 a[186:187], v12 offset:29440
  v_exp_f32 v61, v61
  v_mfma_f32_16x16x32_bf16 a[120:123], a[188:191], v[120:123], a[120:123]
  v_cvt_pk_bf16_f32 v109, v46, v47
  v_mfma_f32_16x16x32_bf16 a[116:119], a[188:191], v[116:119], a[116:119]
  v_exp_f32 v62, v62
  v_mfma_f32_16x16x32_bf16 a[112:115], a[188:191], v[112:115], a[112:115]
  ds_read_b64_tr_b16 a[188:189], v13 offset:25344
  v_mfma_f32_16x16x32_bf16 v[212:215], v[208:211], v[112:115], v[212:215]
  ds_read_b64_tr_b16 a[190:191], v13 offset:29440
  v_exp_f32 v63, v63
  v_mfma_f32_16x16x32_bf16 v[216:219], v[208:211], v[116:119], v[216:219]
  v_cvt_pk_bf16_f32 v110, v60, v61
  s_nop 0
  v_mfma_f32_16x16x32_bf16 v[220:223], v[208:211], v[120:123], v[220:223]
  v_cvt_pk_bf16_f32 v111, v62, v63
  v_mfma_f32_16x16x32_bf16 v[224:227], v[208:211], v[124:127], v[224:227]
  s_waitcnt lgkmcnt(15)
  v_mfma_f32_16x16x32_bf16 v[32:35], a[128:131], v[128:131], v[192:195]
  v_exp_f32 v64, v64
  v_mfma_f32_16x16x32_bf16 v[36:39], a[128:131], v[144:147], v[196:199]
  v_exp_f32 v65, v65
  v_mfma_f32_16x16x32_bf16 v[40:43], a[128:131], v[160:163], v[200:203]
  v_mfma_f32_16x16x32_bf16 v[44:47], a[128:131], v[176:179], v[204:207]
  v_exp_f32 v66, v66
  v_mfma_f32_16x16x32_bf16 v[60:63], a[144:147], v[176:179], v[204:207]
  v_exp_f32 v67, v67
  v_mfma_f32_16x16x32_bf16 v[56:59], a[144:147], v[160:163], v[200:203]
  v_mfma_f32_16x16x32_bf16 v[52:55], a[144:147], v[144:147], v[196:199]
  v_cvt_pk_bf16_f32 v112, v64, v65
  v_mfma_f32_16x16x32_bf16 v[48:51], a[144:147], v[128:131], v[192:195]
  v_exp_f32 v80, v80
  v_mfma_f32_16x16x32_bf16 v[32:35], a[132:135], v[132:135], v[32:35]
  v_exp_f32 v81, v81
  v_mfma_f32_16x16x32_bf16 v[36:39], a[132:135], v[148:151], v[36:39]
  v_mfma_f32_16x16x32_bf16 v[40:43], a[132:135], v[164:167], v[40:43]
  v_cvt_pk_bf16_f32 v113, v66, v67
  v_mfma_f32_16x16x32_bf16 v[44:47], a[132:135], v[180:183], v[44:47]
  s_waitcnt vmcnt(23) lgkmcnt(0)
  s_barrier
  v_mfma_f32_16x16x32_bf16 v[60:63], a[148:151], v[180:183], v[60:63]
  ds_read_b128 a[128:131], v16 offset:32768
  ds_read_b128 a[144:147], v16 offset:33792
  v_mfma_f32_16x16x32_bf16 v[56:59], a[148:151], v[164:167], v[56:59]
  ds_read_b128 a[132:135], v16 offset:34816
  v_mfma_f32_16x16x32_bf16 v[52:55], a[148:151], v[148:151], v[52:55]
  v_exp_f32 v82, v82
  v_mfma_f32_16x16x32_bf16 v[48:51], a[148:151], v[132:135], v[48:51]
  ds_read_b128 a[148:151], v16 offset:35840
  s_waitcnt lgkmcnt(15)
  v_mfma_f32_16x16x32_bf16 v[32:35], a[136:139], v[136:139], v[32:35]
  s_add_u32 m0, s63, 131072
  s_add_u32 s42, s64, 786432
  v_exp_f32 v83, v83
  v_mfma_f32_16x16x32_bf16 v[36:39], a[136:139], v[152:155], v[36:39]
  buffer_load_dwordx4 v4, s[4:7], s42 offen offset:0 lds
  v_cvt_pk_bf16_f32 v114, v80, v81
  v_mfma_f32_16x16x32_bf16 v[40:43], a[136:139], v[168:171], v[40:43]
  v_exp_f32 v68, v68
  v_mfma_f32_16x16x32_bf16 v[44:47], a[136:139], v[184:187], v[44:47]
  ds_read_b128 a[136:139], v16 offset:36864
  v_mfma_f32_16x16x32_bf16 v[60:63], a[152:155], v[184:187], v[60:63]
  v_exp_f32 v69, v69
  v_mfma_f32_16x16x32_bf16 v[56:59], a[152:155], v[168:171], v[56:59]
  buffer_load_dwordx4 v5, s[4:7], s42 offen offset:1024 lds
  v_cvt_pk_bf16_f32 v115, v82, v83
  v_mfma_f32_16x16x32_bf16 v[52:55], a[152:155], v[152:155], v[52:55]
  v_exp_f32 v70, v70
  v_mfma_f32_16x16x32_bf16 v[48:51], a[152:155], v[136:139], v[48:51]
  ds_read_b128 a[152:155], v16 offset:37888
  v_mfma_f32_16x16x32_bf16 v[32:35], a[140:143], v[140:143], v[32:35]
  v_exp_f32 v71, v71
  v_mfma_f32_16x16x32_bf16 v[36:39], a[140:143], v[156:159], v[36:39]
  v_cvt_pk_bf16_f32 v116, v68, v69
  v_mfma_f32_16x16x32_bf16 v[40:43], a[140:143], v[172:175], v[40:43]
  v_exp_f32 v84, v84
  v_mfma_f32_16x16x32_bf16 v[44:47], a[140:143], v[188:191], v[44:47]
  ds_read_b128 a[140:143], v16 offset:38912
  v_mfma_f32_16x16x32_bf16 v[60:63], a[156:159], v[188:191], v[60:63]
  buffer_load_dwordx4 v6, s[4:7], s42 offen offset:2048 lds
  v_exp_f32 v85, v85
  v_mfma_f32_16x16x32_bf16 v[56:59], a[156:159], v[172:175], v[56:59]
  v_cvt_pk_bf16_f32 v117, v70, v71
  v_mfma_f32_16x16x32_bf16 v[52:55], a[156:159], v[156:159], v[52:55]
  v_exp_f32 v86, v86
  v_mfma_f32_16x16x32_bf16 v[48:51], a[156:159], v[140:143], v[48:51]
  ds_read_b128 a[156:159], v16 offset:39936
  s_waitcnt lgkmcnt(15)
  v_mfma_f32_16x16x32_bf16 a[0:3], a[160:163], v[96:99], a[0:3]
  v_exp_f32 v87, v87
  v_mfma_f32_16x16x32_bf16 a[4:7], a[160:163], v[100:103], a[4:7]
  v_cvt_pk_bf16_f32 v118, v84, v85
  v_mfma_f32_16x16x32_bf16 a[8:11], a[160:163], v[104:107], a[8:11]
  buffer_load_dwordx4 v7, s[4:7], s42 offen offset:3072 lds
  v_exp_f32 v72, v72
  v_mfma_f32_16x16x32_bf16 a[12:15], a[160:163], v[108:111], a[12:15]
  ds_read_b64_tr_b16 a[160:161], v8 offset:40960
  ds_read_b64_tr_b16 a[162:163], v8 offset:45056
  v_mfma_f32_16x16x32_bf16 a[28:31], a[164:167], v[108:111], a[28:31]
  v_exp_f32 v73, v73
  v_mfma_f32_16x16x32_bf16 a[24:27], a[164:167], v[104:107], a[24:27]
  v_cvt_pk_bf16_f32 v119, v86, v87
  v_mfma_f32_16x16x32_bf16 a[20:23], a[164:167], v[100:103], a[20:23]
  v_exp_f32 v74, v74
  v_mfma_f32_16x16x32_bf16 a[16:19], a[164:167], v[96:99], a[16:19]
  ds_read_b64_tr_b16 a[164:165], v9 offset:40960
  ds_read_b64_tr_b16 a[166:167], v9 offset:45056
  v_mfma_f32_16x16x32_bf16 a[32:35], a[168:171], v[96:99], a[32:35]
  s_add_u32 m0, s63, 135168
  s_add_u32 s43, s64, 819200
  v_exp_f32 v75, v75
  v_mfma_f32_16x16x32_bf16 a[36:39], a[168:171], v[100:103], a[36:39]
  buffer_load_dwordx4 v4, s[4:7], s43 offen offset:0 lds
  v_cvt_pk_bf16_f32 v120, v72, v73
  v_mfma_f32_16x16x32_bf16 a[40:43], a[168:171], v[104:107], a[40:43]
  v_exp_f32 v88, v88
  v_mfma_f32_16x16x32_bf16 a[44:47], a[168:171], v[108:111], a[44:47]
  ds_read_b64_tr_b16 a[168:169], v8 offset:41216
  ds_read_b64_tr_b16 a[170:171], v8 offset:45312
  v_mfma_f32_16x16x32_bf16 a[60:63], a[172:175], v[108:111], a[60:63]
  v_exp_f32 v89, v89
  v_mfma_f32_16x16x32_bf16 a[56:59], a[172:175], v[104:107], a[56:59]
  v_cvt_pk_bf16_f32 v121, v74, v75
  v_mfma_f32_16x16x32_bf16 a[52:55], a[172:175], v[100:103], a[52:55]
  v_exp_f32 v90, v90
  v_mfma_f32_16x16x32_bf16 a[48:51], a[172:175], v[96:99], a[48:51]
  ds_read_b64_tr_b16 a[172:173], v9 offset:41216
  s_waitcnt lgkmcnt(15)
  v_mfma_f32_16x16x32_bf16 a[64:67], a[176:179], v[96:99], a[64:67]
  ds_read_b64_tr_b16 a[174:175], v9 offset:45312
  buffer_load_dwordx4 v5, s[4:7], s43 offen offset:1024 lds
  v_exp_f32 v91, v91
  v_mfma_f32_16x16x32_bf16 a[68:71], a[176:179], v[100:103], a[68:71]
  v_cvt_pk_bf16_f32 v122, v88, v89
  v_mfma_f32_16x16x32_bf16 a[72:75], a[176:179], v[104:107], a[72:75]
  v_exp_f32 v76, v76
  v_mfma_f32_16x16x32_bf16 a[76:79], a[176:179], v[108:111], a[76:79]
  ds_read_b64_tr_b16 a[176:177], v8 offset:41472
  ds_read_b64_tr_b16 a[178:179], v8 offset:45568
  v_mfma_f32_16x16x32_bf16 a[92:95], a[180:183], v[108:111], a[92:95]
  v_exp_f32 v77, v77
  v_mfma_f32_16x16x32_bf16 a[88:91], a[180:183], v[104:107], a[88:91]
  v_cvt_pk_bf16_f32 v123, v90, v91
  v_mfma_f32_16x16x32_bf16 a[84:87], a[180:183], v[100:103], a[84:87]
  buffer_load_dwordx4 v6, s[4:7], s43 offen offset:2048 lds
  v_mfma_f32_16x16x32_bf16 a[80:83], a[180:183], v[96:99], a[80:83]
  ds_read_b64_tr_b16 a[180:181], v9 offset:41472
  v_exp_f32 v78, v78
  v_mfma_f32_16x16x32_bf16 a[96:99], a[184:187], v[96:99], a[96:99]
  ds_read_b64_tr_b16 a[182:183], v9 offset:45568
  v_exp_f32 v79, v79
  v_mfma_f32_16x16x32_bf16 a[100:103], a[184:187], v[100:103], a[100:103]
  v_cvt_pk_bf16_f32 v124, v76, v77
  v_mfma_f32_16x16x32_bf16 a[104:107], a[184:187], v[104:107], a[104:107]
  v_exp_f32 v92, v92
  v_mfma_f32_16x16x32_bf16 a[108:111], a[184:187], v[108:111], a[108:111]
  ds_read_b64_tr_b16 a[184:185], v8 offset:41728
  ds_read_b64_tr_b16 a[186:187], v8 offset:45824
  v_mfma_f32_16x16x32_bf16 a[124:127], a[188:191], v[108:111], a[124:127]
  buffer_load_dwordx4 v7, s[4:7], s43 offen offset:3072 lds
  v_exp_f32 v93, v93
  v_mfma_f32_16x16x32_bf16 a[120:123], a[188:191], v[104:107], a[120:123]
  v_cvt_pk_bf16_f32 v125, v78, v79
  v_mfma_f32_16x16x32_bf16 a[116:119], a[188:191], v[100:103], a[116:119]
  v_exp_f32 v94, v94
  v_mfma_f32_16x16x32_bf16 a[112:115], a[188:191], v[96:99], a[112:115]
  ds_read_b64_tr_b16 a[188:189], v9 offset:41728
  v_mfma_f32_16x16x32_bf16 v[212:215], v[208:211], v[96:99], v[212:215]
  ds_read_b64_tr_b16 a[190:191], v9 offset:45824
  v_exp_f32 v95, v95
  v_mfma_f32_16x16x32_bf16 v[216:219], v[208:211], v[100:103], v[216:219]
  v_cvt_pk_bf16_f32 v126, v92, v93
  s_nop 0
  v_mfma_f32_16x16x32_bf16 v[220:223], v[208:211], v[104:107], v[220:223]
  v_cvt_pk_bf16_f32 v127, v94, v95
  v_mfma_f32_16x16x32_bf16 v[224:227], v[208:211], v[108:111], v[224:227]
  s_waitcnt lgkmcnt(15)
  v_mfma_f32_16x16x32_bf16 v[64:67], a[128:131], v[128:131], v[192:195]
  v_exp_f32 v32, v32
  v_mfma_f32_16x16x32_bf16 v[68:71], a[128:131], v[144:147], v[196:199]
  v_exp_f32 v33, v33
  v_mfma_f32_16x16x32_bf16 v[72:75], a[128:131], v[160:163], v[200:203]
  v_mfma_f32_16x16x32_bf16 v[76:79], a[128:131], v[176:179], v[204:207]
  buffer_load_dwordx4 a[224:227], v20, s[16:19], s68 offen offset:2048 sc1
  v_mfma_f32_16x16x32_bf16 v[92:95], a[144:147], v[176:179], v[204:207]
  v_exp_f32 v34, v34
  v_mfma_f32_16x16x32_bf16 v[88:91], a[144:147], v[160:163], v[200:203]
  v_exp_f32 v35, v35
  v_mfma_f32_16x16x32_bf16 v[84:87], a[144:147], v[144:147], v[196:199]
  v_cvt_pk_bf16_f32 v96, v32, v33
  v_mfma_f32_16x16x32_bf16 v[80:83], a[144:147], v[128:131], v[192:195]
  v_exp_f32 v48, v48
  v_mfma_f32_16x16x32_bf16 v[64:67], a[132:135], v[132:135], v[64:67]
  v_exp_f32 v49, v49
  v_mfma_f32_16x16x32_bf16 v[68:71], a[132:135], v[148:151], v[68:71]
  v_mfma_f32_16x16x32_bf16 v[72:75], a[132:135], v[164:167], v[72:75]
  buffer_load_dwordx4 a[228:231], v20, s[16:19], s69 offen offset:2048 sc1
  v_cvt_pk_bf16_f32 v97, v34, v35
  v_mfma_f32_16x16x32_bf16 v[76:79], a[132:135], v[180:183], v[76:79]
  v_exp_f32 v50, v50
  v_mfma_f32_16x16x32_bf16 v[92:95], a[148:151], v[180:183], v[92:95]
  v_mfma_f32_16x16x32_bf16 v[88:91], a[148:151], v[164:167], v[88:91]
  v_exp_f32 v51, v51
  v_mfma_f32_16x16x32_bf16 v[84:87], a[148:151], v[148:151], v[84:87]
  v_cvt_pk_bf16_f32 v98, v48, v49
  v_mfma_f32_16x16x32_bf16 v[80:83], a[148:151], v[132:135], v[80:83]
  s_waitcnt lgkmcnt(15)
  v_mfma_f32_16x16x32_bf16 v[64:67], a[136:139], v[136:139], v[64:67]
  v_exp_f32 v36, v36
  v_mfma_f32_16x16x32_bf16 v[68:71], a[136:139], v[152:155], v[68:71]
  v_exp_f32 v37, v37
  v_mfma_f32_16x16x32_bf16 v[72:75], a[136:139], v[168:171], v[72:75]
  buffer_load_dwordx4 a[232:235], v20, s[16:19], s70 offen offset:2048 sc1
  v_cvt_pk_bf16_f32 v99, v50, v51
  v_mfma_f32_16x16x32_bf16 v[76:79], a[136:139], v[184:187], v[76:79]
  v_exp_f32 v38, v38
  v_mfma_f32_16x16x32_bf16 v[92:95], a[152:155], v[184:187], v[92:95]
  v_mfma_f32_16x16x32_bf16 v[88:91], a[152:155], v[168:171], v[88:91]
  v_exp_f32 v39, v39
  v_mfma_f32_16x16x32_bf16 v[84:87], a[152:155], v[152:155], v[84:87]
  v_cvt_pk_bf16_f32 v100, v36, v37
  v_mfma_f32_16x16x32_bf16 v[80:83], a[152:155], v[136:139], v[80:83]
  v_exp_f32 v52, v52
  v_mfma_f32_16x16x32_bf16 v[64:67], a[140:143], v[140:143], v[64:67]
  v_mfma_f32_16x16x32_bf16 v[68:71], a[140:143], v[156:159], v[68:71]
  v_exp_f32 v53, v53
  v_mfma_f32_16x16x32_bf16 v[72:75], a[140:143], v[172:175], v[72:75]
  buffer_load_dwordx4 a[236:239], v20, s[16:19], s71 offen offset:2048 sc1
  v_cvt_pk_bf16_f32 v101, v38, v39
  v_mfma_f32_16x16x32_bf16 v[76:79], a[140:143], v[188:191], v[76:79]
  v_exp_f32 v54, v54
  v_mfma_f32_16x16x32_bf16 v[92:95], a[156:159], v[188:191], v[92:95]
  v_mfma_f32_16x16x32_bf16 v[88:91], a[156:159], v[172:175], v[88:91]
  v_exp_f32 v55, v55
  v_mfma_f32_16x16x32_bf16 v[84:87], a[156:159], v[156:159], v[84:87]
  v_cvt_pk_bf16_f32 v102, v52, v53
  v_mfma_f32_16x16x32_bf16 v[80:83], a[156:159], v[140:143], v[80:83]
  s_waitcnt lgkmcnt(8)
  v_mfma_f32_16x16x32_bf16 a[0:3], a[160:163], v[112:115], a[0:3]
  v_exp_f32 v40, v40
  v_mfma_f32_16x16x32_bf16 a[4:7], a[160:163], v[116:119], a[4:7]
  v_exp_f32 v41, v41
  v_mfma_f32_16x16x32_bf16 a[8:11], a[160:163], v[120:123], a[8:11]
  buffer_load_dwordx4 a[240:243], v20, s[16:19], s68 offen offset:3072 sc1
  v_mfma_f32_16x16x32_bf16 a[12:15], a[160:163], v[124:127], a[12:15]
  ds_read_b64_tr_b16 a[160:161], v8 offset:49152
  v_cvt_pk_bf16_f32 v103, v54, v55
  v_mfma_f32_16x16x32_bf16 a[28:31], a[164:167], v[124:127], a[28:31]
  ds_read_b64_tr_b16 a[162:163], v8 offset:53248
  v_mfma_f32_16x16x32_bf16 a[24:27], a[164:167], v[120:123], a[24:27]
  v_exp_f32 v42, v42
  v_mfma_f32_16x16x32_bf16 a[20:23], a[164:167], v[116:119], a[20:23]
  v_exp_f32 v43, v43
  v_mfma_f32_16x16x32_bf16 a[16:19], a[164:167], v[112:115], a[16:19]
  ds_read_b64_tr_b16 a[164:165], v9 offset:49152
  v_cvt_pk_bf16_f32 v104, v40, v41
  v_mfma_f32_16x16x32_bf16 a[32:35], a[168:171], v[112:115], a[32:35]
  ds_read_b64_tr_b16 a[166:167], v9 offset:53248
  v_mfma_f32_16x16x32_bf16 a[36:39], a[168:171], v[116:119], a[36:39]
  v_exp_f32 v56, v56
  v_mfma_f32_16x16x32_bf16 a[40:43], a[168:171], v[120:123], a[40:43]
  buffer_load_dwordx4 a[244:247], v20, s[16:19], s69 offen offset:3072 sc1
  v_mfma_f32_16x16x32_bf16 a[44:47], a[168:171], v[124:127], a[44:47]
  ds_read_b64_tr_b16 a[168:169], v8 offset:49408
  ds_read_b64_tr_b16 a[170:171], v8 offset:53504
  v_mfma_f32_16x16x32_bf16 a[60:63], a[172:175], v[124:127], a[60:63]
  v_exp_f32 v57, v57
  v_mfma_f32_16x16x32_bf16 a[56:59], a[172:175], v[120:123], a[56:59]
  v_cvt_pk_bf16_f32 v105, v42, v43
  v_mfma_f32_16x16x32_bf16 a[52:55], a[172:175], v[116:119], a[52:55]
  v_exp_f32 v58, v58
  v_mfma_f32_16x16x32_bf16 a[48:51], a[172:175], v[112:115], a[48:51]
  ds_read_b64_tr_b16 a[172:173], v9 offset:49408
  s_waitcnt lgkmcnt(7)
  v_mfma_f32_16x16x32_bf16 a[64:67], a[176:179], v[112:115], a[64:67]
  ds_read_b64_tr_b16 a[174:175], v9 offset:53504
  v_exp_f32 v59, v59
  v_mfma_f32_16x16x32_bf16 a[68:71], a[176:179], v[116:119], a[68:71]
  v_cvt_pk_bf16_f32 v106, v56, v57
  v_mfma_f32_16x16x32_bf16 a[72:75], a[176:179], v[120:123], a[72:75]
  buffer_load_dwordx4 a[248:251], v20, s[16:19], s70 offen offset:3072 sc1
  v_mfma_f32_16x16x32_bf16 a[76:79], a[176:179], v[124:127], a[76:79]
  ds_read_b64_tr_b16 a[176:177], v8 offset:49664
  v_exp_f32 v44, v44
  v_mfma_f32_16x16x32_bf16 a[92:95], a[180:183], v[124:127], a[92:95]
  ds_read_b64_tr_b16 a[178:179], v8 offset:53760
  v_exp_f32 v45, v45
  v_mfma_f32_16x16x32_bf16 a[88:91], a[180:183], v[120:123], a[88:91]
  v_cvt_pk_bf16_f32 v107, v58, v59
  v_mfma_f32_16x16x32_bf16 a[84:87], a[180:183], v[116:119], a[84:87]
  v_exp_f32 v46, v46
  v_mfma_f32_16x16x32_bf16 a[80:83], a[180:183], v[112:115], a[80:83]
  ds_read_b64_tr_b16 a[180:181], v9 offset:49664
  ds_read_b64_tr_b16 a[182:183], v9 offset:53760
  v_mfma_f32_16x16x32_bf16 a[96:99], a[184:187], v[112:115], a[96:99]
  v_exp_f32 v47, v47
  v_mfma_f32_16x16x32_bf16 a[100:103], a[184:187], v[116:119], a[100:103]
  v_cvt_pk_bf16_f32 v108, v44, v45
  v_mfma_f32_16x16x32_bf16 a[104:107], a[184:187], v[120:123], a[104:107]
  buffer_load_dwordx4 a[252:255], v20, s[16:19], s71 offen offset:3072 sc1
  v_mfma_f32_16x16x32_bf16 a[108:111], a[184:187], v[124:127], a[108:111]
  ds_read_b64_tr_b16 a[184:185], v8 offset:49920
  v_exp_f32 v60, v60
  v_mfma_f32_16x16x32_bf16 a[124:127], a[188:191], v[124:127], a[124:127]
  ds_read_b64_tr_b16 a[186:187], v8 offset:54016
  v_exp_f32 v61, v61
  v_mfma_f32_16x16x32_bf16 a[120:123], a[188:191], v[120:123], a[120:123]
  v_cvt_pk_bf16_f32 v109, v46, v47
  v_mfma_f32_16x16x32_bf16 a[116:119], a[188:191], v[116:119], a[116:119]
  v_exp_f32 v62, v62
  v_mfma_f32_16x16x32_bf16 a[112:115], a[188:191], v[112:115], a[112:115]
  ds_read_b64_tr_b16 a[188:189], v9 offset:49920
  v_mfma_f32_16x16x32_bf16 v[212:215], v[208:211], v[112:115], v[212:215]
  ds_read_b64_tr_b16 a[190:191], v9 offset:54016
  v_exp_f32 v63, v63
  v_mfma_f32_16x16x32_bf16 v[216:219], v[208:211], v[116:119], v[216:219]
  v_cvt_pk_bf16_f32 v110, v60, v61
  s_nop 0
  v_mfma_f32_16x16x32_bf16 v[220:223], v[208:211], v[120:123], v[220:223]
  v_cvt_pk_bf16_f32 v111, v62, v63
  v_mfma_f32_16x16x32_bf16 v[224:227], v[208:211], v[124:127], v[224:227]
  s_waitcnt lgkmcnt(8)
  v_mfma_f32_16x16x32_bf16 a[0:3], a[160:163], v[96:99], a[0:3]
  v_exp_f32 v64, v64
  v_mfma_f32_16x16x32_bf16 a[4:7], a[160:163], v[100:103], a[4:7]
  v_exp_f32 v65, v65
  v_mfma_f32_16x16x32_bf16 a[8:11], a[160:163], v[104:107], a[8:11]
  v_exp_f32 v66, v66
  v_mfma_f32_16x16x32_bf16 a[12:15], a[160:163], v[108:111], a[12:15]
  ds_read_b64_tr_b16 a[160:161], v8 offset:57344
  ds_read_b64_tr_b16 a[162:163], v8 offset:61440
  v_mfma_f32_16x16x32_bf16 a[28:31], a[164:167], v[108:111], a[28:31]
  v_exp_f32 v67, v67
  v_mfma_f32_16x16x32_bf16 a[24:27], a[164:167], v[104:107], a[24:27]
  v_cvt_pk_bf16_f32 v112, v64, v65
  v_mfma_f32_16x16x32_bf16 a[20:23], a[164:167], v[100:103], a[20:23]
  v_exp_f32 v80, v80
  v_mfma_f32_16x16x32_bf16 a[16:19], a[164:167], v[96:99], a[16:19]
  ds_read_b64_tr_b16 a[164:165], v9 offset:57344
  v_exp_f32 v81, v81
  v_mfma_f32_16x16x32_bf16 a[32:35], a[168:171], v[96:99], a[32:35]
  ds_read_b64_tr_b16 a[166:167], v9 offset:61440
  v_cvt_pk_bf16_f32 v113, v66, v67
  v_exp_f32 v82, v82
  v_mfma_f32_16x16x32_bf16 a[36:39], a[168:171], v[100:103], a[36:39]
  v_exp_f32 v83, v83
  v_mfma_f32_16x16x32_bf16 a[40:43], a[168:171], v[104:107], a[40:43]
  v_cvt_pk_bf16_f32 v114, v80, v81
  v_exp_f32 v68, v68
  v_mfma_f32_16x16x32_bf16 a[44:47], a[168:171], v[108:111], a[44:47]
  ds_read_b64_tr_b16 a[168:169], v8 offset:57600
  v_exp_f32 v69, v69
  v_mfma_f32_16x16x32_bf16 a[60:63], a[172:175], v[108:111], a[60:63]
  ds_read_b64_tr_b16 a[170:171], v8 offset:61696
  v_cvt_pk_bf16_f32 v115, v82, v83
  v_mfma_f32_16x16x32_bf16 a[56:59], a[172:175], v[104:107], a[56:59]
  v_exp_f32 v70, v70
  v_exp_f32 v71, v71
  v_mfma_f32_16x16x32_bf16 a[52:55], a[172:175], v[100:103], a[52:55]
  v_cvt_pk_bf16_f32 v116, v68, v69
  v_mfma_f32_16x16x32_bf16 a[48:51], a[172:175], v[96:99], a[48:51]
  ds_read_b64_tr_b16 a[172:173], v9 offset:57600
  v_exp_f32 v84, v84
  s_waitcnt lgkmcnt(7)
  v_mfma_f32_16x16x32_bf16 a[64:67], a[176:179], v[96:99], a[64:67]
  ds_read_b64_tr_b16 a[174:175], v9 offset:61696
  v_exp_f32 v85, v85
  v_cvt_pk_bf16_f32 v117, v70, v71
  v_mfma_f32_16x16x32_bf16 a[68:71], a[176:179], v[100:103], a[68:71]
  v_exp_f32 v86, v86
  v_mfma_f32_16x16x32_bf16 a[72:75], a[176:179], v[104:107], a[72:75]
  v_exp_f32 v87, v87
  v_cvt_pk_bf16_f32 v118, v84, v85
  v_mfma_f32_16x16x32_bf16 a[76:79], a[176:179], v[108:111], a[76:79]
  ds_read_b64_tr_b16 a[176:177], v8 offset:57856
  v_exp_f32 v72, v72
  v_mfma_f32_16x16x32_bf16 a[92:95], a[180:183], v[108:111], a[92:95]
  ds_read_b64_tr_b16 a[178:179], v8 offset:61952
  v_exp_f32 v73, v73
  v_mfma_f32_16x16x32_bf16 a[88:91], a[180:183], v[104:107], a[88:91]
  v_cvt_pk_bf16_f32 v119, v86, v87
  v_exp_f32 v74, v74
  v_mfma_f32_16x16x32_bf16 a[84:87], a[180:183], v[100:103], a[84:87]
  v_exp_f32 v75, v75
  v_mfma_f32_16x16x32_bf16 a[80:83], a[180:183], v[96:99], a[80:83]
  ds_read_b64_tr_b16 a[180:181], v9 offset:57856
  v_cvt_pk_bf16_f32 v120, v72, v73
  v_exp_f32 v88, v88
  v_mfma_f32_16x16x32_bf16 a[96:99], a[184:187], v[96:99], a[96:99]
  ds_read_b64_tr_b16 a[182:183], v9 offset:61952
  v_exp_f32 v89, v89
  v_mfma_f32_16x16x32_bf16 a[100:103], a[184:187], v[100:103], a[100:103]
  v_cvt_pk_bf16_f32 v121, v74, v75
  v_exp_f32 v90, v90
  v_mfma_f32_16x16x32_bf16 a[104:107], a[184:187], v[104:107], a[104:107]
  v_exp_f32 v91, v91
  v_mfma_f32_16x16x32_bf16 a[108:111], a[184:187], v[108:111], a[108:111]
  ds_read_b64_tr_b16 a[184:185], v8 offset:58112
  v_cvt_pk_bf16_f32 v122, v88, v89
  v_exp_f32 v76, v76
  v_mfma_f32_16x16x32_bf16 a[124:127], a[188:191], v[108:111], a[124:127]
  ds_read_b64_tr_b16 a[186:187], v8 offset:62208
  v_exp_f32 v77, v77
  v_mfma_f32_16x16x32_bf16 a[120:123], a[188:191], v[104:107], a[120:123]
  v_cvt_pk_bf16_f32 v123, v90, v91
  v_exp_f32 v78, v78
  v_mfma_f32_16x16x32_bf16 a[116:119], a[188:191], v[100:103], a[116:119]
  v_exp_f32 v79, v79
  v_mfma_f32_16x16x32_bf16 a[112:115], a[188:191], v[96:99], a[112:115]
  ds_read_b64_tr_b16 a[188:189], v9 offset:58112
  v_cvt_pk_bf16_f32 v124, v76, v77
  v_exp_f32 v92, v92
  v_mfma_f32_16x16x32_bf16 v[212:215], v[208:211], v[96:99], v[212:215]
  ds_read_b64_tr_b16 a[190:191], v9 offset:62208
  v_exp_f32 v93, v93
  v_mfma_f32_16x16x32_bf16 v[216:219], v[208:211], v[100:103], v[216:219]
  v_cvt_pk_bf16_f32 v125, v78, v79
  v_mfma_f32_16x16x32_bf16 v[220:223], v[208:211], v[104:107], v[220:223]
  v_exp_f32 v94, v94
  v_exp_f32 v95, v95
  v_mfma_f32_16x16x32_bf16 v[224:227], v[208:211], v[108:111], v[224:227]
  v_cvt_pk_bf16_f32 v126, v92, v93
  s_nop 0
  v_cvt_pk_bf16_f32 v127, v94, v95
  s_waitcnt lgkmcnt(8)
  v_mfma_f32_16x16x32_bf16 a[0:3], a[160:163], v[112:115], a[0:3]
  v_mfma_f32_16x16x32_bf16 a[4:7], a[160:163], v[116:119], a[4:7]
  v_mfma_f32_16x16x32_bf16 a[8:11], a[160:163], v[120:123], a[8:11]
  v_mfma_f32_16x16x32_bf16 a[12:15], a[160:163], v[124:127], a[12:15]
  v_mfma_f32_16x16x32_bf16 a[28:31], a[164:167], v[124:127], a[28:31]
  v_mfma_f32_16x16x32_bf16 a[24:27], a[164:167], v[120:123], a[24:27]
  v_mfma_f32_16x16x32_bf16 a[20:23], a[164:167], v[116:119], a[20:23]
  v_mfma_f32_16x16x32_bf16 a[16:19], a[164:167], v[112:115], a[16:19]
  v_mfma_f32_16x16x32_bf16 a[32:35], a[168:171], v[112:115], a[32:35]
  v_mfma_f32_16x16x32_bf16 a[36:39], a[168:171], v[116:119], a[36:39]
  v_mfma_f32_16x16x32_bf16 a[40:43], a[168:171], v[120:123], a[40:43]
  v_mfma_f32_16x16x32_bf16 a[44:47], a[168:171], v[124:127], a[44:47]
  v_mfma_f32_16x16x32_bf16 a[60:63], a[172:175], v[124:127], a[60:63]
  v_mfma_f32_16x16x32_bf16 a[56:59], a[172:175], v[120:123], a[56:59]
  v_mfma_f32_16x16x32_bf16 a[52:55], a[172:175], v[116:119], a[52:55]
  v_mfma_f32_16x16x32_bf16 a[48:51], a[172:175], v[112:115], a[48:51]
  s_waitcnt lgkmcnt(0)
  v_mfma_f32_16x16x32_bf16 a[64:67], a[176:179], v[112:115], a[64:67]
  v_mfma_f32_16x16x32_bf16 a[68:71], a[176:179], v[116:119], a[68:71]
  v_mfma_f32_16x16x32_bf16 a[72:75], a[176:179], v[120:123], a[72:75]
  v_mfma_f32_16x16x32_bf16 a[76:79], a[176:179], v[124:127], a[76:79]
  v_mfma_f32_16x16x32_bf16 a[92:95], a[180:183], v[124:127], a[92:95]
  v_mfma_f32_16x16x32_bf16 a[88:91], a[180:183], v[120:123], a[88:91]
  v_mfma_f32_16x16x32_bf16 a[84:87], a[180:183], v[116:119], a[84:87]
  v_mfma_f32_16x16x32_bf16 a[80:83], a[180:183], v[112:115], a[80:83]
  v_mfma_f32_16x16x32_bf16 a[96:99], a[184:187], v[112:115], a[96:99]
  v_mfma_f32_16x16x32_bf16 a[100:103], a[184:187], v[116:119], a[100:103]
  v_mfma_f32_16x16x32_bf16 a[104:107], a[184:187], v[120:123], a[104:107]
  v_mfma_f32_16x16x32_bf16 a[108:111], a[184:187], v[124:127], a[108:111]
  v_mfma_f32_16x16x32_bf16 a[124:127], a[188:191], v[124:127], a[124:127]
  v_mfma_f32_16x16x32_bf16 a[120:123], a[188:191], v[120:123], a[120:123]
  v_mfma_f32_16x16x32_bf16 a[116:119], a[188:191], v[116:119], a[116:119]
  v_mfma_f32_16x16x32_bf16 a[112:115], a[188:191], v[112:115], a[112:115]
  v_mfma_f32_16x16x32_bf16 v[212:215], v[208:211], v[112:115], v[212:215]
  v_mfma_f32_16x16x32_bf16 v[216:219], v[208:211], v[116:119], v[216:219]
  v_mfma_f32_16x16x32_bf16 v[220:223], v[208:211], v[120:123], v[220:223]
  v_mfma_f32_16x16x32_bf16 v[224:227], v[208:211], v[124:127], v[224:227]
  s_load_dwordx2 s[12:13], s[0:1], 64
  s_mov_b32 s85, 0x5f800000
  s_nop 5
  v_add_f32 v229, v212, v216
  v_add_f32 v230, v220, v224
  v_add_f32 v229, v229, v230
  v_cmp_nge_f32 vcc, s85, v229
  s_cmp_lg_u64 vcc, 0
  s_cbranch_scc1 L_main_slow
L_main_slow_ret:
  s_waitcnt lgkmcnt(0)
  s_mov_b32 s14, 4194304
  s_mov_b32 s15, 0x00020000
  ds_read_b64_tr_b16 v[32:33], v10 offset:0
  ds_read_b64_tr_b16 v[34:35], v10 offset:4096
  ds_read_b64_tr_b16 v[36:37], v11 offset:0
  ds_read_b64_tr_b16 v[38:39], v11 offset:4096
  ds_read_b64_tr_b16 v[40:41], v10 offset:256
  ds_read_b64_tr_b16 v[42:43], v10 offset:4352
  ds_read_b64_tr_b16 v[44:45], v11 offset:256
  ds_read_b64_tr_b16 v[46:47], v11 offset:4352
  ds_read_b64_tr_b16 v[48:49], v10 offset:512
  ds_read_b64_tr_b16 v[50:51], v10 offset:4608
  ds_read_b64_tr_b16 v[52:53], v11 offset:512
  ds_read_b64_tr_b16 v[54:55], v11 offset:4608
  ds_read_b64_tr_b16 v[56:57], v10 offset:768
  ds_read_b64_tr_b16 v[58:59], v10 offset:4864
  ds_read_b64_tr_b16 v[60:61], v11 offset:768
  ds_read_b64_tr_b16 v[62:63], v11 offset:4864
  v_rcp_f32 v252, v212
  v_rcp_f32 v253, v216
  v_rcp_f32 v254, v220
  v_rcp_f32 v255, v224
  s_add_u32 s89, s76, 58982400
  s_waitcnt vmcnt(20) lgkmcnt(8)
  v_mfma_f32_16x16x32_bf16 v[96:99], v[32:35], a[192:195], 0
  v_accvgpr_read_b32 v228, a0
  v_mfma_f32_16x16x32_bf16 v[100:103], v[32:35], a[196:199], 0
  s_add_u32 s68, s66, 4096
  v_mfma_f32_16x16x32_bf16 v[104:107], v[32:35], a[200:203], 0
  buffer_load_dwordx4 a[128:131], v20, s[16:19], s68 offen offset:0 sc1
  v_mfma_f32_16x16x32_bf16 v[108:111], v[32:35], a[204:207], 0
  ds_read_b64_tr_b16 v[32:33], v10 offset:8192
  v_accvgpr_read_b32 v229, a1
  v_mfma_f32_16x16x32_bf16 v[124:127], v[36:39], a[204:207], 0
  ds_read_b64_tr_b16 v[34:35], v10 offset:12288
  v_accvgpr_read_b32 v230, a2
  v_mfma_f32_16x16x32_bf16 v[120:123], v[36:39], a[200:203], 0
  v_accvgpr_read_b32 v231, a3
  v_mfma_f32_16x16x32_bf16 v[116:119], v[36:39], a[196:199], 0
  v_accvgpr_read_b32 v232, a16
  v_mfma_f32_16x16x32_bf16 v[112:115], v[36:39], a[192:195], 0
  ds_read_b64_tr_b16 v[36:37], v11 offset:8192
  v_accvgpr_read_b32 v233, a17
  v_mfma_f32_16x16x32_bf16 v[128:131], v[40:43], a[192:195], 0
  ds_read_b64_tr_b16 v[38:39], v11 offset:12288
  v_accvgpr_read_b32 v234, a18
  v_mfma_f32_16x16x32_bf16 v[132:135], v[40:43], a[196:199], 0
  s_add_u32 s69, s66, 119040
  v_mfma_f32_16x16x32_bf16 v[136:139], v[40:43], a[200:203], 0
  buffer_load_dwordx4 a[132:135], v20, s[16:19], s69 offen offset:0 sc1
  v_accvgpr_read_b32 v235, a19
  v_mfma_f32_16x16x32_bf16 v[140:143], v[40:43], a[204:207], 0
  ds_read_b64_tr_b16 v[40:41], v10 offset:8448
  v_mul_f32 v228, v228, v252
  v_mfma_f32_16x16x32_bf16 v[156:159], v[44:47], a[204:207], 0
  ds_read_b64_tr_b16 v[42:43], v10 offset:12544
  v_mul_f32 v229, v229, v252
  v_mfma_f32_16x16x32_bf16 v[152:155], v[44:47], a[200:203], 0
  v_mul_f32 v230, v230, v252
  v_mfma_f32_16x16x32_bf16 v[148:151], v[44:47], a[196:199], 0
  v_mul_f32 v231, v231, v252
  v_mfma_f32_16x16x32_bf16 v[144:147], v[44:47], a[192:195], 0
  ds_read_b64_tr_b16 v[44:45], v11 offset:8448
  v_mul_f32 v232, v232, v252
  s_waitcnt lgkmcnt(7)
  v_mfma_f32_16x16x32_bf16 v[160:163], v[48:51], a[192:195], 0
  ds_read_b64_tr_b16 v[46:47], v11 offset:12544
  v_mul_f32 v233, v233, v252
  v_mfma_f32_16x16x32_bf16 v[164:167], v[48:51], a[196:199], 0
  s_add_u32 s70, s66, 233984
  v_mfma_f32_16x16x32_bf16 v[168:171], v[48:51], a[200:203], 0
  buffer_load_dwordx4 a[136:139], v20, s[16:19], s70 offen offset:0 sc1
  v_mul_f32 v234, v234, v252
  v_mfma_f32_16x16x32_bf16 v[172:175], v[48:51], a[204:207], 0
  ds_read_b64_tr_b16 v[48:49], v10 offset:8704
  v_mul_f32 v235, v235, v252
  v_mfma_f32_16x16x32_bf16 v[188:191], v[52:55], a[204:207], 0
  ds_read_b64_tr_b16 v[50:51], v10 offset:12800
  v_cvt_pk_bf16_f32 v236, v228, v229
  v_mfma_f32_16x16x32_bf16 v[184:187], v[52:55], a[200:203], 0
  v_cvt_pk_bf16_f32 v237, v230, v231
  v_mfma_f32_16x16x32_bf16 v[180:183], v[52:55], a[196:199], 0
  v_cvt_pk_bf16_f32 v238, v232, v233
  v_mfma_f32_16x16x32_bf16 v[176:179], v[52:55], a[192:195], 0
  ds_read_b64_tr_b16 v[52:53], v11 offset:8704
  v_cvt_pk_bf16_f32 v239, v234, v235
  v_mfma_f32_16x16x32_bf16 v[192:195], v[56:59], a[192:195], 0
  ds_read_b64_tr_b16 v[54:55], v11 offset:12800
  buffer_store_dwordx4 v[236:239], v20, s[16:19], s56 offen offset:0 sc1
  v_mfma_f32_16x16x32_bf16 v[196:199], v[56:59], a[196:199], 0
  s_add_u32 s71, s66, 348928
  v_mfma_f32_16x16x32_bf16 v[200:203], v[56:59], a[200:203], 0
  buffer_load_dwordx4 a[140:143], v20, s[16:19], s71 offen offset:0 sc1
  v_accvgpr_read_b32 v228, a32
  v_mfma_f32_16x16x32_bf16 v[204:207], v[56:59], a[204:207], 0
  ds_read_b64_tr_b16 v[56:57], v10 offset:8960
  v_accvgpr_read_b32 v229, a33
  v_mfma_f32_16x16x32_bf16 v[220:223], v[60:63], a[204:207], 0
  ds_read_b64_tr_b16 v[58:59], v10 offset:13056
  v_accvgpr_read_b32 v230, a34
  v_mfma_f32_16x16x32_bf16 v[216:219], v[60:63], a[200:203], 0
  v_accvgpr_read_b32 v231, a35
  v_mfma_f32_16x16x32_bf16 v[212:215], v[60:63], a[196:199], 0
  v_accvgpr_read_b32 v232, a48
  v_mfma_f32_16x16x32_bf16 v[208:211], v[60:63], a[192:195], 0
  ds_read_b64_tr_b16 v[60:61], v11 offset:8960
  v_accvgpr_read_b32 v233, a49
  s_waitcnt vmcnt(21) lgkmcnt(7)
  v_mfma_f32_16x16x32_bf16 v[96:99], v[32:35], a[208:211], v[96:99]
  v_accvgpr_read_b32 v234, a50
  ds_read_b64_tr_b16 v[62:63], v11 offset:13056
  v_mfma_f32_16x16x32_bf16 v[100:103], v[32:35], a[212:215], v[100:103]
  buffer_load_dwordx4 a[144:147], v20, s[16:19], s68 offen offset:1024 sc1
  v_mfma_f32_16x16x32_bf16 v[104:107], v[32:35], a[216:219], v[104:107]
  v_accvgpr_read_b32 v235, a51
  v_mfma_f32_16x16x32_bf16 v[108:111], v[32:35], a[220:223], v[108:111]
  ds_read_b64_tr_b16 v[32:33], v10 offset:16384
  v_mul_f32 v228, v228, v252
  v_mfma_f32_16x16x32_bf16 v[124:127], v[36:39], a[220:223], v[124:127]
  ds_read_b64_tr_b16 v[34:35], v10 offset:20480
  v_mul_f32 v229, v229, v252
  v_mfma_f32_16x16x32_bf16 v[120:123], v[36:39], a[216:219], v[120:123]
  v_mul_f32 v230, v230, v252
  v_mfma_f32_16x16x32_bf16 v[116:119], v[36:39], a[212:215], v[116:119]
  v_mul_f32 v231, v231, v252
  v_mfma_f32_16x16x32_bf16 v[112:115], v[36:39], a[208:211], v[112:115]
  ds_read_b64_tr_b16 v[36:37], v11 offset:16384
  v_mul_f32 v232, v232, v252
  v_mfma_f32_16x16x32_bf16 v[128:131], v[40:43], a[208:211], v[128:131]
  ds_read_b64_tr_b16 v[38:39], v11 offset:20480
  buffer_load_dwordx4 a[148:151], v20, s[16:19], s69 offen offset:1024 sc1
  v_mul_f32 v233, v233, v252
  v_mfma_f32_16x16x32_bf16 v[132:135], v[40:43], a[212:215], v[132:135]
  v_mul_f32 v234, v234, v252
  v_mfma_f32_16x16x32_bf16 v[136:139], v[40:43], a[216:219], v[136:139]
  v_mul_f32 v235, v235, v252
  v_mfma_f32_16x16x32_bf16 v[140:143], v[40:43], a[220:223], v[140:143]
  ds_read_b64_tr_b16 v[40:41], v10 offset:16640
  v_cvt_pk_bf16_f32 v240, v228, v229
  v_mfma_f32_16x16x32_bf16 v[156:159], v[44:47], a[220:223], v[156:159]
  ds_read_b64_tr_b16 v[42:43], v10 offset:20736
  v_mfma_f32_16x16x32_bf16 v[152:155], v[44:47], a[216:219], v[152:155]
  v_cvt_pk_bf16_f32 v241, v230, v231
  v_mfma_f32_16x16x32_bf16 v[148:151], v[44:47], a[212:215], v[148:151]
  v_cvt_pk_bf16_f32 v242, v232, v233
  v_mfma_f32_16x16x32_bf16 v[144:147], v[44:47], a[208:211], v[144:147]
  ds_read_b64_tr_b16 v[44:45], v11 offset:16640
  v_cvt_pk_bf16_f32 v243, v234, v235
  s_waitcnt lgkmcnt(7)
  v_mfma_f32_16x16x32_bf16 v[160:163], v[48:51], a[208:211], v[160:163]
  ds_read_b64_tr_b16 v[46:47], v11 offset:20736
  buffer_load_dwordx4 a[152:155], v20, s[16:19], s70 offen offset:1024 sc1
  buffer_store_dwordx4 v[240:243], v20, s[16:19], s56 offen offset:1024 sc1
  v_mfma_f32_16x16x32_bf16 v[164:167], v[48:51], a[212:215], v[164:167]
  v_accvgpr_read_b32 v228, a64
  v_mfma_f32_16x16x32_bf16 v[168:171], v[48:51], a[216:219], v[168:171]
  v_accvgpr_read_b32 v229, a65
  v_mfma_f32_16x16x32_bf16 v[172:175], v[48:51], a[220:223], v[172:175]
  ds_read_b64_tr_b16 v[48:49], v10 offset:16896
  v_accvgpr_read_b32 v230, a66
  v_mfma_f32_16x16x32_bf16 v[188:191], v[52:55], a[220:223], v[188:191]
  ds_read_b64_tr_b16 v[50:51], v10 offset:20992
  v_mfma_f32_16x16x32_bf16 v[184:187], v[52:55], a[216:219], v[184:187]
  v_accvgpr_read_b32 v231, a67
  v_mfma_f32_16x16x32_bf16 v[180:183], v[52:55], a[212:215], v[180:183]
  v_accvgpr_read_b32 v232, a80
  v_mfma_f32_16x16x32_bf16 v[176:179], v[52:55], a[208:211], v[176:179]
  ds_read_b64_tr_b16 v[52:53], v11 offset:16896
  v_accvgpr_read_b32 v233, a81
  v_mfma_f32_16x16x32_bf16 v[192:195], v[56:59], a[208:211], v[192:195]
  ds_read_b64_tr_b16 v[54:55], v11 offset:20992
  buffer_load_dwordx4 a[156:159], v20, s[16:19], s71 offen offset:1024 sc1
  v_accvgpr_read_b32 v234, a82
  v_mfma_f32_16x16x32_bf16 v[196:199], v[56:59], a[212:215], v[196:199]
  v_accvgpr_read_b32 v235, a83
  v_mfma_f32_16x16x32_bf16 v[200:203], v[56:59], a[216:219], v[200:203]
  v_mul_f32 v228, v228, v252
  v_mfma_f32_16x16x32_bf16 v[204:207], v[56:59], a[220:223], v[204:207]
  ds_read_b64_tr_b16 v[56:57], v10 offset:17152
  v_mul_f32 v229, v229, v252
  v_mfma_f32_16x16x32_bf16 v[220:223], v[60:63], a[220:223], v[220:223]
  ds_read_b64_tr_b16 v[58:59], v10 offset:21248
  v_mfma_f32_16x16x32_bf16 v[216:219], v[60:63], a[216:219], v[216:219]
  v_mul_f32 v230, v230, v252
  v_mfma_f32_16x16x32_bf16 v[212:215], v[60:63], a[212:215], v[212:215]
  v_mul_f32 v231, v231, v252
  v_mfma_f32_16x16x32_bf16 v[208:211], v[60:63], a[208:211], v[208:211]
  ds_read_b64_tr_b16 v[60:61], v11 offset:17152
  v_mul_f32 v232, v232, v252
  s_waitcnt vmcnt(14) lgkmcnt(7)
  v_mfma_f32_16x16x32_bf16 v[96:99], v[32:35], a[224:227], v[96:99]
  v_mul_f32 v233, v233, v252
  ds_read_b64_tr_b16 v[62:63], v11 offset:21248
  v_mfma_f32_16x16x32_bf16 v[100:103], v[32:35], a[228:231], v[100:103]
  buffer_load_dwordx4 a[160:163], v20, s[16:19], s68 offen offset:2048 sc1
  v_mfma_f32_16x16x32_bf16 v[104:107], v[32:35], a[232:235], v[104:107]
  v_mul_f32 v234, v234, v252
  v_mfma_f32_16x16x32_bf16 v[108:111], v[32:35], a[236:239], v[108:111]
  ds_read_b64_tr_b16 v[32:33], v10 offset:24576
  v_mul_f32 v235, v235, v252
  v_mfma_f32_16x16x32_bf16 v[124:127], v[36:39], a[236:239], v[124:127]
  ds_read_b64_tr_b16 v[34:35], v10 offset:28672
  v_cvt_pk_bf16_f32 v236, v228, v229
  v_mfma_f32_16x16x32_bf16 v[120:123], v[36:39], a[232:235], v[120:123]
  v_cvt_pk_bf16_f32 v237, v230, v231
  v_mfma_f32_16x16x32_bf16 v[116:119], v[36:39], a[228:231], v[116:119]
  v_cvt_pk_bf16_f32 v238, v232, v233
  v_mfma_f32_16x16x32_bf16 v[112:115], v[36:39], a[224:227], v[112:115]
  ds_read_b64_tr_b16 v[36:37], v11 offset:24576
  v_cvt_pk_bf16_f32 v239, v234, v235
  v_mfma_f32_16x16x32_bf16 v[128:131], v[40:43], a[224:227], v[128:131]
  ds_read_b64_tr_b16 v[38:39], v11 offset:28672
  buffer_load_dwordx4 a[164:167], v20, s[16:19], s69 offen offset:2048 sc1
  buffer_store_dwordx4 v[236:239], v20, s[16:19], s56 offen offset:2048 sc1
  v_mfma_f32_16x16x32_bf16 v[132:135], v[40:43], a[228:231], v[132:135]
  v_accvgpr_read_b32 v228, a96
  v_mfma_f32_16x16x32_bf16 v[136:139], v[40:43], a[232:235], v[136:139]
  v_accvgpr_read_b32 v229, a97
  v_mfma_f32_16x16x32_bf16 v[140:143], v[40:43], a[236:239], v[140:143]
  ds_read_b64_tr_b16 v[40:41], v10 offset:24832
  v_accvgpr_read_b32 v230, a98
  v_mfma_f32_16x16x32_bf16 v[156:159], v[44:47], a[236:239], v[156:159]
  ds_read_b64_tr_b16 v[42:43], v10 offset:28928
  v_mfma_f32_16x16x32_bf16 v[152:155], v[44:47], a[232:235], v[152:155]
  v_accvgpr_read_b32 v231, a99
  v_mfma_f32_16x16x32_bf16 v[148:151], v[44:47], a[228:231], v[148:151]
  v_accvgpr_read_b32 v232, a112
  v_mfma_f32_16x16x32_bf16 v[144:147], v[44:47], a[224:227], v[144:147]
  ds_read_b64_tr_b16 v[44:45], v11 offset:24832
  v_accvgpr_read_b32 v233, a113
  s_waitcnt lgkmcnt(7)
  v_mfma_f32_16x16x32_bf16 v[160:163], v[48:51], a[224:227], v[160:163]
  ds_read_b64_tr_b16 v[46:47], v11 offset:28928
  buffer_load_dwordx4 a[168:171], v20, s[16:19], s70 offen offset:2048 sc1
  v_accvgpr_read_b32 v234, a114
  v_mfma_f32_16x16x32_bf16 v[164:167], v[48:51], a[228:231], v[164:167]
  v_accvgpr_read_b32 v235, a115
  v_mfma_f32_16x16x32_bf16 v[168:171], v[48:51], a[232:235], v[168:171]
  v_mul_f32 v228, v228, v252
  v_mfma_f32_16x16x32_bf16 v[172:175], v[48:51], a[236:239], v[172:175]
  ds_read_b64_tr_b16 v[48:49], v10 offset:25088
  v_mul_f32 v229, v229, v252
  v_mfma_f32_16x16x32_bf16 v[188:191], v[52:55], a[236:239], v[188:191]
  ds_read_b64_tr_b16 v[50:51], v10 offset:29184
  v_mfma_f32_16x16x32_bf16 v[184:187], v[52:55], a[232:235], v[184:187]
  v_mul_f32 v230, v230, v252
  v_mfma_f32_16x16x32_bf16 v[180:183], v[52:55], a[228:231], v[180:183]
  v_mul_f32 v231, v231, v252
  v_mfma_f32_16x16x32_bf16 v[176:179], v[52:55], a[224:227], v[176:179]
  ds_read_b64_tr_b16 v[52:53], v11 offset:25088
  v_mul_f32 v232, v232, v252
  v_mfma_f32_16x16x32_bf16 v[192:195], v[56:59], a[224:227], v[192:195]
  ds_read_b64_tr_b16 v[54:55], v11 offset:29184
  buffer_load_dwordx4 a[172:175], v20, s[16:19], s71 offen offset:2048 sc1
  v_mul_f32 v233, v233, v252
  v_mfma_f32_16x16x32_bf16 v[196:199], v[56:59], a[228:231], v[196:199]
  v_mul_f32 v234, v234, v252
  v_mfma_f32_16x16x32_bf16 v[200:203], v[56:59], a[232:235], v[200:203]
  v_mul_f32 v235, v235, v252
  v_mfma_f32_16x16x32_bf16 v[204:207], v[56:59], a[236:239], v[204:207]
  ds_read_b64_tr_b16 v[56:57], v10 offset:25344
  v_cvt_pk_bf16_f32 v240, v228, v229
  v_mfma_f32_16x16x32_bf16 v[220:223], v[60:63], a[236:239], v[220:223]
  ds_read_b64_tr_b16 v[58:59], v10 offset:29440
  v_mfma_f32_16x16x32_bf16 v[216:219], v[60:63], a[232:235], v[216:219]
  v_cvt_pk_bf16_f32 v241, v230, v231
  v_mfma_f32_16x16x32_bf16 v[212:215], v[60:63], a[228:231], v[212:215]
  v_cvt_pk_bf16_f32 v242, v232, v233
  v_mfma_f32_16x16x32_bf16 v[208:211], v[60:63], a[224:227], v[208:211]
  ds_read_b64_tr_b16 v[60:61], v11 offset:25344
  v_cvt_pk_bf16_f32 v243, v234, v235
  s_waitcnt vmcnt(15) lgkmcnt(7)
  v_mfma_f32_16x16x32_bf16 v[96:99], v[32:35], a[240:243], v[96:99]
  buffer_store_dwordx4 v[240:243], v20, s[16:19], s56 offen offset:3072 sc1
  ds_read_b64_tr_b16 v[62:63], v11 offset:29440
  v_mfma_f32_16x16x32_bf16 v[100:103], v[32:35], a[244:247], v[100:103]
  buffer_load_dwordx4 a[176:179], v20, s[16:19], s68 offen offset:3072 sc1
  v_mfma_f32_16x16x32_bf16 v[104:107], v[32:35], a[248:251], v[104:107]
  v_accvgpr_read_b32 v228, a4
  v_mfma_f32_16x16x32_bf16 v[108:111], v[32:35], a[252:255], v[108:111]
  v_accvgpr_read_b32 v229, a5
  v_mfma_f32_16x16x32_bf16 v[124:127], v[36:39], a[252:255], v[124:127]
  v_accvgpr_read_b32 v230, a6
  v_mfma_f32_16x16x32_bf16 v[120:123], v[36:39], a[248:251], v[120:123]
  v_accvgpr_read_b32 v231, a7
  v_mfma_f32_16x16x32_bf16 v[116:119], v[36:39], a[244:247], v[116:119]
  v_accvgpr_read_b32 v232, a20
  v_mfma_f32_16x16x32_bf16 v[112:115], v[36:39], a[240:243], v[112:115]
  s_barrier
  v_mfma_f32_16x16x32_bf16 v[128:131], v[40:43], a[240:243], v[128:131]
  ds_read_b64_tr_b16 v[32:33], v8 offset:0
  buffer_load_dwordx4 a[180:183], v20, s[16:19], s69 offen offset:3072 sc1
  v_accvgpr_read_b32 v233, a21
  v_accvgpr_read_b32 v234, a22
  v_mfma_f32_16x16x32_bf16 v[132:135], v[40:43], a[244:247], v[132:135]
  ds_read_b64_tr_b16 v[34:35], v8 offset:4096
  v_accvgpr_read_b32 v235, a23
  v_mfma_f32_16x16x32_bf16 v[136:139], v[40:43], a[248:251], v[136:139]
  ds_read_b64_tr_b16 v[36:37], v9 offset:0
  v_mul_f32 v228, v228, v253
  v_mfma_f32_16x16x32_bf16 v[140:143], v[40:43], a[252:255], v[140:143]
  ds_read_b64_tr_b16 v[38:39], v9 offset:4096
  v_mul_f32 v229, v229, v253
  v_mfma_f32_16x16x32_bf16 v[156:159], v[44:47], a[252:255], v[156:159]
  ds_read_b64_tr_b16 v[40:41], v8 offset:256
  v_mul_f32 v230, v230, v253
  v_mfma_f32_16x16x32_bf16 v[152:155], v[44:47], a[248:251], v[152:155]
  ds_read_b64_tr_b16 v[42:43], v8 offset:4352
  v_mfma_f32_16x16x32_bf16 v[148:151], v[44:47], a[244:247], v[148:151]
  v_mul_f32 v231, v231, v253
  v_mfma_f32_16x16x32_bf16 v[144:147], v[44:47], a[240:243], v[144:147]
  ds_read_b64_tr_b16 v[44:45], v9 offset:256
  v_mul_f32 v232, v232, v253
  s_waitcnt lgkmcnt(7)
  v_mfma_f32_16x16x32_bf16 v[160:163], v[48:51], a[240:243], v[160:163]
  ds_read_b64_tr_b16 v[46:47], v9 offset:4352
  buffer_load_dwordx4 a[184:187], v20, s[16:19], s70 offen offset:3072 sc1
  v_mul_f32 v233, v233, v253
  v_mfma_f32_16x16x32_bf16 v[164:167], v[48:51], a[244:247], v[164:167]
  v_mul_f32 v234, v234, v253
  v_mfma_f32_16x16x32_bf16 v[168:171], v[48:51], a[248:251], v[168:171]
  v_mul_f32 v235, v235, v253
  v_mfma_f32_16x16x32_bf16 v[172:175], v[48:51], a[252:255], v[172:175]
  ds_read_b64_tr_b16 v[48:49], v8 offset:512
  v_cvt_pk_bf16_f32 v236, v228, v229
  v_mfma_f32_16x16x32_bf16 v[188:191], v[52:55], a[252:255], v[188:191]
  ds_read_b64_tr_b16 v[50:51], v8 offset:4608
  v_mfma_f32_16x16x32_bf16 v[184:187], v[52:55], a[248:251], v[184:187]
  v_cvt_pk_bf16_f32 v237, v230, v231
  v_mfma_f32_16x16x32_bf16 v[180:183], v[52:55], a[244:247], v[180:183]
  v_cvt_pk_bf16_f32 v238, v232, v233
  v_mfma_f32_16x16x32_bf16 v[176:179], v[52:55], a[240:243], v[176:179]
  ds_read_b64_tr_b16 v[52:53], v9 offset:512
  v_cvt_pk_bf16_f32 v239, v234, v235
  v_mfma_f32_16x16x32_bf16 v[192:195], v[56:59], a[240:243], v[192:195]
  ds_read_b64_tr_b16 v[54:55], v9 offset:4608
  buffer_load_dwordx4 a[188:191], v20, s[16:19], s71 offen offset:3072 sc1
  buffer_store_dwordx4 v[236:239], v20, s[16:19], s57 offen offset:0 sc1
  v_mfma_f32_16x16x32_bf16 v[196:199], v[56:59], a[244:247], v[196:199]
  v_accvgpr_read_b32 v228, a36
  v_mfma_f32_16x16x32_bf16 v[200:203], v[56:59], a[248:251], v[200:203]
  v_accvgpr_read_b32 v229, a37
  v_mfma_f32_16x16x32_bf16 v[204:207], v[56:59], a[252:255], v[204:207]
  ds_read_b64_tr_b16 v[56:57], v8 offset:768
  v_accvgpr_read_b32 v230, a38
  v_mfma_f32_16x16x32_bf16 v[220:223], v[60:63], a[252:255], v[220:223]
  ds_read_b64_tr_b16 v[58:59], v8 offset:4864
  v_mfma_f32_16x16x32_bf16 v[216:219], v[60:63], a[248:251], v[216:219]
  v_accvgpr_read_b32 v231, a39
  v_mfma_f32_16x16x32_bf16 v[212:215], v[60:63], a[244:247], v[212:215]
  v_accvgpr_read_b32 v232, a52
  v_mfma_f32_16x16x32_bf16 v[208:211], v[60:63], a[240:243], v[208:211]
  ds_read_b64_tr_b16 v[60:61], v9 offset:768
  v_accvgpr_read_b32 v233, a53
  s_waitcnt vmcnt(16) lgkmcnt(7)
  v_mfma_f32_16x16x32_bf16 v[96:99], v[32:35], a[128:131], v[96:99]
  v_accvgpr_read_b32 v234, a54
  ds_read_b64_tr_b16 v[62:63], v9 offset:4864
  v_mfma_f32_16x16x32_bf16 v[100:103], v[32:35], a[132:135], v[100:103]
  s_add_u32 s68, s66, 8192
  v_mfma_f32_16x16x32_bf16 v[104:107], v[32:35], a[136:139], v[104:107]
  buffer_load_dwordx4 a[192:195], v20, s[16:19], s68 offen offset:0 sc1
  v_accvgpr_read_b32 v235, a55
  v_mfma_f32_16x16x32_bf16 v[108:111], v[32:35], a[140:143], v[108:111]
  ds_read_b64_tr_b16 v[32:33], v8 offset:8192
  v_mul_f32 v228, v228, v253
  v_mfma_f32_16x16x32_bf16 v[124:127], v[36:39], a[140:143], v[124:127]
  ds_read_b64_tr_b16 v[34:35], v8 offset:12288
  v_mul_f32 v229, v229, v253
  v_mfma_f32_16x16x32_bf16 v[120:123], v[36:39], a[136:139], v[120:123]
  v_mul_f32 v230, v230, v253
  v_mfma_f32_16x16x32_bf16 v[116:119], v[36:39], a[132:135], v[116:119]
  v_mul_f32 v231, v231, v253
  v_mfma_f32_16x16x32_bf16 v[112:115], v[36:39], a[128:131], v[112:115]
  ds_read_b64_tr_b16 v[36:37], v9 offset:8192
  v_mul_f32 v232, v232, v253
  v_mfma_f32_16x16x32_bf16 v[128:131], v[40:43], a[128:131], v[128:131]
  ds_read_b64_tr_b16 v[38:39], v9 offset:12288
  v_mul_f32 v233, v233, v253
  v_mfma_f32_16x16x32_bf16 v[132:135], v[40:43], a[132:135], v[132:135]
  s_add_u32 s69, s66, 123136
  v_mfma_f32_16x16x32_bf16 v[136:139], v[40:43], a[136:139], v[136:139]
  buffer_load_dwordx4 a[196:199], v20, s[16:19], s69 offen offset:0 sc1
  v_mul_f32 v234, v234, v253
  v_mfma_f32_16x16x32_bf16 v[140:143], v[40:43], a[140:143], v[140:143]
  ds_read_b64_tr_b16 v[40:41], v8 offset:8448
  v_mul_f32 v235, v235, v253
  v_mfma_f32_16x16x32_bf16 v[156:159], v[44:47], a[140:143], v[156:159]
  ds_read_b64_tr_b16 v[42:43], v8 offset:12544
  v_cvt_pk_bf16_f32 v240, v228, v229
  v_mfma_f32_16x16x32_bf16 v[152:155], v[44:47], a[136:139], v[152:155]
  v_cvt_pk_bf16_f32 v241, v230, v231
  v_mfma_f32_16x16x32_bf16 v[148:151], v[44:47], a[132:135], v[148:151]
  v_cvt_pk_bf16_f32 v242, v232, v233
  v_mfma_f32_16x16x32_bf16 v[144:147], v[44:47], a[128:131], v[144:147]
  ds_read_b64_tr_b16 v[44:45], v9 offset:8448
  v_cvt_pk_bf16_f32 v243, v234, v235
  s_waitcnt lgkmcnt(7)
  v_mfma_f32_16x16x32_bf16 v[160:163], v[48:51], a[128:131], v[160:163]
  ds_read_b64_tr_b16 v[46:47], v9 offset:12544
  buffer_store_dwordx4 v[240:243], v20, s[16:19], s57 offen offset:1024 sc1
  v_mfma_f32_16x16x32_bf16 v[164:167], v[48:51], a[132:135], v[164:167]
  s_add_u32 s70, s66, 238080
  v_mfma_f32_16x16x32_bf16 v[168:171], v[48:51], a[136:139], v[168:171]
  buffer_load_dwordx4 a[200:203], v20, s[16:19], s70 offen offset:0 sc1
  v_accvgpr_read_b32 v228, a68
  v_mfma_f32_16x16x32_bf16 v[172:175], v[48:51], a[140:143], v[172:175]
  ds_read_b64_tr_b16 v[48:49], v8 offset:8704
  v_accvgpr_read_b32 v229, a69
  v_mfma_f32_16x16x32_bf16 v[188:191], v[52:55], a[140:143], v[188:191]
  ds_read_b64_tr_b16 v[50:51], v8 offset:12800
  v_accvgpr_read_b32 v230, a70
  v_mfma_f32_16x16x32_bf16 v[184:187], v[52:55], a[136:139], v[184:187]
  v_accvgpr_read_b32 v231, a71
  v_mfma_f32_16x16x32_bf16 v[180:183], v[52:55], a[132:135], v[180:183]
  v_accvgpr_read_b32 v232, a84
  v_mfma_f32_16x16x32_bf16 v[176:179], v[52:55], a[128:131], v[176:179]
  ds_read_b64_tr_b16 v[52:53], v9 offset:8704
  v_accvgpr_read_b32 v233, a85
  v_mfma_f32_16x16x32_bf16 v[192:195], v[56:59], a[128:131], v[192:195]
  ds_read_b64_tr_b16 v[54:55], v9 offset:12800
  v_accvgpr_read_b32 v234, a86
  v_mfma_f32_16x16x32_bf16 v[196:199], v[56:59], a[132:135], v[196:199]
  s_add_u32 s71, s66, 353024
  v_mfma_f32_16x16x32_bf16 v[200:203], v[56:59], a[136:139], v[200:203]
  buffer_load_dwordx4 a[204:207], v20, s[16:19], s71 offen offset:0 sc1
  v_accvgpr_read_b32 v235, a87
  v_mfma_f32_16x16x32_bf16 v[204:207], v[56:59], a[140:143], v[204:207]
  ds_read_b64_tr_b16 v[56:57], v8 offset:8960
  v_mul_f32 v228, v228, v253
  v_mfma_f32_16x16x32_bf16 v[220:223], v[60:63], a[140:143], v[220:223]
  ds_read_b64_tr_b16 v[58:59], v8 offset:13056
  v_mul_f32 v229, v229, v253
  v_mfma_f32_16x16x32_bf16 v[216:219], v[60:63], a[136:139], v[216:219]
  v_mul_f32 v230, v230, v253
  v_mfma_f32_16x16x32_bf16 v[212:215], v[60:63], a[132:135], v[212:215]
  v_mul_f32 v231, v231, v253
  v_mfma_f32_16x16x32_bf16 v[208:211], v[60:63], a[128:131], v[208:211]
  ds_read_b64_tr_b16 v[60:61], v9 offset:8960
  v_mul_f32 v232, v232, v253
  s_waitcnt vmcnt(16) lgkmcnt(7)
  v_mfma_f32_16x16x32_bf16 v[96:99], v[32:35], a[144:147], v[96:99]
  v_mul_f32 v233, v233, v253
  ds_read_b64_tr_b16 v[62:63], v9 offset:13056
  v_mfma_f32_16x16x32_bf16 v[100:103], v[32:35], a[148:151], v[100:103]
  buffer_load_dwordx4 a[208:211], v20, s[16:19], s68 offen offset:1024 sc1
  v_mfma_f32_16x16x32_bf16 v[104:107], v[32:35], a[152:155], v[104:107]
  v_mul_f32 v234, v234, v253
  v_mfma_f32_16x16x32_bf16 v[108:111], v[32:35], a[156:159], v[108:111]
  ds_read_b64_tr_b16 v[32:33], v8 offset:16384
  v_mul_f32 v235, v235, v253
  v_mfma_f32_16x16x32_bf16 v[124:127], v[36:39], a[156:159], v[124:127]
  ds_read_b64_tr_b16 v[34:35], v8 offset:20480
  v_cvt_pk_bf16_f32 v236, v228, v229
  v_mfma_f32_16x16x32_bf16 v[120:123], v[36:39], a[152:155], v[120:123]
  v_cvt_pk_bf16_f32 v237, v230, v231
  v_mfma_f32_16x16x32_bf16 v[116:119], v[36:39], a[148:151], v[116:119]
  v_cvt_pk_bf16_f32 v238, v232, v233
  v_mfma_f32_16x16x32_bf16 v[112:115], v[36:39], a[144:147], v[112:115]
  ds_read_b64_tr_b16 v[36:37], v9 offset:16384
  v_cvt_pk_bf16_f32 v239, v234, v235
  v_mfma_f32_16x16x32_bf16 v[128:131], v[40:43], a[144:147], v[128:131]
  ds_read_b64_tr_b16 v[38:39], v9 offset:20480
  buffer_load_dwordx4 a[212:215], v20, s[16:19], s69 offen offset:1024 sc1
  buffer_store_dwordx4 v[236:239], v20, s[16:19], s57 offen offset:2048 sc1
  v_mfma_f32_16x16x32_bf16 v[132:135], v[40:43], a[148:151], v[132:135]
  v_accvgpr_read_b32 v228, a100
  v_mfma_f32_16x16x32_bf16 v[136:139], v[40:43], a[152:155], v[136:139]
  v_accvgpr_read_b32 v229, a101
  v_mfma_f32_16x16x32_bf16 v[140:143], v[40:43], a[156:159], v[140:143]
  ds_read_b64_tr_b16 v[40:41], v8 offset:16640
  v_accvgpr_read_b32 v230, a102
  v_mfma_f32_16x16x32_bf16 v[156:159], v[44:47], a[156:159], v[156:159]
  ds_read_b64_tr_b16 v[42:43], v8 offset:20736
  v_mfma_f32_16x16x32_bf16 v[152:155], v[44:47], a[152:155], v[152:155]
  v_accvgpr_read_b32 v231, a103
  v_mfma_f32_16x16x32_bf16 v[148:151], v[44:47], a[148:151], v[148:151]
  v_accvgpr_read_b32 v232, a116
  v_mfma_f32_16x16x32_bf16 v[144:147], v[44:47], a[144:147], v[144:147]
  ds_read_b64_tr_b16 v[44:45], v9 offset:16640
  v_accvgpr_read_b32 v233, a117
  s_waitcnt lgkmcnt(7)
  v_mfma_f32_16x16x32_bf16 v[160:163], v[48:51], a[144:147], v[160:163]
  ds_read_b64_tr_b16 v[46:47], v9 offset:20736
  buffer_load_dwordx4 a[216:219], v20, s[16:19], s70 offen offset:1024 sc1
  v_accvgpr_read_b32 v234, a118
  v_mfma_f32_16x16x32_bf16 v[164:167], v[48:51], a[148:151], v[164:167]
  v_accvgpr_read_b32 v235, a119
  v_mfma_f32_16x16x32_bf16 v[168:171], v[48:51], a[152:155], v[168:171]
  v_mul_f32 v228, v228, v253
  v_mfma_f32_16x16x32_bf16 v[172:175], v[48:51], a[156:159], v[172:175]
  ds_read_b64_tr_b16 v[48:49], v8 offset:16896
  v_mul_f32 v229, v229, v253
  v_mfma_f32_16x16x32_bf16 v[188:191], v[52:55], a[156:159], v[188:191]
  ds_read_b64_tr_b16 v[50:51], v8 offset:20992
  v_mfma_f32_16x16x32_bf16 v[184:187], v[52:55], a[152:155], v[184:187]
  v_mul_f32 v230, v230, v253
  v_mfma_f32_16x16x32_bf16 v[180:183], v[52:55], a[148:151], v[180:183]
  v_mul_f32 v231, v231, v253
  v_mfma_f32_16x16x32_bf16 v[176:179], v[52:55], a[144:147], v[176:179]
  ds_read_b64_tr_b16 v[52:53], v9 offset:16896
  v_mul_f32 v232, v232, v253
  v_mfma_f32_16x16x32_bf16 v[192:195], v[56:59], a[144:147], v[192:195]
  ds_read_b64_tr_b16 v[54:55], v9 offset:20992
  buffer_load_dwordx4 a[220:223], v20, s[16:19], s71 offen offset:1024 sc1
  v_mul_f32 v233, v233, v253
  v_mfma_f32_16x16x32_bf16 v[196:199], v[56:59], a[148:151], v[196:199]
  v_mul_f32 v234, v234, v253
  v_mfma_f32_16x16x32_bf16 v[200:203], v[56:59], a[152:155], v[200:203]
  v_mul_f32 v235, v235, v253
  v_mfma_f32_16x16x32_bf16 v[204:207], v[56:59], a[156:159], v[204:207]
  ds_read_b64_tr_b16 v[56:57], v8 offset:17152
  v_cvt_pk_bf16_f32 v240, v228, v229
  v_mfma_f32_16x16x32_bf16 v[220:223], v[60:63], a[156:159], v[220:223]
  ds_read_b64_tr_b16 v[58:59], v8 offset:21248
  v_mfma_f32_16x16x32_bf16 v[216:219], v[60:63], a[152:155], v[216:219]
  v_cvt_pk_bf16_f32 v241, v230, v231
  v_mfma_f32_16x16x32_bf16 v[212:215], v[60:63], a[148:151], v[212:215]
  v_cvt_pk_bf16_f32 v242, v232, v233
  v_mfma_f32_16x16x32_bf16 v[208:211], v[60:63], a[144:147], v[208:211]
  ds_read_b64_tr_b16 v[60:61], v9 offset:17152
  v_cvt_pk_bf16_f32 v243, v234, v235
  s_waitcnt vmcnt(16) lgkmcnt(7)
  v_mfma_f32_16x16x32_bf16 v[96:99], v[32:35], a[160:163], v[96:99]
  buffer_store_dwordx4 v[240:243], v20, s[16:19], s57 offen offset:3072 sc1
  ds_read_b64_tr_b16 v[62:63], v9 offset:21248
  v_mfma_f32_16x16x32_bf16 v[100:103], v[32:35], a[164:167], v[100:103]
  buffer_load_dwordx4 a[224:227], v20, s[16:19], s68 offen offset:2048 sc1
  v_mfma_f32_16x16x32_bf16 v[104:107], v[32:35], a[168:171], v[104:107]
  v_accvgpr_read_b32 v228, a8
  v_mfma_f32_16x16x32_bf16 v[108:111], v[32:35], a[172:175], v[108:111]
  ds_read_b64_tr_b16 v[32:33], v8 offset:24576
  v_accvgpr_read_b32 v229, a9
  v_mfma_f32_16x16x32_bf16 v[124:127], v[36:39], a[172:175], v[124:127]
  ds_read_b64_tr_b16 v[34:35], v8 offset:28672
  v_accvgpr_read_b32 v230, a10
  v_mfma_f32_16x16x32_bf16 v[120:123], v[36:39], a[168:171], v[120:123]
  v_accvgpr_read_b32 v231, a11
  v_mfma_f32_16x16x32_bf16 v[116:119], v[36:39], a[164:167], v[116:119]
  v_accvgpr_read_b32 v232, a24
  v_mfma_f32_16x16x32_bf16 v[112:115], v[36:39], a[160:163], v[112:115]
  ds_read_b64_tr_b16 v[36:37], v9 offset:24576
  v_accvgpr_read_b32 v233, a25
  v_mfma_f32_16x16x32_bf16 v[128:131], v[40:43], a[160:163], v[128:131]
  ds_read_b64_tr_b16 v[38:39], v9 offset:28672
  buffer_load_dwordx4 a[228:231], v20, s[16:19], s69 offen offset:2048 sc1
  v_accvgpr_read_b32 v234, a26
  v_mfma_f32_16x16x32_bf16 v[132:135], v[40:43], a[164:167], v[132:135]
  v_accvgpr_read_b32 v235, a27
  v_mfma_f32_16x16x32_bf16 v[136:139], v[40:43], a[168:171], v[136:139]
  v_mul_f32 v228, v228, v254
  v_mfma_f32_16x16x32_bf16 v[140:143], v[40:43], a[172:175], v[140:143]
  ds_read_b64_tr_b16 v[40:41], v8 offset:24832
  v_mul_f32 v229, v229, v254
  v_mfma_f32_16x16x32_bf16 v[156:159], v[44:47], a[172:175], v[156:159]
  ds_read_b64_tr_b16 v[42:43], v8 offset:28928
  v_mfma_f32_16x16x32_bf16 v[152:155], v[44:47], a[168:171], v[152:155]
  v_mul_f32 v230, v230, v254
  v_mfma_f32_16x16x32_bf16 v[148:151], v[44:47], a[164:167], v[148:151]
  v_mul_f32 v231, v231, v254
  v_mfma_f32_16x16x32_bf16 v[144:147], v[44:47], a[160:163], v[144:147]
  ds_read_b64_tr_b16 v[44:45], v9 offset:24832
  v_mul_f32 v232, v232, v254
  s_waitcnt lgkmcnt(7)
  v_mfma_f32_16x16x32_bf16 v[160:163], v[48:51], a[160:163], v[160:163]
  ds_read_b64_tr_b16 v[46:47], v9 offset:28928
  buffer_load_dwordx4 a[232:235], v20, s[16:19], s70 offen offset:2048 sc1
  v_mul_f32 v233, v233, v254
  v_mfma_f32_16x16x32_bf16 v[164:167], v[48:51], a[164:167], v[164:167]
  v_mul_f32 v234, v234, v254
  v_mfma_f32_16x16x32_bf16 v[168:171], v[48:51], a[168:171], v[168:171]
  v_mul_f32 v235, v235, v254
  v_mfma_f32_16x16x32_bf16 v[172:175], v[48:51], a[172:175], v[172:175]
  ds_read_b64_tr_b16 v[48:49], v8 offset:25088
  v_cvt_pk_bf16_f32 v236, v228, v229
  v_mfma_f32_16x16x32_bf16 v[188:191], v[52:55], a[172:175], v[188:191]
  ds_read_b64_tr_b16 v[50:51], v8 offset:29184
  v_mfma_f32_16x16x32_bf16 v[184:187], v[52:55], a[168:171], v[184:187]
  v_cvt_pk_bf16_f32 v237, v230, v231
  v_mfma_f32_16x16x32_bf16 v[180:183], v[52:55], a[164:167], v[180:183]
  v_cvt_pk_bf16_f32 v238, v232, v233
  v_mfma_f32_16x16x32_bf16 v[176:179], v[52:55], a[160:163], v[176:179]
  ds_read_b64_tr_b16 v[52:53], v9 offset:25088
  v_cvt_pk_bf16_f32 v239, v234, v235
  v_mfma_f32_16x16x32_bf16 v[192:195], v[56:59], a[160:163], v[192:195]
  ds_read_b64_tr_b16 v[54:55], v9 offset:29184
  buffer_load_dwordx4 a[236:239], v20, s[16:19], s71 offen offset:2048 sc1
  buffer_store_dwordx4 v[236:239], v20, s[16:19], s58 offen offset:0 sc1
  v_mfma_f32_16x16x32_bf16 v[196:199], v[56:59], a[164:167], v[196:199]
  v_accvgpr_read_b32 v228, a40
  v_mfma_f32_16x16x32_bf16 v[200:203], v[56:59], a[168:171], v[200:203]
  v_accvgpr_read_b32 v229, a41
  v_mfma_f32_16x16x32_bf16 v[204:207], v[56:59], a[172:175], v[204:207]
  ds_read_b64_tr_b16 v[56:57], v8 offset:25344
  v_accvgpr_read_b32 v230, a42
  v_mfma_f32_16x16x32_bf16 v[220:223], v[60:63], a[172:175], v[220:223]
  ds_read_b64_tr_b16 v[58:59], v8 offset:29440
  v_mfma_f32_16x16x32_bf16 v[216:219], v[60:63], a[168:171], v[216:219]
  v_accvgpr_read_b32 v231, a43
  v_mfma_f32_16x16x32_bf16 v[212:215], v[60:63], a[164:167], v[212:215]
  v_accvgpr_read_b32 v232, a56
  v_mfma_f32_16x16x32_bf16 v[208:211], v[60:63], a[160:163], v[208:211]
  ds_read_b64_tr_b16 v[60:61], v9 offset:25344
  v_accvgpr_read_b32 v233, a57
  s_waitcnt vmcnt(17) lgkmcnt(7)
  v_mfma_f32_16x16x32_bf16 v[96:99], v[32:35], a[176:179], v[96:99]
  v_accvgpr_read_b32 v234, a58
  ds_read_b64_tr_b16 v[62:63], v9 offset:29440
  v_mfma_f32_16x16x32_bf16 v[100:103], v[32:35], a[180:183], v[100:103]
  buffer_load_dwordx4 a[240:243], v20, s[16:19], s68 offen offset:3072 sc1
  v_mfma_f32_16x16x32_bf16 v[104:107], v[32:35], a[184:187], v[104:107]
  v_accvgpr_read_b32 v235, a59
  v_mfma_f32_16x16x32_bf16 v[108:111], v[32:35], a[188:191], v[108:111]
  v_mul_f32 v228, v228, v254
  v_mfma_f32_16x16x32_bf16 v[124:127], v[36:39], a[188:191], v[124:127]
  v_mul_f32 v229, v229, v254
  v_mfma_f32_16x16x32_bf16 v[120:123], v[36:39], a[184:187], v[120:123]
  v_mul_f32 v230, v230, v254
  v_mfma_f32_16x16x32_bf16 v[116:119], v[36:39], a[180:183], v[116:119]
  v_mul_f32 v231, v231, v254
  v_mfma_f32_16x16x32_bf16 v[112:115], v[36:39], a[176:179], v[112:115]
  s_waitcnt vmcnt(62)
  s_barrier
  v_mfma_f32_16x16x32_bf16 v[128:131], v[40:43], a[176:179], v[128:131]
  ds_read_b64_tr_b16 v[32:33], v10 offset:32768
  buffer_load_dwordx4 a[244:247], v20, s[16:19], s69 offen offset:3072 sc1
  v_mul_f32 v232, v232, v254
  v_mul_f32 v233, v233, v254
  v_mfma_f32_16x16x32_bf16 v[132:135], v[40:43], a[180:183], v[132:135]
  ds_read_b64_tr_b16 v[34:35], v10 offset:36864
  v_mul_f32 v234, v234, v254
  v_mfma_f32_16x16x32_bf16 v[136:139], v[40:43], a[184:187], v[136:139]
  ds_read_b64_tr_b16 v[36:37], v11 offset:32768
  v_mul_f32 v235, v235, v254
  v_mfma_f32_16x16x32_bf16 v[140:143], v[40:43], a[188:191], v[140:143]
  ds_read_b64_tr_b16 v[38:39], v11 offset:36864
  v_cvt_pk_bf16_f32 v240, v228, v229
  v_mfma_f32_16x16x32_bf16 v[156:159], v[44:47], a[188:191], v[156:159]
  ds_read_b64_tr_b16 v[40:41], v10 offset:33024
  v_cvt_pk_bf16_f32 v241, v230, v231
  v_mfma_f32_16x16x32_bf16 v[152:155], v[44:47], a[184:187], v[152:155]
  ds_read_b64_tr_b16 v[42:43], v10 offset:37120
  v_mfma_f32_16x16x32_bf16 v[148:151], v[44:47], a[180:183], v[148:151]
  v_cvt_pk_bf16_f32 v242, v232, v233
  v_mfma_f32_16x16x32_bf16 v[144:147], v[44:47], a[176:179], v[144:147]
  ds_read_b64_tr_b16 v[44:45], v11 offset:33024
  v_cvt_pk_bf16_f32 v243, v234, v235
  s_waitcnt lgkmcnt(7)
  v_mfma_f32_16x16x32_bf16 v[160:163], v[48:51], a[176:179], v[160:163]
  ds_read_b64_tr_b16 v[46:47], v11 offset:37120
  buffer_load_dwordx4 a[248:251], v20, s[16:19], s70 offen offset:3072 sc1
  buffer_store_dwordx4 v[240:243], v20, s[16:19], s58 offen offset:1024 sc1
  v_mfma_f32_16x16x32_bf16 v[164:167], v[48:51], a[180:183], v[164:167]
  v_accvgpr_read_b32 v228, a72
  v_mfma_f32_16x16x32_bf16 v[168:171], v[48:51], a[184:187], v[168:171]
  v_accvgpr_read_b32 v229, a73
  v_mfma_f32_16x16x32_bf16 v[172:175], v[48:51], a[188:191], v[172:175]
  ds_read_b64_tr_b16 v[48:49], v10 offset:33280
  v_accvgpr_read_b32 v230, a74
  v_mfma_f32_16x16x32_bf16 v[188:191], v[52:55], a[188:191], v[188:191]
  ds_read_b64_tr_b16 v[50:51], v10 offset:37376
  v_mfma_f32_16x16x32_bf16 v[184:187], v[52:55], a[184:187], v[184:187]
  v_accvgpr_read_b32 v231, a75
  v_mfma_f32_16x16x32_bf16 v[180:183], v[52:55], a[180:183], v[180:183]
  v_accvgpr_read_b32 v232, a88
  v_mfma_f32_16x16x32_bf16 v[176:179], v[52:55], a[176:179], v[176:179]
  ds_read_b64_tr_b16 v[52:53], v11 offset:33280
  v_accvgpr_read_b32 v233, a89
  v_mfma_f32_16x16x32_bf16 v[192:195], v[56:59], a[176:179], v[192:195]
  ds_read_b64_tr_b16 v[54:55], v11 offset:37376
  buffer_load_dwordx4 a[252:255], v20, s[16:19], s71 offen offset:3072 sc1
  v_accvgpr_read_b32 v234, a90
  v_mfma_f32_16x16x32_bf16 v[196:199], v[56:59], a[180:183], v[196:199]
  v_accvgpr_read_b32 v235, a91
  v_mfma_f32_16x16x32_bf16 v[200:203], v[56:59], a[184:187], v[200:203]
  v_mul_f32 v228, v228, v254
  v_mfma_f32_16x16x32_bf16 v[204:207], v[56:59], a[188:191], v[204:207]
  ds_read_b64_tr_b16 v[56:57], v10 offset:33536
  v_mul_f32 v229, v229, v254
  v_mfma_f32_16x16x32_bf16 v[220:223], v[60:63], a[188:191], v[220:223]
  ds_read_b64_tr_b16 v[58:59], v10 offset:37632
  v_mfma_f32_16x16x32_bf16 v[216:219], v[60:63], a[184:187], v[216:219]
  v_mul_f32 v230, v230, v254
  v_mfma_f32_16x16x32_bf16 v[212:215], v[60:63], a[180:183], v[212:215]
  v_mul_f32 v231, v231, v254
  v_mfma_f32_16x16x32_bf16 v[208:211], v[60:63], a[176:179], v[208:211]
  ds_read_b64_tr_b16 v[60:61], v11 offset:33536
  v_mul_f32 v232, v232, v254
  s_waitcnt vmcnt(16) lgkmcnt(7)
  v_mfma_f32_16x16x32_bf16 v[96:99], v[32:35], a[192:195], v[96:99]
  v_mul_f32 v233, v233, v254
  ds_read_b64_tr_b16 v[62:63], v11 offset:37632
  v_mfma_f32_16x16x32_bf16 v[100:103], v[32:35], a[196:199], v[100:103]
  s_add_u32 s68, s66, 12288
  v_mfma_f32_16x16x32_bf16 v[104:107], v[32:35], a[200:203], v[104:107]
  buffer_load_dwordx4 a[128:131], v20, s[16:19], s68 offen offset:0 sc1
  v_mul_f32 v234, v234, v254
  v_mfma_f32_16x16x32_bf16 v[108:111], v[32:35], a[204:207], v[108:111]
  ds_read_b64_tr_b16 v[32:33], v10 offset:40960
  v_mul_f32 v235, v235, v254
  v_mfma_f32_16x16x32_bf16 v[124:127], v[36:39], a[204:207], v[124:127]
  ds_read_b64_tr_b16 v[34:35], v10 offset:45056
  v_cvt_pk_bf16_f32 v236, v228, v229
  v_mfma_f32_16x16x32_bf16 v[120:123], v[36:39], a[200:203], v[120:123]
  v_cvt_pk_bf16_f32 v237, v230, v231
  v_mfma_f32_16x16x32_bf16 v[116:119], v[36:39], a[196:199], v[116:119]
  v_cvt_pk_bf16_f32 v238, v232, v233
  v_mfma_f32_16x16x32_bf16 v[112:115], v[36:39], a[192:195], v[112:115]
  ds_read_b64_tr_b16 v[36:37], v11 offset:40960
  v_cvt_pk_bf16_f32 v239, v234, v235
  v_mfma_f32_16x16x32_bf16 v[128:131], v[40:43], a[192:195], v[128:131]
  ds_read_b64_tr_b16 v[38:39], v11 offset:45056
  buffer_store_dwordx4 v[236:239], v20, s[16:19], s58 offen offset:2048 sc1
  v_mfma_f32_16x16x32_bf16 v[132:135], v[40:43], a[196:199], v[132:135]
  s_add_u32 s69, s66, 127232
  v_mfma_f32_16x16x32_bf16 v[136:139], v[40:43], a[200:203], v[136:139]
  buffer_load_dwordx4 a[132:135], v20, s[16:19], s69 offen offset:0 sc1
  v_accvgpr_read_b32 v228, a104
  v_mfma_f32_16x16x32_bf16 v[140:143], v[40:43], a[204:207], v[140:143]
  ds_read_b64_tr_b16 v[40:41], v10 offset:41216
  v_accvgpr_read_b32 v229, a105
  v_mfma_f32_16x16x32_bf16 v[156:159], v[44:47], a[204:207], v[156:159]
  ds_read_b64_tr_b16 v[42:43], v10 offset:45312
  v_accvgpr_read_b32 v230, a106
  v_mfma_f32_16x16x32_bf16 v[152:155], v[44:47], a[200:203], v[152:155]
  v_accvgpr_read_b32 v231, a107
  v_mfma_f32_16x16x32_bf16 v[148:151], v[44:47], a[196:199], v[148:151]
  v_accvgpr_read_b32 v232, a120
  v_mfma_f32_16x16x32_bf16 v[144:147], v[44:47], a[192:195], v[144:147]
  ds_read_b64_tr_b16 v[44:45], v11 offset:41216
  v_accvgpr_read_b32 v233, a121
  s_waitcnt lgkmcnt(7)
  v_mfma_f32_16x16x32_bf16 v[160:163], v[48:51], a[192:195], v[160:163]
  ds_read_b64_tr_b16 v[46:47], v11 offset:45312
  v_accvgpr_read_b32 v234, a122
  v_mfma_f32_16x16x32_bf16 v[164:167], v[48:51], a[196:199], v[164:167]
  s_add_u32 s70, s66, 242176
  v_mfma_f32_16x16x32_bf16 v[168:171], v[48:51], a[200:203], v[168:171]
  buffer_load_dwordx4 a[136:139], v20, s[16:19], s70 offen offset:0 sc1
  v_accvgpr_read_b32 v235, a123
  v_mfma_f32_16x16x32_bf16 v[172:175], v[48:51], a[204:207], v[172:175]
  ds_read_b64_tr_b16 v[48:49], v10 offset:41472
  v_mul_f32 v228, v228, v254
  v_mfma_f32_16x16x32_bf16 v[188:191], v[52:55], a[204:207], v[188:191]
  ds_read_b64_tr_b16 v[50:51], v10 offset:45568
  v_mul_f32 v229, v229, v254
  v_mfma_f32_16x16x32_bf16 v[184:187], v[52:55], a[200:203], v[184:187]
  v_mul_f32 v230, v230, v254
  v_mfma_f32_16x16x32_bf16 v[180:183], v[52:55], a[196:199], v[180:183]
  v_mul_f32 v231, v231, v254
  v_mfma_f32_16x16x32_bf16 v[176:179], v[52:55], a[192:195], v[176:179]
  ds_read_b64_tr_b16 v[52:53], v11 offset:41472
  v_mul_f32 v232, v232, v254
  v_mfma_f32_16x16x32_bf16 v[192:195], v[56:59], a[192:195], v[192:195]
  ds_read_b64_tr_b16 v[54:55], v11 offset:45568
  v_mul_f32 v233, v233, v254
  v_mfma_f32_16x16x32_bf16 v[196:199], v[56:59], a[196:199], v[196:199]
  s_add_u32 s71, s66, 357120
  v_mfma_f32_16x16x32_bf16 v[200:203], v[56:59], a[200:203], v[200:203]
  buffer_load_dwordx4 a[140:143], v20, s[16:19], s71 offen offset:0 sc1
  v_mul_f32 v234, v234, v254
  v_mfma_f32_16x16x32_bf16 v[204:207], v[56:59], a[204:207], v[204:207]
  ds_read_b64_tr_b16 v[56:57], v10 offset:41728
  v_mul_f32 v235, v235, v254
  v_mfma_f32_16x16x32_bf16 v[220:223], v[60:63], a[204:207], v[220:223]
  ds_read_b64_tr_b16 v[58:59], v10 offset:45824
  v_cvt_pk_bf16_f32 v240, v228, v229
  v_mfma_f32_16x16x32_bf16 v[216:219], v[60:63], a[200:203], v[216:219]
  v_cvt_pk_bf16_f32 v241, v230, v231
  v_mfma_f32_16x16x32_bf16 v[212:215], v[60:63], a[196:199], v[212:215]
  v_cvt_pk_bf16_f32 v242, v232, v233
  v_mfma_f32_16x16x32_bf16 v[208:211], v[60:63], a[192:195], v[208:211]
  ds_read_b64_tr_b16 v[60:61], v11 offset:41728
  v_cvt_pk_bf16_f32 v243, v234, v235
  s_waitcnt vmcnt(16) lgkmcnt(7)
  v_mfma_f32_16x16x32_bf16 v[96:99], v[32:35], a[208:211], v[96:99]
  buffer_store_dwordx4 v[240:243], v20, s[16:19], s58 offen offset:3072 sc1
  ds_read_b64_tr_b16 v[62:63], v11 offset:45824
  v_mfma_f32_16x16x32_bf16 v[100:103], v[32:35], a[212:215], v[100:103]
  buffer_load_dwordx4 a[144:147], v20, s[16:19], s68 offen offset:1024 sc1
  v_mfma_f32_16x16x32_bf16 v[104:107], v[32:35], a[216:219], v[104:107]
  v_accvgpr_read_b32 v228, a12
  v_mfma_f32_16x16x32_bf16 v[108:111], v[32:35], a[220:223], v[108:111]
  ds_read_b64_tr_b16 v[32:33], v10 offset:49152
  v_accvgpr_read_b32 v229, a13
  v_mfma_f32_16x16x32_bf16 v[124:127], v[36:39], a[220:223], v[124:127]
  ds_read_b64_tr_b16 v[34:35], v10 offset:53248
  v_accvgpr_read_b32 v230, a14
  v_mfma_f32_16x16x32_bf16 v[120:123], v[36:39], a[216:219], v[120:123]
  s_add_u32 m0, s63, 32768
  s_add_u32 s42, s64, 1048576
  v_accvgpr_read_b32 v231, a15
  v_mfma_f32_16x16x32_bf16 v[116:119], v[36:39], a[212:215], v[116:119]
  buffer_load_dwordx4 v4, s[4:7], s42 offen offset:0 lds
  v_accvgpr_read_b32 v232, a28
  v_mfma_f32_16x16x32_bf16 v[112:115], v[36:39], a[208:211], v[112:115]
  ds_read_b64_tr_b16 v[36:37], v11 offset:49152
  v_accvgpr_read_b32 v233, a29
  v_mfma_f32_16x16x32_bf16 v[128:131], v[40:43], a[208:211], v[128:131]
  ds_read_b64_tr_b16 v[38:39], v11 offset:53248
  v_accvgpr_read_b32 v234, a30
  v_mfma_f32_16x16x32_bf16 v[132:135], v[40:43], a[212:215], v[132:135]
  v_accvgpr_read_b32 v235, a31
  v_mfma_f32_16x16x32_bf16 v[136:139], v[40:43], a[216:219], v[136:139]
  buffer_load_dwordx4 a[148:151], v20, s[16:19], s69 offen offset:1024 sc1
  v_mfma_f32_16x16x32_bf16 v[140:143], v[40:43], a[220:223], v[140:143]
  ds_read_b64_tr_b16 v[40:41], v10 offset:49408
  v_mul_f32 v228, v228, v255
  v_mfma_f32_16x16x32_bf16 v[156:159], v[44:47], a[220:223], v[156:159]
  ds_read_b64_tr_b16 v[42:43], v10 offset:53504
  v_mul_f32 v229, v229, v255
  v_mfma_f32_16x16x32_bf16 v[152:155], v[44:47], a[216:219], v[152:155]
  v_mul_f32 v230, v230, v255
  v_mfma_f32_16x16x32_bf16 v[148:151], v[44:47], a[212:215], v[148:151]
  v_mul_f32 v231, v231, v255
  v_mfma_f32_16x16x32_bf16 v[144:147], v[44:47], a[208:211], v[144:147]
  ds_read_b64_tr_b16 v[44:45], v11 offset:49408
  v_mul_f32 v232, v232, v255
  s_waitcnt lgkmcnt(7)
  v_mfma_f32_16x16x32_bf16 v[160:163], v[48:51], a[208:211], v[160:163]
  ds_read_b64_tr_b16 v[46:47], v11 offset:53504
  buffer_load_dwordx4 a[152:155], v20, s[16:19], s70 offen offset:1024 sc1
  v_mul_f32 v233, v233, v255
  v_mfma_f32_16x16x32_bf16 v[164:167], v[48:51], a[212:215], v[164:167]
  v_mul_f32 v234, v234, v255
  v_mfma_f32_16x16x32_bf16 v[168:171], v[48:51], a[216:219], v[168:171]
  v_mul_f32 v235, v235, v255
  v_mfma_f32_16x16x32_bf16 v[172:175], v[48:51], a[220:223], v[172:175]
  ds_read_b64_tr_b16 v[48:49], v10 offset:49664
  v_cvt_pk_bf16_f32 v236, v228, v229
  v_mfma_f32_16x16x32_bf16 v[188:191], v[52:55], a[220:223], v[188:191]
  ds_read_b64_tr_b16 v[50:51], v10 offset:53760
  v_mfma_f32_16x16x32_bf16 v[184:187], v[52:55], a[216:219], v[184:187]
  buffer_load_dwordx4 v5, s[4:7], s42 offen offset:1024 lds
  v_cvt_pk_bf16_f32 v237, v230, v231
  v_mfma_f32_16x16x32_bf16 v[180:183], v[52:55], a[212:215], v[180:183]
  v_cvt_pk_bf16_f32 v238, v232, v233
  v_mfma_f32_16x16x32_bf16 v[176:179], v[52:55], a[208:211], v[176:179]
  ds_read_b64_tr_b16 v[52:53], v11 offset:49664
  v_cvt_pk_bf16_f32 v239, v234, v235
  v_mfma_f32_16x16x32_bf16 v[192:195], v[56:59], a[208:211], v[192:195]
  ds_read_b64_tr_b16 v[54:55], v11 offset:53760
  buffer_store_dwordx4 v[236:239], v20, s[16:19], s59 offen offset:0 sc1
  v_mfma_f32_16x16x32_bf16 v[196:199], v[56:59], a[212:215], v[196:199]
  v_accvgpr_read_b32 v228, a44
  v_mfma_f32_16x16x32_bf16 v[200:203], v[56:59], a[216:219], v[200:203]
  buffer_load_dwordx4 a[156:159], v20, s[16:19], s71 offen offset:1024 sc1
  v_mfma_f32_16x16x32_bf16 v[204:207], v[56:59], a[220:223], v[204:207]
  ds_read_b64_tr_b16 v[56:57], v10 offset:49920
  v_accvgpr_read_b32 v229, a45
  v_mfma_f32_16x16x32_bf16 v[220:223], v[60:63], a[220:223], v[220:223]
  ds_read_b64_tr_b16 v[58:59], v10 offset:54016
  v_accvgpr_read_b32 v230, a46
  v_mfma_f32_16x16x32_bf16 v[216:219], v[60:63], a[216:219], v[216:219]
  v_accvgpr_read_b32 v231, a47
  v_mfma_f32_16x16x32_bf16 v[212:215], v[60:63], a[212:215], v[212:215]
  v_accvgpr_read_b32 v232, a60
  v_mfma_f32_16x16x32_bf16 v[208:211], v[60:63], a[208:211], v[208:211]
  ds_read_b64_tr_b16 v[60:61], v11 offset:49920
  v_accvgpr_read_b32 v233, a61
  s_waitcnt vmcnt(19) lgkmcnt(7)
  v_mfma_f32_16x16x32_bf16 v[96:99], v[32:35], a[224:227], v[96:99]
  v_accvgpr_read_b32 v234, a62
  ds_read_b64_tr_b16 v[62:63], v11 offset:54016
  v_mfma_f32_16x16x32_bf16 v[100:103], v[32:35], a[228:231], v[100:103]
  buffer_load_dwordx4 a[160:163], v20, s[16:19], s68 offen offset:2048 sc1
  v_mfma_f32_16x16x32_bf16 v[104:107], v[32:35], a[232:235], v[104:107]
  v_accvgpr_read_b32 v235, a63
  v_mfma_f32_16x16x32_bf16 v[108:111], v[32:35], a[236:239], v[108:111]
  ds_read_b64_tr_b16 v[32:33], v10 offset:57344
  v_mul_f32 v228, v228, v255
  v_mfma_f32_16x16x32_bf16 v[124:127], v[36:39], a[236:239], v[124:127]
  ds_read_b64_tr_b16 v[34:35], v10 offset:61440
  buffer_load_dwordx4 v6, s[4:7], s42 offen offset:2048 lds
  v_mul_f32 v229, v229, v255
  v_mfma_f32_16x16x32_bf16 v[120:123], v[36:39], a[232:235], v[120:123]
  v_mul_f32 v230, v230, v255
  v_mfma_f32_16x16x32_bf16 v[116:119], v[36:39], a[228:231], v[116:119]
  v_mul_f32 v231, v231, v255
  v_mfma_f32_16x16x32_bf16 v[112:115], v[36:39], a[224:227], v[112:115]
  ds_read_b64_tr_b16 v[36:37], v11 offset:57344
  v_mul_f32 v232, v232, v255
  v_mfma_f32_16x16x32_bf16 v[128:131], v[40:43], a[224:227], v[128:131]
  ds_read_b64_tr_b16 v[38:39], v11 offset:61440
  v_mul_f32 v233, v233, v255
  v_mfma_f32_16x16x32_bf16 v[132:135], v[40:43], a[228:231], v[132:135]
  buffer_load_dwordx4 a[164:167], v20, s[16:19], s69 offen offset:2048 sc1
  v_mfma_f32_16x16x32_bf16 v[136:139], v[40:43], a[232:235], v[136:139]
  v_mul_f32 v234, v234, v255
  v_mfma_f32_16x16x32_bf16 v[140:143], v[40:43], a[236:239], v[140:143]
  ds_read_b64_tr_b16 v[40:41], v10 offset:57600
  v_mul_f32 v235, v235, v255
  v_mfma_f32_16x16x32_bf16 v[156:159], v[44:47], a[236:239], v[156:159]
  ds_read_b64_tr_b16 v[42:43], v10 offset:61696
  v_cvt_pk_bf16_f32 v240, v228, v229
  v_mfma_f32_16x16x32_bf16 v[152:155], v[44:47], a[232:235], v[152:155]
  buffer_load_dwordx4 v7, s[4:7], s42 offen offset:3072 lds
  v_cvt_pk_bf16_f32 v241, v230, v231
  v_mfma_f32_16x16x32_bf16 v[148:151], v[44:47], a[228:231], v[148:151]
  v_cvt_pk_bf16_f32 v242, v232, v233
  v_mfma_f32_16x16x32_bf16 v[144:147], v[44:47], a[224:227], v[144:147]
  ds_read_b64_tr_b16 v[44:45], v11 offset:57600
  v_cvt_pk_bf16_f32 v243, v234, v235
  s_waitcnt lgkmcnt(7)
  v_mfma_f32_16x16x32_bf16 v[160:163], v[48:51], a[224:227], v[160:163]
  ds_read_b64_tr_b16 v[46:47], v11 offset:61696
  buffer_store_dwordx4 v[240:243], v20, s[16:19], s59 offen offset:1024 sc1
  v_mfma_f32_16x16x32_bf16 v[164:167], v[48:51], a[228:231], v[164:167]
  v_accvgpr_read_b32 v228, a76
  v_mfma_f32_16x16x32_bf16 v[168:171], v[48:51], a[232:235], v[168:171]
  buffer_load_dwordx4 a[168:171], v20, s[16:19], s70 offen offset:2048 sc1
  v_mfma_f32_16x16x32_bf16 v[172:175], v[48:51], a[236:239], v[172:175]
  ds_read_b64_tr_b16 v[48:49], v10 offset:57856
  v_accvgpr_read_b32 v229, a77
  v_mfma_f32_16x16x32_bf16 v[188:191], v[52:55], a[236:239], v[188:191]
  ds_read_b64_tr_b16 v[50:51], v10 offset:61952
  v_accvgpr_read_b32 v230, a78
  v_mfma_f32_16x16x32_bf16 v[184:187], v[52:55], a[232:235], v[184:187]
  s_add_u32 m0, s63, 36864
  s_add_u32 s43, s64, 1081344
  v_accvgpr_read_b32 v231, a79
  v_mfma_f32_16x16x32_bf16 v[180:183], v[52:55], a[228:231], v[180:183]
  buffer_load_dwordx4 v4, s[4:7], s43 offen offset:0 lds
  v_accvgpr_read_b32 v232, a92
  v_mfma_f32_16x16x32_bf16 v[176:179], v[52:55], a[224:227], v[176:179]
  ds_read_b64_tr_b16 v[52:53], v11 offset:57856
  v_accvgpr_read_b32 v233, a93
  v_mfma_f32_16x16x32_bf16 v[192:195], v[56:59], a[224:227], v[192:195]
  ds_read_b64_tr_b16 v[54:55], v11 offset:61952
  v_accvgpr_read_b32 v234, a94
  v_mfma_f32_16x16x32_bf16 v[196:199], v[56:59], a[228:231], v[196:199]
  v_accvgpr_read_b32 v235, a95
  v_mfma_f32_16x16x32_bf16 v[200:203], v[56:59], a[232:235], v[200:203]
  v_mul_f32 v228, v228, v255
  v_mfma_f32_16x16x32_bf16 v[204:207], v[56:59], a[236:239], v[204:207]
  ds_read_b64_tr_b16 v[56:57], v10 offset:58112
  buffer_load_dwordx4 a[172:175], v20, s[16:19], s71 offen offset:2048 sc1
  v_mfma_f32_16x16x32_bf16 v[220:223], v[60:63], a[236:239], v[220:223]
  ds_read_b64_tr_b16 v[58:59], v10 offset:62208
  v_mul_f32 v229, v229, v255
  v_mfma_f32_16x16x32_bf16 v[216:219], v[60:63], a[232:235], v[216:219]
  v_mul_f32 v230, v230, v255
  v_mfma_f32_16x16x32_bf16 v[212:215], v[60:63], a[228:231], v[212:215]
  v_mul_f32 v231, v231, v255
  v_mfma_f32_16x16x32_bf16 v[208:211], v[60:63], a[224:227], v[208:211]
  ds_read_b64_tr_b16 v[60:61], v11 offset:58112
  v_mul_f32 v232, v232, v255
  s_waitcnt vmcnt(21) lgkmcnt(7)
  v_mfma_f32_16x16x32_bf16 v[96:99], v[32:35], a[240:243], v[96:99]
  v_mul_f32 v233, v233, v255
  ds_read_b64_tr_b16 v[62:63], v11 offset:62208
  v_mfma_f32_16x16x32_bf16 v[100:103], v[32:35], a[244:247], v[100:103]
  buffer_load_dwordx4 a[176:179], v20, s[16:19], s68 offen offset:3072 sc1
  v_mfma_f32_16x16x32_bf16 v[104:107], v[32:35], a[248:251], v[104:107]
  v_mul_f32 v234, v234, v255
  v_mfma_f32_16x16x32_bf16 v[108:111], v[32:35], a[252:255], v[108:111]
  v_mul_f32 v235, v235, v255
  v_mfma_f32_16x16x32_bf16 v[124:127], v[36:39], a[252:255], v[124:127]
  buffer_load_dwordx4 v5, s[4:7], s43 offen offset:1024 lds
  v_cvt_pk_bf16_f32 v236, v228, v229
  v_mfma_f32_16x16x32_bf16 v[120:123], v[36:39], a[248:251], v[120:123]
  v_cvt_pk_bf16_f32 v237, v230, v231
  v_mfma_f32_16x16x32_bf16 v[116:119], v[36:39], a[244:247], v[116:119]
  v_cvt_pk_bf16_f32 v238, v232, v233
  v_mfma_f32_16x16x32_bf16 v[112:115], v[36:39], a[240:243], v[112:115]
  s_waitcnt vmcnt(63)
  s_barrier
  v_mfma_f32_16x16x32_bf16 v[128:131], v[40:43], a[240:243], v[128:131]
  ds_read_b64_tr_b16 v[32:33], v12 offset:0
  v_cvt_pk_bf16_f32 v239, v234, v235
  buffer_store_dwordx4 v[236:239], v20, s[16:19], s59 offen offset:2048 sc1
  v_mfma_f32_16x16x32_bf16 v[132:135], v[40:43], a[244:247], v[132:135]
  ds_read_b64_tr_b16 v[34:35], v12 offset:4096
  buffer_load_dwordx4 a[180:183], v20, s[16:19], s69 offen offset:3072 sc1
  v_mfma_f32_16x16x32_bf16 v[136:139], v[40:43], a[248:251], v[136:139]
  ds_read_b64_tr_b16 v[36:37], v13 offset:0
  v_accvgpr_read_b32 v228, a108
  v_mfma_f32_16x16x32_bf16 v[140:143], v[40:43], a[252:255], v[140:143]
  ds_read_b64_tr_b16 v[38:39], v13 offset:4096
  v_accvgpr_read_b32 v229, a109
  v_mfma_f32_16x16x32_bf16 v[156:159], v[44:47], a[252:255], v[156:159]
  ds_read_b64_tr_b16 v[40:41], v12 offset:256
  v_accvgpr_read_b32 v230, a110
  v_mfma_f32_16x16x32_bf16 v[152:155], v[44:47], a[248:251], v[152:155]
  ds_read_b64_tr_b16 v[42:43], v12 offset:4352
  buffer_load_dwordx4 v6, s[4:7], s43 offen offset:2048 lds
  v_accvgpr_read_b32 v231, a111
  v_mfma_f32_16x16x32_bf16 v[148:151], v[44:47], a[244:247], v[148:151]
  v_accvgpr_read_b32 v232, a124
  v_mfma_f32_16x16x32_bf16 v[144:147], v[44:47], a[240:243], v[144:147]
  ds_read_b64_tr_b16 v[44:45], v13 offset:256
  v_accvgpr_read_b32 v233, a125
  s_waitcnt lgkmcnt(7)
  v_mfma_f32_16x16x32_bf16 v[160:163], v[48:51], a[240:243], v[160:163]
  ds_read_b64_tr_b16 v[46:47], v13 offset:4352
  v_accvgpr_read_b32 v234, a126
  v_mfma_f32_16x16x32_bf16 v[164:167], v[48:51], a[244:247], v[164:167]
  v_accvgpr_read_b32 v235, a127
  v_mfma_f32_16x16x32_bf16 v[168:171], v[48:51], a[248:251], v[168:171]
  buffer_load_dwordx4 a[184:187], v20, s[16:19], s70 offen offset:3072 sc1
  v_mfma_f32_16x16x32_bf16 v[172:175], v[48:51], a[252:255], v[172:175]
  ds_read_b64_tr_b16 v[48:49], v12 offset:512
  v_mul_f32 v228, v228, v255
  v_mfma_f32_16x16x32_bf16 v[188:191], v[52:55], a[252:255], v[188:191]
  ds_read_b64_tr_b16 v[50:51], v12 offset:4608
  v_mul_f32 v229, v229, v255
  v_mfma_f32_16x16x32_bf16 v[184:187], v[52:55], a[248:251], v[184:187]
  v_mul_f32 v230, v230, v255
  v_mfma_f32_16x16x32_bf16 v[180:183], v[52:55], a[244:247], v[180:183]
  buffer_load_dwordx4 v7, s[4:7], s43 offen offset:3072 lds
  v_mul_f32 v231, v231, v255
  v_mfma_f32_16x16x32_bf16 v[176:179], v[52:55], a[240:243], v[176:179]
  ds_read_b64_tr_b16 v[52:53], v13 offset:512
  v_mul_f32 v232, v232, v255
  v_mfma_f32_16x16x32_bf16 v[192:195], v[56:59], a[240:243], v[192:195]
  ds_read_b64_tr_b16 v[54:55], v13 offset:4608
  v_mul_f32 v233, v233, v255
  v_mfma_f32_16x16x32_bf16 v[196:199], v[56:59], a[244:247], v[196:199]
  v_mul_f32 v234, v234, v255
  v_mfma_f32_16x16x32_bf16 v[200:203], v[56:59], a[248:251], v[200:203]
  v_mul_f32 v235, v235, v255
  v_mfma_f32_16x16x32_bf16 v[204:207], v[56:59], a[252:255], v[204:207]
  ds_read_b64_tr_b16 v[56:57], v12 offset:768
  buffer_load_dwordx4 a[188:191], v20, s[16:19], s71 offen offset:3072 sc1
  v_mfma_f32_16x16x32_bf16 v[220:223], v[60:63], a[252:255], v[220:223]
  ds_read_b64_tr_b16 v[58:59], v12 offset:4864
  v_cvt_pk_bf16_f32 v240, v228, v229
  v_mfma_f32_16x16x32_bf16 v[216:219], v[60:63], a[248:251], v[216:219]
  v_cvt_pk_bf16_f32 v241, v230, v231
  v_mfma_f32_16x16x32_bf16 v[212:215], v[60:63], a[244:247], v[212:215]
  v_cvt_pk_bf16_f32 v242, v232, v233
  v_mfma_f32_16x16x32_bf16 v[208:211], v[60:63], a[240:243], v[208:211]
  ds_read_b64_tr_b16 v[60:61], v13 offset:768
  v_cvt_pk_bf16_f32 v243, v234, v235
  buffer_store_dwordx4 v[240:243], v20, s[16:19], s59 offen offset:3072 sc1
  s_waitcnt vmcnt(25) lgkmcnt(7)
  v_mfma_f32_16x16x32_bf16 v[96:99], v[32:35], a[128:131], v[96:99]
  ds_read_b64_tr_b16 v[62:63], v13 offset:4864
  v_mfma_f32_16x16x32_bf16 v[100:103], v[32:35], a[132:135], v[100:103]
  s_add_u32 s68, s66, 16384
  v_mfma_f32_16x16x32_bf16 v[104:107], v[32:35], a[136:139], v[104:107]
  buffer_load_dwordx4 a[192:195], v20, s[16:19], s68 offen offset:0 sc1
  v_mfma_f32_16x16x32_bf16 v[108:111], v[32:35], a[140:143], v[108:111]
  ds_read_b64_tr_b16 v[32:33], v12 offset:8192
  ds_read_b64_tr_b16 v[34:35], v12 offset:12288
  v_mfma_f32_16x16x32_bf16 v[124:127], v[36:39], a[140:143], v[124:127]
  s_add_u32 m0, s63, 65536
  s_add_u32 s42, s64, 1310720
  v_mfma_f32_16x16x32_bf16 v[120:123], v[36:39], a[136:139], v[120:123]
  buffer_load_dwordx4 v4, s[4:7], s42 offen offset:0 lds
  v_mfma_f32_16x16x32_bf16 v[116:119], v[36:39], a[132:135], v[116:119]
  s_add_u32 s69, s66, 131328
  v_mfma_f32_16x16x32_bf16 v[112:115], v[36:39], a[128:131], v[112:115]
  ds_read_b64_tr_b16 v[36:37], v13 offset:8192
  buffer_load_dwordx4 a[196:199], v20, s[16:19], s69 offen offset:0 sc1
  v_mfma_f32_16x16x32_bf16 v[128:131], v[40:43], a[128:131], v[128:131]
  ds_read_b64_tr_b16 v[38:39], v13 offset:12288
  v_mfma_f32_16x16x32_bf16 v[132:135], v[40:43], a[132:135], v[132:135]
  s_add_u32 s70, s66, 246272
  v_mfma_f32_16x16x32_bf16 v[136:139], v[40:43], a[136:139], v[136:139]
  buffer_load_dwordx4 a[200:203], v20, s[16:19], s70 offen offset:0 sc1
  v_mfma_f32_16x16x32_bf16 v[140:143], v[40:43], a[140:143], v[140:143]
  ds_read_b64_tr_b16 v[40:41], v12 offset:8448
  v_mfma_f32_16x16x32_bf16 v[156:159], v[44:47], a[140:143], v[156:159]
  ds_read_b64_tr_b16 v[42:43], v12 offset:12544
  buffer_load_dwordx4 v5, s[4:7], s42 offen offset:1024 lds
  v_mfma_f32_16x16x32_bf16 v[152:155], v[44:47], a[136:139], v[152:155]
  s_add_u32 s71, s66, 361216
  v_mfma_f32_16x16x32_bf16 v[148:151], v[44:47], a[132:135], v[148:151]
  buffer_load_dwordx4 a[204:207], v20, s[16:19], s71 offen offset:0 sc1
  v_mfma_f32_16x16x32_bf16 v[144:147], v[44:47], a[128:131], v[144:147]
  s_waitcnt lgkmcnt(6)
  v_mfma_f32_16x16x32_bf16 v[160:163], v[48:51], a[128:131], v[160:163]
  ds_read_b64_tr_b16 v[44:45], v13 offset:8448
  v_mfma_f32_16x16x32_bf16 v[164:167], v[48:51], a[132:135], v[164:167]
  ds_read_b64_tr_b16 v[46:47], v13 offset:12544
  v_mfma_f32_16x16x32_bf16 v[168:171], v[48:51], a[136:139], v[168:171]
  buffer_load_dwordx4 a[208:211], v20, s[16:19], s68 offen offset:1024 sc1
  v_mfma_f32_16x16x32_bf16 v[172:175], v[48:51], a[140:143], v[172:175]
  ds_read_b64_tr_b16 v[48:49], v12 offset:8704
  v_mfma_f32_16x16x32_bf16 v[188:191], v[52:55], a[140:143], v[188:191]
  ds_read_b64_tr_b16 v[50:51], v12 offset:12800
  v_mfma_f32_16x16x32_bf16 v[184:187], v[52:55], a[136:139], v[184:187]
  buffer_load_dwordx4 v6, s[4:7], s42 offen offset:2048 lds
  v_mfma_f32_16x16x32_bf16 v[180:183], v[52:55], a[132:135], v[180:183]
  buffer_load_dwordx4 a[212:215], v20, s[16:19], s69 offen offset:1024 sc1
  v_mfma_f32_16x16x32_bf16 v[176:179], v[52:55], a[128:131], v[176:179]
  ds_read_b64_tr_b16 v[52:53], v13 offset:8704
  v_mfma_f32_16x16x32_bf16 v[192:195], v[56:59], a[128:131], v[192:195]
  ds_read_b64_tr_b16 v[54:55], v13 offset:12800
  v_mfma_f32_16x16x32_bf16 v[196:199], v[56:59], a[132:135], v[196:199]
  buffer_load_dwordx4 a[216:219], v20, s[16:19], s70 offen offset:1024 sc1
  v_mfma_f32_16x16x32_bf16 v[200:203], v[56:59], a[136:139], v[200:203]
  buffer_load_dwordx4 v7, s[4:7], s42 offen offset:3072 lds
  v_mfma_f32_16x16x32_bf16 v[204:207], v[56:59], a[140:143], v[204:207]
  ds_read_b64_tr_b16 v[56:57], v12 offset:8960
  v_mfma_f32_16x16x32_bf16 v[220:223], v[60:63], a[140:143], v[220:223]
  ds_read_b64_tr_b16 v[58:59], v12 offset:13056
  v_mfma_f32_16x16x32_bf16 v[216:219], v[60:63], a[136:139], v[216:219]
  buffer_load_dwordx4 a[220:223], v20, s[16:19], s71 offen offset:1024 sc1
  v_mfma_f32_16x16x32_bf16 v[212:215], v[60:63], a[132:135], v[212:215]
  v_mfma_f32_16x16x32_bf16 v[208:211], v[60:63], a[128:131], v[208:211]
  s_waitcnt vmcnt(29) lgkmcnt(6)
  v_mfma_f32_16x16x32_bf16 v[96:99], v[32:35], a[144:147], v[96:99]
  ds_read_b64_tr_b16 v[60:61], v13 offset:8960
  v_mfma_f32_16x16x32_bf16 v[100:103], v[32:35], a[148:151], v[100:103]
  ds_read_b64_tr_b16 v[62:63], v13 offset:13056
  v_mfma_f32_16x16x32_bf16 v[104:107], v[32:35], a[152:155], v[104:107]
  buffer_load_dwordx4 a[224:227], v20, s[16:19], s68 offen offset:2048 sc1
  v_mfma_f32_16x16x32_bf16 v[108:111], v[32:35], a[156:159], v[108:111]
  ds_read_b64_tr_b16 v[32:33], v12 offset:16384
  ds_read_b64_tr_b16 v[34:35], v12 offset:20480
  v_mfma_f32_16x16x32_bf16 v[124:127], v[36:39], a[156:159], v[124:127]
  s_add_u32 m0, s63, 69632
  s_add_u32 s43, s64, 1343488
  v_mfma_f32_16x16x32_bf16 v[120:123], v[36:39], a[152:155], v[120:123]
  buffer_load_dwordx4 v4, s[4:7], s43 offen offset:0 lds
  v_mfma_f32_16x16x32_bf16 v[116:119], v[36:39], a[148:151], v[116:119]
  v_mfma_f32_16x16x32_bf16 v[112:115], v[36:39], a[144:147], v[112:115]
  ds_read_b64_tr_b16 v[36:37], v13 offset:16384
  v_mfma_f32_16x16x32_bf16 v[128:131], v[40:43], a[144:147], v[128:131]
  ds_read_b64_tr_b16 v[38:39], v13 offset:20480
  v_mfma_f32_16x16x32_bf16 v[132:135], v[40:43], a[148:151], v[132:135]
  buffer_load_dwordx4 a[228:231], v20, s[16:19], s69 offen offset:2048 sc1
  v_mfma_f32_16x16x32_bf16 v[136:139], v[40:43], a[152:155], v[136:139]
  v_mfma_f32_16x16x32_bf16 v[140:143], v[40:43], a[156:159], v[140:143]
  ds_read_b64_tr_b16 v[40:41], v12 offset:16640
  v_mfma_f32_16x16x32_bf16 v[156:159], v[44:47], a[156:159], v[156:159]
  ds_read_b64_tr_b16 v[42:43], v12 offset:20736
  v_mfma_f32_16x16x32_bf16 v[152:155], v[44:47], a[152:155], v[152:155]
  buffer_load_dwordx4 v5, s[4:7], s43 offen offset:1024 lds
  v_mfma_f32_16x16x32_bf16 v[148:151], v[44:47], a[148:151], v[148:151]
  v_mfma_f32_16x16x32_bf16 v[144:147], v[44:47], a[144:147], v[144:147]
  s_waitcnt lgkmcnt(6)
  v_mfma_f32_16x16x32_bf16 v[160:163], v[48:51], a[144:147], v[160:163]
  ds_read_b64_tr_b16 v[44:45], v13 offset:16640
  v_mfma_f32_16x16x32_bf16 v[164:167], v[48:51], a[148:151], v[164:167]
  ds_read_b64_tr_b16 v[46:47], v13 offset:20736
  v_mfma_f32_16x16x32_bf16 v[168:171], v[48:51], a[152:155], v[168:171]
  buffer_load_dwordx4 a[232:235], v20, s[16:19], s70 offen offset:2048 sc1
  v_mfma_f32_16x16x32_bf16 v[172:175], v[48:51], a[156:159], v[172:175]
  ds_read_b64_tr_b16 v[48:49], v12 offset:16896
  v_mfma_f32_16x16x32_bf16 v[188:191], v[52:55], a[156:159], v[188:191]
  ds_read_b64_tr_b16 v[50:51], v12 offset:20992
  v_mfma_f32_16x16x32_bf16 v[184:187], v[52:55], a[152:155], v[184:187]
  buffer_load_dwordx4 v6, s[4:7], s43 offen offset:2048 lds
  v_mfma_f32_16x16x32_bf16 v[180:183], v[52:55], a[148:151], v[180:183]
  v_mfma_f32_16x16x32_bf16 v[176:179], v[52:55], a[144:147], v[176:179]
  ds_read_b64_tr_b16 v[52:53], v13 offset:16896
  v_mfma_f32_16x16x32_bf16 v[192:195], v[56:59], a[144:147], v[192:195]
  ds_read_b64_tr_b16 v[54:55], v13 offset:20992
  v_mfma_f32_16x16x32_bf16 v[196:199], v[56:59], a[148:151], v[196:199]
  buffer_load_dwordx4 a[236:239], v20, s[16:19], s71 offen offset:2048 sc1
  v_mfma_f32_16x16x32_bf16 v[200:203], v[56:59], a[152:155], v[200:203]
  v_mfma_f32_16x16x32_bf16 v[204:207], v[56:59], a[156:159], v[204:207]
  ds_read_b64_tr_b16 v[56:57], v12 offset:17152
  v_mfma_f32_16x16x32_bf16 v[220:223], v[60:63], a[156:159], v[220:223]
  ds_read_b64_tr_b16 v[58:59], v12 offset:21248
  v_mfma_f32_16x16x32_bf16 v[216:219], v[60:63], a[152:155], v[216:219]
  buffer_load_dwordx4 v7, s[4:7], s43 offen offset:3072 lds
  v_mfma_f32_16x16x32_bf16 v[212:215], v[60:63], a[148:151], v[212:215]
  v_mfma_f32_16x16x32_bf16 v[208:211], v[60:63], a[144:147], v[208:211]
  s_waitcnt vmcnt(29) lgkmcnt(6)
  v_mfma_f32_16x16x32_bf16 v[96:99], v[32:35], a[160:163], v[96:99]
  ds_read_b64_tr_b16 v[60:61], v13 offset:17152
  v_mfma_f32_16x16x32_bf16 v[100:103], v[32:35], a[164:167], v[100:103]
  ds_read_b64_tr_b16 v[62:63], v13 offset:21248
  v_mfma_f32_16x16x32_bf16 v[104:107], v[32:35], a[168:171], v[104:107]
  buffer_load_dwordx4 a[240:243], v20, s[16:19], s68 offen offset:3072 sc1
  v_mfma_f32_16x16x32_bf16 v[108:111], v[32:35], a[172:175], v[108:111]
  ds_read_b64_tr_b16 v[32:33], v12 offset:24576
  ds_read_b64_tr_b16 v[34:35], v12 offset:28672
  v_mfma_f32_16x16x32_bf16 v[124:127], v[36:39], a[172:175], v[124:127]
  s_add_u32 m0, s63, 0
  s_add_u32 s42, s64, 1572864
  v_mfma_f32_16x16x32_bf16 v[120:123], v[36:39], a[168:171], v[120:123]
  buffer_load_dwordx4 v4, s[4:7], s42 offen offset:0 lds
  v_mfma_f32_16x16x32_bf16 v[116:119], v[36:39], a[164:167], v[116:119]
  v_mfma_f32_16x16x32_bf16 v[112:115], v[36:39], a[160:163], v[112:115]
  ds_read_b64_tr_b16 v[36:37], v13 offset:24576
  v_mfma_f32_16x16x32_bf16 v[128:131], v[40:43], a[160:163], v[128:131]
  ds_read_b64_tr_b16 v[38:39], v13 offset:28672
  v_mfma_f32_16x16x32_bf16 v[132:135], v[40:43], a[164:167], v[132:135]
  buffer_load_dwordx4 a[244:247], v20, s[16:19], s69 offen offset:3072 sc1
  v_mfma_f32_16x16x32_bf16 v[136:139], v[40:43], a[168:171], v[136:139]
  v_mfma_f32_16x16x32_bf16 v[140:143], v[40:43], a[172:175], v[140:143]
  ds_read_b64_tr_b16 v[40:41], v12 offset:24832
  v_mfma_f32_16x16x32_bf16 v[156:159], v[44:47], a[172:175], v[156:159]
  ds_read_b64_tr_b16 v[42:43], v12 offset:28928
  v_mfma_f32_16x16x32_bf16 v[152:155], v[44:47], a[168:171], v[152:155]
  buffer_load_dwordx4 v5, s[4:7], s42 offen offset:1024 lds
  v_mfma_f32_16x16x32_bf16 v[148:151], v[44:47], a[164:167], v[148:151]
  v_mfma_f32_16x16x32_bf16 v[144:147], v[44:47], a[160:163], v[144:147]
  s_waitcnt lgkmcnt(6)
  v_mfma_f32_16x16x32_bf16 v[160:163], v[48:51], a[160:163], v[160:163]
  ds_read_b64_tr_b16 v[44:45], v13 offset:24832
  v_mfma_f32_16x16x32_bf16 v[164:167], v[48:51], a[164:167], v[164:167]
  ds_read_b64_tr_b16 v[46:47], v13 offset:28928
  v_mfma_f32_16x16x32_bf16 v[168:171], v[48:51], a[168:171], v[168:171]
  buffer_load_dwordx4 a[248:251], v20, s[16:19], s70 offen offset:3072 sc1
  v_mfma_f32_16x16x32_bf16 v[172:175], v[48:51], a[172:175], v[172:175]
  ds_read_b64_tr_b16 v[48:49], v12 offset:25088
  v_mfma_f32_16x16x32_bf16 v[188:191], v[52:55], a[172:175], v[188:191]
  ds_read_b64_tr_b16 v[50:51], v12 offset:29184
  v_mfma_f32_16x16x32_bf16 v[184:187], v[52:55], a[168:171], v[184:187]
  buffer_load_dwordx4 v6, s[4:7], s42 offen offset:2048 lds
  v_mfma_f32_16x16x32_bf16 v[180:183], v[52:55], a[164:167], v[180:183]
  v_mfma_f32_16x16x32_bf16 v[176:179], v[52:55], a[160:163], v[176:179]
  ds_read_b64_tr_b16 v[52:53], v13 offset:25088
  v_mfma_f32_16x16x32_bf16 v[192:195], v[56:59], a[160:163], v[192:195]
  ds_read_b64_tr_b16 v[54:55], v13 offset:29184
  v_mfma_f32_16x16x32_bf16 v[196:199], v[56:59], a[164:167], v[196:199]
  buffer_load_dwordx4 a[252:255], v20, s[16:19], s71 offen offset:3072 sc1
  v_mfma_f32_16x16x32_bf16 v[200:203], v[56:59], a[168:171], v[200:203]
  v_mfma_f32_16x16x32_bf16 v[204:207], v[56:59], a[172:175], v[204:207]
  ds_read_b64_tr_b16 v[56:57], v12 offset:25344
  v_mfma_f32_16x16x32_bf16 v[220:223], v[60:63], a[172:175], v[220:223]
  ds_read_b64_tr_b16 v[58:59], v12 offset:29440
  v_mfma_f32_16x16x32_bf16 v[216:219], v[60:63], a[168:171], v[216:219]
  buffer_load_dwordx4 v7, s[4:7], s42 offen offset:3072 lds
  v_mfma_f32_16x16x32_bf16 v[212:215], v[60:63], a[164:167], v[212:215]
  v_mfma_f32_16x16x32_bf16 v[208:211], v[60:63], a[160:163], v[208:211]
  s_waitcnt vmcnt(29) lgkmcnt(6)
  v_mfma_f32_16x16x32_bf16 v[96:99], v[32:35], a[176:179], v[96:99]
  ds_read_b64_tr_b16 v[60:61], v13 offset:25344
  ds_read_b64_tr_b16 v[62:63], v13 offset:29440
  v_mfma_f32_16x16x32_bf16 v[100:103], v[32:35], a[180:183], v[100:103]
  s_add_u32 s68, s66, 20480
  v_mfma_f32_16x16x32_bf16 v[104:107], v[32:35], a[184:187], v[104:107]
  buffer_load_dwordx4 a[128:131], v20, s[16:19], s68 offen offset:0 sc1
  v_mfma_f32_16x16x32_bf16 v[108:111], v[32:35], a[188:191], v[108:111]
  s_add_u32 m0, s63, 4096
  s_add_u32 s43, s64, 1605632
  v_mfma_f32_16x16x32_bf16 v[124:127], v[36:39], a[188:191], v[124:127]
  buffer_load_dwordx4 v4, s[4:7], s43 offen offset:0 lds
  v_mfma_f32_16x16x32_bf16 v[120:123], v[36:39], a[184:187], v[120:123]
  v_mfma_f32_16x16x32_bf16 v[116:119], v[36:39], a[180:183], v[116:119]
  v_mfma_f32_16x16x32_bf16 v[112:115], v[36:39], a[176:179], v[112:115]
  s_waitcnt vmcnt(32)
  s_barrier
  v_mfma_f32_16x16x32_bf16 v[128:131], v[40:43], a[176:179], v[128:131]
  ds_read_b64_tr_b16 v[32:33], v8 offset:32768
  ds_read_b64_tr_b16 v[34:35], v8 offset:36864
  v_mfma_f32_16x16x32_bf16 v[132:135], v[40:43], a[180:183], v[132:135]
  ds_read_b64_tr_b16 v[36:37], v9 offset:32768
  ds_read_b64_tr_b16 v[38:39], v9 offset:36864
  v_mfma_f32_16x16x32_bf16 v[136:139], v[40:43], a[184:187], v[136:139]
  s_add_u32 s69, s66, 135424
  v_mfma_f32_16x16x32_bf16 v[140:143], v[40:43], a[188:191], v[140:143]
  ds_read_b64_tr_b16 v[40:41], v8 offset:33024
  v_mfma_f32_16x16x32_bf16 v[156:159], v[44:47], a[188:191], v[156:159]
  ds_read_b64_tr_b16 v[42:43], v8 offset:37120
  v_mfma_f32_16x16x32_bf16 v[152:155], v[44:47], a[184:187], v[152:155]
  buffer_load_dwordx4 a[132:135], v20, s[16:19], s69 offen offset:0 sc1
  v_mfma_f32_16x16x32_bf16 v[148:151], v[44:47], a[180:183], v[148:151]
  buffer_load_dwordx4 v5, s[4:7], s43 offen offset:1024 lds
  v_mfma_f32_16x16x32_bf16 v[144:147], v[44:47], a[176:179], v[144:147]
  ds_read_b64_tr_b16 v[44:45], v9 offset:33024
  s_waitcnt lgkmcnt(7)
  v_mfma_f32_16x16x32_bf16 v[160:163], v[48:51], a[176:179], v[160:163]
  ds_read_b64_tr_b16 v[46:47], v9 offset:37120
  v_mfma_f32_16x16x32_bf16 v[164:167], v[48:51], a[180:183], v[164:167]
  s_add_u32 s70, s66, 250368
  v_mfma_f32_16x16x32_bf16 v[168:171], v[48:51], a[184:187], v[168:171]
  buffer_load_dwordx4 a[136:139], v20, s[16:19], s70 offen offset:0 sc1
  v_mfma_f32_16x16x32_bf16 v[172:175], v[48:51], a[188:191], v[172:175]
  ds_read_b64_tr_b16 v[48:49], v8 offset:33280
  v_mfma_f32_16x16x32_bf16 v[188:191], v[52:55], a[188:191], v[188:191]
  ds_read_b64_tr_b16 v[50:51], v8 offset:37376
  v_mfma_f32_16x16x32_bf16 v[184:187], v[52:55], a[184:187], v[184:187]
  buffer_load_dwordx4 v6, s[4:7], s43 offen offset:2048 lds
  v_mfma_f32_16x16x32_bf16 v[180:183], v[52:55], a[180:183], v[180:183]
  v_mfma_f32_16x16x32_bf16 v[176:179], v[52:55], a[176:179], v[176:179]
  ds_read_b64_tr_b16 v[52:53], v9 offset:33280
  ds_read_b64_tr_b16 v[54:55], v9 offset:37376
  v_mfma_f32_16x16x32_bf16 v[192:195], v[56:59], a[176:179], v[192:195]
  s_add_u32 s71, s66, 365312
  v_mfma_f32_16x16x32_bf16 v[196:199], v[56:59], a[180:183], v[196:199]
  buffer_load_dwordx4 a[140:143], v20, s[16:19], s71 offen offset:0 sc1
  v_mfma_f32_16x16x32_bf16 v[200:203], v[56:59], a[184:187], v[200:203]
  v_mfma_f32_16x16x32_bf16 v[204:207], v[56:59], a[188:191], v[204:207]
  ds_read_b64_tr_b16 v[56:57], v8 offset:33536
  v_mfma_f32_16x16x32_bf16 v[220:223], v[60:63], a[188:191], v[220:223]
  ds_read_b64_tr_b16 v[58:59], v8 offset:37632
  v_mfma_f32_16x16x32_bf16 v[216:219], v[60:63], a[184:187], v[216:219]
  buffer_load_dwordx4 v7, s[4:7], s43 offen offset:3072 lds
  v_mfma_f32_16x16x32_bf16 v[212:215], v[60:63], a[180:183], v[212:215]
  v_mfma_f32_16x16x32_bf16 v[208:211], v[60:63], a[176:179], v[208:211]
  s_waitcnt vmcnt(30) lgkmcnt(6)
  v_mfma_f32_16x16x32_bf16 v[96:99], v[32:35], a[192:195], v[96:99]
  ds_read_b64_tr_b16 v[60:61], v9 offset:33536
  v_mfma_f32_16x16x32_bf16 v[100:103], v[32:35], a[196:199], v[100:103]
  ds_read_b64_tr_b16 v[62:63], v9 offset:37632
  v_mfma_f32_16x16x32_bf16 v[104:107], v[32:35], a[200:203], v[104:107]
  buffer_load_dwordx4 a[144:147], v20, s[16:19], s68 offen offset:1024 sc1
  v_mfma_f32_16x16x32_bf16 v[108:111], v[32:35], a[204:207], v[108:111]
  ds_read_b64_tr_b16 v[32:33], v8 offset:40960
  v_mfma_f32_16x16x32_bf16 v[124:127], v[36:39], a[204:207], v[124:127]
  ds_read_b64_tr_b16 v[34:35], v8 offset:45056
  v_mfma_f32_16x16x32_bf16 v[120:123], v[36:39], a[200:203], v[120:123]
  s_add_u32 s72, s72, 65536
  s_add_u32 s73, s73, 65536
  s_waitcnt vmcnt(37)
  buffer_store_dword v26, v23, s[16:19], s72 offen offset:0 sc1
  v_mfma_f32_16x16x32_bf16 v[116:119], v[36:39], a[196:199], v[116:119]
  s_add_u32 m0, s63, 98304
  s_add_u32 s42, s65, 0
  v_mfma_f32_16x16x32_bf16 v[112:115], v[36:39], a[192:195], v[112:115]
  ds_read_b64_tr_b16 v[36:37], v9 offset:40960
  v_mfma_f32_16x16x32_bf16 v[128:131], v[40:43], a[192:195], v[128:131]
  ds_read_b64_tr_b16 v[38:39], v9 offset:45056
  v_mfma_f32_16x16x32_bf16 v[132:135], v[40:43], a[196:199], v[132:135]
  buffer_load_dwordx4 v4, s[8:11], s42 offen offset:0 lds
  v_mfma_f32_16x16x32_bf16 v[136:139], v[40:43], a[200:203], v[136:139]
  buffer_load_dwordx4 a[148:151], v20, s[16:19], s69 offen offset:1024 sc1
  v_mfma_f32_16x16x32_bf16 v[140:143], v[40:43], a[204:207], v[140:143]
  ds_read_b64_tr_b16 v[40:41], v8 offset:41216
  v_mfma_f32_16x16x32_bf16 v[156:159], v[44:47], a[204:207], v[156:159]
  ds_read_b64_tr_b16 v[42:43], v8 offset:45312
  v_mfma_f32_16x16x32_bf16 v[152:155], v[44:47], a[200:203], v[152:155]
  buffer_load_dwordx4 v5, s[8:11], s42 offen offset:1024 lds
  v_mfma_f32_16x16x32_bf16 v[148:151], v[44:47], a[196:199], v[148:151]
  v_mfma_f32_16x16x32_bf16 v[144:147], v[44:47], a[192:195], v[144:147]
  s_waitcnt lgkmcnt(6)
  v_mfma_f32_16x16x32_bf16 v[160:163], v[48:51], a[192:195], v[160:163]
  ds_read_b64_tr_b16 v[44:45], v9 offset:41216
  v_mfma_f32_16x16x32_bf16 v[164:167], v[48:51], a[196:199], v[164:167]
  ds_read_b64_tr_b16 v[46:47], v9 offset:45312
  v_mfma_f32_16x16x32_bf16 v[168:171], v[48:51], a[200:203], v[168:171]
  buffer_load_dwordx4 a[152:155], v20, s[16:19], s70 offen offset:1024 sc1
  v_mfma_f32_16x16x32_bf16 v[172:175], v[48:51], a[204:207], v[172:175]
  ds_read_b64_tr_b16 v[48:49], v8 offset:41472
  v_mfma_f32_16x16x32_bf16 v[188:191], v[52:55], a[204:207], v[188:191]
  ds_read_b64_tr_b16 v[50:51], v8 offset:45568
  v_mfma_f32_16x16x32_bf16 v[184:187], v[52:55], a[200:203], v[184:187]
  buffer_load_dword v251, v24, s[32:35], s3 offen
  v_mfma_f32_16x16x32_bf16 v[180:183], v[52:55], a[196:199], v[180:183]
  buffer_load_dwordx4 v6, s[8:11], s42 offen offset:2048 lds
  v_mfma_f32_16x16x32_bf16 v[176:179], v[52:55], a[192:195], v[176:179]
  ds_read_b64_tr_b16 v[52:53], v9 offset:41472
  v_mfma_f32_16x16x32_bf16 v[192:195], v[56:59], a[192:195], v[192:195]
  ds_read_b64_tr_b16 v[54:55], v9 offset:45568
  v_mfma_f32_16x16x32_bf16 v[196:199], v[56:59], a[196:199], v[196:199]
  buffer_load_dwordx4 a[156:159], v20, s[16:19], s71 offen offset:1024 sc1
  v_mfma_f32_16x16x32_bf16 v[200:203], v[56:59], a[200:203], v[200:203]
  v_mfma_f32_16x16x32_bf16 v[204:207], v[56:59], a[204:207], v[204:207]
  ds_read_b64_tr_b16 v[56:57], v8 offset:41728
  v_mfma_f32_16x16x32_bf16 v[220:223], v[60:63], a[204:207], v[220:223]
  ds_read_b64_tr_b16 v[58:59], v8 offset:45824
  v_mfma_f32_16x16x32_bf16 v[216:219], v[60:63], a[200:203], v[216:219]
  buffer_load_dwordx4 v7, s[8:11], s42 offen offset:3072 lds
  v_mfma_f32_16x16x32_bf16 v[212:215], v[60:63], a[196:199], v[212:215]
  v_mfma_f32_16x16x32_bf16 v[208:211], v[60:63], a[192:195], v[208:211]
  s_waitcnt vmcnt(34) lgkmcnt(6)
  v_mfma_f32_16x16x32_bf16 v[96:99], v[32:35], a[208:211], v[96:99]
  ds_read_b64_tr_b16 v[60:61], v9 offset:41728
  v_mfma_f32_16x16x32_bf16 v[100:103], v[32:35], a[212:215], v[100:103]
  ds_read_b64_tr_b16 v[62:63], v9 offset:45824
  v_mfma_f32_16x16x32_bf16 v[104:107], v[32:35], a[216:219], v[104:107]
  buffer_load_dwordx4 a[160:163], v20, s[16:19], s68 offen offset:2048 sc1
  v_mfma_f32_16x16x32_bf16 v[108:111], v[32:35], a[220:223], v[108:111]
  ds_read_b64_tr_b16 v[32:33], v8 offset:49152
  ds_read_b64_tr_b16 v[34:35], v8 offset:53248
  v_mfma_f32_16x16x32_bf16 v[124:127], v[36:39], a[220:223], v[124:127]
  s_add_u32 m0, s63, 102400
  s_add_u32 s43, s65, 32768
  v_mfma_f32_16x16x32_bf16 v[120:123], v[36:39], a[216:219], v[120:123]
  buffer_load_dwordx4 v4, s[8:11], s43 offen offset:0 lds
  v_mfma_f32_16x16x32_bf16 v[116:119], v[36:39], a[212:215], v[116:119]
  v_mfma_f32_16x16x32_bf16 v[112:115], v[36:39], a[208:211], v[112:115]
  ds_read_b64_tr_b16 v[36:37], v9 offset:49152
  v_mfma_f32_16x16x32_bf16 v[128:131], v[40:43], a[208:211], v[128:131]
  ds_read_b64_tr_b16 v[38:39], v9 offset:53248
  v_mfma_f32_16x16x32_bf16 v[132:135], v[40:43], a[212:215], v[132:135]
  buffer_load_dwordx4 a[164:167], v20, s[16:19], s69 offen offset:2048 sc1
  v_mfma_f32_16x16x32_bf16 v[136:139], v[40:43], a[216:219], v[136:139]
  v_mfma_f32_16x16x32_bf16 v[140:143], v[40:43], a[220:223], v[140:143]
  ds_read_b64_tr_b16 v[40:41], v8 offset:49408
  v_mfma_f32_16x16x32_bf16 v[156:159], v[44:47], a[220:223], v[156:159]
  ds_read_b64_tr_b16 v[42:43], v8 offset:53504
  v_mfma_f32_16x16x32_bf16 v[152:155], v[44:47], a[216:219], v[152:155]
  buffer_load_dwordx4 v5, s[8:11], s43 offen offset:1024 lds
  v_mfma_f32_16x16x32_bf16 v[148:151], v[44:47], a[212:215], v[148:151]
  v_mfma_f32_16x16x32_bf16 v[144:147], v[44:47], a[208:211], v[144:147]
  s_waitcnt lgkmcnt(6)
  v_mfma_f32_16x16x32_bf16 v[160:163], v[48:51], a[208:211], v[160:163]
  ds_read_b64_tr_b16 v[44:45], v9 offset:49408
  v_mfma_f32_16x16x32_bf16 v[164:167], v[48:51], a[212:215], v[164:167]
  ds_read_b64_tr_b16 v[46:47], v9 offset:53504
  v_mfma_f32_16x16x32_bf16 v[168:171], v[48:51], a[216:219], v[168:171]
  buffer_load_dwordx4 a[168:171], v20, s[16:19], s70 offen offset:2048 sc1
  v_mfma_f32_16x16x32_bf16 v[172:175], v[48:51], a[220:223], v[172:175]
  ds_read_b64_tr_b16 v[48:49], v8 offset:49664
  v_mfma_f32_16x16x32_bf16 v[188:191], v[52:55], a[220:223], v[188:191]
  ds_read_b64_tr_b16 v[50:51], v8 offset:53760
  v_mfma_f32_16x16x32_bf16 v[184:187], v[52:55], a[216:219], v[184:187]
  buffer_load_dwordx4 v6, s[8:11], s43 offen offset:2048 lds
  v_mfma_f32_16x16x32_bf16 v[180:183], v[52:55], a[212:215], v[180:183]
  v_mfma_f32_16x16x32_bf16 v[176:179], v[52:55], a[208:211], v[176:179]
  ds_read_b64_tr_b16 v[52:53], v9 offset:49664
  v_mfma_f32_16x16x32_bf16 v[192:195], v[56:59], a[208:211], v[192:195]
  ds_read_b64_tr_b16 v[54:55], v9 offset:53760
  v_mfma_f32_16x16x32_bf16 v[196:199], v[56:59], a[212:215], v[196:199]
  buffer_load_dwordx4 a[172:175], v20, s[16:19], s71 offen offset:2048 sc1
  v_mfma_f32_16x16x32_bf16 v[200:203], v[56:59], a[216:219], v[200:203]
  v_mfma_f32_16x16x32_bf16 v[204:207], v[56:59], a[220:223], v[204:207]
  ds_read_b64_tr_b16 v[56:57], v8 offset:49920
  v_mfma_f32_16x16x32_bf16 v[220:223], v[60:63], a[220:223], v[220:223]
  ds_read_b64_tr_b16 v[58:59], v8 offset:54016
  v_mfma_f32_16x16x32_bf16 v[216:219], v[60:63], a[216:219], v[216:219]
  buffer_load_dwordx4 v7, s[8:11], s43 offen offset:3072 lds
  v_mfma_f32_16x16x32_bf16 v[212:215], v[60:63], a[212:215], v[212:215]
  v_mfma_f32_16x16x32_bf16 v[208:211], v[60:63], a[208:211], v[208:211]
  s_waitcnt vmcnt(35) lgkmcnt(6)
  v_mfma_f32_16x16x32_bf16 v[96:99], v[32:35], a[224:227], v[96:99]
  ds_read_b64_tr_b16 v[60:61], v9 offset:49920
  v_mfma_f32_16x16x32_bf16 v[100:103], v[32:35], a[228:231], v[100:103]
  ds_read_b64_tr_b16 v[62:63], v9 offset:54016
  v_mfma_f32_16x16x32_bf16 v[104:107], v[32:35], a[232:235], v[104:107]
  buffer_load_dwordx4 a[176:179], v20, s[16:19], s68 offen offset:3072 sc1
  v_mfma_f32_16x16x32_bf16 v[108:111], v[32:35], a[236:239], v[108:111]
  ds_read_b64_tr_b16 v[32:33], v8 offset:57344
  v_mfma_f32_16x16x32_bf16 v[124:127], v[36:39], a[236:239], v[124:127]
  ds_read_b64_tr_b16 v[34:35], v8 offset:61440
  v_mfma_f32_16x16x32_bf16 v[120:123], v[36:39], a[232:235], v[120:123]
  v_mfma_f32_16x16x32_bf16 v[116:119], v[36:39], a[228:231], v[116:119]
  v_mfma_f32_16x16x32_bf16 v[112:115], v[36:39], a[224:227], v[112:115]
  ds_read_b64_tr_b16 v[36:37], v9 offset:57344
  v_mfma_f32_16x16x32_bf16 v[128:131], v[40:43], a[224:227], v[128:131]
  ds_read_b64_tr_b16 v[38:39], v9 offset:61440
  v_mfma_f32_16x16x32_bf16 v[132:135], v[40:43], a[228:231], v[132:135]
  buffer_load_dwordx4 a[180:183], v20, s[16:19], s69 offen offset:3072 sc1
  v_mfma_f32_16x16x32_bf16 v[136:139], v[40:43], a[232:235], v[136:139]
  v_mfma_f32_16x16x32_bf16 v[140:143], v[40:43], a[236:239], v[140:143]
  ds_read_b64_tr_b16 v[40:41], v8 offset:57600
  v_mfma_f32_16x16x32_bf16 v[156:159], v[44:47], a[236:239], v[156:159]
  ds_read_b64_tr_b16 v[42:43], v8 offset:61696
  v_mfma_f32_16x16x32_bf16 v[152:155], v[44:47], a[232:235], v[152:155]
  v_mfma_f32_16x16x32_bf16 v[148:151], v[44:47], a[228:231], v[148:151]
  v_mfma_f32_16x16x32_bf16 v[144:147], v[44:47], a[224:227], v[144:147]
  s_waitcnt lgkmcnt(6)
  v_mfma_f32_16x16x32_bf16 v[160:163], v[48:51], a[224:227], v[160:163]
  ds_read_b64_tr_b16 v[44:45], v9 offset:57600
  v_mfma_f32_16x16x32_bf16 v[164:167], v[48:51], a[228:231], v[164:167]
  ds_read_b64_tr_b16 v[46:47], v9 offset:61696
  v_mfma_f32_16x16x32_bf16 v[168:171], v[48:51], a[232:235], v[168:171]
  buffer_load_dwordx4 a[184:187], v20, s[16:19], s70 offen offset:3072 sc1
  v_mfma_f32_16x16x32_bf16 v[172:175], v[48:51], a[236:239], v[172:175]
  ds_read_b64_tr_b16 v[48:49], v8 offset:57856
  v_mfma_f32_16x16x32_bf16 v[188:191], v[52:55], a[236:239], v[188:191]
  ds_read_b64_tr_b16 v[50:51], v8 offset:61952
  v_mfma_f32_16x16x32_bf16 v[184:187], v[52:55], a[232:235], v[184:187]
  v_mfma_f32_16x16x32_bf16 v[180:183], v[52:55], a[228:231], v[180:183]
  v_mfma_f32_16x16x32_bf16 v[176:179], v[52:55], a[224:227], v[176:179]
  ds_read_b64_tr_b16 v[52:53], v9 offset:57856
  v_mfma_f32_16x16x32_bf16 v[192:195], v[56:59], a[224:227], v[192:195]
  ds_read_b64_tr_b16 v[54:55], v9 offset:61952
  v_mfma_f32_16x16x32_bf16 v[196:199], v[56:59], a[228:231], v[196:199]
  buffer_load_dwordx4 a[188:191], v20, s[16:19], s71 offen offset:3072 sc1
  v_mfma_f32_16x16x32_bf16 v[200:203], v[56:59], a[232:235], v[200:203]
  v_mfma_f32_16x16x32_bf16 v[204:207], v[56:59], a[236:239], v[204:207]
  ds_read_b64_tr_b16 v[56:57], v8 offset:58112
  v_mfma_f32_16x16x32_bf16 v[220:223], v[60:63], a[236:239], v[220:223]
  ds_read_b64_tr_b16 v[58:59], v8 offset:62208
  v_mfma_f32_16x16x32_bf16 v[216:219], v[60:63], a[232:235], v[216:219]
  v_mfma_f32_16x16x32_bf16 v[212:215], v[60:63], a[228:231], v[212:215]
  v_mfma_f32_16x16x32_bf16 v[208:211], v[60:63], a[224:227], v[208:211]
  s_waitcnt vmcnt(31) lgkmcnt(6)
  v_mfma_f32_16x16x32_bf16 v[96:99], v[32:35], a[240:243], v[96:99]
  ds_read_b64_tr_b16 v[60:61], v9 offset:58112
  ds_read_b64_tr_b16 v[62:63], v9 offset:62208
  v_mfma_f32_16x16x32_bf16 v[100:103], v[32:35], a[244:247], v[100:103]
  s_add_u32 s68, s66, 24576
  v_mfma_f32_16x16x32_bf16 v[104:107], v[32:35], a[248:251], v[104:107]
  buffer_load_dwordx4 a[192:195], v20, s[16:19], s68 offen offset:0 sc1
  v_mfma_f32_16x16x32_bf16 v[108:111], v[32:35], a[252:255], v[108:111]
  v_mfma_f32_16x16x32_bf16 v[124:127], v[36:39], a[252:255], v[124:127]
  v_mfma_f32_16x16x32_bf16 v[120:123], v[36:39], a[248:251], v[120:123]
  v_mfma_f32_16x16x32_bf16 v[116:119], v[36:39], a[244:247], v[116:119]
  buffer_load_dword v25, v27, s[16:19], s73 offen offset:0 sc1
  v_mfma_f32_16x16x32_bf16 v[112:115], v[36:39], a[240:243], v[112:115]
  s_waitcnt vmcnt(40)
  s_barrier
  v_mfma_f32_16x16x32_bf16 v[128:131], v[40:43], a[240:243], v[128:131]
  ds_read_b64_tr_b16 v[32:33], v10 offset:0
  ds_read_b64_tr_b16 v[34:35], v10 offset:4096
  v_mfma_f32_16x16x32_bf16 v[132:135], v[40:43], a[244:247], v[132:135]
  ds_read_b64_tr_b16 v[36:37], v11 offset:0
  v_mfma_f32_16x16x32_bf16 v[136:139], v[40:43], a[248:251], v[136:139]
  ds_read_b64_tr_b16 v[38:39], v11 offset:4096
  v_mfma_f32_16x16x32_bf16 v[140:143], v[40:43], a[252:255], v[140:143]
  ds_read_b64_tr_b16 v[40:41], v10 offset:256
  ds_read_b64_tr_b16 v[42:43], v10 offset:4352
  v_mfma_f32_16x16x32_bf16 v[156:159], v[44:47], a[252:255], v[156:159]
  s_add_u32 s69, s66, 139520
  v_mfma_f32_16x16x32_bf16 v[152:155], v[44:47], a[248:251], v[152:155]
  buffer_load_dwordx4 a[196:199], v20, s[16:19], s69 offen offset:0 sc1
  v_mfma_f32_16x16x32_bf16 v[148:151], v[44:47], a[244:247], v[148:151]
  v_mfma_f32_16x16x32_bf16 v[144:147], v[44:47], a[240:243], v[144:147]
  s_waitcnt lgkmcnt(6)
  v_mfma_f32_16x16x32_bf16 v[160:163], v[48:51], a[240:243], v[160:163]
  ds_read_b64_tr_b16 v[44:45], v11 offset:256
  v_mfma_f32_16x16x32_bf16 v[164:167], v[48:51], a[244:247], v[164:167]
  ds_read_b64_tr_b16 v[46:47], v11 offset:4352
  v_mfma_f32_16x16x32_bf16 v[168:171], v[48:51], a[248:251], v[168:171]
  s_add_u32 s70, s66, 254464
  v_mfma_f32_16x16x32_bf16 v[172:175], v[48:51], a[252:255], v[172:175]
  ds_read_b64_tr_b16 v[48:49], v10 offset:512
  v_mfma_f32_16x16x32_bf16 v[188:191], v[52:55], a[252:255], v[188:191]
  ds_read_b64_tr_b16 v[50:51], v10 offset:4608
  v_mfma_f32_16x16x32_bf16 v[184:187], v[52:55], a[248:251], v[184:187]
  buffer_load_dwordx4 a[200:203], v20, s[16:19], s70 offen offset:0 sc1
  v_mfma_f32_16x16x32_bf16 v[180:183], v[52:55], a[244:247], v[180:183]
  v_mfma_f32_16x16x32_bf16 v[176:179], v[52:55], a[240:243], v[176:179]
  ds_read_b64_tr_b16 v[52:53], v11 offset:512
  v_mfma_f32_16x16x32_bf16 v[192:195], v[56:59], a[240:243], v[192:195]
  ds_read_b64_tr_b16 v[54:55], v11 offset:4608
  v_mfma_f32_16x16x32_bf16 v[196:199], v[56:59], a[244:247], v[196:199]
  s_add_u32 s71, s66, 369408
  v_mfma_f32_16x16x32_bf16 v[200:203], v[56:59], a[248:251], v[200:203]
  buffer_load_dwordx4 a[204:207], v20, s[16:19], s71 offen offset:0 sc1
  v_mfma_f32_16x16x32_bf16 v[204:207], v[56:59], a[252:255], v[204:207]
  ds_read_b64_tr_b16 v[56:57], v10 offset:768
  v_mfma_f32_16x16x32_bf16 v[220:223], v[60:63], a[252:255], v[220:223]
  ds_read_b64_tr_b16 v[58:59], v10 offset:4864
  v_mfma_f32_16x16x32_bf16 v[216:219], v[60:63], a[248:251], v[216:219]
  v_mfma_f32_16x16x32_bf16 v[212:215], v[60:63], a[244:247], v[212:215]
  v_mfma_f32_16x16x32_bf16 v[208:211], v[60:63], a[240:243], v[208:211]
  s_waitcnt vmcnt(28) lgkmcnt(6)
  v_mfma_f32_16x16x32_bf16 v[96:99], v[32:35], a[128:131], v[96:99]
  ds_read_b64_tr_b16 v[60:61], v11 offset:768
  v_mfma_f32_16x16x32_bf16 v[100:103], v[32:35], a[132:135], v[100:103]
  ds_read_b64_tr_b16 v[62:63], v11 offset:4864
  v_mfma_f32_16x16x32_bf16 v[104:107], v[32:35], a[136:139], v[104:107]
  buffer_load_dwordx4 a[208:211], v20, s[16:19], s68 offen offset:1024 sc1
  v_mfma_f32_16x16x32_bf16 v[108:111], v[32:35], a[140:143], v[108:111]
  ds_read_b64_tr_b16 v[32:33], v10 offset:8192
  ds_read_b64_tr_b16 v[34:35], v10 offset:12288
  v_mfma_f32_16x16x32_bf16 v[124:127], v[36:39], a[140:143], v[124:127]
  s_add_u32 m0, s63, 131072
  s_add_u32 s42, s65, 262144
  v_mfma_f32_16x16x32_bf16 v[120:123], v[36:39], a[136:139], v[120:123]
  buffer_load_dwordx4 v4, s[8:11], s42 offen offset:0 lds
  v_mfma_f32_16x16x32_bf16 v[116:119], v[36:39], a[132:135], v[116:119]
  v_mfma_f32_16x16x32_bf16 v[112:115], v[36:39], a[128:131], v[112:115]
  ds_read_b64_tr_b16 v[36:37], v11 offset:8192
  v_mfma_f32_16x16x32_bf16 v[128:131], v[40:43], a[128:131], v[128:131]
  ds_read_b64_tr_b16 v[38:39], v11 offset:12288
  v_mfma_f32_16x16x32_bf16 v[132:135], v[40:43], a[132:135], v[132:135]
  buffer_load_dwordx4 a[212:215], v20, s[16:19], s69 offen offset:1024 sc1
  v_mfma_f32_16x16x32_bf16 v[136:139], v[40:43], a[136:139], v[136:139]
  v_mfma_f32_16x16x32_bf16 v[140:143], v[40:43], a[140:143], v[140:143]
  ds_read_b64_tr_b16 v[40:41], v10 offset:8448
  v_mfma_f32_16x16x32_bf16 v[156:159], v[44:47], a[140:143], v[156:159]
  ds_read_b64_tr_b16 v[42:43], v10 offset:12544
  v_mfma_f32_16x16x32_bf16 v[152:155], v[44:47], a[136:139], v[152:155]
  buffer_load_dwordx4 v5, s[8:11], s42 offen offset:1024 lds
  v_mfma_f32_16x16x32_bf16 v[148:151], v[44:47], a[132:135], v[148:151]
  v_mfma_f32_16x16x32_bf16 v[144:147], v[44:47], a[128:131], v[144:147]
  s_waitcnt lgkmcnt(6)
  v_mfma_f32_16x16x32_bf16 v[160:163], v[48:51], a[128:131], v[160:163]
  ds_read_b64_tr_b16 v[44:45], v11 offset:8448
  v_mfma_f32_16x16x32_bf16 v[164:167], v[48:51], a[132:135], v[164:167]
  ds_read_b64_tr_b16 v[46:47], v11 offset:12544
  v_mfma_f32_16x16x32_bf16 v[168:171], v[48:51], a[136:139], v[168:171]
  buffer_load_dwordx4 a[216:219], v20, s[16:19], s70 offen offset:1024 sc1
  v_mfma_f32_16x16x32_bf16 v[172:175], v[48:51], a[140:143], v[172:175]
  ds_read_b64_tr_b16 v[48:49], v10 offset:8704
  v_mfma_f32_16x16x32_bf16 v[188:191], v[52:55], a[140:143], v[188:191]
  ds_read_b64_tr_b16 v[50:51], v10 offset:12800
  v_mfma_f32_16x16x32_bf16 v[184:187], v[52:55], a[136:139], v[184:187]
  buffer_load_dwordx4 v6, s[8:11], s42 offen offset:2048 lds
  v_mfma_f32_16x16x32_bf16 v[180:183], v[52:55], a[132:135], v[180:183]
  v_mfma_f32_16x16x32_bf16 v[176:179], v[52:55], a[128:131], v[176:179]
  ds_read_b64_tr_b16 v[52:53], v11 offset:8704
  v_mfma_f32_16x16x32_bf16 v[192:195], v[56:59], a[128:131], v[192:195]
  ds_read_b64_tr_b16 v[54:55], v11 offset:12800
  v_mfma_f32_16x16x32_bf16 v[196:199], v[56:59], a[132:135], v[196:199]
  buffer_load_dwordx4 a[220:223], v20, s[16:19], s71 offen offset:1024 sc1
  v_mfma_f32_16x16x32_bf16 v[200:203], v[56:59], a[136:139], v[200:203]
  v_mfma_f32_16x16x32_bf16 v[204:207], v[56:59], a[140:143], v[204:207]
  ds_read_b64_tr_b16 v[56:57], v10 offset:8960
  v_mfma_f32_16x16x32_bf16 v[220:223], v[60:63], a[140:143], v[220:223]
  ds_read_b64_tr_b16 v[58:59], v10 offset:13056
  v_mfma_f32_16x16x32_bf16 v[216:219], v[60:63], a[136:139], v[216:219]
  buffer_load_dwordx4 v7, s[8:11], s42 offen offset:3072 lds
  v_mfma_f32_16x16x32_bf16 v[212:215], v[60:63], a[132:135], v[212:215]
  v_mfma_f32_16x16x32_bf16 v[208:211], v[60:63], a[128:131], v[208:211]
  s_waitcnt vmcnt(26) lgkmcnt(6)
  v_mfma_f32_16x16x32_bf16 v[96:99], v[32:35], a[144:147], v[96:99]
  ds_read_b64_tr_b16 v[60:61], v11 offset:8960
  v_mfma_f32_16x16x32_bf16 v[100:103], v[32:35], a[148:151], v[100:103]
  ds_read_b64_tr_b16 v[62:63], v11 offset:13056
  v_mfma_f32_16x16x32_bf16 v[104:107], v[32:35], a[152:155], v[104:107]
  buffer_load_dwordx4 a[224:227], v20, s[16:19], s68 offen offset:2048 sc1
  v_mfma_f32_16x16x32_bf16 v[108:111], v[32:35], a[156:159], v[108:111]
  ds_read_b64_tr_b16 v[32:33], v10 offset:16384
  ds_read_b64_tr_b16 v[34:35], v10 offset:20480
  v_mfma_f32_16x16x32_bf16 v[124:127], v[36:39], a[156:159], v[124:127]
  s_add_u32 m0, s63, 135168
  s_add_u32 s43, s65, 294912
  v_mfma_f32_16x16x32_bf16 v[120:123], v[36:39], a[152:155], v[120:123]
  buffer_load_dwordx4 v4, s[8:11], s43 offen offset:0 lds
  v_mfma_f32_16x16x32_bf16 v[116:119], v[36:39], a[148:151], v[116:119]
  v_mfma_f32_16x16x32_bf16 v[112:115], v[36:39], a[144:147], v[112:115]
  ds_read_b64_tr_b16 v[36:37], v11 offset:16384
  v_mfma_f32_16x16x32_bf16 v[128:131], v[40:43], a[144:147], v[128:131]
  ds_read_b64_tr_b16 v[38:39], v11 offset:20480
  v_mfma_f32_16x16x32_bf16 v[132:135], v[40:43], a[148:151], v[132:135]
  buffer_load_dwordx4 a[228:231], v20, s[16:19], s69 offen offset:2048 sc1
  v_mfma_f32_16x16x32_bf16 v[136:139], v[40:43], a[152:155], v[136:139]
  v_mfma_f32_16x16x32_bf16 v[140:143], v[40:43], a[156:159], v[140:143]
  ds_read_b64_tr_b16 v[40:41], v10 offset:16640
  v_mfma_f32_16x16x32_bf16 v[156:159], v[44:47], a[156:159], v[156:159]
  ds_read_b64_tr_b16 v[42:43], v10 offset:20736
  v_mfma_f32_16x16x32_bf16 v[152:155], v[44:47], a[152:155], v[152:155]
  buffer_load_dwordx4 v5, s[8:11], s43 offen offset:1024 lds
  v_mfma_f32_16x16x32_bf16 v[148:151], v[44:47], a[148:151], v[148:151]
  v_mfma_f32_16x16x32_bf16 v[144:147], v[44:47], a[144:147], v[144:147]
  s_waitcnt lgkmcnt(6)
  v_mfma_f32_16x16x32_bf16 v[160:163], v[48:51], a[144:147], v[160:163]
  ds_read_b64_tr_b16 v[44:45], v11 offset:16640
  v_mfma_f32_16x16x32_bf16 v[164:167], v[48:51], a[148:151], v[164:167]
  ds_read_b64_tr_b16 v[46:47], v11 offset:20736
  v_mfma_f32_16x16x32_bf16 v[168:171], v[48:51], a[152:155], v[168:171]
  buffer_load_dwordx4 a[232:235], v20, s[16:19], s70 offen offset:2048 sc1
  v_mfma_f32_16x16x32_bf16 v[172:175], v[48:51], a[156:159], v[172:175]
  ds_read_b64_tr_b16 v[48:49], v10 offset:16896
  v_mfma_f32_16x16x32_bf16 v[188:191], v[52:55], a[156:159], v[188:191]
  ds_read_b64_tr_b16 v[50:51], v10 offset:20992
  v_mfma_f32_16x16x32_bf16 v[184:187], v[52:55], a[152:155], v[184:187]
  buffer_load_dwordx4 v6, s[8:11], s43 offen offset:2048 lds
  v_mfma_f32_16x16x32_bf16 v[180:183], v[52:55], a[148:151], v[180:183]
  v_mfma_f32_16x16x32_bf16 v[176:179], v[52:55], a[144:147], v[176:179]
  ds_read_b64_tr_b16 v[52:53], v11 offset:16896
  v_mfma_f32_16x16x32_bf16 v[192:195], v[56:59], a[144:147], v[192:195]
  ds_read_b64_tr_b16 v[54:55], v11 offset:20992
  v_mfma_f32_16x16x32_bf16 v[196:199], v[56:59], a[148:151], v[196:199]
  buffer_load_dwordx4 a[236:239], v20, s[16:19], s71 offen offset:2048 sc1
  v_mfma_f32_16x16x32_bf16 v[200:203], v[56:59], a[152:155], v[200:203]
  v_mfma_f32_16x16x32_bf16 v[204:207], v[56:59], a[156:159], v[204:207]
  ds_read_b64_tr_b16 v[56:57], v10 offset:17152
  v_mfma_f32_16x16x32_bf16 v[220:223], v[60:63], a[156:159], v[220:223]
  ds_read_b64_tr_b16 v[58:59], v10 offset:21248
  v_mfma_f32_16x16x32_bf16 v[216:219], v[60:63], a[152:155], v[216:219]
  buffer_load_dwordx4 v7, s[8:11], s43 offen offset:3072 lds
  v_mfma_f32_16x16x32_bf16 v[212:215], v[60:63], a[148:151], v[212:215]
  v_mfma_f32_16x16x32_bf16 v[208:211], v[60:63], a[144:147], v[208:211]
  s_waitcnt vmcnt(26) lgkmcnt(6)
  v_mfma_f32_16x16x32_bf16 v[96:99], v[32:35], a[160:163], v[96:99]
  ds_read_b64_tr_b16 v[60:61], v11 offset:17152
  v_mfma_f32_16x16x32_bf16 v[100:103], v[32:35], a[164:167], v[100:103]
  ds_read_b64_tr_b16 v[62:63], v11 offset:21248
  v_mfma_f32_16x16x32_bf16 v[104:107], v[32:35], a[168:171], v[104:107]
  buffer_load_dwordx4 a[240:243], v20, s[16:19], s68 offen offset:3072 sc1
  v_mfma_f32_16x16x32_bf16 v[108:111], v[32:35], a[172:175], v[108:111]
  ds_read_b64_tr_b16 v[32:33], v10 offset:24576
  v_mfma_f32_16x16x32_bf16 v[124:127], v[36:39], a[172:175], v[124:127]
  ds_read_b64_tr_b16 v[34:35], v10 offset:28672
  v_mfma_f32_16x16x32_bf16 v[120:123], v[36:39], a[168:171], v[120:123]
  v_mfma_f32_16x16x32_bf16 v[116:119], v[36:39], a[164:167], v[116:119]
  v_mfma_f32_16x16x32_bf16 v[112:115], v[36:39], a[160:163], v[112:115]
  ds_read_b64_tr_b16 v[36:37], v11 offset:24576
  v_mfma_f32_16x16x32_bf16 v[128:131], v[40:43], a[160:163], v[128:131]
  ds_read_b64_tr_b16 v[38:39], v11 offset:28672
  v_mfma_f32_16x16x32_bf16 v[132:135], v[40:43], a[164:167], v[132:135]
  buffer_load_dwordx4 a[244:247], v20, s[16:19], s69 offen offset:3072 sc1
  v_mfma_f32_16x16x32_bf16 v[136:139], v[40:43], a[168:171], v[136:139]
  v_mfma_f32_16x16x32_bf16 v[140:143], v[40:43], a[172:175], v[140:143]
  ds_read_b64_tr_b16 v[40:41], v10 offset:24832
  v_mfma_f32_16x16x32_bf16 v[156:159], v[44:47], a[172:175], v[156:159]
  ds_read_b64_tr_b16 v[42:43], v10 offset:28928
  v_mfma_f32_16x16x32_bf16 v[152:155], v[44:47], a[168:171], v[152:155]
  v_mfma_f32_16x16x32_bf16 v[148:151], v[44:47], a[164:167], v[148:151]
  v_mfma_f32_16x16x32_bf16 v[144:147], v[44:47], a[160:163], v[144:147]
  s_waitcnt lgkmcnt(6)
  v_mfma_f32_16x16x32_bf16 v[160:163], v[48:51], a[160:163], v[160:163]
  ds_read_b64_tr_b16 v[44:45], v11 offset:24832
  v_mfma_f32_16x16x32_bf16 v[164:167], v[48:51], a[164:167], v[164:167]
  ds_read_b64_tr_b16 v[46:47], v11 offset:28928
  v_mfma_f32_16x16x32_bf16 v[168:171], v[48:51], a[168:171], v[168:171]
  buffer_load_dwordx4 a[248:251], v20, s[16:19], s70 offen offset:3072 sc1
  v_mfma_f32_16x16x32_bf16 v[172:175], v[48:51], a[172:175], v[172:175]
  ds_read_b64_tr_b16 v[48:49], v10 offset:25088
  v_mfma_f32_16x16x32_bf16 v[188:191], v[52:55], a[172:175], v[188:191]
  ds_read_b64_tr_b16 v[50:51], v10 offset:29184
  v_mfma_f32_16x16x32_bf16 v[184:187], v[52:55], a[168:171], v[184:187]
  v_mfma_f32_16x16x32_bf16 v[180:183], v[52:55], a[164:167], v[180:183]
  v_mfma_f32_16x16x32_bf16 v[176:179], v[52:55], a[160:163], v[176:179]
  ds_read_b64_tr_b16 v[52:53], v11 offset:25088
  v_mfma_f32_16x16x32_bf16 v[192:195], v[56:59], a[160:163], v[192:195]
  ds_read_b64_tr_b16 v[54:55], v11 offset:29184
  v_mfma_f32_16x16x32_bf16 v[196:199], v[56:59], a[164:167], v[196:199]
  buffer_load_dwordx4 a[252:255], v20, s[16:19], s71 offen offset:3072 sc1
  v_mfma_f32_16x16x32_bf16 v[200:203], v[56:59], a[168:171], v[200:203]
  v_mfma_f32_16x16x32_bf16 v[204:207], v[56:59], a[172:175], v[204:207]
  ds_read_b64_tr_b16 v[56:57], v10 offset:25344
  v_mfma_f32_16x16x32_bf16 v[220:223], v[60:63], a[172:175], v[220:223]
  ds_read_b64_tr_b16 v[58:59], v10 offset:29440
  v_mfma_f32_16x16x32_bf16 v[216:219], v[60:63], a[168:171], v[216:219]
  v_mfma_f32_16x16x32_bf16 v[212:215], v[60:63], a[164:167], v[212:215]
  v_mfma_f32_16x16x32_bf16 v[208:211], v[60:63], a[160:163], v[208:211]
  s_waitcnt vmcnt(23)
  v_cmp_eq_u32 vcc, v26, v25
  s_and_b32 s84, vcc_lo, 0xff
  s_cmp_eq_u32 s84, 0xff
  s_cbranch_scc0 L_main_spin_3
L_main_spin_3_ok:
  s_waitcnt vmcnt(25) lgkmcnt(6)
  v_mfma_f32_16x16x32_bf16 v[96:99], v[32:35], a[176:179], v[96:99]
  ds_read_b64_tr_b16 v[60:61], v11 offset:25344
  ds_read_b64_tr_b16 v[62:63], v11 offset:29440
  v_mfma_f32_16x16x32_bf16 v[100:103], v[32:35], a[180:183], v[100:103]
  s_add_u32 s68, s67, 0
  v_mfma_f32_16x16x32_bf16 v[104:107], v[32:35], a[184:187], v[104:107]
  buffer_load_dwordx4 a[128:131], v20, s[16:19], s68 offen offset:0 sc1
  v_mfma_f32_16x16x32_bf16 v[108:111], v[32:35], a[188:191], v[108:111]
  v_mfma_f32_16x16x32_bf16 v[124:127], v[36:39], a[188:191], v[124:127]
  v_mfma_f32_16x16x32_bf16 v[120:123], v[36:39], a[184:187], v[120:123]
  v_mfma_f32_16x16x32_bf16 v[116:119], v[36:39], a[180:183], v[116:119]
  v_mfma_f32_16x16x32_bf16 v[112:115], v[36:39], a[176:179], v[112:115]
  s_waitcnt vmcnt(48)
  s_barrier
  v_mfma_f32_16x16x32_bf16 v[128:131], v[40:43], a[176:179], v[128:131]
  ds_read_b64_tr_b16 v[32:33], v8 offset:0
  ds_read_b64_tr_b16 v[34:35], v8 offset:4096
  v_mfma_f32_16x16x32_bf16 v[132:135], v[40:43], a[180:183], v[132:135]
  ds_read_b64_tr_b16 v[36:37], v9 offset:0
  ds_read_b64_tr_b16 v[38:39], v9 offset:4096
  v_mfma_f32_16x16x32_bf16 v[136:139], v[40:43], a[184:187], v[136:139]
  s_add_u32 s69, s67, 131328
  v_mfma_f32_16x16x32_bf16 v[140:143], v[40:43], a[188:191], v[140:143]
  ds_read_b64_tr_b16 v[40:41], v8 offset:256
  v_mfma_f32_16x16x32_bf16 v[156:159], v[44:47], a[188:191], v[156:159]
  ds_read_b64_tr_b16 v[42:43], v8 offset:4352
  v_mfma_f32_16x16x32_bf16 v[152:155], v[44:47], a[184:187], v[152:155]
  buffer_load_dwordx4 a[132:135], v20, s[16:19], s69 offen offset:0 sc1
  v_mfma_f32_16x16x32_bf16 v[148:151], v[44:47], a[180:183], v[148:151]
  v_mfma_f32_16x16x32_bf16 v[144:147], v[44:47], a[176:179], v[144:147]
  ds_read_b64_tr_b16 v[44:45], v9 offset:256
  s_waitcnt lgkmcnt(7)
  v_mfma_f32_16x16x32_bf16 v[160:163], v[48:51], a[176:179], v[160:163]
  ds_read_b64_tr_b16 v[46:47], v9 offset:4352
  v_mfma_f32_16x16x32_bf16 v[164:167], v[48:51], a[180:183], v[164:167]
  s_add_u32 s70, s67, 262656
  v_mfma_f32_16x16x32_bf16 v[168:171], v[48:51], a[184:187], v[168:171]
  buffer_load_dwordx4 a[136:139], v20, s[16:19], s70 offen offset:0 sc1
  v_mfma_f32_16x16x32_bf16 v[172:175], v[48:51], a[188:191], v[172:175]
  ds_read_b64_tr_b16 v[48:49], v8 offset:512
  v_mfma_f32_16x16x32_bf16 v[188:191], v[52:55], a[188:191], v[188:191]
  ds_read_b64_tr_b16 v[50:51], v8 offset:4608
  v_mfma_f32_16x16x32_bf16 v[184:187], v[52:55], a[184:187], v[184:187]
  v_mfma_f32_16x16x32_bf16 v[180:183], v[52:55], a[180:183], v[180:183]
  v_mfma_f32_16x16x32_bf16 v[176:179], v[52:55], a[176:179], v[176:179]
  ds_read_b64_tr_b16 v[52:53], v9 offset:512
  ds_read_b64_tr_b16 v[54:55], v9 offset:4608
  v_mfma_f32_16x16x32_bf16 v[192:195], v[56:59], a[176:179], v[192:195]
  s_add_u32 s71, s67, 393984
  v_mfma_f32_16x16x32_bf16 v[196:199], v[56:59], a[180:183], v[196:199]
  buffer_load_dwordx4 a[140:143], v20, s[16:19], s71 offen offset:0 sc1
  v_mfma_f32_16x16x32_bf16 v[200:203], v[56:59], a[184:187], v[200:203]
  v_mfma_f32_16x16x32_bf16 v[204:207], v[56:59], a[188:191], v[204:207]
  ds_read_b64_tr_b16 v[56:57], v8 offset:768
  v_mfma_f32_16x16x32_bf16 v[220:223], v[60:63], a[188:191], v[220:223]
  ds_read_b64_tr_b16 v[58:59], v8 offset:4864
  v_mfma_f32_16x16x32_bf16 v[216:219], v[60:63], a[184:187], v[216:219]
  v_mfma_f32_16x16x32_bf16 v[212:215], v[60:63], a[180:183], v[212:215]
  v_mfma_f32_16x16x32_bf16 v[208:211], v[60:63], a[176:179], v[208:211]
  s_waitcnt vmcnt(24) lgkmcnt(6)
  v_mfma_f32_16x16x32_bf16 v[96:99], v[32:35], a[192:195], v[96:99]
  ds_read_b64_tr_b16 v[60:61], v9 offset:768
  v_mfma_f32_16x16x32_bf16 v[100:103], v[32:35], a[196:199], v[100:103]
  ds_read_b64_tr_b16 v[62:63], v9 offset:4864
  v_mfma_f32_16x16x32_bf16 v[104:107], v[32:35], a[200:203], v[104:107]
  buffer_load_dwordx4 a[144:147], v20, s[16:19], s68 offen offset:1024 sc1
  v_mfma_f32_16x16x32_bf16 v[108:111], v[32:35], a[204:207], v[108:111]
  ds_read_b64_tr_b16 v[32:33], v8 offset:8192
  ds_read_b64_tr_b16 v[34:35], v8 offset:12288
  v_mfma_f32_16x16x32_bf16 v[124:127], v[36:39], a[204:207], v[124:127]
  s_add_u32 m0, s63, 32768
  s_add_u32 s42, s65, 524288
  v_mfma_f32_16x16x32_bf16 v[120:123], v[36:39], a[200:203], v[120:123]
  buffer_load_dwordx4 v4, s[8:11], s42 offen offset:0 lds
  v_mfma_f32_16x16x32_bf16 v[116:119], v[36:39], a[196:199], v[116:119]
  v_mfma_f32_16x16x32_bf16 v[112:115], v[36:39], a[192:195], v[112:115]
  ds_read_b64_tr_b16 v[36:37], v9 offset:8192
  v_mfma_f32_16x16x32_bf16 v[128:131], v[40:43], a[192:195], v[128:131]
  ds_read_b64_tr_b16 v[38:39], v9 offset:12288
  v_mfma_f32_16x16x32_bf16 v[132:135], v[40:43], a[196:199], v[132:135]
  buffer_load_dwordx4 a[148:151], v20, s[16:19], s69 offen offset:1024 sc1
  v_mfma_f32_16x16x32_bf16 v[136:139], v[40:43], a[200:203], v[136:139]
  v_mfma_f32_16x16x32_bf16 v[140:143], v[40:43], a[204:207], v[140:143]
  ds_read_b64_tr_b16 v[40:41], v8 offset:8448
  v_mfma_f32_16x16x32_bf16 v[156:159], v[44:47], a[204:207], v[156:159]
  ds_read_b64_tr_b16 v[42:43], v8 offset:12544
  v_mfma_f32_16x16x32_bf16 v[152:155], v[44:47], a[200:203], v[152:155]
  buffer_load_dwordx4 v5, s[8:11], s42 offen offset:1024 lds
  v_mfma_f32_16x16x32_bf16 v[148:151], v[44:47], a[196:199], v[148:151]
  v_mfma_f32_16x16x32_bf16 v[144:147], v[44:47], a[192:195], v[144:147]
  s_waitcnt lgkmcnt(6)
  v_mfma_f32_16x16x32_bf16 v[160:163], v[48:51], a[192:195], v[160:163]
  ds_read_b64_tr_b16 v[44:45], v9 offset:8448
  v_mfma_f32_16x16x32_bf16 v[164:167], v[48:51], a[196:199], v[164:167]
  ds_read_b64_tr_b16 v[46:47], v9 offset:12544
  v_mfma_f32_16x16x32_bf16 v[168:171], v[48:51], a[200:203], v[168:171]
  buffer_load_dwordx4 a[152:155], v20, s[16:19], s70 offen offset:1024 sc1
  v_mfma_f32_16x16x32_bf16 v[172:175], v[48:51], a[204:207], v[172:175]
  ds_read_b64_tr_b16 v[48:49], v8 offset:8704
  v_mfma_f32_16x16x32_bf16 v[188:191], v[52:55], a[204:207], v[188:191]
  ds_read_b64_tr_b16 v[50:51], v8 offset:12800
  v_mfma_f32_16x16x32_bf16 v[184:187], v[52:55], a[200:203], v[184:187]
  buffer_load_dwordx4 v6, s[8:11], s42 offen offset:2048 lds
  v_mfma_f32_16x16x32_bf16 v[180:183], v[52:55], a[196:199], v[180:183]
  v_mfma_f32_16x16x32_bf16 v[176:179], v[52:55], a[192:195], v[176:179]
  ds_read_b64_tr_b16 v[52:53], v9 offset:8704
  v_mfma_f32_16x16x32_bf16 v[192:195], v[56:59], a[192:195], v[192:195]
  ds_read_b64_tr_b16 v[54:55], v9 offset:12800
  v_mfma_f32_16x16x32_bf16 v[196:199], v[56:59], a[196:199], v[196:199]
  buffer_load_dwordx4 a[156:159], v20, s[16:19], s71 offen offset:1024 sc1
  v_mfma_f32_16x16x32_bf16 v[200:203], v[56:59], a[200:203], v[200:203]
  v_mfma_f32_16x16x32_bf16 v[204:207], v[56:59], a[204:207], v[204:207]
  ds_read_b64_tr_b16 v[56:57], v8 offset:8960
  v_mfma_f32_16x16x32_bf16 v[220:223], v[60:63], a[204:207], v[220:223]
  ds_read_b64_tr_b16 v[58:59], v8 offset:13056
  v_mfma_f32_16x16x32_bf16 v[216:219], v[60:63], a[200:203], v[216:219]
  buffer_load_dwordx4 v7, s[8:11], s42 offen offset:3072 lds
  v_mfma_f32_16x16x32_bf16 v[212:215], v[60:63], a[196:199], v[212:215]
  v_mfma_f32_16x16x32_bf16 v[208:211], v[60:63], a[192:195], v[208:211]
  s_waitcnt vmcnt(25) lgkmcnt(6)
  v_mfma_f32_16x16x32_bf16 v[96:99], v[32:35], a[208:211], v[96:99]
  ds_read_b64_tr_b16 v[60:61], v9 offset:8960
  v_mfma_f32_16x16x32_bf16 v[100:103], v[32:35], a[212:215], v[100:103]
  ds_read_b64_tr_b16 v[62:63], v9 offset:13056
  v_mfma_f32_16x16x32_bf16 v[104:107], v[32:35], a[216:219], v[104:107]
  buffer_load_dwordx4 a[160:163], v20, s[16:19], s68 offen offset:2048 sc1
  v_mfma_f32_16x16x32_bf16 v[108:111], v[32:35], a[220:223], v[108:111]
  ds_read_b64_tr_b16 v[32:33], v8 offset:16384
  ds_read_b64_tr_b16 v[34:35], v8 offset:20480
  v_mfma_f32_16x16x32_bf16 v[124:127], v[36:39], a[220:223], v[124:127]
  s_add_u32 m0, s63, 36864
  s_add_u32 s43, s65, 557056
  v_mfma_f32_16x16x32_bf16 v[120:123], v[36:39], a[216:219], v[120:123]
  buffer_load_dwordx4 v4, s[8:11], s43 offen offset:0 lds
  v_mfma_f32_16x16x32_bf16 v[116:119], v[36:39], a[212:215], v[116:119]
  v_mfma_f32_16x16x32_bf16 v[112:115], v[36:39], a[208:211], v[112:115]
  ds_read_b64_tr_b16 v[36:37], v9 offset:16384
  v_mfma_f32_16x16x32_bf16 v[128:131], v[40:43], a[208:211], v[128:131]
  ds_read_b64_tr_b16 v[38:39], v9 offset:20480
  v_mfma_f32_16x16x32_bf16 v[132:135], v[40:43], a[212:215], v[132:135]
  buffer_load_dwordx4 a[164:167], v20, s[16:19], s69 offen offset:2048 sc1
  v_mfma_f32_16x16x32_bf16 v[136:139], v[40:43], a[216:219], v[136:139]
  v_mfma_f32_16x16x32_bf16 v[140:143], v[40:43], a[220:223], v[140:143]
  ds_read_b64_tr_b16 v[40:41], v8 offset:16640
  v_mfma_f32_16x16x32_bf16 v[156:159], v[44:47], a[220:223], v[156:159]
  ds_read_b64_tr_b16 v[42:43], v8 offset:20736
  v_mfma_f32_16x16x32_bf16 v[152:155], v[44:47], a[216:219], v[152:155]
  buffer_load_dwordx4 v5, s[8:11], s43 offen offset:1024 lds
  v_mfma_f32_16x16x32_bf16 v[148:151], v[44:47], a[212:215], v[148:151]
  v_mfma_f32_16x16x32_bf16 v[144:147], v[44:47], a[208:211], v[144:147]
  s_waitcnt lgkmcnt(6)
  v_mfma_f32_16x16x32_bf16 v[160:163], v[48:51], a[208:211], v[160:163]
  ds_read_b64_tr_b16 v[44:45], v9 offset:16640
  v_mfma_f32_16x16x32_bf16 v[164:167], v[48:51], a[212:215], v[164:167]
  ds_read_b64_tr_b16 v[46:47], v9 offset:20736
  v_mfma_f32_16x16x32_bf16 v[168:171], v[48:51], a[216:219], v[168:171]
  buffer_load_dwordx4 a[168:171], v20, s[16:19], s70 offen offset:2048 sc1
  v_mfma_f32_16x16x32_bf16 v[172:175], v[48:51], a[220:223], v[172:175]
  ds_read_b64_tr_b16 v[48:49], v8 offset:16896
  v_mfma_f32_16x16x32_bf16 v[188:191], v[52:55], a[220:223], v[188:191]
  ds_read_b64_tr_b16 v[50:51], v8 offset:20992
  v_mfma_f32_16x16x32_bf16 v[184:187], v[52:55], a[216:219], v[184:187]
  buffer_load_dwordx4 v6, s[8:11], s43 offen offset:2048 lds
  v_mfma_f32_16x16x32_bf16 v[180:183], v[52:55], a[212:215], v[180:183]
  v_mfma_f32_16x16x32_bf16 v[176:179], v[52:55], a[208:211], v[176:179]
  ds_read_b64_tr_b16 v[52:53], v9 offset:16896
  v_mfma_f32_16x16x32_bf16 v[192:195], v[56:59], a[208:211], v[192:195]
  ds_read_b64_tr_b16 v[54:55], v9 offset:20992
  v_mfma_f32_16x16x32_bf16 v[196:199], v[56:59], a[212:215], v[196:199]
  buffer_load_dwordx4 a[172:175], v20, s[16:19], s71 offen offset:2048 sc1
  v_mfma_f32_16x16x32_bf16 v[200:203], v[56:59], a[216:219], v[200:203]
  v_mfma_f32_16x16x32_bf16 v[204:207], v[56:59], a[220:223], v[204:207]
  ds_read_b64_tr_b16 v[56:57], v8 offset:17152
  v_mfma_f32_16x16x32_bf16 v[220:223], v[60:63], a[220:223], v[220:223]
  ds_read_b64_tr_b16 v[58:59], v8 offset:21248
  v_mfma_f32_16x16x32_bf16 v[216:219], v[60:63], a[216:219], v[216:219]
  buffer_load_dwordx4 v7, s[8:11], s43 offen offset:3072 lds
  v_mfma_f32_16x16x32_bf16 v[212:215], v[60:63], a[212:215], v[212:215]
  v_mfma_f32_16x16x32_bf16 v[208:211], v[60:63], a[208:211], v[208:211]
  s_waitcnt vmcnt(25) lgkmcnt(6)
  v_mfma_f32_16x16x32_bf16 v[96:99], v[32:35], a[224:227], v[96:99]
  ds_read_b64_tr_b16 v[60:61], v9 offset:17152
  v_mfma_f32_16x16x32_bf16 v[100:103], v[32:35], a[228:231], v[100:103]
  ds_read_b64_tr_b16 v[62:63], v9 offset:21248
  v_mfma_f32_16x16x32_bf16 v[104:107], v[32:35], a[232:235], v[104:107]
  buffer_load_dwordx4 a[176:179], v20, s[16:19], s68 offen offset:3072 sc1
  v_mfma_f32_16x16x32_bf16 v[108:111], v[32:35], a[236:239], v[108:111]
  ds_read_b64_tr_b16 v[32:33], v8 offset:24576
  v_mfma_f32_16x16x32_bf16 v[124:127], v[36:39], a[236:239], v[124:127]
  ds_read_b64_tr_b16 v[34:35], v8 offset:28672
  v_mfma_f32_16x16x32_bf16 v[120:123], v[36:39], a[232:235], v[120:123]
  buffer_load_dwordx4 a[180:183], v20, s[16:19], s69 offen offset:3072 sc1
  v_mfma_f32_16x16x32_bf16 v[116:119], v[36:39], a[228:231], v[116:119]
  v_mfma_f32_16x16x32_bf16 v[112:115], v[36:39], a[224:227], v[112:115]
  ds_read_b64_tr_b16 v[36:37], v9 offset:24576
  v_mfma_f32_16x16x32_bf16 v[128:131], v[40:43], a[224:227], v[128:131]
  ds_read_b64_tr_b16 v[38:39], v9 offset:28672
  v_mfma_f32_16x16x32_bf16 v[132:135], v[40:43], a[228:231], v[132:135]
  buffer_load_dwordx4 a[184:187], v20, s[16:19], s70 offen offset:3072 sc1
  v_mfma_f32_16x16x32_bf16 v[136:139], v[40:43], a[232:235], v[136:139]
  v_mfma_f32_16x16x32_bf16 v[140:143], v[40:43], a[236:239], v[140:143]
  ds_read_b64_tr_b16 v[40:41], v8 offset:24832
  v_mfma_f32_16x16x32_bf16 v[156:159], v[44:47], a[236:239], v[156:159]
  ds_read_b64_tr_b16 v[42:43], v8 offset:28928
  v_mfma_f32_16x16x32_bf16 v[152:155], v[44:47], a[232:235], v[152:155]
  buffer_load_dwordx4 a[188:191], v20, s[16:19], s71 offen offset:3072 sc1
  v_mfma_f32_16x16x32_bf16 v[148:151], v[44:47], a[228:231], v[148:151]
  v_mfma_f32_16x16x32_bf16 v[144:147], v[44:47], a[224:227], v[144:147]
  ds_read_b64_tr_b16 v[44:45], v9 offset:24832
  s_waitcnt lgkmcnt(7)
  v_mfma_f32_16x16x32_bf16 v[160:163], v[48:51], a[224:227], v[160:163]
  ds_read_b64_tr_b16 v[46:47], v9 offset:28928
  v_mfma_f32_16x16x32_bf16 v[164:167], v[48:51], a[228:231], v[164:167]
  s_add_u32 s68, s67, 4096
  v_mfma_f32_16x16x32_bf16 v[168:171], v[48:51], a[232:235], v[168:171]
  buffer_load_dwordx4 a[192:195], v20, s[16:19], s68 offen offset:0 sc1
  v_mfma_f32_16x16x32_bf16 v[172:175], v[48:51], a[236:239], v[172:175]
  ds_read_b64_tr_b16 v[48:49], v8 offset:25088
  ds_read_b64_tr_b16 v[50:51], v8 offset:29184
  v_mfma_f32_16x16x32_bf16 v[188:191], v[52:55], a[236:239], v[188:191]
  s_add_u32 s69, s67, 135424
  v_mfma_f32_16x16x32_bf16 v[184:187], v[52:55], a[232:235], v[184:187]
  buffer_load_dwordx4 a[196:199], v20, s[16:19], s69 offen offset:0 sc1
  v_mfma_f32_16x16x32_bf16 v[180:183], v[52:55], a[228:231], v[180:183]
  v_mfma_f32_16x16x32_bf16 v[176:179], v[52:55], a[224:227], v[176:179]
  ds_read_b64_tr_b16 v[52:53], v9 offset:25088
  ds_read_b64_tr_b16 v[54:55], v9 offset:29184
  v_mfma_f32_16x16x32_bf16 v[192:195], v[56:59], a[224:227], v[192:195]
  s_add_u32 s70, s67, 266752
  v_mfma_f32_16x16x32_bf16 v[196:199], v[56:59], a[228:231], v[196:199]
  buffer_load_dwordx4 a[200:203], v20, s[16:19], s70 offen offset:0 sc1
  v_mfma_f32_16x16x32_bf16 v[200:203], v[56:59], a[232:235], v[200:203]
  v_mfma_f32_16x16x32_bf16 v[204:207], v[56:59], a[236:239], v[204:207]
  ds_read_b64_tr_b16 v[56:57], v8 offset:25344
  ds_read_b64_tr_b16 v[58:59], v8 offset:29440
  v_mfma_f32_16x16x32_bf16 v[220:223], v[60:63], a[236:239], v[220:223]
  s_add_u32 s71, s67, 398080
  v_mfma_f32_16x16x32_bf16 v[216:219], v[60:63], a[232:235], v[216:219]
  buffer_load_dwordx4 a[204:207], v20, s[16:19], s71 offen offset:0 sc1
  v_mfma_f32_16x16x32_bf16 v[212:215], v[60:63], a[228:231], v[212:215]
  v_mfma_f32_16x16x32_bf16 v[208:211], v[60:63], a[224:227], v[208:211]
  s_waitcnt vmcnt(28) lgkmcnt(6)
  v_mfma_f32_16x16x32_bf16 v[96:99], v[32:35], a[240:243], v[96:99]
  ds_read_b64_tr_b16 v[60:61], v9 offset:25344
  v_mfma_f32_16x16x32_bf16 v[100:103], v[32:35], a[244:247], v[100:103]
  ds_read_b64_tr_b16 v[62:63], v9 offset:29440
  v_mfma_f32_16x16x32_bf16 v[104:107], v[32:35], a[248:251], v[104:107]
  buffer_load_dwordx4 a[208:211], v20, s[16:19], s68 offen offset:1024 sc1
  v_mfma_f32_16x16x32_bf16 v[108:111], v[32:35], a[252:255], v[108:111]
  v_mfma_f32_16x16x32_bf16 v[124:127], v[36:39], a[252:255], v[124:127]
  buffer_load_dwordx4 a[212:215], v20, s[16:19], s69 offen offset:1024 sc1
  v_mfma_f32_16x16x32_bf16 v[120:123], v[36:39], a[248:251], v[120:123]
  v_mfma_f32_16x16x32_bf16 v[116:119], v[36:39], a[244:247], v[116:119]
  v_mfma_f32_16x16x32_bf16 v[112:115], v[36:39], a[240:243], v[112:115]
  s_waitcnt vmcnt(59)
  s_barrier
  v_mfma_f32_16x16x32_bf16 v[128:131], v[40:43], a[240:243], v[128:131]
  ds_read_b64_tr_b16 v[32:33], v10 offset:32768
  buffer_load_dwordx4 a[216:219], v20, s[16:19], s70 offen offset:1024 sc1
  v_mfma_f32_16x16x32_bf16 v[132:135], v[40:43], a[244:247], v[132:135]
  ds_read_b64_tr_b16 v[34:35], v10 offset:36864
  v_mfma_f32_16x16x32_bf16 v[136:139], v[40:43], a[248:251], v[136:139]
  ds_read_b64_tr_b16 v[36:37], v11 offset:32768
  v_mfma_f32_16x16x32_bf16 v[140:143], v[40:43], a[252:255], v[140:143]
  ds_read_b64_tr_b16 v[38:39], v11 offset:36864
  v_mfma_f32_16x16x32_bf16 v[156:159], v[44:47], a[252:255], v[156:159]
  ds_read_b64_tr_b16 v[40:41], v10 offset:33024
  v_mfma_f32_16x16x32_bf16 v[152:155], v[44:47], a[248:251], v[152:155]
  ds_read_b64_tr_b16 v[42:43], v10 offset:37120
  v_mfma_f32_16x16x32_bf16 v[148:151], v[44:47], a[244:247], v[148:151]
  buffer_load_dwordx4 a[220:223], v20, s[16:19], s71 offen offset:1024 sc1
  v_mfma_f32_16x16x32_bf16 v[144:147], v[44:47], a[240:243], v[144:147]
  s_waitcnt lgkmcnt(6)
  v_mfma_f32_16x16x32_bf16 v[160:163], v[48:51], a[240:243], v[160:163]
  ds_read_b64_tr_b16 v[44:45], v11 offset:33024
  v_mfma_f32_16x16x32_bf16 v[164:167], v[48:51], a[244:247], v[164:167]
  ds_read_b64_tr_b16 v[46:47], v11 offset:37120
  v_mfma_f32_16x16x32_bf16 v[168:171], v[48:51], a[248:251], v[168:171]
  buffer_load_dwordx4 a[224:227], v20, s[16:19], s68 offen offset:2048 sc1
  v_mfma_f32_16x16x32_bf16 v[172:175], v[48:51], a[252:255], v[172:175]
  ds_read_b64_tr_b16 v[48:49], v10 offset:33280
  v_mfma_f32_16x16x32_bf16 v[188:191], v[52:55], a[252:255], v[188:191]
  ds_read_b64_tr_b16 v[50:51], v10 offset:37376
  v_mfma_f32_16x16x32_bf16 v[184:187], v[52:55], a[248:251], v[184:187]
  buffer_load_dwordx4 a[228:231], v20, s[16:19], s69 offen offset:2048 sc1
  v_mfma_f32_16x16x32_bf16 v[180:183], v[52:55], a[244:247], v[180:183]
  v_mfma_f32_16x16x32_bf16 v[176:179], v[52:55], a[240:243], v[176:179]
  ds_read_b64_tr_b16 v[52:53], v11 offset:33280
  v_mfma_f32_16x16x32_bf16 v[192:195], v[56:59], a[240:243], v[192:195]
  ds_read_b64_tr_b16 v[54:55], v11 offset:37376
  v_mfma_f32_16x16x32_bf16 v[196:199], v[56:59], a[244:247], v[196:199]
  buffer_load_dwordx4 a[232:235], v20, s[16:19], s70 offen offset:2048 sc1
  v_mfma_f32_16x16x32_bf16 v[200:203], v[56:59], a[248:251], v[200:203]
  v_mfma_f32_16x16x32_bf16 v[204:207], v[56:59], a[252:255], v[204:207]
  ds_read_b64_tr_b16 v[56:57], v10 offset:33536
  v_mfma_f32_16x16x32_bf16 v[220:223], v[60:63], a[252:255], v[220:223]
  ds_read_b64_tr_b16 v[58:59], v10 offset:37632
  v_mfma_f32_16x16x32_bf16 v[216:219], v[60:63], a[248:251], v[216:219]
  buffer_load_dwordx4 a[236:239], v20, s[16:19], s71 offen offset:2048 sc1
  v_mfma_f32_16x16x32_bf16 v[212:215], v[60:63], a[244:247], v[212:215]
  v_mfma_f32_16x16x32_bf16 v[208:211], v[60:63], a[240:243], v[208:211]
  s_waitcnt vmcnt(32) lgkmcnt(6)
  v_mfma_f32_16x16x32_bf16 a[0:3], v[32:35], a[128:131], 0
  ds_read_b64_tr_b16 v[60:61], v11 offset:33536
  v_mfma_f32_16x16x32_bf16 a[4:7], v[32:35], a[132:135], 0
  ds_read_b64_tr_b16 v[62:63], v11 offset:37632
  v_mfma_f32_16x16x32_bf16 a[8:11], v[32:35], a[136:139], 0
  buffer_load_dwordx4 a[240:243], v20, s[16:19], s68 offen offset:3072 sc1
  v_mfma_f32_16x16x32_bf16 a[12:15], v[32:35], a[140:143], 0
  ds_read_b64_tr_b16 v[32:33], v10 offset:40960
  v_cvt_pk_bf16_f32 v128, v128, v129
  v_mfma_f32_16x16x32_bf16 a[28:31], v[36:39], a[140:143], 0
  ds_read_b64_tr_b16 v[34:35], v10 offset:45056
  v_cvt_pk_bf16_f32 v129, v130, v131
  v_mfma_f32_16x16x32_bf16 a[24:27], v[36:39], a[136:139], 0
  s_add_u32 m0, s63, 65536
  s_add_u32 s42, s65, 786432
  v_mfma_f32_16x16x32_bf16 a[20:23], v[36:39], a[132:135], 0
  buffer_load_dwordx4 v4, s[8:11], s42 offen offset:0 lds
  v_mfma_f32_16x16x32_bf16 a[16:19], v[36:39], a[128:131], 0
  ds_read_b64_tr_b16 v[36:37], v11 offset:40960
  v_cvt_pk_bf16_f32 v130, v132, v133
  v_mfma_f32_16x16x32_bf16 a[32:35], v[40:43], a[128:131], 0
  ds_read_b64_tr_b16 v[38:39], v11 offset:45056
  v_cvt_pk_bf16_f32 v131, v134, v135
  v_mfma_f32_16x16x32_bf16 a[36:39], v[40:43], a[132:135], 0
  buffer_load_dwordx4 a[244:247], v20, s[16:19], s69 offen offset:3072 sc1
  v_mfma_f32_16x16x32_bf16 a[40:43], v[40:43], a[136:139], 0
  v_cvt_pk_bf16_f32 v132, v136, v137
  v_mfma_f32_16x16x32_bf16 a[44:47], v[40:43], a[140:143], 0
  ds_read_b64_tr_b16 v[40:41], v10 offset:41216
  v_cvt_pk_bf16_f32 v133, v138, v139
  v_mfma_f32_16x16x32_bf16 a[60:63], v[44:47], a[140:143], 0
  ds_read_b64_tr_b16 v[42:43], v10 offset:45312
  v_mfma_f32_16x16x32_bf16 a[56:59], v[44:47], a[136:139], 0
  buffer_load_dwordx4 v5, s[8:11], s42 offen offset:1024 lds
  v_cvt_pk_bf16_f32 v134, v140, v141
  v_mfma_f32_16x16x32_bf16 a[52:55], v[44:47], a[132:135], 0
  v_cvt_pk_bf16_f32 v135, v142, v143
  v_mfma_f32_16x16x32_bf16 a[48:51], v[44:47], a[128:131], 0
  s_waitcnt lgkmcnt(6)
  v_mfma_f32_16x16x32_bf16 a[64:67], v[48:51], a[128:131], 0
  ds_read_b64_tr_b16 v[44:45], v11 offset:41216
  buffer_load_dwordx4 a[248:251], v20, s[16:19], s70 offen offset:3072 sc1
  v_cvt_pk_bf16_f32 v136, v144, v145
  v_mfma_f32_16x16x32_bf16 a[68:71], v[48:51], a[132:135], 0
  ds_read_b64_tr_b16 v[46:47], v11 offset:45312
  v_cvt_pk_bf16_f32 v137, v146, v147
  v_mfma_f32_16x16x32_bf16 a[72:75], v[48:51], a[136:139], 0
  v_cvt_pk_bf16_f32 v138, v148, v149
  v_mfma_f32_16x16x32_bf16 a[76:79], v[48:51], a[140:143], 0
  ds_read_b64_tr_b16 v[48:49], v10 offset:41472
  v_mfma_f32_16x16x32_bf16 a[92:95], v[52:55], a[140:143], 0
  ds_read_b64_tr_b16 v[50:51], v10 offset:45568
  v_cvt_pk_bf16_f32 v139, v150, v151
  v_mfma_f32_16x16x32_bf16 a[88:91], v[52:55], a[136:139], 0
  buffer_load_dwordx4 v6, s[8:11], s42 offen offset:2048 lds
  v_mfma_f32_16x16x32_bf16 a[84:87], v[52:55], a[132:135], 0
  v_cvt_pk_bf16_f32 v140, v152, v153
  v_mfma_f32_16x16x32_bf16 a[80:83], v[52:55], a[128:131], 0
  ds_read_b64_tr_b16 v[52:53], v11 offset:41472
  v_cvt_pk_bf16_f32 v141, v154, v155
  v_mfma_f32_16x16x32_bf16 a[96:99], v[56:59], a[128:131], 0
  ds_read_b64_tr_b16 v[54:55], v11 offset:45568
  v_mfma_f32_16x16x32_bf16 a[100:103], v[56:59], a[132:135], 0
  buffer_load_dwordx4 a[252:255], v20, s[16:19], s71 offen offset:3072 sc1
  v_cvt_pk_bf16_f32 v142, v156, v157
  v_mfma_f32_16x16x32_bf16 a[104:107], v[56:59], a[136:139], 0
  v_cvt_pk_bf16_f32 v143, v158, v159
  v_mfma_f32_16x16x32_bf16 a[108:111], v[56:59], a[140:143], 0
  ds_read_b64_tr_b16 v[56:57], v10 offset:41728
  v_mfma_f32_16x16x32_bf16 a[124:127], v[60:63], a[140:143], 0
  ds_read_b64_tr_b16 v[58:59], v10 offset:45824
  v_mfma_f32_16x16x32_bf16 a[120:123], v[60:63], a[136:139], 0
  buffer_load_dwordx4 v7, s[8:11], s42 offen offset:3072 lds
  v_mfma_f32_16x16x32_bf16 a[116:119], v[60:63], a[132:135], 0
  v_mfma_f32_16x16x32_bf16 a[112:115], v[60:63], a[128:131], 0
  s_waitcnt vmcnt(33) lgkmcnt(6)
  v_mfma_f32_16x16x32_bf16 a[0:3], v[32:35], a[144:147], a[0:3]
  ds_read_b64_tr_b16 v[60:61], v11 offset:41728
  ds_read_b64_tr_b16 v[62:63], v11 offset:45824
  v_mfma_f32_16x16x32_bf16 a[4:7], v[32:35], a[148:151], a[4:7]
  s_add_u32 s68, s67, 8192
  v_mfma_f32_16x16x32_bf16 a[8:11], v[32:35], a[152:155], a[8:11]
  buffer_load_dwordx4 a[128:131], v20, s[16:19], s68 offen offset:0 sc1
  v_mfma_f32_16x16x32_bf16 a[12:15], v[32:35], a[156:159], a[12:15]
  ds_read_b64_tr_b16 v[32:33], v10 offset:49152
  v_mfma_f32_16x16x32_bf16 a[28:31], v[36:39], a[156:159], a[28:31]
  ds_read_b64_tr_b16 v[34:35], v10 offset:53248
  v_cvt_pk_bf16_f32 v160, v160, v161
  v_mfma_f32_16x16x32_bf16 a[24:27], v[36:39], a[152:155], a[24:27]
  s_xor_b32 s86, s74, 8192
  s_add_u32 s86, s86, 67108864
  v_cvt_pk_bf16_f32 v161, v162, v163
  v_mfma_f32_16x16x32_bf16 a[20:23], v[36:39], a[148:151], a[20:23]
  buffer_store_dwordx4 v[128:131], v20, s[16:19], s86 offen sc1
  v_mfma_f32_16x16x32_bf16 a[16:19], v[36:39], a[144:147], a[16:19]
  ds_read_b64_tr_b16 v[36:37], v11 offset:49152
  v_cvt_pk_bf16_f32 v162, v164, v165
  v_mfma_f32_16x16x32_bf16 a[32:35], v[40:43], a[144:147], a[32:35]
  ds_read_b64_tr_b16 v[38:39], v11 offset:53248
  v_cvt_pk_bf16_f32 v163, v166, v167
  v_mfma_f32_16x16x32_bf16 a[36:39], v[40:43], a[148:151], a[36:39]
  v_cvt_pk_bf16_f32 v164, v168, v169
  v_mfma_f32_16x16x32_bf16 a[40:43], v[40:43], a[152:155], a[40:43]
  v_cvt_pk_bf16_f32 v165, v170, v171
  v_mfma_f32_16x16x32_bf16 a[44:47], v[40:43], a[156:159], a[44:47]
  ds_read_b64_tr_b16 v[40:41], v10 offset:49408
  ds_read_b64_tr_b16 v[42:43], v10 offset:53504
  v_mfma_f32_16x16x32_bf16 a[60:63], v[44:47], a[156:159], a[60:63]
  s_add_u32 s69, s67, 139520
  v_mfma_f32_16x16x32_bf16 a[56:59], v[44:47], a[152:155], a[56:59]
  buffer_load_dwordx4 a[132:135], v20, s[16:19], s69 offen offset:0 sc1
  v_cvt_pk_bf16_f32 v166, v172, v173
  v_mfma_f32_16x16x32_bf16 a[52:55], v[44:47], a[148:151], a[52:55]
  v_cvt_pk_bf16_f32 v167, v174, v175
  v_mfma_f32_16x16x32_bf16 a[48:51], v[44:47], a[144:147], a[48:51]
  s_waitcnt lgkmcnt(6)
  v_mfma_f32_16x16x32_bf16 a[64:67], v[48:51], a[144:147], a[64:67]
  ds_read_b64_tr_b16 v[44:45], v11 offset:49408
  v_cvt_pk_bf16_f32 v168, v176, v177
  v_mfma_f32_16x16x32_bf16 a[68:71], v[48:51], a[148:151], a[68:71]
  ds_read_b64_tr_b16 v[46:47], v11 offset:53504
  v_cvt_pk_bf16_f32 v169, v178, v179
  v_mfma_f32_16x16x32_bf16 a[72:75], v[48:51], a[152:155], a[72:75]
  s_add_u32 s70, s67, 270848
  v_mfma_f32_16x16x32_bf16 a[76:79], v[48:51], a[156:159], a[76:79]
  ds_read_b64_tr_b16 v[48:49], v10 offset:49664
  buffer_load_dwordx4 a[136:139], v20, s[16:19], s70 offen offset:0 sc1
  v_cvt_pk_bf16_f32 v170, v180, v181
  v_mfma_f32_16x16x32_bf16 a[92:95], v[52:55], a[156:159], a[92:95]
  ds_read_b64_tr_b16 v[50:51], v10 offset:53760
  v_cvt_pk_bf16_f32 v171, v182, v183
  v_mfma_f32_16x16x32_bf16 a[88:91], v[52:55], a[152:155], a[88:91]
  v_cvt_pk_bf16_f32 v172, v184, v185
  v_mfma_f32_16x16x32_bf16 a[84:87], v[52:55], a[148:151], a[84:87]
  v_cvt_pk_bf16_f32 v173, v186, v187
  v_mfma_f32_16x16x32_bf16 a[80:83], v[52:55], a[144:147], a[80:83]
  ds_read_b64_tr_b16 v[52:53], v11 offset:49664
  v_mfma_f32_16x16x32_bf16 a[96:99], v[56:59], a[144:147], a[96:99]
  ds_read_b64_tr_b16 v[54:55], v11 offset:53760
  v_cvt_pk_bf16_f32 v174, v188, v189
  v_mfma_f32_16x16x32_bf16 a[100:103], v[56:59], a[148:151], a[100:103]
  s_add_u32 s71, s67, 402176
  v_mfma_f32_16x16x32_bf16 a[104:107], v[56:59], a[152:155], a[104:107]
  buffer_load_dwordx4 a[140:143], v20, s[16:19], s71 offen offset:0 sc1
  v_cvt_pk_bf16_f32 v175, v190, v191
  v_mfma_f32_16x16x32_bf16 a[108:111], v[56:59], a[156:159], a[108:111]
  ds_read_b64_tr_b16 v[56:57], v10 offset:49920
  v_mfma_f32_16x16x32_bf16 a[124:127], v[60:63], a[156:159], a[124:127]
  ds_read_b64_tr_b16 v[58:59], v10 offset:54016
  v_mfma_f32_16x16x32_bf16 a[120:123], v[60:63], a[152:155], a[120:123]
  v_mfma_f32_16x16x32_bf16 a[116:119], v[60:63], a[148:151], a[116:119]
  v_mfma_f32_16x16x32_bf16 a[112:115], v[60:63], a[144:147], a[112:115]
  s_waitcnt vmcnt(30) lgkmcnt(6)
  v_mfma_f32_16x16x32_bf16 a[0:3], v[32:35], a[160:163], a[0:3]
  ds_read_b64_tr_b16 v[60:61], v11 offset:49920
  v_mfma_f32_16x16x32_bf16 a[4:7], v[32:35], a[164:167], a[4:7]
  ds_read_b64_tr_b16 v[62:63], v11 offset:54016
  v_mfma_f32_16x16x32_bf16 a[8:11], v[32:35], a[168:171], a[8:11]
  buffer_load_dwordx4 a[144:147], v20, s[16:19], s68 offen offset:1024 sc1
  v_mfma_f32_16x16x32_bf16 a[12:15], v[32:35], a[172:175], a[12:15]
  ds_read_b64_tr_b16 v[32:33], v10 offset:57344
  v_mfma_f32_16x16x32_bf16 a[28:31], v[36:39], a[172:175], a[28:31]
  ds_read_b64_tr_b16 v[34:35], v10 offset:61440
  v_cvt_pk_bf16_f32 v192, v192, v193
  v_mfma_f32_16x16x32_bf16 a[24:27], v[36:39], a[168:171], a[24:27]
  s_xor_b32 s86, s74, 8192
  s_add_u32 s86, s86, 68157440
  v_cvt_pk_bf16_f32 v193, v194, v195
  v_mfma_f32_16x16x32_bf16 a[20:23], v[36:39], a[164:167], a[20:23]
  buffer_store_dwordx4 v[132:135], v20, s[16:19], s86 offen sc1
  v_mfma_f32_16x16x32_bf16 a[16:19], v[36:39], a[160:163], a[16:19]
  ds_read_b64_tr_b16 v[36:37], v11 offset:57344
  v_cvt_pk_bf16_f32 v194, v196, v197
  v_mfma_f32_16x16x32_bf16 a[32:35], v[40:43], a[160:163], a[32:35]
  ds_read_b64_tr_b16 v[38:39], v11 offset:61440
  v_cvt_pk_bf16_f32 v195, v198, v199
  v_mfma_f32_16x16x32_bf16 a[36:39], v[40:43], a[164:167], a[36:39]
  v_cvt_pk_bf16_f32 v196, v200, v201
  v_mfma_f32_16x16x32_bf16 a[40:43], v[40:43], a[168:171], a[40:43]
  v_cvt_pk_bf16_f32 v197, v202, v203
  v_mfma_f32_16x16x32_bf16 a[44:47], v[40:43], a[172:175], a[44:47]
  ds_read_b64_tr_b16 v[40:41], v10 offset:57600
  v_mfma_f32_16x16x32_bf16 a[60:63], v[44:47], a[172:175], a[60:63]
  ds_read_b64_tr_b16 v[42:43], v10 offset:61696
  v_mfma_f32_16x16x32_bf16 a[56:59], v[44:47], a[168:171], a[56:59]
  buffer_load_dwordx4 a[148:151], v20, s[16:19], s69 offen offset:1024 sc1
  v_cvt_pk_bf16_f32 v198, v204, v205
  v_mfma_f32_16x16x32_bf16 a[52:55], v[44:47], a[164:167], a[52:55]
  v_cvt_pk_bf16_f32 v199, v206, v207
  v_mfma_f32_16x16x32_bf16 a[48:51], v[44:47], a[160:163], a[48:51]
  s_waitcnt lgkmcnt(6)
  v_mfma_f32_16x16x32_bf16 a[64:67], v[48:51], a[160:163], a[64:67]
  ds_read_b64_tr_b16 v[44:45], v11 offset:57600
  v_cvt_pk_bf16_f32 v200, v208, v209
  v_mfma_f32_16x16x32_bf16 a[68:71], v[48:51], a[164:167], a[68:71]
  ds_read_b64_tr_b16 v[46:47], v11 offset:61696
  v_cvt_pk_bf16_f32 v201, v210, v211
  v_mfma_f32_16x16x32_bf16 a[72:75], v[48:51], a[168:171], a[72:75]
  v_cvt_pk_bf16_f32 v202, v212, v213
  v_mfma_f32_16x16x32_bf16 a[76:79], v[48:51], a[172:175], a[76:79]
  ds_read_b64_tr_b16 v[48:49], v10 offset:57856
  buffer_load_dwordx4 a[152:155], v20, s[16:19], s70 offen offset:1024 sc1
  v_mfma_f32_16x16x32_bf16 a[92:95], v[52:55], a[172:175], a[92:95]
  ds_read_b64_tr_b16 v[50:51], v10 offset:61952
  v_cvt_pk_bf16_f32 v203, v214, v215
  v_mfma_f32_16x16x32_bf16 a[88:91], v[52:55], a[168:171], a[88:91]
  v_cvt_pk_bf16_f32 v204, v216, v217
  v_mfma_f32_16x16x32_bf16 a[84:87], v[52:55], a[164:167], a[84:87]
  v_cvt_pk_bf16_f32 v205, v218, v219
  v_mfma_f32_16x16x32_bf16 a[80:83], v[52:55], a[160:163], a[80:83]
  ds_read_b64_tr_b16 v[52:53], v11 offset:57856
  v_mfma_f32_16x16x32_bf16 a[96:99], v[56:59], a[160:163], a[96:99]
  ds_read_b64_tr_b16 v[54:55], v11 offset:61952
  v_mfma_f32_16x16x32_bf16 a[100:103], v[56:59], a[164:167], a[100:103]
  buffer_load_dwordx4 a[156:159], v20, s[16:19], s71 offen offset:1024 sc1
  v_cvt_pk_bf16_f32 v206, v220, v221
  v_mfma_f32_16x16x32_bf16 a[104:107], v[56:59], a[168:171], a[104:107]
  v_cvt_pk_bf16_f32 v207, v222, v223
  v_mfma_f32_16x16x32_bf16 a[108:111], v[56:59], a[172:175], a[108:111]
  ds_read_b64_tr_b16 v[56:57], v10 offset:58112
  v_mfma_f32_16x16x32_bf16 a[124:127], v[60:63], a[172:175], a[124:127]
  ds_read_b64_tr_b16 v[58:59], v10 offset:62208
  v_mfma_f32_16x16x32_bf16 a[120:123], v[60:63], a[168:171], a[120:123]
  v_mfma_f32_16x16x32_bf16 a[116:119], v[60:63], a[164:167], a[116:119]
  v_mfma_f32_16x16x32_bf16 a[112:115], v[60:63], a[160:163], a[112:115]
  s_waitcnt vmcnt(30) lgkmcnt(6)
  v_mfma_f32_16x16x32_bf16 a[0:3], v[32:35], a[176:179], a[0:3]
  ds_read_b64_tr_b16 v[60:61], v11 offset:58112
  v_mfma_f32_16x16x32_bf16 a[4:7], v[32:35], a[180:183], a[4:7]
  ds_read_b64_tr_b16 v[62:63], v11 offset:62208
  v_mfma_f32_16x16x32_bf16 a[8:11], v[32:35], a[184:187], a[8:11]
  buffer_load_dwordx4 a[160:163], v20, s[16:19], s68 offen offset:2048 sc1
  v_mfma_f32_16x16x32_bf16 a[12:15], v[32:35], a[188:191], a[12:15]
  v_mfma_f32_16x16x32_bf16 a[28:31], v[36:39], a[188:191], a[28:31]
  v_mfma_f32_16x16x32_bf16 a[24:27], v[36:39], a[184:187], a[24:27]
  s_xor_b32 s86, s74, 8192
  s_add_u32 s86, s86, 69206016
  v_mfma_f32_16x16x32_bf16 a[20:23], v[36:39], a[180:183], a[20:23]
  buffer_store_dwordx4 v[136:139], v20, s[16:19], s86 offen sc1
  v_mfma_f32_16x16x32_bf16 a[16:19], v[36:39], a[176:179], a[16:19]
  s_waitcnt vmcnt(60)
  s_barrier
  v_mfma_f32_16x16x32_bf16 a[32:35], v[40:43], a[176:179], a[32:35]
  ds_read_b64_tr_b16 v[32:33], v12 offset:0
  ds_read_b64_tr_b16 v[34:35], v12 offset:4096
  v_mfma_f32_16x16x32_bf16 a[36:39], v[40:43], a[180:183], a[36:39]
  ds_read_b64_tr_b16 v[36:37], v13 offset:0
  v_mfma_f32_16x16x32_bf16 a[40:43], v[40:43], a[184:187], a[40:43]
  ds_read_b64_tr_b16 v[38:39], v13 offset:4096
  v_mfma_f32_16x16x32_bf16 a[44:47], v[40:43], a[188:191], a[44:47]
  ds_read_b64_tr_b16 v[40:41], v12 offset:256
  v_mfma_f32_16x16x32_bf16 a[60:63], v[44:47], a[188:191], a[60:63]
  ds_read_b64_tr_b16 v[42:43], v12 offset:4352
  v_mfma_f32_16x16x32_bf16 a[56:59], v[44:47], a[184:187], a[56:59]
  buffer_load_dwordx4 a[164:167], v20, s[16:19], s69 offen offset:2048 sc1
  v_mfma_f32_16x16x32_bf16 a[52:55], v[44:47], a[180:183], a[52:55]
  v_mfma_f32_16x16x32_bf16 a[48:51], v[44:47], a[176:179], a[48:51]
  s_waitcnt lgkmcnt(6)
  v_mfma_f32_16x16x32_bf16 a[64:67], v[48:51], a[176:179], a[64:67]
  ds_read_b64_tr_b16 v[44:45], v13 offset:256
  v_mfma_f32_16x16x32_bf16 a[68:71], v[48:51], a[180:183], a[68:71]
  ds_read_b64_tr_b16 v[46:47], v13 offset:4352
  v_mfma_f32_16x16x32_bf16 a[72:75], v[48:51], a[184:187], a[72:75]
  v_mfma_f32_16x16x32_bf16 a[76:79], v[48:51], a[188:191], a[76:79]
  ds_read_b64_tr_b16 v[48:49], v12 offset:512
  v_mfma_f32_16x16x32_bf16 a[92:95], v[52:55], a[188:191], a[92:95]
  ds_read_b64_tr_b16 v[50:51], v12 offset:4608
  v_mfma_f32_16x16x32_bf16 a[88:91], v[52:55], a[184:187], a[88:91]
  buffer_load_dwordx4 a[168:171], v20, s[16:19], s70 offen offset:2048 sc1
  v_mfma_f32_16x16x32_bf16 a[84:87], v[52:55], a[180:183], a[84:87]
  v_mfma_f32_16x16x32_bf16 a[80:83], v[52:55], a[176:179], a[80:83]
  ds_read_b64_tr_b16 v[52:53], v13 offset:512
  v_mfma_f32_16x16x32_bf16 a[96:99], v[56:59], a[176:179], a[96:99]
  ds_read_b64_tr_b16 v[54:55], v13 offset:4608
  v_mfma_f32_16x16x32_bf16 a[100:103], v[56:59], a[180:183], a[100:103]
  buffer_load_dwordx4 a[172:175], v20, s[16:19], s71 offen offset:2048 sc1
  v_mfma_f32_16x16x32_bf16 a[104:107], v[56:59], a[184:187], a[104:107]
  v_mfma_f32_16x16x32_bf16 a[108:111], v[56:59], a[188:191], a[108:111]
  ds_read_b64_tr_b16 v[56:57], v12 offset:768
  v_mfma_f32_16x16x32_bf16 a[124:127], v[60:63], a[188:191], a[124:127]
  ds_read_b64_tr_b16 v[58:59], v12 offset:4864
  v_mfma_f32_16x16x32_bf16 a[120:123], v[60:63], a[184:187], a[120:123]
  v_mfma_f32_16x16x32_bf16 a[116:119], v[60:63], a[180:183], a[116:119]
  v_mfma_f32_16x16x32_bf16 a[112:115], v[60:63], a[176:179], a[112:115]
  s_waitcnt vmcnt(31) lgkmcnt(6)
  v_mfma_f32_16x16x32_bf16 a[0:3], v[32:35], a[192:195], a[0:3]
  ds_read_b64_tr_b16 v[60:61], v13 offset:768
  v_mfma_f32_16x16x32_bf16 a[4:7], v[32:35], a[196:199], a[4:7]
  ds_read_b64_tr_b16 v[62:63], v13 offset:4864
  v_mfma_f32_16x16x32_bf16 a[8:11], v[32:35], a[200:203], a[8:11]
  buffer_load_dwordx4 a[176:179], v20, s[16:19], s68 offen offset:3072 sc1
  v_mfma_f32_16x16x32_bf16 a[12:15], v[32:35], a[204:207], a[12:15]
  ds_read_b64_tr_b16 v[32:33], v12 offset:8192
  v_mfma_f32_16x16x32_bf16 a[28:31], v[36:39], a[204:207], a[28:31]
  ds_read_b64_tr_b16 v[34:35], v12 offset:12288
  v_mfma_f32_16x16x32_bf16 a[24:27], v[36:39], a[200:203], a[24:27]
  s_xor_b32 s86, s74, 8192
  s_add_u32 s86, s86, 70254592
  v_mfma_f32_16x16x32_bf16 a[20:23], v[36:39], a[196:199], a[20:23]
  buffer_store_dwordx4 v[140:143], v20, s[16:19], s86 offen sc1
  v_mfma_f32_16x16x32_bf16 a[16:19], v[36:39], a[192:195], a[16:19]
  ds_read_b64_tr_b16 v[36:37], v13 offset:8192
  v_mfma_f32_16x16x32_bf16 a[32:35], v[40:43], a[192:195], a[32:35]
  ds_read_b64_tr_b16 v[38:39], v13 offset:12288
  v_mfma_f32_16x16x32_bf16 a[36:39], v[40:43], a[196:199], a[36:39]
  v_mfma_f32_16x16x32_bf16 a[40:43], v[40:43], a[200:203], a[40:43]
  v_mfma_f32_16x16x32_bf16 a[44:47], v[40:43], a[204:207], a[44:47]
  ds_read_b64_tr_b16 v[40:41], v12 offset:8448
  v_mfma_f32_16x16x32_bf16 a[60:63], v[44:47], a[204:207], a[60:63]
  ds_read_b64_tr_b16 v[42:43], v12 offset:12544
  v_mfma_f32_16x16x32_bf16 a[56:59], v[44:47], a[200:203], a[56:59]
  buffer_load_dwordx4 a[180:183], v20, s[16:19], s69 offen offset:3072 sc1
  v_mfma_f32_16x16x32_bf16 a[52:55], v[44:47], a[196:199], a[52:55]
  v_mfma_f32_16x16x32_bf16 a[48:51], v[44:47], a[192:195], a[48:51]
  s_waitcnt lgkmcnt(6)
  v_mfma_f32_16x16x32_bf16 a[64:67], v[48:51], a[192:195], a[64:67]
  ds_read_b64_tr_b16 v[44:45], v13 offset:8448
  v_mfma_f32_16x16x32_bf16 a[68:71], v[48:51], a[196:199], a[68:71]
  ds_read_b64_tr_b16 v[46:47], v13 offset:12544
  v_mfma_f32_16x16x32_bf16 a[72:75], v[48:51], a[200:203], a[72:75]
  v_mfma_f32_16x16x32_bf16 a[76:79], v[48:51], a[204:207], a[76:79]
  ds_read_b64_tr_b16 v[48:49], v12 offset:8704
  v_mfma_f32_16x16x32_bf16 a[92:95], v[52:55], a[204:207], a[92:95]
  ds_read_b64_tr_b16 v[50:51], v12 offset:12800
  v_mfma_f32_16x16x32_bf16 a[88:91], v[52:55], a[200:203], a[88:91]
  buffer_load_dwordx4 a[184:187], v20, s[16:19], s70 offen offset:3072 sc1
  v_mfma_f32_16x16x32_bf16 a[84:87], v[52:55], a[196:199], a[84:87]
  v_mfma_f32_16x16x32_bf16 a[80:83], v[52:55], a[192:195], a[80:83]
  ds_read_b64_tr_b16 v[52:53], v13 offset:8704
  v_mfma_f32_16x16x32_bf16 a[96:99], v[56:59], a[192:195], a[96:99]
  ds_read_b64_tr_b16 v[54:55], v13 offset:12800
  v_mfma_f32_16x16x32_bf16 a[100:103], v[56:59], a[196:199], a[100:103]
  buffer_load_dwordx4 a[188:191], v20, s[16:19], s71 offen offset:3072 sc1
  v_mfma_f32_16x16x32_bf16 a[104:107], v[56:59], a[200:203], a[104:107]
  v_mfma_f32_16x16x32_bf16 a[108:111], v[56:59], a[204:207], a[108:111]
  ds_read_b64_tr_b16 v[56:57], v12 offset:8960
  v_mfma_f32_16x16x32_bf16 a[124:127], v[60:63], a[204:207], a[124:127]
  ds_read_b64_tr_b16 v[58:59], v12 offset:13056
  v_mfma_f32_16x16x32_bf16 a[120:123], v[60:63], a[200:203], a[120:123]
  v_mfma_f32_16x16x32_bf16 a[116:119], v[60:63], a[196:199], a[116:119]
  v_mfma_f32_16x16x32_bf16 a[112:115], v[60:63], a[192:195], a[112:115]
  s_waitcnt vmcnt(32) lgkmcnt(6)
  v_mfma_f32_16x16x32_bf16 a[0:3], v[32:35], a[208:211], a[0:3]
  ds_read_b64_tr_b16 v[60:61], v13 offset:8960
  ds_read_b64_tr_b16 v[62:63], v13 offset:13056
  v_mfma_f32_16x16x32_bf16 a[4:7], v[32:35], a[212:215], a[4:7]
  s_add_u32 s68, s67, 12288
  v_mfma_f32_16x16x32_bf16 a[8:11], v[32:35], a[216:219], a[8:11]
  buffer_load_dwordx4 a[192:195], v20, s[16:19], s68 offen offset:0 sc1
  v_mfma_f32_16x16x32_bf16 a[12:15], v[32:35], a[220:223], a[12:15]
  ds_read_b64_tr_b16 v[32:33], v12 offset:16384
  v_mfma_f32_16x16x32_bf16 a[28:31], v[36:39], a[220:223], a[28:31]
  ds_read_b64_tr_b16 v[34:35], v12 offset:20480
  v_mfma_f32_16x16x32_bf16 a[24:27], v[36:39], a[216:219], a[24:27]
  s_xor_b32 s86, s74, 16384
  s_add_u32 s86, s86, 71303168
  v_mfma_f32_16x16x32_bf16 a[20:23], v[36:39], a[212:215], a[20:23]
  buffer_store_dwordx4 v[160:163], v20, s[16:19], s86 offen sc1
  v_mfma_f32_16x16x32_bf16 a[16:19], v[36:39], a[208:211], a[16:19]
  ds_read_b64_tr_b16 v[36:37], v13 offset:16384
  v_mfma_f32_16x16x32_bf16 a[32:35], v[40:43], a[208:211], a[32:35]
  ds_read_b64_tr_b16 v[38:39], v13 offset:20480
  v_mfma_f32_16x16x32_bf16 a[36:39], v[40:43], a[212:215], a[36:39]
  v_mfma_f32_16x16x32_bf16 a[40:43], v[40:43], a[216:219], a[40:43]
  v_mfma_f32_16x16x32_bf16 a[44:47], v[40:43], a[220:223], a[44:47]
  ds_read_b64_tr_b16 v[40:41], v12 offset:16640
  ds_read_b64_tr_b16 v[42:43], v12 offset:20736
  v_mfma_f32_16x16x32_bf16 a[60:63], v[44:47], a[220:223], a[60:63]
  s_add_u32 s69, s67, 143616
  v_mfma_f32_16x16x32_bf16 a[56:59], v[44:47], a[216:219], a[56:59]
  buffer_load_dwordx4 a[196:199], v20, s[16:19], s69 offen offset:0 sc1
  v_mfma_f32_16x16x32_bf16 a[52:55], v[44:47], a[212:215], a[52:55]
  v_mfma_f32_16x16x32_bf16 a[48:51], v[44:47], a[208:211], a[48:51]
  s_waitcnt lgkmcnt(6)
  v_mfma_f32_16x16x32_bf16 a[64:67], v[48:51], a[208:211], a[64:67]
  ds_read_b64_tr_b16 v[44:45], v13 offset:16640
  v_mfma_f32_16x16x32_bf16 a[68:71], v[48:51], a[212:215], a[68:71]
  ds_read_b64_tr_b16 v[46:47], v13 offset:20736
  v_mfma_f32_16x16x32_bf16 a[72:75], v[48:51], a[216:219], a[72:75]
  s_add_u32 s70, s67, 274944
  v_mfma_f32_16x16x32_bf16 a[76:79], v[48:51], a[220:223], a[76:79]
  ds_read_b64_tr_b16 v[48:49], v12 offset:16896
  v_mfma_f32_16x16x32_bf16 a[92:95], v[52:55], a[220:223], a[92:95]
  ds_read_b64_tr_b16 v[50:51], v12 offset:20992
  v_mfma_f32_16x16x32_bf16 a[88:91], v[52:55], a[216:219], a[88:91]
  buffer_load_dwordx4 a[200:203], v20, s[16:19], s70 offen offset:0 sc1
  v_mfma_f32_16x16x32_bf16 a[84:87], v[52:55], a[212:215], a[84:87]
  v_mfma_f32_16x16x32_bf16 a[80:83], v[52:55], a[208:211], a[80:83]
  ds_read_b64_tr_b16 v[52:53], v13 offset:16896
  v_mfma_f32_16x16x32_bf16 a[96:99], v[56:59], a[208:211], a[96:99]
  ds_read_b64_tr_b16 v[54:55], v13 offset:20992
  v_mfma_f32_16x16x32_bf16 a[100:103], v[56:59], a[212:215], a[100:103]
  s_add_u32 s71, s67, 406272
  v_mfma_f32_16x16x32_bf16 a[104:107], v[56:59], a[216:219], a[104:107]
  buffer_load_dwordx4 a[204:207], v20, s[16:19], s71 offen offset:0 sc1
  v_mfma_f32_16x16x32_bf16 a[108:111], v[56:59], a[220:223], a[108:111]
  ds_read_b64_tr_b16 v[56:57], v12 offset:17152
  v_mfma_f32_16x16x32_bf16 a[124:127], v[60:63], a[220:223], a[124:127]
  ds_read_b64_tr_b16 v[58:59], v12 offset:21248
  v_mfma_f32_16x16x32_bf16 a[120:123], v[60:63], a[216:219], a[120:123]
  v_mfma_f32_16x16x32_bf16 a[116:119], v[60:63], a[212:215], a[116:119]
  v_mfma_f32_16x16x32_bf16 a[112:115], v[60:63], a[208:211], a[112:115]
  s_waitcnt vmcnt(33) lgkmcnt(6)
  v_mfma_f32_16x16x32_bf16 a[0:3], v[32:35], a[224:227], a[0:3]
  ds_read_b64_tr_b16 v[60:61], v13 offset:17152
  v_mfma_f32_16x16x32_bf16 a[4:7], v[32:35], a[228:231], a[4:7]
  ds_read_b64_tr_b16 v[62:63], v13 offset:21248
  v_mfma_f32_16x16x32_bf16 a[8:11], v[32:35], a[232:235], a[8:11]
  buffer_load_dwordx4 a[208:211], v20, s[16:19], s68 offen offset:1024 sc1
  v_mfma_f32_16x16x32_bf16 a[12:15], v[32:35], a[236:239], a[12:15]
  ds_read_b64_tr_b16 v[32:33], v12 offset:24576
  v_mfma_f32_16x16x32_bf16 a[28:31], v[36:39], a[236:239], a[28:31]
  ds_read_b64_tr_b16 v[34:35], v12 offset:28672
  v_mfma_f32_16x16x32_bf16 a[24:27], v[36:39], a[232:235], a[24:27]
  s_xor_b32 s86, s74, 16384
  s_add_u32 s86, s86, 72351744
  v_mfma_f32_16x16x32_bf16 a[20:23], v[36:39], a[228:231], a[20:23]
  buffer_store_dwordx4 v[164:167], v20, s[16:19], s86 offen sc1
  v_mfma_f32_16x16x32_bf16 a[16:19], v[36:39], a[224:227], a[16:19]
  ds_read_b64_tr_b16 v[36:37], v13 offset:24576
  v_mfma_f32_16x16x32_bf16 a[32:35], v[40:43], a[224:227], a[32:35]
  ds_read_b64_tr_b16 v[38:39], v13 offset:28672
  v_mfma_f32_16x16x32_bf16 a[36:39], v[40:43], a[228:231], a[36:39]
  s_add_u32 m0, s63, 69632
  s_add_u32 s43, s65, 819200
  v_mfma_f32_16x16x32_bf16 a[40:43], v[40:43], a[232:235], a[40:43]
  buffer_load_dwordx4 v4, s[8:11], s43 offen offset:0 lds
  v_mfma_f32_16x16x32_bf16 a[44:47], v[40:43], a[236:239], a[44:47]
  ds_read_b64_tr_b16 v[40:41], v12 offset:24832
  v_mfma_f32_16x16x32_bf16 a[60:63], v[44:47], a[236:239], a[60:63]
  ds_read_b64_tr_b16 v[42:43], v12 offset:28928
  v_mfma_f32_16x16x32_bf16 a[56:59], v[44:47], a[232:235], a[56:59]
  v_mfma_f32_16x16x32_bf16 a[52:55], v[44:47], a[228:231], a[52:55]
  v_mfma_f32_16x16x32_bf16 a[48:51], v[44:47], a[224:227], a[48:51]
  s_waitcnt lgkmcnt(6)
  v_mfma_f32_16x16x32_bf16 a[64:67], v[48:51], a[224:227], a[64:67]
  ds_read_b64_tr_b16 v[44:45], v13 offset:24832
  v_mfma_f32_16x16x32_bf16 a[68:71], v[48:51], a[228:231], a[68:71]
  ds_read_b64_tr_b16 v[46:47], v13 offset:28928
  v_mfma_f32_16x16x32_bf16 a[72:75], v[48:51], a[232:235], a[72:75]
  buffer_load_dwordx4 a[212:215], v20, s[16:19], s69 offen offset:1024 sc1
  v_mfma_f32_16x16x32_bf16 a[76:79], v[48:51], a[236:239], a[76:79]
  ds_read_b64_tr_b16 v[48:49], v12 offset:25088
  v_mfma_f32_16x16x32_bf16 a[92:95], v[52:55], a[236:239], a[92:95]
  ds_read_b64_tr_b16 v[50:51], v12 offset:29184
  v_mfma_f32_16x16x32_bf16 a[88:91], v[52:55], a[232:235], a[88:91]
  buffer_load_dwordx4 a[216:219], v20, s[16:19], s70 offen offset:1024 sc1
  v_mfma_f32_16x16x32_bf16 a[84:87], v[52:55], a[228:231], a[84:87]
  v_mfma_f32_16x16x32_bf16 a[80:83], v[52:55], a[224:227], a[80:83]
  ds_read_b64_tr_b16 v[52:53], v13 offset:25088
  v_mfma_f32_16x16x32_bf16 a[96:99], v[56:59], a[224:227], a[96:99]
  ds_read_b64_tr_b16 v[54:55], v13 offset:29184
  v_mfma_f32_16x16x32_bf16 a[100:103], v[56:59], a[228:231], a[100:103]
  v_mfma_f32_16x16x32_bf16 a[104:107], v[56:59], a[232:235], a[104:107]
  buffer_load_dwordx4 a[220:223], v20, s[16:19], s71 offen offset:1024 sc1
  v_mfma_f32_16x16x32_bf16 a[108:111], v[56:59], a[236:239], a[108:111]
  ds_read_b64_tr_b16 v[56:57], v12 offset:25344
  v_mfma_f32_16x16x32_bf16 a[124:127], v[60:63], a[236:239], a[124:127]
  ds_read_b64_tr_b16 v[58:59], v12 offset:29440
  v_mfma_f32_16x16x32_bf16 a[120:123], v[60:63], a[232:235], a[120:123]
  v_mfma_f32_16x16x32_bf16 a[116:119], v[60:63], a[228:231], a[116:119]
  v_mfma_f32_16x16x32_bf16 a[112:115], v[60:63], a[224:227], a[112:115]
  s_waitcnt vmcnt(32) lgkmcnt(6)
  v_mfma_f32_16x16x32_bf16 a[0:3], v[32:35], a[240:243], a[0:3]
  ds_read_b64_tr_b16 v[60:61], v13 offset:25344
  v_mfma_f32_16x16x32_bf16 a[4:7], v[32:35], a[244:247], a[4:7]
  ds_read_b64_tr_b16 v[62:63], v13 offset:29440
  v_mfma_f32_16x16x32_bf16 a[8:11], v[32:35], a[248:251], a[8:11]
  buffer_load_dwordx4 a[224:227], v20, s[16:19], s68 offen offset:2048 sc1
  v_mfma_f32_16x16x32_bf16 a[12:15], v[32:35], a[252:255], a[12:15]
  s_xor_b32 s86, s74, 16384
  s_add_u32 s86, s86, 73400320
  v_mfma_f32_16x16x32_bf16 a[28:31], v[36:39], a[252:255], a[28:31]
  buffer_store_dwordx4 v[168:171], v20, s[16:19], s86 offen sc1
  v_mfma_f32_16x16x32_bf16 a[24:27], v[36:39], a[248:251], a[24:27]
  v_mfma_f32_16x16x32_bf16 a[20:23], v[36:39], a[244:247], a[20:23]
  v_mfma_f32_16x16x32_bf16 a[16:19], v[36:39], a[240:243], a[16:19]
  s_waitcnt vmcnt(57)
  s_barrier
  v_mfma_f32_16x16x32_bf16 a[32:35], v[40:43], a[240:243], a[32:35]
  ds_read_b64_tr_b16 v[32:33], v8 offset:32768
  buffer_load_dwordx4 v5, s[8:11], s43 offen offset:1024 lds
  v_mfma_f32_16x16x32_bf16 a[36:39], v[40:43], a[244:247], a[36:39]
  ds_read_b64_tr_b16 v[34:35], v8 offset:36864
  v_mfma_f32_16x16x32_bf16 a[40:43], v[40:43], a[248:251], a[40:43]
  ds_read_b64_tr_b16 v[36:37], v9 offset:32768
  v_mfma_f32_16x16x32_bf16 a[44:47], v[40:43], a[252:255], a[44:47]
  ds_read_b64_tr_b16 v[38:39], v9 offset:36864
  v_mfma_f32_16x16x32_bf16 a[60:63], v[44:47], a[252:255], a[60:63]
  ds_read_b64_tr_b16 v[40:41], v8 offset:33024
  v_mfma_f32_16x16x32_bf16 a[56:59], v[44:47], a[248:251], a[56:59]
  ds_read_b64_tr_b16 v[42:43], v8 offset:37120
  v_mfma_f32_16x16x32_bf16 a[52:55], v[44:47], a[244:247], a[52:55]
  buffer_load_dwordx4 a[228:231], v20, s[16:19], s69 offen offset:2048 sc1
  v_mfma_f32_16x16x32_bf16 a[48:51], v[44:47], a[240:243], a[48:51]
  s_waitcnt lgkmcnt(6)
  v_mfma_f32_16x16x32_bf16 a[64:67], v[48:51], a[240:243], a[64:67]
  ds_read_b64_tr_b16 v[44:45], v9 offset:33024
  v_mfma_f32_16x16x32_bf16 a[68:71], v[48:51], a[244:247], a[68:71]
  ds_read_b64_tr_b16 v[46:47], v9 offset:37120
  v_mfma_f32_16x16x32_bf16 a[72:75], v[48:51], a[248:251], a[72:75]
  buffer_load_dwordx4 v6, s[8:11], s43 offen offset:2048 lds
  v_mfma_f32_16x16x32_bf16 a[76:79], v[48:51], a[252:255], a[76:79]
  ds_read_b64_tr_b16 v[48:49], v8 offset:33280
  v_mfma_f32_16x16x32_bf16 a[92:95], v[52:55], a[252:255], a[92:95]
  ds_read_b64_tr_b16 v[50:51], v8 offset:37376
  v_mfma_f32_16x16x32_bf16 a[88:91], v[52:55], a[248:251], a[88:91]
  buffer_load_dwordx4 a[232:235], v20, s[16:19], s70 offen offset:2048 sc1
  v_mfma_f32_16x16x32_bf16 a[84:87], v[52:55], a[244:247], a[84:87]
  v_mfma_f32_16x16x32_bf16 a[80:83], v[52:55], a[240:243], a[80:83]
  ds_read_b64_tr_b16 v[52:53], v9 offset:33280
  v_mfma_f32_16x16x32_bf16 a[96:99], v[56:59], a[240:243], a[96:99]
  ds_read_b64_tr_b16 v[54:55], v9 offset:37376
  v_mfma_f32_16x16x32_bf16 a[100:103], v[56:59], a[244:247], a[100:103]
  buffer_load_dwordx4 v7, s[8:11], s43 offen offset:3072 lds
  v_mfma_f32_16x16x32_bf16 a[104:107], v[56:59], a[248:251], a[104:107]
  v_mfma_f32_16x16x32_bf16 a[108:111], v[56:59], a[252:255], a[108:111]
  ds_read_b64_tr_b16 v[56:57], v8 offset:33536
  v_mfma_f32_16x16x32_bf16 a[124:127], v[60:63], a[252:255], a[124:127]
  ds_read_b64_tr_b16 v[58:59], v8 offset:37632
  v_mfma_f32_16x16x32_bf16 a[120:123], v[60:63], a[248:251], a[120:123]
  buffer_load_dwordx4 a[236:239], v20, s[16:19], s71 offen offset:2048 sc1
  v_mfma_f32_16x16x32_bf16 a[116:119], v[60:63], a[244:247], a[116:119]
  v_mfma_f32_16x16x32_bf16 a[112:115], v[60:63], a[240:243], a[112:115]
  s_waitcnt vmcnt(34) lgkmcnt(6)
  v_mfma_f32_16x16x32_bf16 a[0:3], v[32:35], a[128:131], a[0:3]
  ds_read_b64_tr_b16 v[60:61], v9 offset:33536
  v_mfma_f32_16x16x32_bf16 a[4:7], v[32:35], a[132:135], a[4:7]
  ds_read_b64_tr_b16 v[62:63], v9 offset:37632
  v_mfma_f32_16x16x32_bf16 a[8:11], v[32:35], a[136:139], a[8:11]
  buffer_load_dwordx4 a[240:243], v20, s[16:19], s68 offen offset:3072 sc1
  v_mfma_f32_16x16x32_bf16 a[12:15], v[32:35], a[140:143], a[12:15]
  ds_read_b64_tr_b16 v[32:33], v8 offset:40960
  v_mfma_f32_16x16x32_bf16 a[28:31], v[36:39], a[140:143], a[28:31]
  ds_read_b64_tr_b16 v[34:35], v8 offset:45056
  v_mfma_f32_16x16x32_bf16 a[24:27], v[36:39], a[136:139], a[24:27]
  buffer_load_dword v251, v24, s[32:35], s3 offen
  v_mfma_f32_16x16x32_bf16 a[20:23], v[36:39], a[132:135], a[20:23]
  v_mfma_f32_16x16x32_bf16 a[16:19], v[36:39], a[128:131], a[16:19]
  ds_read_b64_tr_b16 v[36:37], v9 offset:40960
  v_mfma_f32_16x16x32_bf16 a[32:35], v[40:43], a[128:131], a[32:35]
  ds_read_b64_tr_b16 v[38:39], v9 offset:45056
  v_mfma_f32_16x16x32_bf16 a[36:39], v[40:43], a[132:135], a[36:39]
  buffer_load_dwordx4 a[244:247], v20, s[16:19], s69 offen offset:3072 sc1
  v_mfma_f32_16x16x32_bf16 a[40:43], v[40:43], a[136:139], a[40:43]
  v_mfma_f32_16x16x32_bf16 a[44:47], v[40:43], a[140:143], a[44:47]
  ds_read_b64_tr_b16 v[40:41], v8 offset:41216
  v_mfma_f32_16x16x32_bf16 a[60:63], v[44:47], a[140:143], a[60:63]
  ds_read_b64_tr_b16 v[42:43], v8 offset:45312
  v_mfma_f32_16x16x32_bf16 a[56:59], v[44:47], a[136:139], a[56:59]
  s_xor_b32 s86, s74, 16384
  s_add_u32 s86, s86, 74448896
  v_mfma_f32_16x16x32_bf16 a[52:55], v[44:47], a[132:135], a[52:55]
  buffer_store_dwordx4 v[172:175], v20, s[16:19], s86 offen sc1
  v_mfma_f32_16x16x32_bf16 a[48:51], v[44:47], a[128:131], a[48:51]
  s_waitcnt lgkmcnt(6)
  v_mfma_f32_16x16x32_bf16 a[64:67], v[48:51], a[128:131], a[64:67]
  ds_read_b64_tr_b16 v[44:45], v9 offset:41216
  v_mfma_f32_16x16x32_bf16 a[68:71], v[48:51], a[132:135], a[68:71]
  ds_read_b64_tr_b16 v[46:47], v9 offset:45312
  v_mfma_f32_16x16x32_bf16 a[72:75], v[48:51], a[136:139], a[72:75]
  buffer_load_dwordx4 a[248:251], v20, s[16:19], s70 offen offset:3072 sc1
  v_mfma_f32_16x16x32_bf16 a[76:79], v[48:51], a[140:143], a[76:79]
  ds_read_b64_tr_b16 v[48:49], v8 offset:41472
  v_mfma_f32_16x16x32_bf16 a[92:95], v[52:55], a[140:143], a[92:95]
  ds_read_b64_tr_b16 v[50:51], v8 offset:45568
  v_mfma_f32_16x16x32_bf16 a[88:91], v[52:55], a[136:139], a[88:91]
  v_mfma_f32_16x16x32_bf16 a[84:87], v[52:55], a[132:135], a[84:87]
  s_xor_b32 s88, s76, 1024
  s_add_u32 s88, s88, 58982400
  s_waitcnt vmcnt(27)
  buffer_store_dword v26, v23, s[16:19], s88 offen offset:4 sc1
  v_mfma_f32_16x16x32_bf16 a[80:83], v[52:55], a[128:131], a[80:83]
  ds_read_b64_tr_b16 v[52:53], v9 offset:41472
  v_mfma_f32_16x16x32_bf16 a[96:99], v[56:59], a[128:131], a[96:99]
  ds_read_b64_tr_b16 v[54:55], v9 offset:45568
  v_mfma_f32_16x16x32_bf16 a[100:103], v[56:59], a[132:135], a[100:103]
  v_mfma_f32_16x16x32_bf16 a[104:107], v[56:59], a[136:139], a[104:107]
  v_mfma_f32_16x16x32_bf16 a[108:111], v[56:59], a[140:143], a[108:111]
  ds_read_b64_tr_b16 v[56:57], v8 offset:41728
  v_mfma_f32_16x16x32_bf16 a[124:127], v[60:63], a[140:143], a[124:127]
  ds_read_b64_tr_b16 v[58:59], v8 offset:45824
  v_mfma_f32_16x16x32_bf16 a[120:123], v[60:63], a[136:139], a[120:123]
  buffer_load_dwordx4 a[252:255], v20, s[16:19], s71 offen offset:3072 sc1
  v_mfma_f32_16x16x32_bf16 a[116:119], v[60:63], a[132:135], a[116:119]
  v_mfma_f32_16x16x32_bf16 a[112:115], v[60:63], a[128:131], a[112:115]
  s_waitcnt vmcnt(36) lgkmcnt(6)
  v_mfma_f32_16x16x32_bf16 a[0:3], v[32:35], a[144:147], a[0:3]
  ds_read_b64_tr_b16 v[60:61], v9 offset:41728
  ds_read_b64_tr_b16 v[62:63], v9 offset:45824
  v_mfma_f32_16x16x32_bf16 a[4:7], v[32:35], a[148:151], a[4:7]
  s_add_u32 s68, s67, 16384
  v_mfma_f32_16x16x32_bf16 a[8:11], v[32:35], a[152:155], a[8:11]
  buffer_load_dwordx4 a[128:131], v20, s[16:19], s68 offen offset:0 sc1
  v_mfma_f32_16x16x32_bf16 a[12:15], v[32:35], a[156:159], a[12:15]
  ds_read_b64_tr_b16 v[32:33], v8 offset:49152
  ds_read_b64_tr_b16 v[34:35], v8 offset:53248
  v_mfma_f32_16x16x32_bf16 a[28:31], v[36:39], a[156:159], a[28:31]
  s_xor_b32 s86, s74, 24576
  s_add_u32 s86, s86, 75497472
  v_mfma_f32_16x16x32_bf16 a[24:27], v[36:39], a[152:155], a[24:27]
  buffer_store_dwordx4 v[192:195], v20, s[16:19], s86 offen sc1
  v_mfma_f32_16x16x32_bf16 a[20:23], v[36:39], a[148:151], a[20:23]
  v_mfma_f32_16x16x32_bf16 a[16:19], v[36:39], a[144:147], a[16:19]
  ds_read_b64_tr_b16 v[36:37], v9 offset:49152
  v_mfma_f32_16x16x32_bf16 a[32:35], v[40:43], a[144:147], a[32:35]
  ds_read_b64_tr_b16 v[38:39], v9 offset:53248
  v_mfma_f32_16x16x32_bf16 a[36:39], v[40:43], a[148:151], a[36:39]
  s_add_u32 m0, s63, 0
  s_add_u32 s42, s65, 1048576
  v_mfma_f32_16x16x32_bf16 a[40:43], v[40:43], a[152:155], a[40:43]
  buffer_load_dwordx4 v4, s[8:11], s42 offen offset:0 lds
  v_mfma_f32_16x16x32_bf16 a[44:47], v[40:43], a[156:159], a[44:47]
  ds_read_b64_tr_b16 v[40:41], v8 offset:49408
  v_mfma_f32_16x16x32_bf16 a[60:63], v[44:47], a[156:159], a[60:63]
  ds_read_b64_tr_b16 v[42:43], v8 offset:53504
  v_mfma_f32_16x16x32_bf16 a[56:59], v[44:47], a[152:155], a[56:59]
  s_add_u32 s69, s67, 147712
  v_mfma_f32_16x16x32_bf16 a[52:55], v[44:47], a[148:151], a[52:55]
  buffer_load_dwordx4 a[132:135], v20, s[16:19], s69 offen offset:0 sc1
  v_mfma_f32_16x16x32_bf16 a[48:51], v[44:47], a[144:147], a[48:51]
  s_waitcnt lgkmcnt(6)
  v_mfma_f32_16x16x32_bf16 a[64:67], v[48:51], a[144:147], a[64:67]
  ds_read_b64_tr_b16 v[44:45], v9 offset:49408
  v_mfma_f32_16x16x32_bf16 a[68:71], v[48:51], a[148:151], a[68:71]
  ds_read_b64_tr_b16 v[46:47], v9 offset:53504
  v_mfma_f32_16x16x32_bf16 a[72:75], v[48:51], a[152:155], a[72:75]
  s_add_u32 s70, s67, 279040
  v_mfma_f32_16x16x32_bf16 a[76:79], v[48:51], a[156:159], a[76:79]
  ds_read_b64_tr_b16 v[48:49], v8 offset:49664
  v_mfma_f32_16x16x32_bf16 a[92:95], v[52:55], a[156:159], a[92:95]
  ds_read_b64_tr_b16 v[50:51], v8 offset:53760
  v_mfma_f32_16x16x32_bf16 a[88:91], v[52:55], a[152:155], a[88:91]
  buffer_load_dwordx4 a[136:139], v20, s[16:19], s70 offen offset:0 sc1
  v_mfma_f32_16x16x32_bf16 a[84:87], v[52:55], a[148:151], a[84:87]
  buffer_load_dwordx4 v5, s[8:11], s42 offen offset:1024 lds
  v_mfma_f32_16x16x32_bf16 a[80:83], v[52:55], a[144:147], a[80:83]
  ds_read_b64_tr_b16 v[52:53], v9 offset:49664
  v_mfma_f32_16x16x32_bf16 a[96:99], v[56:59], a[144:147], a[96:99]
  ds_read_b64_tr_b16 v[54:55], v9 offset:53760
  v_mfma_f32_16x16x32_bf16 a[100:103], v[56:59], a[148:151], a[100:103]
  v_mfma_f32_16x16x32_bf16 a[104:107], v[56:59], a[152:155], a[104:107]
  s_add_u32 s71, s67, 410368
  v_mfma_f32_16x16x32_bf16 a[108:111], v[56:59], a[156:159], a[108:111]
  ds_read_b64_tr_b16 v[56:57], v8 offset:49920
  v_mfma_f32_16x16x32_bf16 a[124:127], v[60:63], a[156:159], a[124:127]
  ds_read_b64_tr_b16 v[58:59], v8 offset:54016
  v_mfma_f32_16x16x32_bf16 a[120:123], v[60:63], a[152:155], a[120:123]
  buffer_load_dwordx4 a[140:143], v20, s[16:19], s71 offen offset:0 sc1
  v_mfma_f32_16x16x32_bf16 a[116:119], v[60:63], a[148:151], a[116:119]
  v_mfma_f32_16x16x32_bf16 a[112:115], v[60:63], a[144:147], a[112:115]
  s_waitcnt vmcnt(38) lgkmcnt(6)
  v_mfma_f32_16x16x32_bf16 a[0:3], v[32:35], a[160:163], a[0:3]
  ds_read_b64_tr_b16 v[60:61], v9 offset:49920
  v_mfma_f32_16x16x32_bf16 a[4:7], v[32:35], a[164:167], a[4:7]
  ds_read_b64_tr_b16 v[62:63], v9 offset:54016
  v_mfma_f32_16x16x32_bf16 a[8:11], v[32:35], a[168:171], a[8:11]
  buffer_load_dwordx4 a[144:147], v20, s[16:19], s68 offen offset:1024 sc1
  v_mfma_f32_16x16x32_bf16 a[12:15], v[32:35], a[172:175], a[12:15]
  ds_read_b64_tr_b16 v[32:33], v8 offset:57344
  v_mfma_f32_16x16x32_bf16 a[28:31], v[36:39], a[172:175], a[28:31]
  ds_read_b64_tr_b16 v[34:35], v8 offset:61440
  v_mfma_f32_16x16x32_bf16 a[24:27], v[36:39], a[168:171], a[24:27]
  buffer_load_dword v25, v27, s[16:19], s89 offen offset:0 sc1
  v_mfma_f32_16x16x32_bf16 a[20:23], v[36:39], a[164:167], a[20:23]
  v_mfma_f32_16x16x32_bf16 a[16:19], v[36:39], a[160:163], a[16:19]
  ds_read_b64_tr_b16 v[36:37], v9 offset:57344
  v_mfma_f32_16x16x32_bf16 a[32:35], v[40:43], a[160:163], a[32:35]
  ds_read_b64_tr_b16 v[38:39], v9 offset:61440
  v_mfma_f32_16x16x32_bf16 a[36:39], v[40:43], a[164:167], a[36:39]
  buffer_load_dwordx4 v6, s[8:11], s42 offen offset:2048 lds
  v_mfma_f32_16x16x32_bf16 a[40:43], v[40:43], a[168:171], a[40:43]
  buffer_load_dwordx4 a[148:151], v20, s[16:19], s69 offen offset:1024 sc1
  v_mfma_f32_16x16x32_bf16 a[44:47], v[40:43], a[172:175], a[44:47]
  ds_read_b64_tr_b16 v[40:41], v8 offset:57600
  v_mfma_f32_16x16x32_bf16 a[60:63], v[44:47], a[172:175], a[60:63]
  ds_read_b64_tr_b16 v[42:43], v8 offset:61696
  v_mfma_f32_16x16x32_bf16 a[56:59], v[44:47], a[168:171], a[56:59]
  v_mfma_f32_16x16x32_bf16 a[52:55], v[44:47], a[164:167], a[52:55]
  buffer_load_dwordx4 v7, s[8:11], s42 offen offset:3072 lds
  v_mfma_f32_16x16x32_bf16 a[48:51], v[44:47], a[160:163], a[48:51]
  s_waitcnt lgkmcnt(6)
  v_mfma_f32_16x16x32_bf16 a[64:67], v[48:51], a[160:163], a[64:67]
  ds_read_b64_tr_b16 v[44:45], v9 offset:57600
  ds_read_b64_tr_b16 v[46:47], v9 offset:61696
  v_mfma_f32_16x16x32_bf16 a[68:71], v[48:51], a[164:167], a[68:71]
  s_xor_b32 s86, s74, 24576
  s_add_u32 s86, s86, 76546048
  v_mfma_f32_16x16x32_bf16 a[72:75], v[48:51], a[168:171], a[72:75]
  buffer_store_dwordx4 v[196:199], v20, s[16:19], s86 offen sc1
  v_mfma_f32_16x16x32_bf16 a[76:79], v[48:51], a[172:175], a[76:79]
  ds_read_b64_tr_b16 v[48:49], v8 offset:57856
  v_mfma_f32_16x16x32_bf16 a[92:95], v[52:55], a[172:175], a[92:95]
  ds_read_b64_tr_b16 v[50:51], v8 offset:61952
  v_mfma_f32_16x16x32_bf16 a[88:91], v[52:55], a[168:171], a[88:91]
  buffer_load_dwordx4 a[152:155], v20, s[16:19], s70 offen offset:1024 sc1
  v_mfma_f32_16x16x32_bf16 a[84:87], v[52:55], a[164:167], a[84:87]
  v_mfma_f32_16x16x32_bf16 a[80:83], v[52:55], a[160:163], a[80:83]
  ds_read_b64_tr_b16 v[52:53], v9 offset:57856
  ds_read_b64_tr_b16 v[54:55], v9 offset:61952
  v_mfma_f32_16x16x32_bf16 a[96:99], v[56:59], a[160:163], a[96:99]
  s_add_u32 m0, s63, 4096
  s_add_u32 s43, s65, 1081344
  v_mfma_f32_16x16x32_bf16 a[100:103], v[56:59], a[164:167], a[100:103]
  buffer_load_dwordx4 v4, s[8:11], s43 offen offset:0 lds
  v_mfma_f32_16x16x32_bf16 a[104:107], v[56:59], a[168:171], a[104:107]
  v_mfma_f32_16x16x32_bf16 a[108:111], v[56:59], a[172:175], a[108:111]
  ds_read_b64_tr_b16 v[56:57], v8 offset:58112
  v_mfma_f32_16x16x32_bf16 a[124:127], v[60:63], a[172:175], a[124:127]
  ds_read_b64_tr_b16 v[58:59], v8 offset:62208
  v_mfma_f32_16x16x32_bf16 a[120:123], v[60:63], a[168:171], a[120:123]
  buffer_load_dwordx4 a[156:159], v20, s[16:19], s71 offen offset:1024 sc1
  v_mfma_f32_16x16x32_bf16 a[116:119], v[60:63], a[164:167], a[116:119]
  v_mfma_f32_16x16x32_bf16 a[112:115], v[60:63], a[160:163], a[112:115]
  s_waitcnt vmcnt(42) lgkmcnt(6)
  v_mfma_f32_16x16x32_bf16 a[0:3], v[32:35], a[176:179], a[0:3]
  ds_read_b64_tr_b16 v[60:61], v9 offset:58112
  v_mfma_f32_16x16x32_bf16 a[4:7], v[32:35], a[180:183], a[4:7]
  ds_read_b64_tr_b16 v[62:63], v9 offset:62208
  v_mfma_f32_16x16x32_bf16 a[8:11], v[32:35], a[184:187], a[8:11]
  buffer_load_dwordx4 a[160:163], v20, s[16:19], s68 offen offset:2048 sc1
  v_mfma_f32_16x16x32_bf16 a[12:15], v[32:35], a[188:191], a[12:15]
  s_xor_b32 s86, s74, 24576
  s_add_u32 s86, s86, 77594624
  v_mfma_f32_16x16x32_bf16 a[28:31], v[36:39], a[188:191], a[28:31]
  buffer_store_dwordx4 v[200:203], v20, s[16:19], s86 offen sc1
  v_mfma_f32_16x16x32_bf16 a[24:27], v[36:39], a[184:187], a[24:27]
  v_mfma_f32_16x16x32_bf16 a[20:23], v[36:39], a[180:183], a[20:23]
  v_mfma_f32_16x16x32_bf16 a[16:19], v[36:39], a[176:179], a[16:19]
  s_waitcnt vmcnt(26)
  s_barrier
  v_mfma_f32_16x16x32_bf16 a[32:35], v[40:43], a[176:179], a[32:35]
  ds_read_b64_tr_b16 v[32:33], v10 offset:0
  buffer_load_dwordx4 v5, s[8:11], s43 offen offset:1024 lds
  v_mfma_f32_16x16x32_bf16 a[36:39], v[40:43], a[180:183], a[36:39]
  ds_read_b64_tr_b16 v[34:35], v10 offset:4096
  v_mfma_f32_16x16x32_bf16 a[40:43], v[40:43], a[184:187], a[40:43]
  ds_read_b64_tr_b16 v[36:37], v11 offset:0
  v_mfma_f32_16x16x32_bf16 a[44:47], v[40:43], a[188:191], a[44:47]
  ds_read_b64_tr_b16 v[38:39], v11 offset:4096
  v_mfma_f32_16x16x32_bf16 a[60:63], v[44:47], a[188:191], a[60:63]
  ds_read_b64_tr_b16 v[40:41], v10 offset:256
  v_mfma_f32_16x16x32_bf16 a[56:59], v[44:47], a[184:187], a[56:59]
  ds_read_b64_tr_b16 v[42:43], v10 offset:4352
  v_mfma_f32_16x16x32_bf16 a[52:55], v[44:47], a[180:183], a[52:55]
  buffer_load_dwordx4 a[164:167], v20, s[16:19], s69 offen offset:2048 sc1
  v_mfma_f32_16x16x32_bf16 a[48:51], v[44:47], a[176:179], a[48:51]
  s_waitcnt lgkmcnt(6)
  v_mfma_f32_16x16x32_bf16 a[64:67], v[48:51], a[176:179], a[64:67]
  ds_read_b64_tr_b16 v[44:45], v11 offset:256
  v_mfma_f32_16x16x32_bf16 a[68:71], v[48:51], a[180:183], a[68:71]
  ds_read_b64_tr_b16 v[46:47], v11 offset:4352
  v_mfma_f32_16x16x32_bf16 a[72:75], v[48:51], a[184:187], a[72:75]
  buffer_load_dwordx4 v6, s[8:11], s43 offen offset:2048 lds
  v_mfma_f32_16x16x32_bf16 a[76:79], v[48:51], a[188:191], a[76:79]
  ds_read_b64_tr_b16 v[48:49], v10 offset:512
  v_mfma_f32_16x16x32_bf16 a[92:95], v[52:55], a[188:191], a[92:95]
  ds_read_b64_tr_b16 v[50:51], v10 offset:4608
  v_mfma_f32_16x16x32_bf16 a[88:91], v[52:55], a[184:187], a[88:91]
  buffer_load_dwordx4 a[168:171], v20, s[16:19], s70 offen offset:2048 sc1
  v_mfma_f32_16x16x32_bf16 a[84:87], v[52:55], a[180:183], a[84:87]
  v_mfma_f32_16x16x32_bf16 a[80:83], v[52:55], a[176:179], a[80:83]
  ds_read_b64_tr_b16 v[52:53], v11 offset:512
  v_mfma_f32_16x16x32_bf16 a[96:99], v[56:59], a[176:179], a[96:99]
  ds_read_b64_tr_b16 v[54:55], v11 offset:4608
  v_mfma_f32_16x16x32_bf16 a[100:103], v[56:59], a[180:183], a[100:103]
  buffer_load_dwordx4 v7, s[8:11], s43 offen offset:3072 lds
  v_mfma_f32_16x16x32_bf16 a[104:107], v[56:59], a[184:187], a[104:107]
  v_mfma_f32_16x16x32_bf16 a[108:111], v[56:59], a[188:191], a[108:111]
  ds_read_b64_tr_b16 v[56:57], v10 offset:768
  v_mfma_f32_16x16x32_bf16 a[124:127], v[60:63], a[188:191], a[124:127]
  ds_read_b64_tr_b16 v[58:59], v10 offset:4864
  v_mfma_f32_16x16x32_bf16 a[120:123], v[60:63], a[184:187], a[120:123]
  buffer_load_dwordx4 a[172:175], v20, s[16:19], s71 offen offset:2048 sc1
  v_mfma_f32_16x16x32_bf16 a[116:119], v[60:63], a[180:183], a[116:119]
  v_mfma_f32_16x16x32_bf16 a[112:115], v[60:63], a[176:179], a[112:115]
  s_waitcnt vmcnt(45) lgkmcnt(6)
  v_mfma_f32_16x16x32_bf16 a[0:3], v[32:35], a[192:195], a[0:3]
  ds_read_b64_tr_b16 v[60:61], v11 offset:768
  v_mfma_f32_16x16x32_bf16 a[4:7], v[32:35], a[196:199], a[4:7]
  ds_read_b64_tr_b16 v[62:63], v11 offset:4864
  v_mfma_f32_16x16x32_bf16 a[8:11], v[32:35], a[200:203], a[8:11]
  buffer_load_dwordx4 a[176:179], v20, s[16:19], s68 offen offset:3072 sc1
  v_mfma_f32_16x16x32_bf16 a[12:15], v[32:35], a[204:207], a[12:15]
  ds_read_b64_tr_b16 v[32:33], v10 offset:8192
  v_mfma_f32_16x16x32_bf16 a[28:31], v[36:39], a[204:207], a[28:31]
  ds_read_b64_tr_b16 v[34:35], v10 offset:12288
  v_mfma_f32_16x16x32_bf16 a[24:27], v[36:39], a[200:203], a[24:27]
  s_xor_b32 s86, s74, 24576
  s_add_u32 s86, s86, 78643200
  v_mfma_f32_16x16x32_bf16 a[20:23], v[36:39], a[196:199], a[20:23]
  buffer_store_dwordx4 v[204:207], v20, s[16:19], s86 offen sc1
  v_mfma_f32_16x16x32_bf16 a[16:19], v[36:39], a[192:195], a[16:19]
  ds_read_b64_tr_b16 v[36:37], v11 offset:8192
  v_mfma_f32_16x16x32_bf16 a[32:35], v[40:43], a[192:195], a[32:35]
  ds_read_b64_tr_b16 v[38:39], v11 offset:12288
  v_mfma_f32_16x16x32_bf16 a[36:39], v[40:43], a[196:199], a[36:39]
  v_mfma_f32_16x16x32_bf16 a[40:43], v[40:43], a[200:203], a[40:43]
  buffer_load_dwordx4 a[180:183], v20, s[16:19], s69 offen offset:3072 sc1
  v_mfma_f32_16x16x32_bf16 a[44:47], v[40:43], a[204:207], a[44:47]
  ds_read_b64_tr_b16 v[40:41], v10 offset:8448
  v_mfma_f32_16x16x32_bf16 a[60:63], v[44:47], a[204:207], a[60:63]
  ds_read_b64_tr_b16 v[42:43], v10 offset:12544
  v_mfma_f32_16x16x32_bf16 a[56:59], v[44:47], a[200:203], a[56:59]
  v_mfma_f32_16x16x32_bf16 a[52:55], v[44:47], a[196:199], a[52:55]
  v_mfma_f32_16x16x32_bf16 a[48:51], v[44:47], a[192:195], a[48:51]
  s_waitcnt lgkmcnt(6)
  v_mfma_f32_16x16x32_bf16 a[64:67], v[48:51], a[192:195], a[64:67]
  ds_read_b64_tr_b16 v[44:45], v11 offset:8448
  v_mfma_f32_16x16x32_bf16 a[68:71], v[48:51], a[196:199], a[68:71]
  ds_read_b64_tr_b16 v[46:47], v11 offset:12544
  v_mfma_f32_16x16x32_bf16 a[72:75], v[48:51], a[200:203], a[72:75]
  buffer_load_dwordx4 a[184:187], v20, s[16:19], s70 offen offset:3072 sc1
  v_mfma_f32_16x16x32_bf16 a[76:79], v[48:51], a[204:207], a[76:79]
  ds_read_b64_tr_b16 v[48:49], v10 offset:8704
  v_mfma_f32_16x16x32_bf16 a[92:95], v[52:55], a[204:207], a[92:95]
  ds_read_b64_tr_b16 v[50:51], v10 offset:12800
  v_mfma_f32_16x16x32_bf16 a[88:91], v[52:55], a[200:203], a[88:91]
  s_xor_b32 s88, s76, 2048
  s_add_u32 s88, s88, 58982400
  s_waitcnt vmcnt(31)
  buffer_store_dword v26, v23, s[16:19], s88 offen offset:8 sc1
  v_mfma_f32_16x16x32_bf16 a[84:87], v[52:55], a[196:199], a[84:87]
  v_mfma_f32_16x16x32_bf16 a[80:83], v[52:55], a[192:195], a[80:83]
  ds_read_b64_tr_b16 v[52:53], v11 offset:8704
  v_mfma_f32_16x16x32_bf16 a[96:99], v[56:59], a[192:195], a[96:99]
  ds_read_b64_tr_b16 v[54:55], v11 offset:12800
  v_mfma_f32_16x16x32_bf16 a[100:103], v[56:59], a[196:199], a[100:103]
  v_mfma_f32_16x16x32_bf16 a[104:107], v[56:59], a[200:203], a[104:107]
  buffer_load_dwordx4 a[188:191], v20, s[16:19], s71 offen offset:3072 sc1
  v_mfma_f32_16x16x32_bf16 a[108:111], v[56:59], a[204:207], a[108:111]
  ds_read_b64_tr_b16 v[56:57], v10 offset:8960
  v_mfma_f32_16x16x32_bf16 a[124:127], v[60:63], a[204:207], a[124:127]
  ds_read_b64_tr_b16 v[58:59], v10 offset:13056
  v_mfma_f32_16x16x32_bf16 a[120:123], v[60:63], a[200:203], a[120:123]
  v_mfma_f32_16x16x32_bf16 a[116:119], v[60:63], a[196:199], a[116:119]
  v_mfma_f32_16x16x32_bf16 a[112:115], v[60:63], a[192:195], a[112:115]
  s_waitcnt vmcnt(21)
  v_cmp_eq_u32 vcc, v26, v25
  s_and_b32 s84, vcc_lo, 0x2
  s_cmp_eq_u32 s84, 0x2
  s_cbranch_scc0 L_main_spin_4
L_main_spin_4_ok:
  s_waitcnt vmcnt(45) lgkmcnt(6)
  v_mfma_f32_16x16x32_bf16 a[0:3], v[32:35], a[208:211], a[0:3]
  ds_read_b64_tr_b16 v[60:61], v11 offset:8960
  ds_read_b64_tr_b16 v[62:63], v11 offset:13056
  v_mfma_f32_16x16x32_bf16 a[4:7], v[32:35], a[212:215], a[4:7]
  s_add_u32 s68, s67, 20480
  v_mfma_f32_16x16x32_bf16 a[8:11], v[32:35], a[216:219], a[8:11]
  buffer_load_dwordx4 a[192:195], v20, s[16:19], s68 offen offset:0 sc1
  v_mfma_f32_16x16x32_bf16 a[12:15], v[32:35], a[220:223], a[12:15]
  ds_read_b64_tr_b16 v[32:33], v10 offset:16384
  ds_read_b64_tr_b16 v[34:35], v10 offset:20480
  v_mfma_f32_16x16x32_bf16 a[28:31], v[36:39], a[220:223], a[28:31]
  s_add_u32 s87, s74, 67108864
  v_mfma_f32_16x16x32_bf16 a[24:27], v[36:39], a[216:219], a[24:27]
  buffer_load_dwordx4 v[144:147], v20, s[16:19], s87 offen sc1
  v_mfma_f32_16x16x32_bf16 a[20:23], v[36:39], a[212:215], a[20:23]
  s_add_u32 m0, s63, 98304
  s_add_u32 s42, s65, 1310720
  v_mfma_f32_16x16x32_bf16 a[16:19], v[36:39], a[208:211], a[16:19]
  ds_read_b64_tr_b16 v[36:37], v11 offset:16384
  v_mfma_f32_16x16x32_bf16 a[32:35], v[40:43], a[208:211], a[32:35]
  ds_read_b64_tr_b16 v[38:39], v11 offset:20480
  v_mfma_f32_16x16x32_bf16 a[36:39], v[40:43], a[212:215], a[36:39]
  buffer_load_dwordx4 v4, s[8:11], s42 offen offset:0 lds
  v_mfma_f32_16x16x32_bf16 a[40:43], v[40:43], a[216:219], a[40:43]
  s_add_u32 s69, s67, 151808
  v_mfma_f32_16x16x32_bf16 a[44:47], v[40:43], a[220:223], a[44:47]
  ds_read_b64_tr_b16 v[40:41], v10 offset:16640
  v_mfma_f32_16x16x32_bf16 a[60:63], v[44:47], a[220:223], a[60:63]
  ds_read_b64_tr_b16 v[42:43], v10 offset:20736
  v_mfma_f32_16x16x32_bf16 a[56:59], v[44:47], a[216:219], a[56:59]
  buffer_load_dwordx4 a[196:199], v20, s[16:19], s69 offen offset:0 sc1
  v_mfma_f32_16x16x32_bf16 a[52:55], v[44:47], a[212:215], a[52:55]
  buffer_load_dwordx4 v5, s[8:11], s42 offen offset:1024 lds
  v_mfma_f32_16x16x32_bf16 a[48:51], v[44:47], a[208:211], a[48:51]
  s_waitcnt lgkmcnt(6)
  v_mfma_f32_16x16x32_bf16 a[64:67], v[48:51], a[208:211], a[64:67]
  ds_read_b64_tr_b16 v[44:45], v11 offset:16640
  ds_read_b64_tr_b16 v[46:47], v11 offset:20736
  v_mfma_f32_16x16x32_bf16 a[68:71], v[48:51], a[212:215], a[68:71]
  s_add_u32 s70, s67, 283136
  v_mfma_f32_16x16x32_bf16 a[72:75], v[48:51], a[216:219], a[72:75]
  buffer_load_dwordx4 a[200:203], v20, s[16:19], s70 offen offset:0 sc1
  v_mfma_f32_16x16x32_bf16 a[76:79], v[48:51], a[220:223], a[76:79]
  ds_read_b64_tr_b16 v[48:49], v10 offset:16896
  v_mfma_f32_16x16x32_bf16 a[92:95], v[52:55], a[220:223], a[92:95]
  ds_read_b64_tr_b16 v[50:51], v10 offset:20992
  v_mfma_f32_16x16x32_bf16 a[88:91], v[52:55], a[216:219], a[88:91]
  buffer_load_dwordx4 v6, s[8:11], s42 offen offset:2048 lds
  v_mfma_f32_16x16x32_bf16 a[84:87], v[52:55], a[212:215], a[84:87]
  v_mfma_f32_16x16x32_bf16 a[80:83], v[52:55], a[208:211], a[80:83]
  ds_read_b64_tr_b16 v[52:53], v11 offset:16896
  ds_read_b64_tr_b16 v[54:55], v11 offset:20992
  v_mfma_f32_16x16x32_bf16 a[96:99], v[56:59], a[208:211], a[96:99]
  s_add_u32 s71, s67, 414464
  v_mfma_f32_16x16x32_bf16 a[100:103], v[56:59], a[212:215], a[100:103]
  buffer_load_dwordx4 a[204:207], v20, s[16:19], s71 offen offset:0 sc1
  v_mfma_f32_16x16x32_bf16 a[104:107], v[56:59], a[216:219], a[104:107]
  v_mfma_f32_16x16x32_bf16 a[108:111], v[56:59], a[220:223], a[108:111]
  ds_read_b64_tr_b16 v[56:57], v10 offset:17152
  v_mfma_f32_16x16x32_bf16 a[124:127], v[60:63], a[220:223], a[124:127]
  ds_read_b64_tr_b16 v[58:59], v10 offset:21248
  v_mfma_f32_16x16x32_bf16 a[120:123], v[60:63], a[216:219], a[120:123]
  buffer_load_dwordx4 v7, s[8:11], s42 offen offset:3072 lds
  v_mfma_f32_16x16x32_bf16 a[116:119], v[60:63], a[212:215], a[116:119]
  v_mfma_f32_16x16x32_bf16 a[112:115], v[60:63], a[208:211], a[112:115]
  s_waitcnt vmcnt(46) lgkmcnt(6)
  v_mfma_f32_16x16x32_bf16 a[0:3], v[32:35], a[224:227], a[0:3]
  ds_read_b64_tr_b16 v[60:61], v11 offset:17152
  v_mfma_f32_16x16x32_bf16 a[4:7], v[32:35], a[228:231], a[4:7]
  ds_read_b64_tr_b16 v[62:63], v11 offset:21248
  v_mfma_f32_16x16x32_bf16 a[8:11], v[32:35], a[232:235], a[8:11]
  buffer_load_dwordx4 a[208:211], v20, s[16:19], s68 offen offset:1024 sc1
  v_mfma_f32_16x16x32_bf16 a[12:15], v[32:35], a[236:239], a[12:15]
  ds_read_b64_tr_b16 v[32:33], v10 offset:24576
  v_mfma_f32_16x16x32_bf16 a[28:31], v[36:39], a[236:239], a[28:31]
  ds_read_b64_tr_b16 v[34:35], v10 offset:28672
  v_mfma_f32_16x16x32_bf16 a[24:27], v[36:39], a[232:235], a[24:27]
  buffer_load_dword v25, v27, s[16:19], s89 offen offset:0 sc1
  v_mfma_f32_16x16x32_bf16 a[20:23], v[36:39], a[228:231], a[20:23]
  s_add_u32 m0, s63, 102400
  s_add_u32 s43, s65, 1343488
  v_mfma_f32_16x16x32_bf16 a[16:19], v[36:39], a[224:227], a[16:19]
  ds_read_b64_tr_b16 v[36:37], v11 offset:24576
  v_mfma_f32_16x16x32_bf16 a[32:35], v[40:43], a[224:227], a[32:35]
  ds_read_b64_tr_b16 v[38:39], v11 offset:28672
  v_mfma_f32_16x16x32_bf16 a[36:39], v[40:43], a[228:231], a[36:39]
  buffer_load_dwordx4 v4, s[8:11], s43 offen offset:0 lds
  v_mfma_f32_16x16x32_bf16 a[40:43], v[40:43], a[232:235], a[40:43]
  buffer_load_dwordx4 a[212:215], v20, s[16:19], s69 offen offset:1024 sc1
  v_mfma_f32_16x16x32_bf16 a[44:47], v[40:43], a[236:239], a[44:47]
  ds_read_b64_tr_b16 v[40:41], v10 offset:24832
  v_mfma_f32_16x16x32_bf16 a[60:63], v[44:47], a[236:239], a[60:63]
  ds_read_b64_tr_b16 v[42:43], v10 offset:28928
  v_mfma_f32_16x16x32_bf16 a[56:59], v[44:47], a[232:235], a[56:59]
  buffer_load_dwordx4 v5, s[8:11], s43 offen offset:1024 lds
  v_mfma_f32_16x16x32_bf16 a[52:55], v[44:47], a[228:231], a[52:55]
  v_mfma_f32_16x16x32_bf16 a[48:51], v[44:47], a[224:227], a[48:51]
  s_waitcnt lgkmcnt(6)
  v_mfma_f32_16x16x32_bf16 a[64:67], v[48:51], a[224:227], a[64:67]
  ds_read_b64_tr_b16 v[44:45], v11 offset:24832
  v_mfma_f32_16x16x32_bf16 a[68:71], v[48:51], a[228:231], a[68:71]
  ds_read_b64_tr_b16 v[46:47], v11 offset:28928
  v_mfma_f32_16x16x32_bf16 a[72:75], v[48:51], a[232:235], a[72:75]
  buffer_load_dwordx4 a[216:219], v20, s[16:19], s70 offen offset:1024 sc1
  v_mfma_f32_16x16x32_bf16 a[76:79], v[48:51], a[236:239], a[76:79]
  ds_read_b64_tr_b16 v[48:49], v10 offset:25088
  ds_read_b64_tr_b16 v[50:51], v10 offset:29184
  v_mfma_f32_16x16x32_bf16 a[92:95], v[52:55], a[236:239], a[92:95]
  s_add_u32 s87, s74, 68157440
  v_mfma_f32_16x16x32_bf16 a[88:91], v[52:55], a[232:235], a[88:91]
  buffer_load_dwordx4 v[148:151], v20, s[16:19], s87 offen sc1
  v_mfma_f32_16x16x32_bf16 a[84:87], v[52:55], a[228:231], a[84:87]
  buffer_load_dwordx4 v6, s[8:11], s43 offen offset:2048 lds
  v_mfma_f32_16x16x32_bf16 a[80:83], v[52:55], a[224:227], a[80:83]
  ds_read_b64_tr_b16 v[52:53], v11 offset:25088
  v_mfma_f32_16x16x32_bf16 a[96:99], v[56:59], a[224:227], a[96:99]
  ds_read_b64_tr_b16 v[54:55], v11 offset:29184
  v_mfma_f32_16x16x32_bf16 a[100:103], v[56:59], a[228:231], a[100:103]
  buffer_load_dwordx4 a[220:223], v20, s[16:19], s71 offen offset:1024 sc1
  v_mfma_f32_16x16x32_bf16 a[104:107], v[56:59], a[232:235], a[104:107]
  v_mfma_f32_16x16x32_bf16 a[108:111], v[56:59], a[236:239], a[108:111]
  ds_read_b64_tr_b16 v[56:57], v10 offset:25344
  v_mfma_f32_16x16x32_bf16 a[124:127], v[60:63], a[236:239], a[124:127]
  ds_read_b64_tr_b16 v[58:59], v10 offset:29440
  v_mfma_f32_16x16x32_bf16 a[120:123], v[60:63], a[232:235], a[120:123]
  buffer_load_dwordx4 v7, s[8:11], s43 offen offset:3072 lds
  v_mfma_f32_16x16x32_bf16 a[116:119], v[60:63], a[228:231], a[116:119]
  v_mfma_f32_16x16x32_bf16 a[112:115], v[60:63], a[224:227], a[112:115]
  s_waitcnt vmcnt(49) lgkmcnt(6)
  v_mfma_f32_16x16x32_bf16 a[0:3], v[32:35], a[240:243], a[0:3]
  ds_read_b64_tr_b16 v[60:61], v11 offset:25344
  v_mfma_f32_16x16x32_bf16 a[4:7], v[32:35], a[244:247], a[4:7]
  ds_read_b64_tr_b16 v[62:63], v11 offset:29440
  v_mfma_f32_16x16x32_bf16 a[8:11], v[32:35], a[248:251], a[8:11]
  buffer_load_dwordx4 a[224:227], v20, s[16:19], s68 offen offset:2048 sc1
  v_mfma_f32_16x16x32_bf16 a[12:15], v[32:35], a[252:255], a[12:15]
  s_add_u32 s87, s74, 69206016
  v_mfma_f32_16x16x32_bf16 a[28:31], v[36:39], a[252:255], a[28:31]
  buffer_load_dwordx4 v[152:155], v20, s[16:19], s87 offen sc1
  v_mfma_f32_16x16x32_bf16 a[24:27], v[36:39], a[248:251], a[24:27]
  v_mfma_f32_16x16x32_bf16 a[20:23], v[36:39], a[244:247], a[20:23]
  s_add_u32 m0, s63, 131072
  s_add_u32 s42, s65, 1572864
  v_mfma_f32_16x16x32_bf16 a[16:19], v[36:39], a[240:243], a[16:19]
  s_waitcnt vmcnt(28)
  s_barrier
  v_mfma_f32_16x16x32_bf16 a[32:35], v[40:43], a[240:243], a[32:35]
  ds_read_b64_tr_b16 v[32:33], v8 offset:0
  buffer_load_dwordx4 v4, s[8:11], s42 offen offset:0 lds
  v_mfma_f32_16x16x32_bf16 a[36:39], v[40:43], a[244:247], a[36:39]
  ds_read_b64_tr_b16 v[34:35], v8 offset:4096
  v_mfma_f32_16x16x32_bf16 a[40:43], v[40:43], a[248:251], a[40:43]
  ds_read_b64_tr_b16 v[36:37], v9 offset:0
  v_mfma_f32_16x16x32_bf16 a[44:47], v[40:43], a[252:255], a[44:47]
  ds_read_b64_tr_b16 v[38:39], v9 offset:4096
  buffer_load_dwordx4 a[228:231], v20, s[16:19], s69 offen offset:2048 sc1
  v_mfma_f32_16x16x32_bf16 a[60:63], v[44:47], a[252:255], a[60:63]
  ds_read_b64_tr_b16 v[40:41], v8 offset:256
  v_mfma_f32_16x16x32_bf16 a[56:59], v[44:47], a[248:251], a[56:59]
  ds_read_b64_tr_b16 v[42:43], v8 offset:4352
  v_mfma_f32_16x16x32_bf16 a[52:55], v[44:47], a[244:247], a[52:55]
  buffer_load_dwordx4 v5, s[8:11], s42 offen offset:1024 lds
  v_mfma_f32_16x16x32_bf16 a[48:51], v[44:47], a[240:243], a[48:51]
  s_waitcnt lgkmcnt(6)
  v_mfma_f32_16x16x32_bf16 a[64:67], v[48:51], a[240:243], a[64:67]
  ds_read_b64_tr_b16 v[44:45], v9 offset:256
  v_mfma_f32_16x16x32_bf16 a[68:71], v[48:51], a[244:247], a[68:71]
  ds_read_b64_tr_b16 v[46:47], v9 offset:4352
  v_mfma_f32_16x16x32_bf16 a[72:75], v[48:51], a[248:251], a[72:75]
  buffer_load_dwordx4 a[232:235], v20, s[16:19], s70 offen offset:2048 sc1
  v_mfma_f32_16x16x32_bf16 a[76:79], v[48:51], a[252:255], a[76:79]
  ds_read_b64_tr_b16 v[48:49], v8 offset:512
  v_mfma_f32_16x16x32_bf16 a[92:95], v[52:55], a[252:255], a[92:95]
  ds_read_b64_tr_b16 v[50:51], v8 offset:4608
  v_mfma_f32_16x16x32_bf16 a[88:91], v[52:55], a[248:251], a[88:91]
  buffer_load_dwordx4 v6, s[8:11], s42 offen offset:2048 lds
  v_mfma_f32_16x16x32_bf16 a[84:87], v[52:55], a[244:247], a[84:87]
  v_mfma_f32_16x16x32_bf16 a[80:83], v[52:55], a[240:243], a[80:83]
  ds_read_b64_tr_b16 v[52:53], v9 offset:512
  v_mfma_f32_16x16x32_bf16 a[96:99], v[56:59], a[240:243], a[96:99]
  ds_read_b64_tr_b16 v[54:55], v9 offset:4608
  v_mfma_f32_16x16x32_bf16 a[100:103], v[56:59], a[244:247], a[100:103]
  buffer_load_dwordx4 a[236:239], v20, s[16:19], s71 offen offset:2048 sc1
  v_mfma_f32_16x16x32_bf16 a[104:107], v[56:59], a[248:251], a[104:107]
  v_mfma_f32_16x16x32_bf16 a[108:111], v[56:59], a[252:255], a[108:111]
  ds_read_b64_tr_b16 v[56:57], v8 offset:768
  v_mfma_f32_16x16x32_bf16 a[124:127], v[60:63], a[252:255], a[124:127]
  ds_read_b64_tr_b16 v[58:59], v8 offset:4864
  v_mfma_f32_16x16x32_bf16 a[120:123], v[60:63], a[248:251], a[120:123]
  buffer_load_dwordx4 v7, s[8:11], s42 offen offset:3072 lds
  v_mfma_f32_16x16x32_bf16 a[116:119], v[60:63], a[244:247], a[116:119]
  v_mfma_f32_16x16x32_bf16 a[112:115], v[60:63], a[240:243], a[112:115]
  s_waitcnt vmcnt(51) lgkmcnt(6)
  v_mfma_f32_16x16x32_bf16 a[0:3], v[32:35], a[128:131], a[0:3]
  ds_read_b64_tr_b16 v[60:61], v9 offset:768
  v_mfma_f32_16x16x32_bf16 a[4:7], v[32:35], a[132:135], a[4:7]
  ds_read_b64_tr_b16 v[62:63], v9 offset:4864
  v_mfma_f32_16x16x32_bf16 a[8:11], v[32:35], a[136:139], a[8:11]
  buffer_load_dwordx4 a[240:243], v20, s[16:19], s68 offen offset:3072 sc1
  v_mfma_f32_16x16x32_bf16 a[12:15], v[32:35], a[140:143], a[12:15]
  ds_read_b64_tr_b16 v[32:33], v8 offset:8192
  ds_read_b64_tr_b16 v[34:35], v8 offset:12288
  v_mfma_f32_16x16x32_bf16 a[28:31], v[36:39], a[140:143], a[28:31]
  s_add_u32 s87, s74, 70254592
  v_mfma_f32_16x16x32_bf16 a[24:27], v[36:39], a[136:139], a[24:27]
  buffer_load_dwordx4 v[156:159], v20, s[16:19], s87 offen sc1
  v_mfma_f32_16x16x32_bf16 a[20:23], v[36:39], a[132:135], a[20:23]
  s_add_u32 m0, s63, 135168
  s_add_u32 s43, s65, 1605632
  v_mfma_f32_16x16x32_bf16 a[16:19], v[36:39], a[128:131], a[16:19]
  ds_read_b64_tr_b16 v[36:37], v9 offset:8192
  v_mfma_f32_16x16x32_bf16 a[32:35], v[40:43], a[128:131], a[32:35]
  ds_read_b64_tr_b16 v[38:39], v9 offset:12288
  v_mfma_f32_16x16x32_bf16 a[36:39], v[40:43], a[132:135], a[36:39]
  buffer_load_dwordx4 v4, s[8:11], s43 offen offset:0 lds
  v_mfma_f32_16x16x32_bf16 a[40:43], v[40:43], a[136:139], a[40:43]
  buffer_load_dwordx4 a[244:247], v20, s[16:19], s69 offen offset:3072 sc1
  v_mfma_f32_16x16x32_bf16 a[44:47], v[40:43], a[140:143], a[44:47]
  ds_read_b64_tr_b16 v[40:41], v8 offset:8448
  v_mfma_f32_16x16x32_bf16 a[60:63], v[44:47], a[140:143], a[60:63]
  ds_read_b64_tr_b16 v[42:43], v8 offset:12544
  v_mfma_f32_16x16x32_bf16 a[56:59], v[44:47], a[136:139], a[56:59]
  buffer_load_dwordx4 v5, s[8:11], s43 offen offset:1024 lds
  v_mfma_f32_16x16x32_bf16 a[52:55], v[44:47], a[132:135], a[52:55]
  v_mfma_f32_16x16x32_bf16 a[48:51], v[44:47], a[128:131], a[48:51]
  s_waitcnt lgkmcnt(6)
  v_mfma_f32_16x16x32_bf16 a[64:67], v[48:51], a[128:131], a[64:67]
  ds_read_b64_tr_b16 v[44:45], v9 offset:8448
  v_mfma_f32_16x16x32_bf16 a[68:71], v[48:51], a[132:135], a[68:71]
  ds_read_b64_tr_b16 v[46:47], v9 offset:12544
  v_mfma_f32_16x16x32_bf16 a[72:75], v[48:51], a[136:139], a[72:75]
  buffer_load_dwordx4 a[248:251], v20, s[16:19], s70 offen offset:3072 sc1
  v_mfma_f32_16x16x32_bf16 a[76:79], v[48:51], a[140:143], a[76:79]
  ds_read_b64_tr_b16 v[48:49], v8 offset:8704
  v_mfma_f32_16x16x32_bf16 a[92:95], v[52:55], a[140:143], a[92:95]
  ds_read_b64_tr_b16 v[50:51], v8 offset:12800
  v_mfma_f32_16x16x32_bf16 a[88:91], v[52:55], a[136:139], a[88:91]
  s_xor_b32 s88, s76, 3072
  s_add_u32 s88, s88, 58982400
  s_waitcnt vmcnt(38)
  buffer_store_dword v26, v23, s[16:19], s88 offen offset:12 sc1
  v_mfma_f32_16x16x32_bf16 a[84:87], v[52:55], a[132:135], a[84:87]
  buffer_load_dwordx4 v6, s[8:11], s43 offen offset:2048 lds
  v_mfma_f32_16x16x32_bf16 a[80:83], v[52:55], a[128:131], a[80:83]
  ds_read_b64_tr_b16 v[52:53], v9 offset:8704
  v_mfma_f32_16x16x32_bf16 a[96:99], v[56:59], a[128:131], a[96:99]
  ds_read_b64_tr_b16 v[54:55], v9 offset:12800
  v_mfma_f32_16x16x32_bf16 a[100:103], v[56:59], a[132:135], a[100:103]
  buffer_load_dwordx4 a[252:255], v20, s[16:19], s71 offen offset:3072 sc1
  v_mfma_f32_16x16x32_bf16 a[104:107], v[56:59], a[136:139], a[104:107]
  v_mfma_f32_16x16x32_bf16 a[108:111], v[56:59], a[140:143], a[108:111]
  ds_read_b64_tr_b16 v[56:57], v8 offset:8960
  v_mfma_f32_16x16x32_bf16 a[124:127], v[60:63], a[140:143], a[124:127]
  ds_read_b64_tr_b16 v[58:59], v8 offset:13056
  v_mfma_f32_16x16x32_bf16 a[120:123], v[60:63], a[136:139], a[120:123]
  buffer_load_dwordx4 v7, s[8:11], s43 offen offset:3072 lds
  v_mfma_f32_16x16x32_bf16 a[116:119], v[60:63], a[132:135], a[116:119]
  v_mfma_f32_16x16x32_bf16 a[112:115], v[60:63], a[128:131], a[112:115]
  s_waitcnt vmcnt(27)
  v_cmp_eq_u32 vcc, v26, v25
  s_and_b32 s84, vcc_lo, 0x4
  s_cmp_eq_u32 s84, 0x4
  s_cbranch_scc0 L_main_spin_5
L_main_spin_5_ok:
  s_waitcnt vmcnt(52) lgkmcnt(6)
  v_mfma_f32_16x16x32_bf16 a[0:3], v[32:35], a[144:147], a[0:3]
  ds_read_b64_tr_b16 v[60:61], v9 offset:8960
  ds_read_b64_tr_b16 v[62:63], v9 offset:13056
  v_mfma_f32_16x16x32_bf16 a[4:7], v[32:35], a[148:151], a[4:7]
  s_add_u32 s68, s67, 24576
  v_mfma_f32_16x16x32_bf16 a[8:11], v[32:35], a[152:155], a[8:11]
  buffer_load_dwordx4 a[128:131], v20, s[16:19], s68 offen offset:0 sc1
  v_mfma_f32_16x16x32_bf16 a[12:15], v[32:35], a[156:159], a[12:15]
  ds_read_b64_tr_b16 v[32:33], v8 offset:16384
  ds_read_b64_tr_b16 v[34:35], v8 offset:20480
  v_mfma_f32_16x16x32_bf16 a[28:31], v[36:39], a[156:159], a[28:31]
  s_add_u32 s87, s74, 71303168
  v_mfma_f32_16x16x32_bf16 a[24:27], v[36:39], a[152:155], a[24:27]
  buffer_load_dwordx4 v[176:179], v20, s[16:19], s87 offen sc1
  v_mfma_f32_16x16x32_bf16 a[20:23], v[36:39], a[148:151], a[20:23]
  s_add_u32 m0, s63, 32768
  s_add_u32 s42, s65, 1835008
  v_mfma_f32_16x16x32_bf16 a[16:19], v[36:39], a[144:147], a[16:19]
  ds_read_b64_tr_b16 v[36:37], v9 offset:16384
  v_mfma_f32_16x16x32_bf16 a[32:35], v[40:43], a[144:147], a[32:35]
  ds_read_b64_tr_b16 v[38:39], v9 offset:20480
  v_mfma_f32_16x16x32_bf16 a[36:39], v[40:43], a[148:151], a[36:39]
  buffer_load_dwordx4 v4, s[8:11], s42 offen offset:0 lds
  v_mfma_f32_16x16x32_bf16 a[40:43], v[40:43], a[152:155], a[40:43]
  s_add_u32 s69, s67, 155904
  v_mfma_f32_16x16x32_bf16 a[44:47], v[40:43], a[156:159], a[44:47]
  ds_read_b64_tr_b16 v[40:41], v8 offset:16640
  v_mfma_f32_16x16x32_bf16 a[60:63], v[44:47], a[156:159], a[60:63]
  ds_read_b64_tr_b16 v[42:43], v8 offset:20736
  v_mfma_f32_16x16x32_bf16 a[56:59], v[44:47], a[152:155], a[56:59]
  buffer_load_dwordx4 a[132:135], v20, s[16:19], s69 offen offset:0 sc1
  v_mfma_f32_16x16x32_bf16 a[52:55], v[44:47], a[148:151], a[52:55]
  buffer_load_dwordx4 v5, s[8:11], s42 offen offset:1024 lds
  v_mfma_f32_16x16x32_bf16 a[48:51], v[44:47], a[144:147], a[48:51]
  s_waitcnt lgkmcnt(6)
  v_mfma_f32_16x16x32_bf16 a[64:67], v[48:51], a[144:147], a[64:67]
  ds_read_b64_tr_b16 v[44:45], v9 offset:16640
  ds_read_b64_tr_b16 v[46:47], v9 offset:20736
  v_mfma_f32_16x16x32_bf16 a[68:71], v[48:51], a[148:151], a[68:71]
  s_add_u32 s70, s67, 287232
  v_mfma_f32_16x16x32_bf16 a[72:75], v[48:51], a[152:155], a[72:75]
  buffer_load_dwordx4 a[136:139], v20, s[16:19], s70 offen offset:0 sc1
  v_mfma_f32_16x16x32_bf16 a[76:79], v[48:51], a[156:159], a[76:79]
  ds_read_b64_tr_b16 v[48:49], v8 offset:16896
  v_mfma_f32_16x16x32_bf16 a[92:95], v[52:55], a[156:159], a[92:95]
  ds_read_b64_tr_b16 v[50:51], v8 offset:20992
  v_mfma_f32_16x16x32_bf16 a[88:91], v[52:55], a[152:155], a[88:91]
  buffer_load_dwordx4 v6, s[8:11], s42 offen offset:2048 lds
  v_mfma_f32_16x16x32_bf16 a[84:87], v[52:55], a[148:151], a[84:87]
  v_mfma_f32_16x16x32_bf16 a[80:83], v[52:55], a[144:147], a[80:83]
  ds_read_b64_tr_b16 v[52:53], v9 offset:16896
  ds_read_b64_tr_b16 v[54:55], v9 offset:20992
  v_mfma_f32_16x16x32_bf16 a[96:99], v[56:59], a[144:147], a[96:99]
  s_add_u32 s71, s67, 418560
  v_mfma_f32_16x16x32_bf16 a[100:103], v[56:59], a[148:151], a[100:103]
  buffer_load_dwordx4 a[140:143], v20, s[16:19], s71 offen offset:0 sc1
  v_mfma_f32_16x16x32_bf16 a[104:107], v[56:59], a[152:155], a[104:107]
  v_mfma_f32_16x16x32_bf16 a[108:111], v[56:59], a[156:159], a[108:111]
  ds_read_b64_tr_b16 v[56:57], v8 offset:17152
  v_mfma_f32_16x16x32_bf16 a[124:127], v[60:63], a[156:159], a[124:127]
  ds_read_b64_tr_b16 v[58:59], v8 offset:21248
  v_mfma_f32_16x16x32_bf16 a[120:123], v[60:63], a[152:155], a[120:123]
  buffer_load_dwordx4 v7, s[8:11], s42 offen offset:3072 lds
  v_mfma_f32_16x16x32_bf16 a[116:119], v[60:63], a[148:151], a[116:119]
  v_mfma_f32_16x16x32_bf16 a[112:115], v[60:63], a[144:147], a[112:115]
  s_waitcnt vmcnt(53) lgkmcnt(6)
  v_mfma_f32_16x16x32_bf16 a[0:3], v[32:35], a[160:163], a[0:3]
  ds_read_b64_tr_b16 v[60:61], v9 offset:17152
  v_mfma_f32_16x16x32_bf16 a[4:7], v[32:35], a[164:167], a[4:7]
  ds_read_b64_tr_b16 v[62:63], v9 offset:21248
  v_mfma_f32_16x16x32_bf16 a[8:11], v[32:35], a[168:171], a[8:11]
  buffer_load_dwordx4 a[144:147], v20, s[16:19], s68 offen offset:1024 sc1
  v_mfma_f32_16x16x32_bf16 a[12:15], v[32:35], a[172:175], a[12:15]
  ds_read_b64_tr_b16 v[32:33], v8 offset:24576
  v_mfma_f32_16x16x32_bf16 a[28:31], v[36:39], a[172:175], a[28:31]
  ds_read_b64_tr_b16 v[34:35], v8 offset:28672
  v_mfma_f32_16x16x32_bf16 a[24:27], v[36:39], a[168:171], a[24:27]
  buffer_load_dword v25, v27, s[16:19], s89 offen offset:0 sc1
  v_mfma_f32_16x16x32_bf16 a[20:23], v[36:39], a[164:167], a[20:23]
  s_add_u32 m0, s63, 36864
  s_add_u32 s43, s65, 1867776
  v_mfma_f32_16x16x32_bf16 a[16:19], v[36:39], a[160:163], a[16:19]
  ds_read_b64_tr_b16 v[36:37], v9 offset:24576
  v_mfma_f32_16x16x32_bf16 a[32:35], v[40:43], a[160:163], a[32:35]
  ds_read_b64_tr_b16 v[38:39], v9 offset:28672
  v_mfma_f32_16x16x32_bf16 a[36:39], v[40:43], a[164:167], a[36:39]
  buffer_load_dwordx4 v4, s[8:11], s43 offen offset:0 lds
  v_mfma_f32_16x16x32_bf16 a[40:43], v[40:43], a[168:171], a[40:43]
  buffer_load_dwordx4 a[148:151], v20, s[16:19], s69 offen offset:1024 sc1
  v_mfma_f32_16x16x32_bf16 a[44:47], v[40:43], a[172:175], a[44:47]
  ds_read_b64_tr_b16 v[40:41], v8 offset:24832
  v_mfma_f32_16x16x32_bf16 a[60:63], v[44:47], a[172:175], a[60:63]
  ds_read_b64_tr_b16 v[42:43], v8 offset:28928
  v_mfma_f32_16x16x32_bf16 a[56:59], v[44:47], a[168:171], a[56:59]
  buffer_load_dwordx4 v5, s[8:11], s43 offen offset:1024 lds
  v_mfma_f32_16x16x32_bf16 a[52:55], v[44:47], a[164:167], a[52:55]
  v_mfma_f32_16x16x32_bf16 a[48:51], v[44:47], a[160:163], a[48:51]
  s_waitcnt lgkmcnt(6)
  v_mfma_f32_16x16x32_bf16 a[64:67], v[48:51], a[160:163], a[64:67]
  ds_read_b64_tr_b16 v[44:45], v9 offset:24832
  v_mfma_f32_16x16x32_bf16 a[68:71], v[48:51], a[164:167], a[68:71]
  ds_read_b64_tr_b16 v[46:47], v9 offset:28928
  v_mfma_f32_16x16x32_bf16 a[72:75], v[48:51], a[168:171], a[72:75]
  buffer_load_dwordx4 a[152:155], v20, s[16:19], s70 offen offset:1024 sc1
  v_mfma_f32_16x16x32_bf16 a[76:79], v[48:51], a[172:175], a[76:79]
  ds_read_b64_tr_b16 v[48:49], v8 offset:25088
  ds_read_b64_tr_b16 v[50:51], v8 offset:29184
  v_mfma_f32_16x16x32_bf16 a[92:95], v[52:55], a[172:175], a[92:95]
  s_add_u32 s87, s74, 72351744
  v_mfma_f32_16x16x32_bf16 a[88:91], v[52:55], a[168:171], a[88:91]
  buffer_load_dwordx4 v[180:183], v20, s[16:19], s87 offen sc1
  v_mfma_f32_16x16x32_bf16 a[84:87], v[52:55], a[164:167], a[84:87]
  buffer_load_dwordx4 v6, s[8:11], s43 offen offset:2048 lds
  v_mfma_f32_16x16x32_bf16 a[80:83], v[52:55], a[160:163], a[80:83]
  ds_read_b64_tr_b16 v[52:53], v9 offset:25088
  v_mfma_f32_16x16x32_bf16 a[96:99], v[56:59], a[160:163], a[96:99]
  ds_read_b64_tr_b16 v[54:55], v9 offset:29184
  v_mfma_f32_16x16x32_bf16 a[100:103], v[56:59], a[164:167], a[100:103]
  buffer_load_dwordx4 a[156:159], v20, s[16:19], s71 offen offset:1024 sc1
  v_mfma_f32_16x16x32_bf16 a[104:107], v[56:59], a[168:171], a[104:107]
  v_mfma_f32_16x16x32_bf16 a[108:111], v[56:59], a[172:175], a[108:111]
  ds_read_b64_tr_b16 v[56:57], v8 offset:25344
  v_mfma_f32_16x16x32_bf16 a[124:127], v[60:63], a[172:175], a[124:127]
  ds_read_b64_tr_b16 v[58:59], v8 offset:29440
  v_mfma_f32_16x16x32_bf16 a[120:123], v[60:63], a[168:171], a[120:123]
  buffer_load_dwordx4 v7, s[8:11], s43 offen offset:3072 lds
  v_mfma_f32_16x16x32_bf16 a[116:119], v[60:63], a[164:167], a[116:119]
  v_mfma_f32_16x16x32_bf16 a[112:115], v[60:63], a[160:163], a[112:115]
  s_waitcnt vmcnt(57) lgkmcnt(6)
  v_mfma_f32_16x16x32_bf16 a[0:3], v[32:35], a[176:179], a[0:3]
  ds_read_b64_tr_b16 v[60:61], v9 offset:25344
  v_mfma_f32_16x16x32_bf16 a[4:7], v[32:35], a[180:183], a[4:7]
  ds_read_b64_tr_b16 v[62:63], v9 offset:29440
  v_mfma_f32_16x16x32_bf16 a[8:11], v[32:35], a[184:187], a[8:11]
  buffer_load_dwordx4 a[160:163], v20, s[16:19], s68 offen offset:2048 sc1
  v_mfma_f32_16x16x32_bf16 a[12:15], v[32:35], a[188:191], a[12:15]
  v_mfma_f32_16x16x32_bf16 a[28:31], v[36:39], a[188:191], a[28:31]
  v_mfma_f32_16x16x32_bf16 a[24:27], v[36:39], a[184:187], a[24:27]
  s_add_u32 s87, s74, 73400320
  v_mfma_f32_16x16x32_bf16 a[20:23], v[36:39], a[180:183], a[20:23]
  buffer_load_dwordx4 v[184:187], v20, s[16:19], s87 offen sc1
  v_mfma_f32_16x16x32_bf16 a[16:19], v[36:39], a[176:179], a[16:19]
  s_waitcnt vmcnt(40)
  s_barrier
  v_mfma_f32_16x16x32_bf16 a[32:35], v[40:43], a[176:179], a[32:35]
  ds_read_b64_tr_b16 v[32:33], v10 offset:32768
  ds_read_b64_tr_b16 v[34:35], v10 offset:36864
  v_mfma_f32_16x16x32_bf16 a[36:39], v[40:43], a[180:183], a[36:39]
  ds_read_b64_tr_b16 v[36:37], v11 offset:32768
  v_mfma_f32_16x16x32_bf16 a[40:43], v[40:43], a[184:187], a[40:43]
  ds_read_b64_tr_b16 v[38:39], v11 offset:36864
  v_mfma_f32_16x16x32_bf16 a[44:47], v[40:43], a[188:191], a[44:47]
  ds_read_b64_tr_b16 v[40:41], v10 offset:33024
  v_mfma_f32_16x16x32_bf16 a[60:63], v[44:47], a[188:191], a[60:63]
  ds_read_b64_tr_b16 v[42:43], v10 offset:37120
  v_mfma_f32_16x16x32_bf16 a[56:59], v[44:47], a[184:187], a[56:59]
  buffer_load_dwordx4 a[164:167], v20, s[16:19], s69 offen offset:2048 sc1
  v_mfma_f32_16x16x32_bf16 a[52:55], v[44:47], a[180:183], a[52:55]
  v_mfma_f32_16x16x32_bf16 a[48:51], v[44:47], a[176:179], a[48:51]
  s_waitcnt lgkmcnt(6)
  v_mfma_f32_16x16x32_bf16 a[64:67], v[48:51], a[176:179], a[64:67]
  ds_read_b64_tr_b16 v[44:45], v11 offset:33024
  v_mfma_f32_16x16x32_bf16 a[68:71], v[48:51], a[180:183], a[68:71]
  ds_read_b64_tr_b16 v[46:47], v11 offset:37120
  v_mfma_f32_16x16x32_bf16 a[72:75], v[48:51], a[184:187], a[72:75]
  v_mfma_f32_16x16x32_bf16 a[76:79], v[48:51], a[188:191], a[76:79]
  ds_read_b64_tr_b16 v[48:49], v10 offset:33280
  v_mfma_f32_16x16x32_bf16 a[92:95], v[52:55], a[188:191], a[92:95]
  ds_read_b64_tr_b16 v[50:51], v10 offset:37376
  v_mfma_f32_16x16x32_bf16 a[88:91], v[52:55], a[184:187], a[88:91]
  buffer_load_dwordx4 a[168:171], v20, s[16:19], s70 offen offset:2048 sc1
  v_mfma_f32_16x16x32_bf16 a[84:87], v[52:55], a[180:183], a[84:87]
  v_mfma_f32_16x16x32_bf16 a[80:83], v[52:55], a[176:179], a[80:83]
  ds_read_b64_tr_b16 v[52:53], v11 offset:33280
  v_mfma_f32_16x16x32_bf16 a[96:99], v[56:59], a[176:179], a[96:99]
  ds_read_b64_tr_b16 v[54:55], v11 offset:37376
  v_mfma_f32_16x16x32_bf16 a[100:103], v[56:59], a[180:183], a[100:103]
  buffer_load_dwordx4 a[172:175], v20, s[16:19], s71 offen offset:2048 sc1
  v_mfma_f32_16x16x32_bf16 a[104:107], v[56:59], a[184:187], a[104:107]
  v_mfma_f32_16x16x32_bf16 a[108:111], v[56:59], a[188:191], a[108:111]
  ds_read_b64_tr_b16 v[56:57], v10 offset:33536
  v_mfma_f32_16x16x32_bf16 a[124:127], v[60:63], a[188:191], a[124:127]
  ds_read_b64_tr_b16 v[58:59], v10 offset:37632
  v_mfma_f32_16x16x32_bf16 a[120:123], v[60:63], a[184:187], a[120:123]
  v_mfma_f32_16x16x32_bf16 a[116:119], v[60:63], a[180:183], a[116:119]
  v_mfma_f32_16x16x32_bf16 a[112:115], v[60:63], a[176:179], a[112:115]
  s_waitcnt vmcnt(32)
  s_waitcnt vmcnt(54) lgkmcnt(6)
  v_mfma_f32_16x16x32_bf16 a[0:3], v[32:35], a[192:195], a[0:3]
  v_lshlrev_b32 v88, 16, v144
  ds_read_b64_tr_b16 v[60:61], v11 offset:33536
  v_mfma_f32_16x16x32_bf16 a[4:7], v[32:35], a[196:199], a[4:7]
  ds_read_b64_tr_b16 v[62:63], v11 offset:37632
  v_mfma_f32_16x16x32_bf16 a[8:11], v[32:35], a[200:203], a[8:11]
  buffer_load_dwordx4 a[176:179], v20, s[16:19], s68 offen offset:3072 sc1
  v_mfma_f32_16x16x32_bf16 a[12:15], v[32:35], a[204:207], a[12:15]
  ds_read_b64_tr_b16 v[32:33], v10 offset:40960
  v_and_b32 v89, 0xffff0000, v144
  v_mfma_f32_16x16x32_bf16 a[28:31], v[36:39], a[204:207], a[28:31]
  ds_read_b64_tr_b16 v[34:35], v10 offset:45056
  v_add_f32 v96, v96, v88
  v_mfma_f32_16x16x32_bf16 a[24:27], v[36:39], a[200:203], a[24:27]
  s_add_u32 s87, s74, 74448896
  v_mfma_f32_16x16x32_bf16 a[20:23], v[36:39], a[196:199], a[20:23]
  buffer_load_dwordx4 v[188:191], v20, s[16:19], s87 offen sc1
  v_add_f32 v97, v97, v89
  v_mfma_f32_16x16x32_bf16 a[16:19], v[36:39], a[192:195], a[16:19]
  ds_read_b64_tr_b16 v[36:37], v11 offset:40960
  v_lshlrev_b32 v90, 16, v145
  v_mfma_f32_16x16x32_bf16 a[32:35], v[40:43], a[192:195], a[32:35]
  ds_read_b64_tr_b16 v[38:39], v11 offset:45056
  v_and_b32 v91, 0xffff0000, v145
  v_mfma_f32_16x16x32_bf16 a[36:39], v[40:43], a[196:199], a[36:39]
  v_add_f32 v98, v98, v90
  v_add_f32 v99, v99, v91
  v_mfma_f32_16x16x32_bf16 a[40:43], v[40:43], a[200:203], a[40:43]
  v_lshlrev_b32 v92, 16, v146
  v_mfma_f32_16x16x32_bf16 a[44:47], v[40:43], a[204:207], a[44:47]
  ds_read_b64_tr_b16 v[40:41], v10 offset:41216
  v_and_b32 v93, 0xffff0000, v146
  v_mfma_f32_16x16x32_bf16 a[60:63], v[44:47], a[204:207], a[60:63]
  ds_read_b64_tr_b16 v[42:43], v10 offset:45312
  buffer_load_dwordx4 a[180:183], v20, s[16:19], s69 offen offset:3072 sc1
  v_mfma_f32_16x16x32_bf16 a[56:59], v[44:47], a[200:203], a[56:59]
  v_add_f32 v100, v100, v92
  v_add_f32 v101, v101, v93
  v_mfma_f32_16x16x32_bf16 a[52:55], v[44:47], a[196:199], a[52:55]
  v_lshlrev_b32 v94, 16, v147
  v_mfma_f32_16x16x32_bf16 a[48:51], v[44:47], a[192:195], a[48:51]
  ds_read_b64_tr_b16 v[44:45], v11 offset:41216
  s_waitcnt lgkmcnt(7)
  v_mfma_f32_16x16x32_bf16 a[64:67], v[48:51], a[192:195], a[64:67]
  ds_read_b64_tr_b16 v[46:47], v11 offset:45312
  v_and_b32 v95, 0xffff0000, v147
  v_mfma_f32_16x16x32_bf16 a[68:71], v[48:51], a[196:199], a[68:71]
  v_add_f32 v102, v102, v94
  v_add_f32 v103, v103, v95
  v_mfma_f32_16x16x32_bf16 a[72:75], v[48:51], a[200:203], a[72:75]
  v_lshlrev_b32 v88, 16, v148
  v_mfma_f32_16x16x32_bf16 a[76:79], v[48:51], a[204:207], a[76:79]
  ds_read_b64_tr_b16 v[48:49], v10 offset:41472
  buffer_load_dwordx4 a[184:187], v20, s[16:19], s70 offen offset:3072 sc1
  v_mfma_f32_16x16x32_bf16 a[92:95], v[52:55], a[204:207], a[92:95]
  ds_read_b64_tr_b16 v[50:51], v10 offset:45568
  v_and_b32 v89, 0xffff0000, v148
  v_mfma_f32_16x16x32_bf16 a[88:91], v[52:55], a[200:203], a[88:91]
  v_add_f32 v104, v104, v88
  v_add_f32 v105, v105, v89
  v_mfma_f32_16x16x32_bf16 a[84:87], v[52:55], a[196:199], a[84:87]
  v_lshlrev_b32 v90, 16, v149
  v_mfma_f32_16x16x32_bf16 a[80:83], v[52:55], a[192:195], a[80:83]
  ds_read_b64_tr_b16 v[52:53], v11 offset:41472
  v_and_b32 v91, 0xffff0000, v149
  v_mfma_f32_16x16x32_bf16 a[96:99], v[56:59], a[192:195], a[96:99]
  ds_read_b64_tr_b16 v[54:55], v11 offset:45568
  v_add_f32 v106, v106, v90
  v_mfma_f32_16x16x32_bf16 a[100:103], v[56:59], a[196:199], a[100:103]
  buffer_load_dwordx4 a[188:191], v20, s[16:19], s71 offen offset:3072 sc1
  v_add_f32 v107, v107, v91
  v_mfma_f32_16x16x32_bf16 a[104:107], v[56:59], a[200:203], a[104:107]
  v_lshlrev_b32 v92, 16, v150
  v_mfma_f32_16x16x32_bf16 a[108:111], v[56:59], a[204:207], a[108:111]
  ds_read_b64_tr_b16 v[56:57], v10 offset:41728
  v_and_b32 v93, 0xffff0000, v150
  v_mfma_f32_16x16x32_bf16 a[124:127], v[60:63], a[204:207], a[124:127]
  ds_read_b64_tr_b16 v[58:59], v10 offset:45824
  v_add_f32 v108, v108, v92
  v_mfma_f32_16x16x32_bf16 a[120:123], v[60:63], a[200:203], a[120:123]
  v_add_f32 v109, v109, v93
  v_mfma_f32_16x16x32_bf16 a[116:119], v[60:63], a[196:199], a[116:119]
  v_lshlrev_b32 v94, 16, v151
  v_mfma_f32_16x16x32_bf16 a[112:115], v[60:63], a[192:195], a[112:115]
  ds_read_b64_tr_b16 v[60:61], v11 offset:41728
  v_and_b32 v95, 0xffff0000, v151
  v_add_f32 v110, v110, v94
  v_add_f32 v111, v111, v95
  s_waitcnt vmcnt(18)
  v_cmp_eq_u32 vcc, v26, v25
  s_and_b32 s84, vcc_lo, 0x8
  s_cmp_eq_u32 s84, 0x8
  s_cbranch_scc0 L_main_spin_6
L_main_spin_6_ok:
  s_waitcnt vmcnt(49) lgkmcnt(7)
  v_mfma_f32_16x16x32_bf16 a[0:3], v[32:35], a[208:211], a[0:3]
  v_lshlrev_b32 v88, 16, v152
  ds_read_b64_tr_b16 v[62:63], v11 offset:45824
  v_mfma_f32_16x16x32_bf16 a[4:7], v[32:35], a[212:215], a[4:7]
  s_add_u32 s68, s67, 28672
  v_mfma_f32_16x16x32_bf16 a[8:11], v[32:35], a[216:219], a[8:11]
  buffer_load_dwordx4 a[192:195], v20, s[16:19], s68 offen offset:0 sc1
  v_mfma_f32_16x16x32_bf16 a[12:15], v[32:35], a[220:223], a[12:15]
  ds_read_b64_tr_b16 v[32:33], v10 offset:49152
  v_and_b32 v89, 0xffff0000, v152
  v_mfma_f32_16x16x32_bf16 a[28:31], v[36:39], a[220:223], a[28:31]
  ds_read_b64_tr_b16 v[34:35], v10 offset:53248
  v_add_f32 v112, v112, v88
  v_mfma_f32_16x16x32_bf16 a[24:27], v[36:39], a[216:219], a[24:27]
  s_add_u32 s87, s74, 75497472
  v_mfma_f32_16x16x32_bf16 a[20:23], v[36:39], a[212:215], a[20:23]
  buffer_load_dwordx4 v[208:211], v20, s[16:19], s87 offen sc1
  v_add_f32 v113, v113, v89
  v_mfma_f32_16x16x32_bf16 a[16:19], v[36:39], a[208:211], a[16:19]
  ds_read_b64_tr_b16 v[36:37], v11 offset:49152
  v_lshlrev_b32 v90, 16, v153
  v_mfma_f32_16x16x32_bf16 a[32:35], v[40:43], a[208:211], a[32:35]
  ds_read_b64_tr_b16 v[38:39], v11 offset:53248
  v_and_b32 v91, 0xffff0000, v153
  v_mfma_f32_16x16x32_bf16 a[36:39], v[40:43], a[212:215], a[36:39]
  v_add_f32 v114, v114, v90
  v_add_f32 v115, v115, v91
  v_mfma_f32_16x16x32_bf16 a[40:43], v[40:43], a[216:219], a[40:43]
  v_lshlrev_b32 v92, 16, v154
  v_mfma_f32_16x16x32_bf16 a[44:47], v[40:43], a[220:223], a[44:47]
  ds_read_b64_tr_b16 v[40:41], v10 offset:49408
  v_and_b32 v93, 0xffff0000, v154
  v_mfma_f32_16x16x32_bf16 a[60:63], v[44:47], a[220:223], a[60:63]
  ds_read_b64_tr_b16 v[42:43], v10 offset:53504
  v_add_f32 v116, v116, v92
  v_mfma_f32_16x16x32_bf16 a[56:59], v[44:47], a[216:219], a[56:59]
  s_add_u32 s69, s67, 160000
  v_mfma_f32_16x16x32_bf16 a[52:55], v[44:47], a[212:215], a[52:55]
  buffer_load_dwordx4 a[196:199], v20, s[16:19], s69 offen offset:0 sc1
  v_add_f32 v117, v117, v93
  v_mfma_f32_16x16x32_bf16 a[48:51], v[44:47], a[208:211], a[48:51]
  ds_read_b64_tr_b16 v[44:45], v11 offset:49408
  v_lshlrev_b32 v94, 16, v155
  s_waitcnt lgkmcnt(7)
  v_mfma_f32_16x16x32_bf16 a[64:67], v[48:51], a[208:211], a[64:67]
  ds_read_b64_tr_b16 v[46:47], v11 offset:53504
  v_and_b32 v95, 0xffff0000, v155
  v_mfma_f32_16x16x32_bf16 a[68:71], v[48:51], a[212:215], a[68:71]
  v_add_f32 v118, v118, v94
  v_add_f32 v119, v119, v95
  v_mfma_f32_16x16x32_bf16 a[72:75], v[48:51], a[216:219], a[72:75]
  s_add_u32 s70, s67, 291328
  v_mfma_f32_16x16x32_bf16 a[76:79], v[48:51], a[220:223], a[76:79]
  ds_read_b64_tr_b16 v[48:49], v10 offset:49664
  buffer_load_dwordx4 a[200:203], v20, s[16:19], s70 offen offset:0 sc1
  v_lshlrev_b32 v88, 16, v156
  v_mfma_f32_16x16x32_bf16 a[92:95], v[52:55], a[220:223], a[92:95]
  ds_read_b64_tr_b16 v[50:51], v10 offset:53760
  v_and_b32 v89, 0xffff0000, v156
  v_mfma_f32_16x16x32_bf16 a[88:91], v[52:55], a[216:219], a[88:91]
  v_add_f32 v120, v120, v88
  v_add_f32 v121, v121, v89
  v_mfma_f32_16x16x32_bf16 a[84:87], v[52:55], a[212:215], a[84:87]
  v_lshlrev_b32 v90, 16, v157
  v_mfma_f32_16x16x32_bf16 a[80:83], v[52:55], a[208:211], a[80:83]
  ds_read_b64_tr_b16 v[52:53], v11 offset:49664
  v_and_b32 v91, 0xffff0000, v157
  v_mfma_f32_16x16x32_bf16 a[96:99], v[56:59], a[208:211], a[96:99]
  ds_read_b64_tr_b16 v[54:55], v11 offset:53760
  v_add_f32 v122, v122, v90
  v_mfma_f32_16x16x32_bf16 a[100:103], v[56:59], a[212:215], a[100:103]
  s_add_u32 s71, s67, 422656
  v_mfma_f32_16x16x32_bf16 a[104:107], v[56:59], a[216:219], a[104:107]
  buffer_load_dwordx4 a[204:207], v20, s[16:19], s71 offen offset:0 sc1
  v_add_f32 v123, v123, v91
  v_mfma_f32_16x16x32_bf16 a[108:111], v[56:59], a[220:223], a[108:111]
  ds_read_b64_tr_b16 v[56:57], v10 offset:49920
  v_lshlrev_b32 v92, 16, v158
  v_mfma_f32_16x16x32_bf16 a[124:127], v[60:63], a[220:223], a[124:127]
  ds_read_b64_tr_b16 v[58:59], v10 offset:54016
  v_and_b32 v93, 0xffff0000, v158
  v_mfma_f32_16x16x32_bf16 a[120:123], v[60:63], a[216:219], a[120:123]
  v_add_f32 v124, v124, v92
  v_add_f32 v125, v125, v93
  v_mfma_f32_16x16x32_bf16 a[116:119], v[60:63], a[212:215], a[116:119]
  v_lshlrev_b32 v94, 16, v159
  v_mfma_f32_16x16x32_bf16 a[112:115], v[60:63], a[208:211], a[112:115]
  ds_read_b64_tr_b16 v[60:61], v11 offset:49920
  v_and_b32 v95, 0xffff0000, v159
  v_add_f32 v126, v126, v94
  v_add_f32 v127, v127, v95
  s_waitcnt vmcnt(45) lgkmcnt(7)
  v_mfma_f32_16x16x32_bf16 a[0:3], v[32:35], a[224:227], a[0:3]
  ds_read_b64_tr_b16 v[62:63], v11 offset:54016
  v_mfma_f32_16x16x32_bf16 a[4:7], v[32:35], a[228:231], a[4:7]
  buffer_load_dwordx4 a[208:211], v20, s[16:19], s68 offen offset:1024 sc1
  v_mfma_f32_16x16x32_bf16 a[8:11], v[32:35], a[232:235], a[8:11]
  v_mfma_f32_16x16x32_bf16 a[12:15], v[32:35], a[236:239], a[12:15]
  ds_read_b64_tr_b16 v[32:33], v10 offset:57344
  v_mfma_f32_16x16x32_bf16 a[28:31], v[36:39], a[236:239], a[28:31]
  ds_read_b64_tr_b16 v[34:35], v10 offset:61440
  v_mfma_f32_16x16x32_bf16 a[24:27], v[36:39], a[232:235], a[24:27]
  s_add_u32 s87, s74, 76546048
  v_mfma_f32_16x16x32_bf16 a[20:23], v[36:39], a[228:231], a[20:23]
  buffer_load_dwordx4 v[212:215], v20, s[16:19], s87 offen sc1
  v_mfma_f32_16x16x32_bf16 a[16:19], v[36:39], a[224:227], a[16:19]
  ds_read_b64_tr_b16 v[36:37], v11 offset:57344
  v_mfma_f32_16x16x32_bf16 a[32:35], v[40:43], a[224:227], a[32:35]
  ds_read_b64_tr_b16 v[38:39], v11 offset:61440
  v_mfma_f32_16x16x32_bf16 a[36:39], v[40:43], a[228:231], a[36:39]
  v_mfma_f32_16x16x32_bf16 a[40:43], v[40:43], a[232:235], a[40:43]
  v_mfma_f32_16x16x32_bf16 a[44:47], v[40:43], a[236:239], a[44:47]
  ds_read_b64_tr_b16 v[40:41], v10 offset:57600
  v_mfma_f32_16x16x32_bf16 a[60:63], v[44:47], a[236:239], a[60:63]
  ds_read_b64_tr_b16 v[42:43], v10 offset:61696
  v_mfma_f32_16x16x32_bf16 a[56:59], v[44:47], a[232:235], a[56:59]
  buffer_load_dwordx4 a[212:215], v20, s[16:19], s69 offen offset:1024 sc1
  v_mfma_f32_16x16x32_bf16 a[52:55], v[44:47], a[228:231], a[52:55]
  v_mfma_f32_16x16x32_bf16 a[48:51], v[44:47], a[224:227], a[48:51]
  s_waitcnt lgkmcnt(6)
  v_mfma_f32_16x16x32_bf16 a[64:67], v[48:51], a[224:227], a[64:67]
  ds_read_b64_tr_b16 v[44:45], v11 offset:57600
  v_mfma_f32_16x16x32_bf16 a[68:71], v[48:51], a[228:231], a[68:71]
  ds_read_b64_tr_b16 v[46:47], v11 offset:61696
  v_mfma_f32_16x16x32_bf16 a[72:75], v[48:51], a[232:235], a[72:75]
  v_mfma_f32_16x16x32_bf16 a[76:79], v[48:51], a[236:239], a[76:79]
  ds_read_b64_tr_b16 v[48:49], v10 offset:57856
  v_mfma_f32_16x16x32_bf16 a[92:95], v[52:55], a[236:239], a[92:95]
  ds_read_b64_tr_b16 v[50:51], v10 offset:61952
  v_mfma_f32_16x16x32_bf16 a[88:91], v[52:55], a[232:235], a[88:91]
  buffer_load_dwordx4 a[216:219], v20, s[16:19], s70 offen offset:1024 sc1
  v_mfma_f32_16x16x32_bf16 a[84:87], v[52:55], a[228:231], a[84:87]
  v_mfma_f32_16x16x32_bf16 a[80:83], v[52:55], a[224:227], a[80:83]
  ds_read_b64_tr_b16 v[52:53], v11 offset:57856
  v_mfma_f32_16x16x32_bf16 a[96:99], v[56:59], a[224:227], a[96:99]
  ds_read_b64_tr_b16 v[54:55], v11 offset:61952
  v_mfma_f32_16x16x32_bf16 a[100:103], v[56:59], a[228:231], a[100:103]
  buffer_load_dwordx4 a[220:223], v20, s[16:19], s71 offen offset:1024 sc1
  v_mfma_f32_16x16x32_bf16 a[104:107], v[56:59], a[232:235], a[104:107]
  v_mfma_f32_16x16x32_bf16 a[108:111], v[56:59], a[236:239], a[108:111]
  ds_read_b64_tr_b16 v[56:57], v10 offset:58112
  v_mfma_f32_16x16x32_bf16 a[124:127], v[60:63], a[236:239], a[124:127]
  ds_read_b64_tr_b16 v[58:59], v10 offset:62208
  v_mfma_f32_16x16x32_bf16 a[120:123], v[60:63], a[232:235], a[120:123]
  v_mfma_f32_16x16x32_bf16 a[116:119], v[60:63], a[228:231], a[116:119]
  v_mfma_f32_16x16x32_bf16 a[112:115], v[60:63], a[224:227], a[112:115]
  s_waitcnt vmcnt(40) lgkmcnt(6)
  v_mfma_f32_16x16x32_bf16 a[0:3], v[32:35], a[240:243], a[0:3]
  ds_read_b64_tr_b16 v[60:61], v11 offset:58112
  v_mfma_f32_16x16x32_bf16 a[4:7], v[32:35], a[244:247], a[4:7]
  ds_read_b64_tr_b16 v[62:63], v11 offset:62208
  v_mfma_f32_16x16x32_bf16 a[8:11], v[32:35], a[248:251], a[8:11]
  buffer_load_dwordx4 a[224:227], v20, s[16:19], s68 offen offset:2048 sc1
  v_mfma_f32_16x16x32_bf16 a[12:15], v[32:35], a[252:255], a[12:15]
  v_mfma_f32_16x16x32_bf16 a[28:31], v[36:39], a[252:255], a[28:31]
  v_mfma_f32_16x16x32_bf16 a[24:27], v[36:39], a[248:251], a[24:27]
  s_add_u32 s87, s74, 77594624
  v_mfma_f32_16x16x32_bf16 a[20:23], v[36:39], a[244:247], a[20:23]
  buffer_load_dwordx4 v[216:219], v20, s[16:19], s87 offen sc1
  v_mfma_f32_16x16x32_bf16 a[16:19], v[36:39], a[240:243], a[16:19]
  s_waitcnt vmcnt(41)
  s_barrier
  v_mfma_f32_16x16x32_bf16 a[32:35], v[40:43], a[240:243], a[32:35]
  ds_read_b64_tr_b16 v[32:33], v12 offset:256
  ds_read_b64_tr_b16 v[34:35], v12 offset:4352
  v_mfma_f32_16x16x32_bf16 a[36:39], v[40:43], a[244:247], a[36:39]
  ds_read_b64_tr_b16 v[36:37], v13 offset:256
  v_mfma_f32_16x16x32_bf16 a[40:43], v[40:43], a[248:251], a[40:43]
  ds_read_b64_tr_b16 v[38:39], v13 offset:4352
  v_mfma_f32_16x16x32_bf16 a[44:47], v[40:43], a[252:255], a[44:47]
  ds_read_b64_tr_b16 v[40:41], v12 offset:8448
  v_mfma_f32_16x16x32_bf16 a[60:63], v[44:47], a[252:255], a[60:63]
  ds_read_b64_tr_b16 v[42:43], v12 offset:12544
  v_mfma_f32_16x16x32_bf16 a[56:59], v[44:47], a[248:251], a[56:59]
  buffer_load_dwordx4 a[228:231], v20, s[16:19], s69 offen offset:2048 sc1
  v_mfma_f32_16x16x32_bf16 a[52:55], v[44:47], a[244:247], a[52:55]
  v_mfma_f32_16x16x32_bf16 a[48:51], v[44:47], a[240:243], a[48:51]
  s_waitcnt lgkmcnt(6)
  v_mfma_f32_16x16x32_bf16 a[64:67], v[48:51], a[240:243], a[64:67]
  ds_read_b64_tr_b16 v[44:45], v13 offset:8448
  v_mfma_f32_16x16x32_bf16 a[68:71], v[48:51], a[244:247], a[68:71]
  ds_read_b64_tr_b16 v[46:47], v13 offset:12544
  v_mfma_f32_16x16x32_bf16 a[72:75], v[48:51], a[248:251], a[72:75]
  v_mfma_f32_16x16x32_bf16 a[76:79], v[48:51], a[252:255], a[76:79]
  ds_read_b64_tr_b16 v[48:49], v12 offset:16640
  v_mfma_f32_16x16x32_bf16 a[92:95], v[52:55], a[252:255], a[92:95]
  ds_read_b64_tr_b16 v[50:51], v12 offset:20736
  v_mfma_f32_16x16x32_bf16 a[88:91], v[52:55], a[248:251], a[88:91]
  buffer_load_dwordx4 a[232:235], v20, s[16:19], s70 offen offset:2048 sc1
  v_mfma_f32_16x16x32_bf16 a[84:87], v[52:55], a[244:247], a[84:87]
  v_mfma_f32_16x16x32_bf16 a[80:83], v[52:55], a[240:243], a[80:83]
  ds_read_b64_tr_b16 v[52:53], v13 offset:16640
  v_mfma_f32_16x16x32_bf16 a[96:99], v[56:59], a[240:243], a[96:99]
  ds_read_b64_tr_b16 v[54:55], v13 offset:20736
  v_mfma_f32_16x16x32_bf16 a[100:103], v[56:59], a[244:247], a[100:103]
  buffer_load_dwordx4 a[236:239], v20, s[16:19], s71 offen offset:2048 sc1
  v_mfma_f32_16x16x32_bf16 a[104:107], v[56:59], a[248:251], a[104:107]
  v_mfma_f32_16x16x32_bf16 a[108:111], v[56:59], a[252:255], a[108:111]
  ds_read_b64_tr_b16 v[56:57], v12 offset:24832
  v_mfma_f32_16x16x32_bf16 a[124:127], v[60:63], a[252:255], a[124:127]
  ds_read_b64_tr_b16 v[58:59], v12 offset:28928
  v_mfma_f32_16x16x32_bf16 a[120:123], v[60:63], a[248:251], a[120:123]
  v_mfma_f32_16x16x32_bf16 a[116:119], v[60:63], a[244:247], a[116:119]
  v_mfma_f32_16x16x32_bf16 a[112:115], v[60:63], a[240:243], a[112:115]
  s_waitcnt vmcnt(18)
  s_waitcnt vmcnt(36) lgkmcnt(6)
  v_mfma_f32_16x16x32_bf16 a[32:35], v[32:35], a[128:131], a[32:35]
  v_lshlrev_b32 v88, 16, v176
  ds_read_b64_tr_b16 v[60:61], v13 offset:24832
  v_mfma_f32_16x16x32_bf16 a[36:39], v[32:35], a[132:135], a[36:39]
  ds_read_b64_tr_b16 v[62:63], v13 offset:28928
  v_mfma_f32_16x16x32_bf16 a[40:43], v[32:35], a[136:139], a[40:43]
  v_and_b32 v89, 0xffff0000, v176
  v_add_f32 v96, v96, v88
  v_mfma_f32_16x16x32_bf16 a[44:47], v[32:35], a[140:143], a[44:47]
  ds_read_b64_tr_b16 v[32:33], v12 offset:512
  buffer_load_dwordx4 a[240:243], v20, s[16:19], s68 offen offset:3072 sc1
  v_mfma_f32_16x16x32_bf16 a[60:63], v[36:39], a[140:143], a[60:63]
  ds_read_b64_tr_b16 v[34:35], v12 offset:4608
  v_add_f32 v97, v97, v89
  v_mfma_f32_16x16x32_bf16 a[56:59], v[36:39], a[136:139], a[56:59]
  v_lshlrev_b32 v90, 16, v177
  v_and_b32 v91, 0xffff0000, v177
  v_mfma_f32_16x16x32_bf16 a[52:55], v[36:39], a[132:135], a[52:55]
  v_add_f32 v98, v98, v90
  v_add_f32 v99, v99, v91
  v_mfma_f32_16x16x32_bf16 a[48:51], v[36:39], a[128:131], a[48:51]
  ds_read_b64_tr_b16 v[36:37], v13 offset:512
  v_lshlrev_b32 v92, 16, v178
  s_waitcnt vmcnt(27)
  v_mfma_f32_16x16x32_bf16 a[32:35], v[40:43], a[144:147], a[32:35]
  ds_read_b64_tr_b16 v[38:39], v13 offset:4608
  v_and_b32 v93, 0xffff0000, v178
  v_mfma_f32_16x16x32_bf16 a[36:39], v[40:43], a[148:151], a[36:39]
  s_add_u32 s87, s74, 78643200
  v_mfma_f32_16x16x32_bf16 a[40:43], v[40:43], a[152:155], a[40:43]
  buffer_load_dwordx4 v[220:223], v20, s[16:19], s87 offen sc1
  v_add_f32 v100, v100, v92
  v_mfma_f32_16x16x32_bf16 a[44:47], v[40:43], a[156:159], a[44:47]
  ds_read_b64_tr_b16 v[40:41], v12 offset:8704
  v_add_f32 v101, v101, v93
  v_lshlrev_b32 v94, 16, v179
  v_mfma_f32_16x16x32_bf16 a[60:63], v[44:47], a[156:159], a[60:63]
  ds_read_b64_tr_b16 v[42:43], v12 offset:12800
  v_and_b32 v95, 0xffff0000, v179
  v_mfma_f32_16x16x32_bf16 a[56:59], v[44:47], a[152:155], a[56:59]
  v_add_f32 v102, v102, v94
  v_add_f32 v103, v103, v95
  v_mfma_f32_16x16x32_bf16 a[52:55], v[44:47], a[148:151], a[52:55]
  buffer_load_dwordx4 a[244:247], v20, s[16:19], s69 offen offset:3072 sc1
  v_lshlrev_b32 v88, 16, v180
  v_mfma_f32_16x16x32_bf16 a[48:51], v[44:47], a[144:147], a[48:51]
  ds_read_b64_tr_b16 v[44:45], v13 offset:8704
  v_and_b32 v89, 0xffff0000, v180
  s_waitcnt vmcnt(23) lgkmcnt(7)
  v_mfma_f32_16x16x32_bf16 a[32:35], v[48:51], a[160:163], a[32:35]
  ds_read_b64_tr_b16 v[46:47], v13 offset:12800
  v_add_f32 v104, v104, v88
  v_add_f32 v105, v105, v89
  v_mfma_f32_16x16x32_bf16 a[36:39], v[48:51], a[164:167], a[36:39]
  v_lshlrev_b32 v90, 16, v181
  v_and_b32 v91, 0xffff0000, v181
  v_mfma_f32_16x16x32_bf16 a[40:43], v[48:51], a[168:171], a[40:43]
  v_add_f32 v106, v106, v90
  v_add_f32 v107, v107, v91
  v_mfma_f32_16x16x32_bf16 a[44:47], v[48:51], a[172:175], a[44:47]
  ds_read_b64_tr_b16 v[48:49], v12 offset:16896
  v_lshlrev_b32 v92, 16, v182
  v_mfma_f32_16x16x32_bf16 a[60:63], v[52:55], a[172:175], a[60:63]
  ds_read_b64_tr_b16 v[50:51], v12 offset:20992
  buffer_load_dwordx4 a[248:251], v20, s[16:19], s70 offen offset:3072 sc1
  v_mfma_f32_16x16x32_bf16 a[56:59], v[52:55], a[168:171], a[56:59]
  v_and_b32 v93, 0xffff0000, v182
  v_add_f32 v108, v108, v92
  v_mfma_f32_16x16x32_bf16 a[52:55], v[52:55], a[164:167], a[52:55]
  v_add_f32 v109, v109, v93
  v_lshlrev_b32 v94, 16, v183
  v_mfma_f32_16x16x32_bf16 a[48:51], v[52:55], a[160:163], a[48:51]
  ds_read_b64_tr_b16 v[52:53], v13 offset:16896
  v_and_b32 v95, 0xffff0000, v183
  s_waitcnt vmcnt(19)
  v_mfma_f32_16x16x32_bf16 a[32:35], v[56:59], a[176:179], a[32:35]
  ds_read_b64_tr_b16 v[54:55], v13 offset:20992
  v_add_f32 v110, v110, v94
  v_mfma_f32_16x16x32_bf16 a[36:39], v[56:59], a[180:183], a[36:39]
  v_add_f32 v111, v111, v95
  v_lshlrev_b32 v88, 16, v184
  v_mfma_f32_16x16x32_bf16 a[40:43], v[56:59], a[184:187], a[40:43]
  buffer_load_dwordx4 a[252:255], v20, s[16:19], s71 offen offset:3072 sc1
  v_and_b32 v89, 0xffff0000, v184
  v_mfma_f32_16x16x32_bf16 a[44:47], v[56:59], a[188:191], a[44:47]
  ds_read_b64_tr_b16 v[56:57], v12 offset:25088
  v_add_f32 v112, v112, v88
  v_mfma_f32_16x16x32_bf16 a[60:63], v[60:63], a[188:191], a[60:63]
  ds_read_b64_tr_b16 v[58:59], v12 offset:29184
  v_add_f32 v113, v113, v89
  v_mfma_f32_16x16x32_bf16 a[56:59], v[60:63], a[184:187], a[56:59]
  v_lshlrev_b32 v90, 16, v185
  v_and_b32 v91, 0xffff0000, v185
  v_mfma_f32_16x16x32_bf16 a[52:55], v[60:63], a[180:183], a[52:55]
  v_add_f32 v114, v114, v90
  v_add_f32 v115, v115, v91
  v_mfma_f32_16x16x32_bf16 a[48:51], v[60:63], a[176:179], a[48:51]
  ds_read_b64_tr_b16 v[60:61], v13 offset:25088
  v_lshlrev_b32 v92, 16, v186
  v_and_b32 v93, 0xffff0000, v186
  v_add_f32 v116, v116, v92
  v_add_f32 v117, v117, v93
  s_waitcnt lgkmcnt(7)
  v_mfma_f32_16x16x32_bf16 a[64:67], v[32:35], a[128:131], a[64:67]
  v_lshlrev_b32 v94, 16, v187
  v_mfma_f32_16x16x32_bf16 a[68:71], v[32:35], a[132:135], a[68:71]
  ds_read_b64_tr_b16 v[62:63], v13 offset:29184
  v_mfma_f32_16x16x32_bf16 a[72:75], v[32:35], a[136:139], a[72:75]
  v_and_b32 v95, 0xffff0000, v187
  v_add_f32 v118, v118, v94
  v_mfma_f32_16x16x32_bf16 a[76:79], v[32:35], a[140:143], a[76:79]
  s_add_u32 s85, s80, 0
  v_mfma_f32_16x16x32_bf16 a[92:95], v[36:39], a[140:143], a[92:95]
  buffer_load_dwordx4 v[224:227], v14, s[20:23], s85 offen
  v_add_f32 v119, v119, v95
  v_mfma_f32_16x16x32_bf16 a[88:91], v[36:39], a[136:139], a[88:91]
  v_lshlrev_b32 v88, 16, v188
  v_and_b32 v89, 0xffff0000, v188
  v_mfma_f32_16x16x32_bf16 a[84:87], v[36:39], a[132:135], a[84:87]
  v_add_f32 v120, v120, v88
  v_add_f32 v121, v121, v89
  v_mfma_f32_16x16x32_bf16 a[80:83], v[36:39], a[128:131], a[80:83]
  s_waitcnt vmcnt(31)
  s_barrier
  v_mfma_f32_16x16x32_bf16 a[64:67], v[40:43], a[144:147], a[64:67]
  ds_read_b64_tr_b16 v[32:33], v8 offset:33024
  v_lshlrev_b32 v90, 16, v189
  v_mfma_f32_16x16x32_bf16 a[68:71], v[40:43], a[148:151], a[68:71]
  ds_read_b64_tr_b16 v[34:35], v8 offset:37120
  v_and_b32 v91, 0xffff0000, v189
  v_mfma_f32_16x16x32_bf16 a[72:75], v[40:43], a[152:155], a[72:75]
  ds_read_b64_tr_b16 v[36:37], v9 offset:33024
  v_add_f32 v122, v122, v90
  v_mfma_f32_16x16x32_bf16 a[76:79], v[40:43], a[156:159], a[76:79]
  ds_read_b64_tr_b16 v[38:39], v9 offset:37120
  v_add_f32 v123, v123, v91
  v_lshlrev_b32 v92, 16, v190
  v_mfma_f32_16x16x32_bf16 a[92:95], v[44:47], a[156:159], a[92:95]
  ds_read_b64_tr_b16 v[40:41], v8 offset:41216
  v_and_b32 v93, 0xffff0000, v190
  v_mfma_f32_16x16x32_bf16 a[88:91], v[44:47], a[152:155], a[88:91]
  ds_read_b64_tr_b16 v[42:43], v8 offset:45312
  v_add_f32 v124, v124, v92
  v_add_f32 v125, v125, v93
  v_mfma_f32_16x16x32_bf16 a[84:87], v[44:47], a[148:151], a[84:87]
  s_add_u32 s85, s80, 32768
  v_lshlrev_b32 v94, 16, v191
  v_mfma_f32_16x16x32_bf16 a[80:83], v[44:47], a[144:147], a[80:83]
  ds_read_b64_tr_b16 v[44:45], v9 offset:41216
  v_and_b32 v95, 0xffff0000, v191
  s_waitcnt lgkmcnt(7)
  v_mfma_f32_16x16x32_bf16 a[64:67], v[48:51], a[160:163], a[64:67]
  ds_read_b64_tr_b16 v[46:47], v9 offset:45312
  buffer_load_dwordx4 v[228:231], v14, s[20:23], s85 offen
  v_add_f32 v126, v126, v94
  v_add_f32 v127, v127, v95
  v_mfma_f32_16x16x32_bf16 a[68:71], v[48:51], a[164:167], a[68:71]
  s_add_u32 s85, s80, 65536
  v_mfma_f32_16x16x32_bf16 a[72:75], v[48:51], a[168:171], a[72:75]
  buffer_load_dwordx4 v[232:235], v14, s[20:23], s85 offen
  v_mfma_f32_16x16x32_bf16 a[76:79], v[48:51], a[172:175], a[76:79]
  ds_read_b64_tr_b16 v[48:49], v8 offset:49408
  v_mfma_f32_16x16x32_bf16 a[92:95], v[52:55], a[172:175], a[92:95]
  ds_read_b64_tr_b16 v[50:51], v8 offset:53504
  v_mfma_f32_16x16x32_bf16 a[88:91], v[52:55], a[168:171], a[88:91]
  v_mfma_f32_16x16x32_bf16 a[84:87], v[52:55], a[164:167], a[84:87]
  v_mfma_f32_16x16x32_bf16 a[80:83], v[52:55], a[160:163], a[80:83]
  ds_read_b64_tr_b16 v[52:53], v9 offset:49408
  ds_read_b64_tr_b16 v[54:55], v9 offset:53504
  v_mfma_f32_16x16x32_bf16 a[64:67], v[56:59], a[176:179], a[64:67]
  s_add_u32 s85, s80, 98304
  v_mfma_f32_16x16x32_bf16 a[68:71], v[56:59], a[180:183], a[68:71]
  buffer_load_dwordx4 v[236:239], v14, s[20:23], s85 offen
  v_mfma_f32_16x16x32_bf16 a[72:75], v[56:59], a[184:187], a[72:75]
  v_mfma_f32_16x16x32_bf16 a[76:79], v[56:59], a[188:191], a[76:79]
  ds_read_b64_tr_b16 v[56:57], v8 offset:57600
  v_mfma_f32_16x16x32_bf16 a[92:95], v[60:63], a[188:191], a[92:95]
  ds_read_b64_tr_b16 v[58:59], v8 offset:61696
  v_mfma_f32_16x16x32_bf16 a[88:91], v[60:63], a[184:187], a[88:91]
  v_mfma_f32_16x16x32_bf16 a[84:87], v[60:63], a[180:183], a[84:87]
  v_mfma_f32_16x16x32_bf16 a[80:83], v[60:63], a[176:179], a[80:83]
  s_waitcnt vmcnt(19) lgkmcnt(6)
  v_mfma_f32_16x16x32_bf16 a[32:35], v[32:35], a[192:195], a[32:35]
  ds_read_b64_tr_b16 v[60:61], v9 offset:57600
  v_mfma_f32_16x16x32_bf16 a[36:39], v[32:35], a[196:199], a[36:39]
  ds_read_b64_tr_b16 v[62:63], v9 offset:61696
  v_mfma_f32_16x16x32_bf16 a[40:43], v[32:35], a[200:203], a[40:43]
  v_mfma_f32_16x16x32_bf16 a[44:47], v[32:35], a[204:207], a[44:47]
  ds_read_b64_tr_b16 v[32:33], v8 offset:33280
  v_mfma_f32_16x16x32_bf16 a[60:63], v[36:39], a[204:207], a[60:63]
  ds_read_b64_tr_b16 v[34:35], v8 offset:37376
  v_mfma_f32_16x16x32_bf16 a[56:59], v[36:39], a[200:203], a[56:59]
  v_mfma_f32_16x16x32_bf16 a[52:55], v[36:39], a[196:199], a[52:55]
  v_mfma_f32_16x16x32_bf16 a[48:51], v[36:39], a[192:195], a[48:51]
  ds_read_b64_tr_b16 v[36:37], v9 offset:33280
  s_waitcnt vmcnt(14)
  v_mfma_f32_16x16x32_bf16 a[32:35], v[40:43], a[208:211], a[32:35]
  ds_read_b64_tr_b16 v[38:39], v9 offset:37376
  v_mfma_f32_16x16x32_bf16 a[36:39], v[40:43], a[212:215], a[36:39]
  v_mfma_f32_16x16x32_bf16 a[40:43], v[40:43], a[216:219], a[40:43]
  v_mfma_f32_16x16x32_bf16 a[44:47], v[40:43], a[220:223], a[44:47]
  ds_read_b64_tr_b16 v[40:41], v8 offset:41472
  v_mfma_f32_16x16x32_bf16 a[60:63], v[44:47], a[220:223], a[60:63]
  ds_read_b64_tr_b16 v[42:43], v8 offset:45568
  v_mfma_f32_16x16x32_bf16 a[56:59], v[44:47], a[216:219], a[56:59]
  v_mfma_f32_16x16x32_bf16 a[52:55], v[44:47], a[212:215], a[52:55]
  v_mfma_f32_16x16x32_bf16 a[48:51], v[44:47], a[208:211], a[48:51]
  s_waitcnt vmcnt(9) lgkmcnt(6)
  v_mfma_f32_16x16x32_bf16 a[32:35], v[48:51], a[224:227], a[32:35]
  ds_read_b64_tr_b16 v[44:45], v9 offset:41472
  v_mfma_f32_16x16x32_bf16 a[36:39], v[48:51], a[228:231], a[36:39]
  ds_read_b64_tr_b16 v[46:47], v9 offset:45568
  v_mfma_f32_16x16x32_bf16 a[40:43], v[48:51], a[232:235], a[40:43]
  v_mfma_f32_16x16x32_bf16 a[44:47], v[48:51], a[236:239], a[44:47]
  ds_read_b64_tr_b16 v[48:49], v8 offset:49664
  v_mfma_f32_16x16x32_bf16 a[60:63], v[52:55], a[236:239], a[60:63]
  ds_read_b64_tr_b16 v[50:51], v8 offset:53760
  v_mfma_f32_16x16x32_bf16 a[56:59], v[52:55], a[232:235], a[56:59]
  v_mfma_f32_16x16x32_bf16 a[52:55], v[52:55], a[228:231], a[52:55]
  v_mfma_f32_16x16x32_bf16 a[48:51], v[52:55], a[224:227], a[48:51]
  ds_read_b64_tr_b16 v[52:53], v9 offset:49664
  s_waitcnt vmcnt(4)
  v_mfma_f32_16x16x32_bf16 a[32:35], v[56:59], a[240:243], a[32:35]
  ds_read_b64_tr_b16 v[54:55], v9 offset:53760
  v_mfma_f32_16x16x32_bf16 a[36:39], v[56:59], a[244:247], a[36:39]
  v_mfma_f32_16x16x32_bf16 a[40:43], v[56:59], a[248:251], a[40:43]
  v_mfma_f32_16x16x32_bf16 a[44:47], v[56:59], a[252:255], a[44:47]
  ds_read_b64_tr_b16 v[56:57], v8 offset:57856
  v_mfma_f32_16x16x32_bf16 a[60:63], v[60:63], a[252:255], a[60:63]
  ds_read_b64_tr_b16 v[58:59], v8 offset:61952
  v_mfma_f32_16x16x32_bf16 a[56:59], v[60:63], a[248:251], a[56:59]
  v_mfma_f32_16x16x32_bf16 a[52:55], v[60:63], a[244:247], a[52:55]
  v_mfma_f32_16x16x32_bf16 a[48:51], v[60:63], a[240:243], a[48:51]
  s_waitcnt lgkmcnt(6)
  v_mfma_f32_16x16x32_bf16 a[64:67], v[32:35], a[192:195], a[64:67]
  ds_read_b64_tr_b16 v[60:61], v9 offset:57856
  v_mfma_f32_16x16x32_bf16 a[68:71], v[32:35], a[196:199], a[68:71]
  ds_read_b64_tr_b16 v[62:63], v9 offset:61952
  v_mfma_f32_16x16x32_bf16 a[72:75], v[32:35], a[200:203], a[72:75]
  v_mfma_f32_16x16x32_bf16 a[76:79], v[32:35], a[204:207], a[76:79]
  ds_read_b64_tr_b16 v[32:33], v12 offset:768
  v_accvgpr_read_b32 v80, a32
  v_mfma_f32_16x16x32_bf16 a[92:95], v[36:39], a[204:207], a[92:95]
  ds_read_b64_tr_b16 v[34:35], v12 offset:4864
  v_accvgpr_read_b32 v81, a33
  v_mfma_f32_16x16x32_bf16 a[88:91], v[36:39], a[200:203], a[88:91]
  v_cvt_pk_bf16_f32 v128, v80, v81
  v_accvgpr_read_b32 v82, a34
  v_mfma_f32_16x16x32_bf16 a[84:87], v[36:39], a[196:199], a[84:87]
  v_accvgpr_read_b32 v83, a35
  v_cvt_pk_bf16_f32 v129, v82, v83
  v_mfma_f32_16x16x32_bf16 a[80:83], v[36:39], a[192:195], a[80:83]
  ds_read_b64_tr_b16 v[36:37], v13 offset:768
  v_accvgpr_read_b32 v84, a36
  v_accvgpr_read_b32 v85, a37
  v_mfma_f32_16x16x32_bf16 a[64:67], v[40:43], a[208:211], a[64:67]
  ds_read_b64_tr_b16 v[38:39], v13 offset:4864
  v_cvt_pk_bf16_f32 v130, v84, v85
  v_accvgpr_read_b32 v86, a38
  v_mfma_f32_16x16x32_bf16 a[68:71], v[40:43], a[212:215], a[68:71]
  v_accvgpr_read_b32 v87, a39
  v_cvt_pk_bf16_f32 v131, v86, v87
  v_mfma_f32_16x16x32_bf16 a[72:75], v[40:43], a[216:219], a[72:75]
  s_xor_b32 s86, s74, 8192
  s_add_u32 s86, s86, 79691776
  buffer_store_dwordx4 v[128:131], v20, s[16:19], s86 offen sc1
  v_accvgpr_read_b32 v80, a40
  v_accvgpr_read_b32 v81, a41
  v_mfma_f32_16x16x32_bf16 a[76:79], v[40:43], a[220:223], a[76:79]
  ds_read_b64_tr_b16 v[40:41], v12 offset:8960
  v_cvt_pk_bf16_f32 v132, v80, v81
  v_accvgpr_read_b32 v82, a42
  v_mfma_f32_16x16x32_bf16 a[92:95], v[44:47], a[220:223], a[92:95]
  ds_read_b64_tr_b16 v[42:43], v12 offset:13056
  v_accvgpr_read_b32 v83, a43
  v_cvt_pk_bf16_f32 v133, v82, v83
  v_mfma_f32_16x16x32_bf16 a[88:91], v[44:47], a[216:219], a[88:91]
  v_accvgpr_read_b32 v84, a44
  v_accvgpr_read_b32 v85, a45
  v_mfma_f32_16x16x32_bf16 a[84:87], v[44:47], a[212:215], a[84:87]
  v_cvt_pk_bf16_f32 v134, v84, v85
  v_accvgpr_read_b32 v86, a46
  v_mfma_f32_16x16x32_bf16 a[80:83], v[44:47], a[208:211], a[80:83]
  ds_read_b64_tr_b16 v[44:45], v13 offset:8960
  v_accvgpr_read_b32 v87, a47
  v_cvt_pk_bf16_f32 v135, v86, v87
  s_waitcnt lgkmcnt(7)
  v_mfma_f32_16x16x32_bf16 a[64:67], v[48:51], a[224:227], a[64:67]
  ds_read_b64_tr_b16 v[46:47], v13 offset:13056
  s_xor_b32 s86, s74, 8192
  s_add_u32 s86, s86, 80740352
  buffer_store_dwordx4 v[132:135], v20, s[16:19], s86 offen sc1
  v_accvgpr_read_b32 v80, a48
  v_accvgpr_read_b32 v81, a49
  v_mfma_f32_16x16x32_bf16 a[68:71], v[48:51], a[228:231], a[68:71]
  v_cvt_pk_bf16_f32 v136, v80, v81
  v_accvgpr_read_b32 v82, a50
  v_mfma_f32_16x16x32_bf16 a[72:75], v[48:51], a[232:235], a[72:75]
  v_accvgpr_read_b32 v83, a51
  v_cvt_pk_bf16_f32 v137, v82, v83
  v_mfma_f32_16x16x32_bf16 a[76:79], v[48:51], a[236:239], a[76:79]
  ds_read_b64_tr_b16 v[48:49], v12 offset:17152
  v_accvgpr_read_b32 v84, a52
  v_accvgpr_read_b32 v85, a53
  v_mfma_f32_16x16x32_bf16 a[92:95], v[52:55], a[236:239], a[92:95]
  ds_read_b64_tr_b16 v[50:51], v12 offset:21248
  v_cvt_pk_bf16_f32 v138, v84, v85
  v_accvgpr_read_b32 v86, a54
  v_mfma_f32_16x16x32_bf16 a[88:91], v[52:55], a[232:235], a[88:91]
  v_accvgpr_read_b32 v87, a55
  v_cvt_pk_bf16_f32 v139, v86, v87
  v_mfma_f32_16x16x32_bf16 a[84:87], v[52:55], a[228:231], a[84:87]
  s_xor_b32 s86, s74, 8192
  s_add_u32 s86, s86, 81788928
  buffer_store_dwordx4 v[136:139], v20, s[16:19], s86 offen sc1
  v_accvgpr_read_b32 v80, a56
  v_accvgpr_read_b32 v81, a57
  v_mfma_f32_16x16x32_bf16 a[80:83], v[52:55], a[224:227], a[80:83]
  ds_read_b64_tr_b16 v[52:53], v13 offset:17152
  v_cvt_pk_bf16_f32 v140, v80, v81
  v_accvgpr_read_b32 v82, a58
  v_mfma_f32_16x16x32_bf16 a[64:67], v[56:59], a[240:243], a[64:67]
  ds_read_b64_tr_b16 v[54:55], v13 offset:21248
  v_accvgpr_read_b32 v83, a59
  v_cvt_pk_bf16_f32 v141, v82, v83
  v_mfma_f32_16x16x32_bf16 a[68:71], v[56:59], a[244:247], a[68:71]
  v_accvgpr_read_b32 v84, a60
  v_accvgpr_read_b32 v85, a61
  v_mfma_f32_16x16x32_bf16 a[72:75], v[56:59], a[248:251], a[72:75]
  v_cvt_pk_bf16_f32 v142, v84, v85
  v_accvgpr_read_b32 v86, a62
  v_mfma_f32_16x16x32_bf16 a[76:79], v[56:59], a[252:255], a[76:79]
  ds_read_b64_tr_b16 v[56:57], v12 offset:25344
  v_accvgpr_read_b32 v87, a63
  v_cvt_pk_bf16_f32 v143, v86, v87
  v_mfma_f32_16x16x32_bf16 a[92:95], v[60:63], a[252:255], a[92:95]
  ds_read_b64_tr_b16 v[58:59], v12 offset:29440
  s_xor_b32 s86, s74, 8192
  s_add_u32 s86, s86, 82837504
  buffer_store_dwordx4 v[140:143], v20, s[16:19], s86 offen sc1
  v_mfma_f32_16x16x32_bf16 a[88:91], v[60:63], a[248:251], a[88:91]
  v_mfma_f32_16x16x32_bf16 a[84:87], v[60:63], a[244:247], a[84:87]
  v_mfma_f32_16x16x32_bf16 a[80:83], v[60:63], a[240:243], a[80:83]
  s_waitcnt lgkmcnt(6)
  v_mfma_f32_16x16x32_bf16 a[96:99], v[32:35], a[128:131], a[96:99]
  ds_read_b64_tr_b16 v[60:61], v13 offset:25344
  v_mfma_f32_16x16x32_bf16 a[100:103], v[32:35], a[132:135], a[100:103]
  ds_read_b64_tr_b16 v[62:63], v13 offset:29440
  v_mfma_f32_16x16x32_bf16 a[104:107], v[32:35], a[136:139], a[104:107]
  v_mfma_f32_16x16x32_bf16 a[108:111], v[32:35], a[140:143], a[108:111]
  ds_read_b64_tr_b16 v[32:33], v8 offset:33536
  v_accvgpr_read_b32 v80, a64
  v_mfma_f32_16x16x32_bf16 a[124:127], v[36:39], a[140:143], a[124:127]
  ds_read_b64_tr_b16 v[34:35], v8 offset:37632
  v_accvgpr_read_b32 v81, a65
  v_mfma_f32_16x16x32_bf16 a[120:123], v[36:39], a[136:139], a[120:123]
  v_cvt_pk_bf16_f32 v160, v80, v81
  v_accvgpr_read_b32 v82, a66
  v_mfma_f32_16x16x32_bf16 a[116:119], v[36:39], a[132:135], a[116:119]
  v_accvgpr_read_b32 v83, a67
  v_cvt_pk_bf16_f32 v161, v82, v83
  v_mfma_f32_16x16x32_bf16 a[112:115], v[36:39], a[128:131], a[112:115]
  ds_read_b64_tr_b16 v[36:37], v9 offset:33536
  v_accvgpr_read_b32 v84, a68
  v_accvgpr_read_b32 v85, a69
  v_mfma_f32_16x16x32_bf16 a[96:99], v[40:43], a[144:147], a[96:99]
  ds_read_b64_tr_b16 v[38:39], v9 offset:37632
  v_cvt_pk_bf16_f32 v162, v84, v85
  v_accvgpr_read_b32 v86, a70
  v_mfma_f32_16x16x32_bf16 a[100:103], v[40:43], a[148:151], a[100:103]
  v_accvgpr_read_b32 v87, a71
  v_cvt_pk_bf16_f32 v163, v86, v87
  v_mfma_f32_16x16x32_bf16 a[104:107], v[40:43], a[152:155], a[104:107]
  s_xor_b32 s86, s74, 16384
  s_add_u32 s86, s86, 83886080
  buffer_store_dwordx4 v[160:163], v20, s[16:19], s86 offen sc1
  v_accvgpr_read_b32 v80, a72
  v_accvgpr_read_b32 v81, a73
  v_mfma_f32_16x16x32_bf16 a[108:111], v[40:43], a[156:159], a[108:111]
  ds_read_b64_tr_b16 v[40:41], v8 offset:41728
  v_cvt_pk_bf16_f32 v164, v80, v81
  v_accvgpr_read_b32 v82, a74
  v_mfma_f32_16x16x32_bf16 a[124:127], v[44:47], a[156:159], a[124:127]
  ds_read_b64_tr_b16 v[42:43], v8 offset:45824
  v_accvgpr_read_b32 v83, a75
  v_cvt_pk_bf16_f32 v165, v82, v83
  v_mfma_f32_16x16x32_bf16 a[120:123], v[44:47], a[152:155], a[120:123]
  v_accvgpr_read_b32 v84, a76
  v_accvgpr_read_b32 v85, a77
  v_mfma_f32_16x16x32_bf16 a[116:119], v[44:47], a[148:151], a[116:119]
  v_cvt_pk_bf16_f32 v166, v84, v85
  v_accvgpr_read_b32 v86, a78
  v_mfma_f32_16x16x32_bf16 a[112:115], v[44:47], a[144:147], a[112:115]
  ds_read_b64_tr_b16 v[44:45], v9 offset:41728
  v_accvgpr_read_b32 v87, a79
  v_cvt_pk_bf16_f32 v167, v86, v87
  s_waitcnt lgkmcnt(7)
  v_mfma_f32_16x16x32_bf16 a[96:99], v[48:51], a[160:163], a[96:99]
  ds_read_b64_tr_b16 v[46:47], v9 offset:45824
  s_xor_b32 s86, s74, 16384
  s_add_u32 s86, s86, 84934656
  buffer_store_dwordx4 v[164:167], v20, s[16:19], s86 offen sc1
  v_accvgpr_read_b32 v80, a80
  v_accvgpr_read_b32 v81, a81
  v_mfma_f32_16x16x32_bf16 a[100:103], v[48:51], a[164:167], a[100:103]
  v_cvt_pk_bf16_f32 v168, v80, v81
  v_accvgpr_read_b32 v82, a82
  v_mfma_f32_16x16x32_bf16 a[104:107], v[48:51], a[168:171], a[104:107]
  v_accvgpr_read_b32 v83, a83
  v_cvt_pk_bf16_f32 v169, v82, v83
  v_mfma_f32_16x16x32_bf16 a[108:111], v[48:51], a[172:175], a[108:111]
  ds_read_b64_tr_b16 v[48:49], v8 offset:49920
  v_accvgpr_read_b32 v84, a84
  v_accvgpr_read_b32 v85, a85
  v_mfma_f32_16x16x32_bf16 a[124:127], v[52:55], a[172:175], a[124:127]
  ds_read_b64_tr_b16 v[50:51], v8 offset:54016
  v_cvt_pk_bf16_f32 v170, v84, v85
  v_accvgpr_read_b32 v86, a86
  v_mfma_f32_16x16x32_bf16 a[120:123], v[52:55], a[168:171], a[120:123]
  v_accvgpr_read_b32 v87, a87
  v_cvt_pk_bf16_f32 v171, v86, v87
  v_mfma_f32_16x16x32_bf16 a[116:119], v[52:55], a[164:167], a[116:119]
  s_xor_b32 s86, s74, 16384
  s_add_u32 s86, s86, 85983232
  buffer_store_dwordx4 v[168:171], v20, s[16:19], s86 offen sc1
  v_accvgpr_read_b32 v80, a88
  v_accvgpr_read_b32 v81, a89
  v_mfma_f32_16x16x32_bf16 a[112:115], v[52:55], a[160:163], a[112:115]
  ds_read_b64_tr_b16 v[52:53], v9 offset:49920
  v_cvt_pk_bf16_f32 v172, v80, v81
  v_accvgpr_read_b32 v82, a90
  v_mfma_f32_16x16x32_bf16 a[96:99], v[56:59], a[176:179], a[96:99]
  ds_read_b64_tr_b16 v[54:55], v9 offset:54016
  v_accvgpr_read_b32 v83, a91
  v_cvt_pk_bf16_f32 v173, v82, v83
  v_mfma_f32_16x16x32_bf16 a[100:103], v[56:59], a[180:183], a[100:103]
  v_accvgpr_read_b32 v84, a92
  v_accvgpr_read_b32 v85, a93
  v_mfma_f32_16x16x32_bf16 a[104:107], v[56:59], a[184:187], a[104:107]
  v_cvt_pk_bf16_f32 v174, v84, v85
  v_accvgpr_read_b32 v86, a94
  v_mfma_f32_16x16x32_bf16 a[108:111], v[56:59], a[188:191], a[108:111]
  ds_read_b64_tr_b16 v[56:57], v8 offset:58112
  v_accvgpr_read_b32 v87, a95
  v_cvt_pk_bf16_f32 v175, v86, v87
  v_mfma_f32_16x16x32_bf16 a[124:127], v[60:63], a[188:191], a[124:127]
  ds_read_b64_tr_b16 v[58:59], v8 offset:62208
  s_xor_b32 s86, s74, 16384
  s_add_u32 s86, s86, 87031808
  buffer_store_dwordx4 v[172:175], v20, s[16:19], s86 offen sc1
  v_mfma_f32_16x16x32_bf16 a[120:123], v[60:63], a[184:187], a[120:123]
  v_mfma_f32_16x16x32_bf16 a[116:119], v[60:63], a[180:183], a[116:119]
  v_mfma_f32_16x16x32_bf16 a[112:115], v[60:63], a[176:179], a[112:115]
  s_waitcnt vmcnt(15)
  s_waitcnt lgkmcnt(6)
  v_mfma_f32_16x16x32_bf16 a[96:99], v[32:35], a[192:195], a[96:99]
  v_lshlrev_b32 v88, 16, v208
  ds_read_b64_tr_b16 v[60:61], v9 offset:58112
  v_mfma_f32_16x16x32_bf16 a[100:103], v[32:35], a[196:199], a[100:103]
  ds_read_b64_tr_b16 v[62:63], v9 offset:62208
  v_mfma_f32_16x16x32_bf16 a[104:107], v[32:35], a[200:203], a[104:107]
  v_and_b32 v89, 0xffff0000, v208
  v_add_f32 v96, v96, v88
  v_mfma_f32_16x16x32_bf16 a[108:111], v[32:35], a[204:207], a[108:111]
  ds_read_b64_tr_b16 v[32:33], v12 offset:0
  s_xor_b32 s88, s76, 1024
  s_add_u32 s88, s88, 58982400
  s_waitcnt vmcnt(4)
  buffer_store_dword v26, v23, s[16:19], s88 offen offset:20 sc1
  v_mfma_f32_16x16x32_bf16 a[124:127], v[36:39], a[204:207], a[124:127]
  ds_read_b64_tr_b16 v[34:35], v12 offset:4096
  v_add_f32 v97, v97, v89
  v_mfma_f32_16x16x32_bf16 a[120:123], v[36:39], a[200:203], a[120:123]
  v_lshlrev_b32 v90, 16, v209
  v_and_b32 v91, 0xffff0000, v209
  v_mfma_f32_16x16x32_bf16 a[116:119], v[36:39], a[196:199], a[116:119]
  v_add_f32 v98, v98, v90
  v_add_f32 v99, v99, v91
  v_mfma_f32_16x16x32_bf16 a[112:115], v[36:39], a[192:195], a[112:115]
  ds_read_b64_tr_b16 v[36:37], v13 offset:0
  v_lshlrev_b32 v92, 16, v210
  v_mfma_f32_16x16x32_bf16 a[96:99], v[40:43], a[208:211], a[96:99]
  ds_read_b64_tr_b16 v[38:39], v13 offset:4096
  v_and_b32 v93, 0xffff0000, v210
  v_mfma_f32_16x16x32_bf16 a[100:103], v[40:43], a[212:215], a[100:103]
  v_add_f32 v100, v100, v92
  v_add_f32 v101, v101, v93
  v_mfma_f32_16x16x32_bf16 a[104:107], v[40:43], a[216:219], a[104:107]
  v_lshlrev_b32 v94, 16, v211
  v_and_b32 v95, 0xffff0000, v211
  v_mfma_f32_16x16x32_bf16 a[108:111], v[40:43], a[220:223], a[108:111]
  ds_read_b64_tr_b16 v[40:41], v12 offset:8192
  v_add_f32 v102, v102, v94
  v_mfma_f32_16x16x32_bf16 a[124:127], v[44:47], a[220:223], a[124:127]
  ds_read_b64_tr_b16 v[42:43], v12 offset:12288
  v_add_f32 v103, v103, v95
  v_mfma_f32_16x16x32_bf16 a[120:123], v[44:47], a[216:219], a[120:123]
  v_lshlrev_b32 v88, 16, v212
  v_and_b32 v89, 0xffff0000, v212
  v_mfma_f32_16x16x32_bf16 a[116:119], v[44:47], a[212:215], a[116:119]
  v_add_f32 v104, v104, v88
  v_mfma_f32_16x16x32_bf16 a[112:115], v[44:47], a[208:211], a[112:115]
  ds_read_b64_tr_b16 v[44:45], v13 offset:8192
  s_waitcnt lgkmcnt(7)
  v_mfma_f32_16x16x32_bf16 a[96:99], v[48:51], a[224:227], a[96:99]
  ds_read_b64_tr_b16 v[46:47], v13 offset:12288
  v_add_f32 v105, v105, v89
  v_mfma_f32_16x16x32_bf16 a[100:103], v[48:51], a[228:231], a[100:103]
  v_lshlrev_b32 v90, 16, v213
  v_and_b32 v91, 0xffff0000, v213
  v_mfma_f32_16x16x32_bf16 a[104:107], v[48:51], a[232:235], a[104:107]
  v_add_f32 v106, v106, v90
  v_add_f32 v107, v107, v91
  v_mfma_f32_16x16x32_bf16 a[108:111], v[48:51], a[236:239], a[108:111]
  ds_read_b64_tr_b16 v[48:49], v12 offset:16384
  v_lshlrev_b32 v92, 16, v214
  v_mfma_f32_16x16x32_bf16 a[124:127], v[52:55], a[236:239], a[124:127]
  ds_read_b64_tr_b16 v[50:51], v12 offset:20480
  v_and_b32 v93, 0xffff0000, v214
  v_mfma_f32_16x16x32_bf16 a[120:123], v[52:55], a[232:235], a[120:123]
  v_add_f32 v108, v108, v92
  v_add_f32 v109, v109, v93
  v_mfma_f32_16x16x32_bf16 a[116:119], v[52:55], a[228:231], a[116:119]
  v_lshlrev_b32 v94, 16, v215
  v_and_b32 v95, 0xffff0000, v215
  v_mfma_f32_16x16x32_bf16 a[112:115], v[52:55], a[224:227], a[112:115]
  ds_read_b64_tr_b16 v[52:53], v13 offset:16384
  v_add_f32 v110, v110, v94
  v_mfma_f32_16x16x32_bf16 a[96:99], v[56:59], a[240:243], a[96:99]
  ds_read_b64_tr_b16 v[54:55], v13 offset:20480
  v_add_f32 v111, v111, v95
  v_mfma_f32_16x16x32_bf16 a[100:103], v[56:59], a[244:247], a[100:103]
  v_lshlrev_b32 v88, 16, v216
  v_and_b32 v89, 0xffff0000, v216
  v_mfma_f32_16x16x32_bf16 a[104:107], v[56:59], a[248:251], a[104:107]
  v_add_f32 v112, v112, v88
  v_add_f32 v113, v113, v89
  v_mfma_f32_16x16x32_bf16 a[108:111], v[56:59], a[252:255], a[108:111]
  ds_read_b64_tr_b16 v[56:57], v12 offset:24576
  v_lshlrev_b32 v90, 16, v217
  v_mfma_f32_16x16x32_bf16 a[124:127], v[60:63], a[252:255], a[124:127]
  ds_read_b64_tr_b16 v[58:59], v12 offset:28672
  v_and_b32 v91, 0xffff0000, v217
  v_mfma_f32_16x16x32_bf16 a[120:123], v[60:63], a[248:251], a[120:123]
  s_xor_b32 s88, s76, 2048
  s_add_u32 s88, s88, 58982400
  s_waitcnt vmcnt(1)
  buffer_store_dword v26, v23, s[16:19], s88 offen offset:24 sc1
  v_add_f32 v114, v114, v90
  v_mfma_f32_16x16x32_bf16 a[116:119], v[60:63], a[244:247], a[116:119]
  v_add_f32 v115, v115, v91
  v_lshlrev_b32 v92, 16, v218
  v_mfma_f32_16x16x32_bf16 a[112:115], v[60:63], a[240:243], a[112:115]
  ds_read_b64_tr_b16 v[60:61], v13 offset:24576
  v_and_b32 v93, 0xffff0000, v218
  v_add_f32 v116, v116, v92
  v_add_f32 v117, v117, v93
  s_waitcnt lgkmcnt(7)
  v_mfma_f32_16x16x32_bf16 a[0:3], v[32:35], a[128:131], a[0:3]
  ds_read_b64_tr_b16 v[62:63], v13 offset:28672
  v_mfma_f32_16x16x32_bf16 a[4:7], v[32:35], a[132:135], a[4:7]
  v_mfma_f32_16x16x32_bf16 a[8:11], v[32:35], a[136:139], a[8:11]
  v_mfma_f32_16x16x32_bf16 a[12:15], v[32:35], a[140:143], a[12:15]
  ds_read_b64_tr_b16 v[32:33], v8 offset:32768
  v_accvgpr_read_b32 v80, a96
  v_mfma_f32_16x16x32_bf16 a[28:31], v[36:39], a[140:143], a[28:31]
  ds_read_b64_tr_b16 v[34:35], v8 offset:36864
  v_accvgpr_read_b32 v81, a97
  v_mfma_f32_16x16x32_bf16 a[24:27], v[36:39], a[136:139], a[24:27]
  v_cvt_pk_bf16_f32 v192, v80, v81
  v_accvgpr_read_b32 v82, a98
  v_mfma_f32_16x16x32_bf16 a[20:23], v[36:39], a[132:135], a[20:23]
  v_accvgpr_read_b32 v83, a99
  v_cvt_pk_bf16_f32 v193, v82, v83
  v_mfma_f32_16x16x32_bf16 a[16:19], v[36:39], a[128:131], a[16:19]
  ds_read_b64_tr_b16 v[36:37], v9 offset:32768
  v_accvgpr_read_b32 v84, a100
  v_accvgpr_read_b32 v85, a101
  v_mfma_f32_16x16x32_bf16 a[0:3], v[40:43], a[144:147], a[0:3]
  ds_read_b64_tr_b16 v[38:39], v9 offset:36864
  v_cvt_pk_bf16_f32 v194, v84, v85
  v_accvgpr_read_b32 v86, a102
  v_mfma_f32_16x16x32_bf16 a[4:7], v[40:43], a[148:151], a[4:7]
  v_accvgpr_read_b32 v87, a103
  v_cvt_pk_bf16_f32 v195, v86, v87
  v_mfma_f32_16x16x32_bf16 a[8:11], v[40:43], a[152:155], a[8:11]
  s_xor_b32 s86, s74, 24576
  s_add_u32 s86, s86, 88080384
  buffer_store_dwordx4 v[192:195], v20, s[16:19], s86 offen sc1
  v_accvgpr_read_b32 v80, a104
  v_accvgpr_read_b32 v81, a105
  v_mfma_f32_16x16x32_bf16 a[12:15], v[40:43], a[156:159], a[12:15]
  ds_read_b64_tr_b16 v[40:41], v8 offset:40960
  v_cvt_pk_bf16_f32 v196, v80, v81
  v_accvgpr_read_b32 v82, a106
  v_mfma_f32_16x16x32_bf16 a[28:31], v[44:47], a[156:159], a[28:31]
  ds_read_b64_tr_b16 v[42:43], v8 offset:45056
  v_accvgpr_read_b32 v83, a107
  v_cvt_pk_bf16_f32 v197, v82, v83
  v_mfma_f32_16x16x32_bf16 a[24:27], v[44:47], a[152:155], a[24:27]
  v_accvgpr_read_b32 v84, a108
  v_accvgpr_read_b32 v85, a109
  v_mfma_f32_16x16x32_bf16 a[20:23], v[44:47], a[148:151], a[20:23]
  v_cvt_pk_bf16_f32 v198, v84, v85
  v_accvgpr_read_b32 v86, a110
  v_mfma_f32_16x16x32_bf16 a[16:19], v[44:47], a[144:147], a[16:19]
  ds_read_b64_tr_b16 v[44:45], v9 offset:40960
  v_accvgpr_read_b32 v87, a111
  v_cvt_pk_bf16_f32 v199, v86, v87
  s_waitcnt lgkmcnt(7)
  v_mfma_f32_16x16x32_bf16 a[0:3], v[48:51], a[160:163], a[0:3]
  ds_read_b64_tr_b16 v[46:47], v9 offset:45056
  s_xor_b32 s86, s74, 24576
  s_add_u32 s86, s86, 89128960
  buffer_store_dwordx4 v[196:199], v20, s[16:19], s86 offen sc1
  v_accvgpr_read_b32 v80, a112
  v_accvgpr_read_b32 v81, a113
  v_mfma_f32_16x16x32_bf16 a[4:7], v[48:51], a[164:167], a[4:7]
  v_cvt_pk_bf16_f32 v200, v80, v81
  v_accvgpr_read_b32 v82, a114
  v_mfma_f32_16x16x32_bf16 a[8:11], v[48:51], a[168:171], a[8:11]
  v_accvgpr_read_b32 v83, a115
  v_cvt_pk_bf16_f32 v201, v82, v83
  v_mfma_f32_16x16x32_bf16 a[12:15], v[48:51], a[172:175], a[12:15]
  ds_read_b64_tr_b16 v[48:49], v8 offset:49152
  v_accvgpr_read_b32 v84, a116
  v_accvgpr_read_b32 v85, a117
  v_mfma_f32_16x16x32_bf16 a[28:31], v[52:55], a[172:175], a[28:31]
  ds_read_b64_tr_b16 v[50:51], v8 offset:53248
  v_cvt_pk_bf16_f32 v202, v84, v85
  v_accvgpr_read_b32 v86, a118
  v_mfma_f32_16x16x32_bf16 a[24:27], v[52:55], a[168:171], a[24:27]
  v_accvgpr_read_b32 v87, a119
  v_cvt_pk_bf16_f32 v203, v86, v87
  v_mfma_f32_16x16x32_bf16 a[20:23], v[52:55], a[164:167], a[20:23]
  s_xor_b32 s86, s74, 24576
  s_add_u32 s86, s86, 90177536
  buffer_store_dwordx4 v[200:203], v20, s[16:19], s86 offen sc1
  v_accvgpr_read_b32 v80, a120
  v_accvgpr_read_b32 v81, a121
  v_mfma_f32_16x16x32_bf16 a[16:19], v[52:55], a[160:163], a[16:19]
  ds_read_b64_tr_b16 v[52:53], v9 offset:49152
  v_cvt_pk_bf16_f32 v204, v80, v81
  v_accvgpr_read_b32 v82, a122
  v_mfma_f32_16x16x32_bf16 a[0:3], v[56:59], a[176:179], a[0:3]
  ds_read_b64_tr_b16 v[54:55], v9 offset:53248
  v_accvgpr_read_b32 v83, a123
  v_cvt_pk_bf16_f32 v205, v82, v83
  v_mfma_f32_16x16x32_bf16 a[4:7], v[56:59], a[180:183], a[4:7]
  v_accvgpr_read_b32 v84, a124
  v_accvgpr_read_b32 v85, a125
  v_mfma_f32_16x16x32_bf16 a[8:11], v[56:59], a[184:187], a[8:11]
  v_cvt_pk_bf16_f32 v206, v84, v85
  v_accvgpr_read_b32 v86, a126
  v_mfma_f32_16x16x32_bf16 a[12:15], v[56:59], a[188:191], a[12:15]
  ds_read_b64_tr_b16 v[56:57], v8 offset:57344
  v_accvgpr_read_b32 v87, a127
  v_cvt_pk_bf16_f32 v207, v86, v87
  v_mfma_f32_16x16x32_bf16 a[28:31], v[60:63], a[188:191], a[28:31]
  ds_read_b64_tr_b16 v[58:59], v8 offset:61440
  s_xor_b32 s86, s74, 24576
  s_add_u32 s86, s86, 91226112
  buffer_store_dwordx4 v[204:207], v20, s[16:19], s86 offen sc1
  v_mfma_f32_16x16x32_bf16 a[24:27], v[60:63], a[184:187], a[24:27]
  v_mfma_f32_16x16x32_bf16 a[20:23], v[60:63], a[180:183], a[20:23]
  v_mfma_f32_16x16x32_bf16 a[16:19], v[60:63], a[176:179], a[16:19]
  s_waitcnt lgkmcnt(6)
  v_mfma_f32_16x16x32_bf16 a[0:3], v[32:35], a[192:195], a[0:3]
  v_lshlrev_b32 v94, 16, v219
  ds_read_b64_tr_b16 v[60:61], v9 offset:57344
  v_mfma_f32_16x16x32_bf16 a[4:7], v[32:35], a[196:199], a[4:7]
  ds_read_b64_tr_b16 v[62:63], v9 offset:61440
  v_mfma_f32_16x16x32_bf16 a[8:11], v[32:35], a[200:203], a[8:11]
  v_and_b32 v95, 0xffff0000, v219
  v_add_f32 v118, v118, v94
  v_mfma_f32_16x16x32_bf16 a[12:15], v[32:35], a[204:207], a[12:15]
  buffer_load_dword v25, v27, s[16:19], s89 offen offset:0 sc1
  v_add_f32 v119, v119, v95
  v_mfma_f32_16x16x32_bf16 a[28:31], v[36:39], a[204:207], a[28:31]
  v_lshlrev_b32 v88, 16, v220
  v_mfma_f32_16x16x32_bf16 a[24:27], v[36:39], a[200:203], a[24:27]
  v_and_b32 v89, 0xffff0000, v220
  v_add_f32 v120, v120, v88
  v_mfma_f32_16x16x32_bf16 a[20:23], v[36:39], a[196:199], a[20:23]
  v_add_f32 v121, v121, v89
  v_mfma_f32_16x16x32_bf16 a[16:19], v[36:39], a[192:195], a[16:19]
  v_lshlrev_b32 v90, 16, v221
  v_mfma_f32_16x16x32_bf16 a[0:3], v[40:43], a[208:211], a[0:3]
  v_and_b32 v91, 0xffff0000, v221
  v_add_f32 v122, v122, v90
  v_mfma_f32_16x16x32_bf16 a[4:7], v[40:43], a[212:215], a[4:7]
  v_add_f32 v123, v123, v91
  v_mfma_f32_16x16x32_bf16 a[8:11], v[40:43], a[216:219], a[8:11]
  v_lshlrev_b32 v92, 16, v222
  v_and_b32 v93, 0xffff0000, v222
  v_mfma_f32_16x16x32_bf16 a[12:15], v[40:43], a[220:223], a[12:15]
  v_add_f32 v124, v124, v92
  v_mfma_f32_16x16x32_bf16 a[28:31], v[44:47], a[220:223], a[28:31]
  v_add_f32 v125, v125, v93
  v_mfma_f32_16x16x32_bf16 a[24:27], v[44:47], a[216:219], a[24:27]
  v_lshlrev_b32 v94, 16, v223
  v_and_b32 v95, 0xffff0000, v223
  v_mfma_f32_16x16x32_bf16 a[20:23], v[44:47], a[212:215], a[20:23]
  v_add_f32 v126, v126, v94
  v_mfma_f32_16x16x32_bf16 a[16:19], v[44:47], a[208:211], a[16:19]
  s_waitcnt lgkmcnt(0)
  v_mfma_f32_16x16x32_bf16 a[0:3], v[48:51], a[224:227], a[0:3]
  v_add_f32 v127, v127, v95
  v_mul_f32 v88, 0xbfb8aa3b, v96
  v_mfma_f32_16x16x32_bf16 a[4:7], v[48:51], a[228:231], a[4:7]
  v_mul_f32 v89, 0xbfb8aa3b, v97
  v_mul_f32 v90, 0xbfb8aa3b, v98
  v_mfma_f32_16x16x32_bf16 a[8:11], v[48:51], a[232:235], a[8:11]
  v_mul_f32 v91, 0xbfb8aa3b, v99
  v_mul_f32 v92, 0xbfb8aa3b, v100
  v_mfma_f32_16x16x32_bf16 a[12:15], v[48:51], a[236:239], a[12:15]
  v_mul_f32 v93, 0xbfb8aa3b, v101
  v_mfma_f32_16x16x32_bf16 a[28:31], v[52:55], a[236:239], a[28:31]
  v_mul_f32 v94, 0xbfb8aa3b, v102
  v_mul_f32 v95, 0xbfb8aa3b, v103
  v_mfma_f32_16x16x32_bf16 a[24:27], v[52:55], a[232:235], a[24:27]
  v_exp_f32 v88, v88
  v_mfma_f32_16x16x32_bf16 a[20:23], v[52:55], a[228:231], a[20:23]
  v_exp_f32 v89, v89
  v_mfma_f32_16x16x32_bf16 a[16:19], v[52:55], a[224:227], a[16:19]
  v_exp_f32 v90, v90
  v_mfma_f32_16x16x32_bf16 a[0:3], v[56:59], a[240:243], a[0:3]
  v_exp_f32 v91, v91
  v_mfma_f32_16x16x32_bf16 a[4:7], v[56:59], a[244:247], a[4:7]
  v_mfma_f32_16x16x32_bf16 a[8:11], v[56:59], a[248:251], a[8:11]
  v_exp_f32 v92, v92
  v_mfma_f32_16x16x32_bf16 a[12:15], v[56:59], a[252:255], a[12:15]
  v_exp_f32 v93, v93
  v_mfma_f32_16x16x32_bf16 a[28:31], v[60:63], a[252:255], a[28:31]
  v_mfma_f32_16x16x32_bf16 a[24:27], v[60:63], a[248:251], a[24:27]
  s_xor_b32 s88, s76, 3072
  s_add_u32 s88, s88, 58982400
  s_waitcnt vmcnt(1)
  buffer_store_dword v26, v23, s[16:19], s88 offen offset:28 sc1
  v_mfma_f32_16x16x32_bf16 a[20:23], v[60:63], a[244:247], a[20:23]
  v_exp_f32 v94, v94
  v_mfma_f32_16x16x32_bf16 a[16:19], v[60:63], a[240:243], a[16:19]
  v_exp_f32 v95, v95
  s_waitcnt vmcnt(1)
  v_cmp_eq_u32 vcc, v26, v25
  s_and_b32 s84, vcc_lo, 0x60
  s_cmp_eq_u32 s84, 0x60
  s_cbranch_scc0 L_main_spin_7
L_main_spin_7_ok:
  s_add_u32 s87, s74, 79691776
  buffer_load_dwordx4 v[144:147], v20, s[16:19], s87 offen sc1
  s_add_u32 s87, s74, 80740352
  buffer_load_dwordx4 v[148:151], v20, s[16:19], s87 offen sc1
  s_add_u32 s87, s74, 81788928
  buffer_load_dwordx4 v[152:155], v20, s[16:19], s87 offen sc1
  s_add_u32 s87, s74, 82837504
  buffer_load_dwordx4 v[156:159], v20, s[16:19], s87 offen sc1
  s_add_u32 s87, s74, 83886080
  buffer_load_dwordx4 v[176:179], v20, s[16:19], s87 offen sc1
  s_add_u32 s87, s74, 84934656
  buffer_load_dwordx4 v[180:183], v20, s[16:19], s87 offen sc1
  s_add_u32 s87, s74, 85983232
  buffer_load_dwordx4 v[184:187], v20, s[16:19], s87 offen sc1
  s_add_u32 s87, s74, 87031808
  buffer_load_dwordx4 v[188:191], v20, s[16:19], s87 offen sc1
  buffer_load_dword v25, v27, s[16:19], s89 offen offset:0 sc1
  s_waitcnt vmcnt(32)
  s_nop 3
  v_accvgpr_read_b32 v32, a0
  v_accvgpr_read_b32 v33, a1
  v_accvgpr_read_b32 v34, a2
  v_accvgpr_read_b32 v35, a3
  v_accvgpr_read_b32 v36, a4
  v_accvgpr_read_b32 v37, a5
  v_accvgpr_read_b32 v38, a6
  v_accvgpr_read_b32 v39, a7
  v_accvgpr_read_b32 v40, a8
  v_accvgpr_read_b32 v41, a9
  v_accvgpr_read_b32 v42, a10
  v_accvgpr_read_b32 v43, a11
  v_accvgpr_read_b32 v44, a12
  v_accvgpr_read_b32 v45, a13
  v_accvgpr_read_b32 v46, a14
  v_accvgpr_read_b32 v47, a15
  v_accvgpr_read_b32 v48, a16
  v_accvgpr_read_b32 v49, a17
  v_accvgpr_read_b32 v50, a18
  v_accvgpr_read_b32 v51, a19
  v_accvgpr_read_b32 v52, a20
  v_accvgpr_read_b32 v53, a21
  v_accvgpr_read_b32 v54, a22
  v_accvgpr_read_b32 v55, a23
  v_accvgpr_read_b32 v56, a24
  v_accvgpr_read_b32 v57, a25
  v_accvgpr_read_b32 v58, a26
  v_accvgpr_read_b32 v59, a27
  v_accvgpr_read_b32 v60, a28
  v_accvgpr_read_b32 v61, a29
  v_accvgpr_read_b32 v62, a30
  v_accvgpr_read_b32 v63, a31
  v_add_f32 v88, 1.0, v88
  v_add_f32 v89, 1.0, v89
  v_add_f32 v90, 1.0, v90
  v_add_f32 v91, 1.0, v91
  v_add_f32 v92, 1.0, v92
  v_add_f32 v93, 1.0, v93
  v_add_f32 v94, 1.0, v94
  v_add_f32 v95, 1.0, v95
  v_rcp_f32 v88, v88
  v_rcp_f32 v89, v89
  v_rcp_f32 v90, v90
  v_rcp_f32 v91, v91
  v_rcp_f32 v92, v92
  v_rcp_f32 v93, v93
  v_rcp_f32 v94, v94
  v_rcp_f32 v95, v95
  v_mul_f32 v96, v96, v88
  v_mul_f32 v97, v97, v89
  v_mul_f32 v98, v98, v90
  v_mul_f32 v99, v99, v91
  v_mul_f32 v100, v100, v92
  v_mul_f32 v101, v101, v93
  v_mul_f32 v102, v102, v94
  v_mul_f32 v103, v103, v95
  v_mul_f32 v88, 0xbfb8aa3b, v104
  v_mul_f32 v89, 0xbfb8aa3b, v105
  v_mul_f32 v90, 0xbfb8aa3b, v106
  v_mul_f32 v91, 0xbfb8aa3b, v107
  v_mul_f32 v92, 0xbfb8aa3b, v108
  v_mul_f32 v93, 0xbfb8aa3b, v109
  v_mul_f32 v94, 0xbfb8aa3b, v110
  v_mul_f32 v95, 0xbfb8aa3b, v111
  v_exp_f32 v88, v88
  v_exp_f32 v89, v89
  v_exp_f32 v90, v90
  v_exp_f32 v91, v91
  v_exp_f32 v92, v92
  v_exp_f32 v93, v93
  v_exp_f32 v94, v94
  v_exp_f32 v95, v95
  v_add_f32 v88, 1.0, v88
  v_add_f32 v89, 1.0, v89
  v_add_f32 v90, 1.0, v90
  v_add_f32 v91, 1.0, v91
  v_add_f32 v92, 1.0, v92
  v_add_f32 v93, 1.0, v93
  v_add_f32 v94, 1.0, v94
  v_add_f32 v95, 1.0, v95
  v_rcp_f32 v88, v88
  v_rcp_f32 v89, v89
  v_rcp_f32 v90, v90
  v_rcp_f32 v91, v91
  v_rcp_f32 v92, v92
  v_rcp_f32 v93, v93
  v_rcp_f32 v94, v94
  v_rcp_f32 v95, v95
  v_mul_f32 v104, v104, v88
  v_mul_f32 v105, v105, v89
  v_mul_f32 v106, v106, v90
  v_mul_f32 v107, v107, v91
  v_mul_f32 v108, v108, v92
  v_mul_f32 v109, v109, v93
  v_mul_f32 v110, v110, v94
  v_mul_f32 v111, v111, v95
  v_mul_f32 v88, 0xbfb8aa3b, v112
  v_mul_f32 v89, 0xbfb8aa3b, v113
  v_mul_f32 v90, 0xbfb8aa3b, v114
  v_mul_f32 v91, 0xbfb8aa3b, v115
  v_mul_f32 v92, 0xbfb8aa3b, v116
  v_mul_f32 v93, 0xbfb8aa3b, v117
  v_mul_f32 v94, 0xbfb8aa3b, v118
  v_mul_f32 v95, 0xbfb8aa3b, v119
  s_waitcnt vmcnt(0)
  v_cmp_eq_u32 vcc, v26, v25
  s_and_b32 s84, vcc_lo, 0x80
  s_cmp_eq_u32 s84, 0x80
  s_cbranch_scc0 L_main_spin_8
L_main_spin_8_ok:
  s_add_u32 s87, s74, 88080384
  buffer_load_dwordx4 v[208:211], v20, s[16:19], s87 offen sc1
  s_add_u32 s87, s74, 89128960
  buffer_load_dwordx4 v[212:215], v20, s[16:19], s87 offen sc1
  s_add_u32 s87, s74, 90177536
  buffer_load_dwordx4 v[216:219], v20, s[16:19], s87 offen sc1
  s_add_u32 s87, s74, 91226112
  buffer_load_dwordx4 v[220:223], v20, s[16:19], s87 offen sc1
  v_exp_f32 v88, v88
  v_exp_f32 v89, v89
  v_exp_f32 v90, v90
  v_exp_f32 v91, v91
  v_exp_f32 v92, v92
  v_exp_f32 v93, v93
  v_exp_f32 v94, v94
  v_exp_f32 v95, v95
  v_add_f32 v88, 1.0, v88
  v_add_f32 v89, 1.0, v89
  v_add_f32 v90, 1.0, v90
  v_add_f32 v91, 1.0, v91
  v_add_f32 v92, 1.0, v92
  v_add_f32 v93, 1.0, v93
  v_add_f32 v94, 1.0, v94
  v_add_f32 v95, 1.0, v95
  v_rcp_f32 v88, v88
  v_rcp_f32 v89, v89
  v_rcp_f32 v90, v90
  v_rcp_f32 v91, v91
  v_rcp_f32 v92, v92
  v_rcp_f32 v93, v93
  v_rcp_f32 v94, v94
  v_rcp_f32 v95, v95
  v_mul_f32 v112, v112, v88
  v_mul_f32 v113, v113, v89
  v_mul_f32 v114, v114, v90
  v_mul_f32 v115, v115, v91
  v_mul_f32 v116, v116, v92
  v_mul_f32 v117, v117, v93
  v_mul_f32 v118, v118, v94
  v_mul_f32 v119, v119, v95
  v_mul_f32 v88, 0xbfb8aa3b, v120
  v_mul_f32 v89, 0xbfb8aa3b, v121
  v_mul_f32 v90, 0xbfb8aa3b, v122
  v_mul_f32 v91, 0xbfb8aa3b, v123
  v_mul_f32 v92, 0xbfb8aa3b, v124
  v_mul_f32 v93, 0xbfb8aa3b, v125
  v_mul_f32 v94, 0xbfb8aa3b, v126
  v_mul_f32 v95, 0xbfb8aa3b, v127
  v_exp_f32 v88, v88
  v_exp_f32 v89, v89
  v_exp_f32 v90, v90
  v_exp_f32 v91, v91
  v_exp_f32 v92, v92
  v_exp_f32 v93, v93
  v_exp_f32 v94, v94
  v_exp_f32 v95, v95
  v_add_f32 v88, 1.0, v88
  v_add_f32 v89, 1.0, v89
  v_add_f32 v90, 1.0, v90
  v_add_f32 v91, 1.0, v91
  v_add_f32 v92, 1.0, v92
  v_add_f32 v93, 1.0, v93
  v_add_f32 v94, 1.0, v94
  v_add_f32 v95, 1.0, v95
  v_rcp_f32 v88, v88
  v_rcp_f32 v89, v89
  v_rcp_f32 v90, v90
  v_rcp_f32 v91, v91
  v_rcp_f32 v92, v92
  v_rcp_f32 v93, v93
  v_rcp_f32 v94, v94
  v_rcp_f32 v95, v95
  v_mul_f32 v120, v120, v88
  v_mul_f32 v121, v121, v89
  v_mul_f32 v122, v122, v90
  v_mul_f32 v123, v123, v91
  v_mul_f32 v124, v124, v92
  v_mul_f32 v125, v125, v93
  v_mul_f32 v126, v126, v94
  v_mul_f32 v127, v127, v95
  s_add_u32 s85, s63, 98304
  v_and_b32 v4, 15, v0
  v_mul_u32_u24 v4, 80, v4
  v_lshl_add_u32 v4, v1, 3, v4
  v_add_u32 v4, s85, v4
  v_add_u32 v5, 2560, v4
  v_lshrrev_b32 v7, 2, v0
  v_mul_u32_u24 v6, 80, v7
  v_lshl_add_u32 v6, v3, 4, v6
  v_add_u32 v6, s85, v6
  v_lshlrev_b32 v7, 11, v7
  v_lshl_add_u32 v7, v3, 4, v7
  ds_write_b128 v6, v[224:227] offset:0
  ds_write_b128 v6, v[228:231] offset:1280
  ds_write_b128 v6, v[232:235] offset:2560
  ds_write_b128 v6, v[236:239] offset:3840
  ds_read2_b64 v[64:67], v4 offset0:0 offset1:4
  ds_read2_b64 v[68:71], v4 offset0:160 offset1:164
  ds_read2_b64 v[72:75], v5 offset0:0 offset1:4
  ds_read2_b64 v[76:79], v5 offset0:160 offset1:164
  s_waitcnt vmcnt(9)
  v_lshlrev_b32 v80, 16, v144
  v_and_b32 v81, 0xffff0000, v144
  v_add_f32 v32, v32, v80
  v_add_f32 v33, v33, v81
  v_lshlrev_b32 v82, 16, v145
  v_and_b32 v83, 0xffff0000, v145
  v_add_f32 v34, v34, v82
  v_add_f32 v35, v35, v83
  v_lshlrev_b32 v84, 16, v146
  v_and_b32 v85, 0xffff0000, v146
  v_add_f32 v36, v36, v84
  v_add_f32 v37, v37, v85
  v_lshlrev_b32 v86, 16, v147
  v_and_b32 v87, 0xffff0000, v147
  v_add_f32 v38, v38, v86
  v_add_f32 v39, v39, v87
  v_lshlrev_b32 v80, 16, v148
  v_and_b32 v81, 0xffff0000, v148
  v_add_f32 v40, v40, v80
  v_add_f32 v41, v41, v81
  v_lshlrev_b32 v82, 16, v149
  v_and_b32 v83, 0xffff0000, v149
  v_add_f32 v42, v42, v82
  v_add_f32 v43, v43, v83
  v_lshlrev_b32 v84, 16, v150
  v_and_b32 v85, 0xffff0000, v150
  v_add_f32 v44, v44, v84
  v_add_f32 v45, v45, v85
  v_lshlrev_b32 v86, 16, v151
  v_and_b32 v87, 0xffff0000, v151
  v_add_f32 v46, v46, v86
  v_add_f32 v47, v47, v87
  v_lshlrev_b32 v80, 16, v152
  v_and_b32 v81, 0xffff0000, v152
  v_add_f32 v48, v48, v80
  v_add_f32 v49, v49, v81
  v_lshlrev_b32 v82, 16, v153
  v_and_b32 v83, 0xffff0000, v153
  v_add_f32 v50, v50, v82
  v_add_f32 v51, v51, v83
  v_lshlrev_b32 v84, 16, v154
  v_and_b32 v85, 0xffff0000, v154
  v_add_f32 v52, v52, v84
  v_add_f32 v53, v53, v85
  v_lshlrev_b32 v86, 16, v155
  v_and_b32 v87, 0xffff0000, v155
  v_add_f32 v54, v54, v86
  v_add_f32 v55, v55, v87
  v_lshlrev_b32 v80, 16, v156
  v_and_b32 v81, 0xffff0000, v156
  v_add_f32 v56, v56, v80
  v_add_f32 v57, v57, v81
  v_lshlrev_b32 v82, 16, v157
  v_and_b32 v83, 0xffff0000, v157
  v_add_f32 v58, v58, v82
  v_add_f32 v59, v59, v83
  v_lshlrev_b32 v84, 16, v158
  v_and_b32 v85, 0xffff0000, v158
  v_add_f32 v60, v60, v84
  v_add_f32 v61, v61, v85
  v_lshlrev_b32 v86, 16, v159
  v_and_b32 v87, 0xffff0000, v159
  v_add_f32 v62, v62, v86
  v_add_f32 v63, v63, v87
  s_waitcnt vmcnt(5)
  v_lshlrev_b32 v80, 16, v176
  v_and_b32 v81, 0xffff0000, v176
  v_add_f32 v32, v32, v80
  v_add_f32 v33, v33, v81
  v_lshlrev_b32 v82, 16, v177
  v_and_b32 v83, 0xffff0000, v177
  v_add_f32 v34, v34, v82
  v_add_f32 v35, v35, v83
  v_lshlrev_b32 v84, 16, v178
  v_and_b32 v85, 0xffff0000, v178
  v_add_f32 v36, v36, v84
  v_add_f32 v37, v37, v85
  v_lshlrev_b32 v86, 16, v179
  v_and_b32 v87, 0xffff0000, v179
  v_add_f32 v38, v38, v86
  v_add_f32 v39, v39, v87
  v_lshlrev_b32 v80, 16, v180
  v_and_b32 v81, 0xffff0000, v180
  v_add_f32 v40, v40, v80
  v_add_f32 v41, v41, v81
  v_lshlrev_b32 v82, 16, v181
  v_and_b32 v83, 0xffff0000, v181
  v_add_f32 v42, v42, v82
  v_add_f32 v43, v43, v83
  v_lshlrev_b32 v84, 16, v182
  v_and_b32 v85, 0xffff0000, v182
  v_add_f32 v44, v44, v84
  v_add_f32 v45, v45, v85
  v_lshlrev_b32 v86, 16, v183
  v_and_b32 v87, 0xffff0000, v183
  v_add_f32 v46, v46, v86
  v_add_f32 v47, v47, v87
  v_lshlrev_b32 v80, 16, v184
  v_and_b32 v81, 0xffff0000, v184
  v_add_f32 v48, v48, v80
  v_add_f32 v49, v49, v81
  v_lshlrev_b32 v82, 16, v185
  v_and_b32 v83, 0xffff0000, v185
  v_add_f32 v50, v50, v82
  v_add_f32 v51, v51, v83
  v_lshlrev_b32 v84, 16, v186
  v_and_b32 v85, 0xffff0000, v186
  v_add_f32 v52, v52, v84
  v_add_f32 v53, v53, v85
  v_lshlrev_b32 v86, 16, v187
  v_and_b32 v87, 0xffff0000, v187
  v_add_f32 v54, v54, v86
  v_add_f32 v55, v55, v87
  v_lshlrev_b32 v80, 16, v188
  v_and_b32 v81, 0xffff0000, v188
  v_add_f32 v56, v56, v80
  v_add_f32 v57, v57, v81
  v_lshlrev_b32 v82, 16, v189
  v_and_b32 v83, 0xffff0000, v189
  v_add_f32 v58, v58, v82
  v_add_f32 v59, v59, v83
  v_lshlrev_b32 v84, 16, v190
  v_and_b32 v85, 0xffff0000, v190
  v_add_f32 v60, v60, v84
  v_add_f32 v61, v61, v85
  v_lshlrev_b32 v86, 16, v191
  v_and_b32 v87, 0xffff0000, v191
  v_add_f32 v62, v62, v86
  v_add_f32 v63, v63, v87
  s_waitcnt lgkmcnt(0)
  v_lshlrev_b32 v80, 16, v64
  v_and_b32 v81, 0xffff0000, v64
  v_lshlrev_b32 v82, 16, v65
  v_and_b32 v83, 0xffff0000, v65
  v_lshlrev_b32 v84, 16, v66
  v_and_b32 v85, 0xffff0000, v66
  v_lshlrev_b32 v86, 16, v67
  v_and_b32 v87, 0xffff0000, v67
  v_fma_f32 v32, v32, v96, v80
  v_fma_f32 v33, v33, v97, v81
  v_fma_f32 v34, v34, v98, v82
  v_fma_f32 v35, v35, v99, v83
  v_fma_f32 v48, v48, v112, v84
  v_fma_f32 v49, v49, v113, v85
  v_fma_f32 v50, v50, v114, v86
  v_fma_f32 v51, v51, v115, v87
  v_lshlrev_b32 v80, 16, v68
  v_and_b32 v81, 0xffff0000, v68
  v_lshlrev_b32 v82, 16, v69
  v_and_b32 v83, 0xffff0000, v69
  v_lshlrev_b32 v84, 16, v70
  v_and_b32 v85, 0xffff0000, v70
  v_lshlrev_b32 v86, 16, v71
  v_and_b32 v87, 0xffff0000, v71
  v_fma_f32 v36, v36, v100, v80
  v_fma_f32 v37, v37, v101, v81
  v_fma_f32 v38, v38, v102, v82
  v_fma_f32 v39, v39, v103, v83
  v_fma_f32 v52, v52, v116, v84
  v_fma_f32 v53, v53, v117, v85
  v_fma_f32 v54, v54, v118, v86
  v_fma_f32 v55, v55, v119, v87
  v_lshlrev_b32 v80, 16, v72
  v_and_b32 v81, 0xffff0000, v72
  v_lshlrev_b32 v82, 16, v73
  v_and_b32 v83, 0xffff0000, v73
  v_lshlrev_b32 v84, 16, v74
  v_and_b32 v85, 0xffff0000, v74
  v_lshlrev_b32 v86, 16, v75
  v_and_b32 v87, 0xffff0000, v75
  v_fma_f32 v40, v40, v104, v80
  v_fma_f32 v41, v41, v105, v81
  v_fma_f32 v42, v42, v106, v82
  v_fma_f32 v43, v43, v107, v83
  v_fma_f32 v56, v56, v120, v84
  v_fma_f32 v57, v57, v121, v85
  v_fma_f32 v58, v58, v122, v86
  v_fma_f32 v59, v59, v123, v87
  v_lshlrev_b32 v80, 16, v76
  v_and_b32 v81, 0xffff0000, v76
  v_lshlrev_b32 v82, 16, v77
  v_and_b32 v83, 0xffff0000, v77
  v_lshlrev_b32 v84, 16, v78
  v_and_b32 v85, 0xffff0000, v78
  v_lshlrev_b32 v86, 16, v79
  v_and_b32 v87, 0xffff0000, v79
  v_fma_f32 v44, v44, v108, v80
  v_fma_f32 v45, v45, v109, v81
  v_fma_f32 v46, v46, v110, v82
  v_fma_f32 v47, v47, v111, v83
  v_fma_f32 v60, v60, v124, v84
  v_fma_f32 v61, v61, v125, v85
  v_fma_f32 v62, v62, v126, v86
  v_fma_f32 v63, v63, v127, v87
  s_waitcnt vmcnt(0)
  v_lshlrev_b32 v80, 16, v208
  v_and_b32 v81, 0xffff0000, v208
  v_lshlrev_b32 v82, 16, v209
  v_and_b32 v83, 0xffff0000, v209
  v_lshlrev_b32 v84, 16, v216
  v_and_b32 v85, 0xffff0000, v216
  v_lshlrev_b32 v86, 16, v217
  v_and_b32 v87, 0xffff0000, v217
  v_fmac_f32 v32, v80, v96
  v_fmac_f32 v33, v81, v97
  v_fmac_f32 v34, v82, v98
  v_fmac_f32 v35, v83, v99
  v_fmac_f32 v48, v84, v112
  v_fmac_f32 v49, v85, v113
  v_fmac_f32 v50, v86, v114
  v_fmac_f32 v51, v87, v115
  v_cvt_pk_bf16_f32 v64, v32, v33
  v_cvt_pk_bf16_f32 v65, v34, v35
  v_cvt_pk_bf16_f32 v66, v48, v49
  v_cvt_pk_bf16_f32 v67, v50, v51
  ds_write2_b64 v4, v[64:65], v[66:67] offset0:0 offset1:4
  ds_read_b128 v[224:227], v6 offset:0
  v_lshlrev_b32 v80, 16, v210
  v_and_b32 v81, 0xffff0000, v210
  v_lshlrev_b32 v82, 16, v211
  v_and_b32 v83, 0xffff0000, v211
  v_lshlrev_b32 v84, 16, v218
  v_and_b32 v85, 0xffff0000, v218
  v_lshlrev_b32 v86, 16, v219
  v_and_b32 v87, 0xffff0000, v219
  v_fmac_f32 v36, v80, v100
  v_fmac_f32 v37, v81, v101
  v_fmac_f32 v38, v82, v102
  v_fmac_f32 v39, v83, v103
  v_fmac_f32 v52, v84, v116
  v_fmac_f32 v53, v85, v117
  v_fmac_f32 v54, v86, v118
  v_fmac_f32 v55, v87, v119
  v_cvt_pk_bf16_f32 v68, v36, v37
  v_cvt_pk_bf16_f32 v69, v38, v39
  v_cvt_pk_bf16_f32 v70, v52, v53
  v_cvt_pk_bf16_f32 v71, v54, v55
  ds_write2_b64 v4, v[68:69], v[70:71] offset0:160 offset1:164
  ds_read_b128 v[228:231], v6 offset:1280
  s_waitcnt lgkmcnt(2)
  s_add_u32 s85, s80, 0
  buffer_store_dwordx4 v[224:227], v7, s[12:15], s85 offen
  v_lshlrev_b32 v80, 16, v212
  v_and_b32 v81, 0xffff0000, v212
  v_lshlrev_b32 v82, 16, v213
  v_and_b32 v83, 0xffff0000, v213
  v_lshlrev_b32 v84, 16, v220
  v_and_b32 v85, 0xffff0000, v220
  v_lshlrev_b32 v86, 16, v221
  v_and_b32 v87, 0xffff0000, v221
  v_fmac_f32 v40, v80, v104
  v_fmac_f32 v41, v81, v105
  v_fmac_f32 v42, v82, v106
  v_fmac_f32 v43, v83, v107
  v_fmac_f32 v56, v84, v120
  v_fmac_f32 v57, v85, v121
  v_fmac_f32 v58, v86, v122
  v_fmac_f32 v59, v87, v123
  v_cvt_pk_bf16_f32 v72, v40, v41
  v_cvt_pk_bf16_f32 v73, v42, v43
  v_cvt_pk_bf16_f32 v74, v56, v57
  v_cvt_pk_bf16_f32 v75, v58, v59
  ds_write2_b64 v5, v[72:73], v[74:75] offset0:0 offset1:4
  ds_read_b128 v[232:235], v6 offset:2560
  s_waitcnt lgkmcnt(2)
  s_add_u32 s85, s80, 32768
  buffer_store_dwordx4 v[228:231], v7, s[12:15], s85 offen
  v_lshlrev_b32 v80, 16, v214
  v_and_b32 v81, 0xffff0000, v214
  v_lshlrev_b32 v82, 16, v215
  v_and_b32 v83, 0xffff0000, v215
  v_lshlrev_b32 v84, 16, v222
  v_and_b32 v85, 0xffff0000, v222
  v_lshlrev_b32 v86, 16, v223
  v_and_b32 v87, 0xffff0000, v223
  v_fmac_f32 v44, v80, v108
  v_fmac_f32 v45, v81, v109
  v_fmac_f32 v46, v82, v110
  v_fmac_f32 v47, v83, v111
  v_fmac_f32 v60, v84, v124
  v_fmac_f32 v61, v85, v125
  v_fmac_f32 v62, v86, v126
  v_fmac_f32 v63, v87, v127
  v_cvt_pk_bf16_f32 v76, v44, v45
  v_cvt_pk_bf16_f32 v77, v46, v47
  v_cvt_pk_bf16_f32 v78, v60, v61
  v_cvt_pk_bf16_f32 v79, v62, v63
  ds_write2_b64 v5, v[76:77], v[78:79] offset0:160 offset1:164
  ds_read_b128 v[236:239], v6 offset:3840
  s_waitcnt lgkmcnt(2)
  s_add_u32 s85, s80, 65536
  buffer_store_dwordx4 v[232:235], v7, s[12:15], s85 offen
  s_waitcnt lgkmcnt(0)
  s_add_u32 s85, s80, 98304
  buffer_store_dwordx4 v[236:239], v7, s[12:15], s85 offen
L_main_done:
  s_endpgm
L_main_spin_1:
  s_sleep 1
  buffer_load_dword v25, v27, s[16:19], s83 offen offset:0 sc1
  s_waitcnt vmcnt(0)
  v_cmp_eq_u32 vcc, v26, v25
  s_and_b32 s84, vcc_lo, 0x11111111
  s_cmp_eq_u32 s84, 0x11111111
  s_cbranch_scc0 L_main_spin_1
  s_branch L_main_spin_1_ok
L_main_spin_2:
  s_sleep 1
  buffer_load_dword v25, v27, s[16:19], s73 offen offset:0 sc1
  s_waitcnt vmcnt(0)
  v_cmp_eq_u32 vcc, v26, v25
  s_and_b32 s84, vcc_lo, 0xff
  s_cmp_eq_u32 s84, 0xff
  s_cbranch_scc0 L_main_spin_2
  s_branch L_main_spin_2_ok
L_main_spin_3:
  s_sleep 1
  buffer_load_dword v25, v27, s[16:19], s73 offen offset:0 sc1
  s_waitcnt vmcnt(0)
  v_cmp_eq_u32 vcc, v26, v25
  s_and_b32 s84, vcc_lo, 0xff
  s_cmp_eq_u32 s84, 0xff
  s_cbranch_scc0 L_main_spin_3
  s_branch L_main_spin_3_ok
L_main_spin_4:
  s_sleep 1
  buffer_load_dword v25, v27, s[16:19], s89 offen offset:0 sc1
  s_waitcnt vmcnt(0)
  v_cmp_eq_u32 vcc, v26, v25
  s_and_b32 s84, vcc_lo, 0x2
  s_cmp_eq_u32 s84, 0x2
  s_cbranch_scc0 L_main_spin_4
  s_branch L_main_spin_4_ok
L_main_spin_5:
  s_sleep 1
  buffer_load_dword v25, v27, s[16:19], s89 offen offset:0 sc1
  s_waitcnt vmcnt(0)
  v_cmp_eq_u32 vcc, v26, v25
  s_and_b32 s84, vcc_lo, 0x4
  s_cmp_eq_u32 s84, 0x4
  s_cbranch_scc0 L_main_spin_5
  s_branch L_main_spin_5_ok
L_main_spin_6:
  s_sleep 1
  buffer_load_dword v25, v27, s[16:19], s89 offen offset:0 sc1
  s_waitcnt vmcnt(0)
  v_cmp_eq_u32 vcc, v26, v25
  s_and_b32 s84, vcc_lo, 0x8
  s_cmp_eq_u32 s84, 0x8
  s_cbranch_scc0 L_main_spin_6
  s_branch L_main_spin_6_ok
L_main_spin_7:
  s_sleep 1
  buffer_load_dword v25, v27, s[16:19], s89 offen offset:0 sc1
  s_waitcnt vmcnt(0)
  v_cmp_eq_u32 vcc, v26, v25
  s_and_b32 s84, vcc_lo, 0x60
  s_cmp_eq_u32 s84, 0x60
  s_cbranch_scc0 L_main_spin_7
  s_branch L_main_spin_7_ok
L_main_spin_8:
  s_sleep 1
  buffer_load_dword v25, v27, s[16:19], s89 offen offset:0 sc1
  s_waitcnt vmcnt(0)
  v_cmp_eq_u32 vcc, v26, v25
  s_and_b32 s84, vcc_lo, 0x80
  s_cmp_eq_u32 s84, 0x80
  s_cbranch_scc0 L_main_spin_8
  s_branch L_main_spin_8_ok
L_main_slow:
  v_and_b32 v252, 15, v0
  v_and_b32 v253, 1, v1
  v_lshrrev_b32 v254, 1, v1
  v_lshl_add_u32 v253, v253, 1, v254
  v_lshlrev_b32 v236, 8, v252
  v_lshl_add_u32 v236, v253, 4, v236
  v_lshlrev_b32 v237, 10, v1
  v_lshl_add_u32 v237, v252, 1, v237
  v_mov_b32 v228, 0xff800000
  v_mov_b32 v229, 0xff800000
  v_mov_b32 v230, 0xff800000
  v_mov_b32 v231, 0xff800000
  s_add_u32 s86, s48, 2048
  s_mov_b32 s88, 16
L_main_slow1:
  s_add_u32 s87, s86, 4096
  buffer_load_dwordx4 a[128:131], v236, s[24:27], s86 offen offset:0
  buffer_load_dwordx4 a[132:135], v236, s[24:27], s86 offen offset:64
  buffer_load_dwordx4 a[136:139], v236, s[24:27], s86 offen offset:128
  buffer_load_dwordx4 a[140:143], v236, s[24:27], s86 offen offset:192
  buffer_load_dwordx4 a[144:147], v236, s[24:27], s87 offen offset:0
  buffer_load_dwordx4 a[148:151], v236, s[24:27], s87 offen offset:64
  buffer_load_dwordx4 a[152:155], v236, s[24:27], s87 offen offset:128
  buffer_load_dwordx4 a[156:159], v236, s[24:27], s87 offen offset:192
  s_waitcnt vmcnt(0)
  v_mfma_f32_16x16x32_bf16 v[32:35], a[128:131], v[128:131], 0
  v_mfma_f32_16x16x32_bf16 v[36:39], a[128:131], v[144:147], 0
  v_mfma_f32_16x16x32_bf16 v[40:43], a[128:131], v[160:163], 0
  v_mfma_f32_16x16x32_bf16 v[44:47], a[128:131], v[176:179], 0
  v_mfma_f32_16x16x32_bf16 v[32:35], a[132:135], v[132:135], v[32:35]
  v_mfma_f32_16x16x32_bf16 v[36:39], a[132:135], v[148:151], v[36:39]
  v_mfma_f32_16x16x32_bf16 v[40:43], a[132:135], v[164:167], v[40:43]
  v_mfma_f32_16x16x32_bf16 v[44:47], a[132:135], v[180:183], v[44:47]
  v_mfma_f32_16x16x32_bf16 v[32:35], a[136:139], v[136:139], v[32:35]
  v_mfma_f32_16x16x32_bf16 v[36:39], a[136:139], v[152:155], v[36:39]
  v_mfma_f32_16x16x32_bf16 v[40:43], a[136:139], v[168:171], v[40:43]
  v_mfma_f32_16x16x32_bf16 v[44:47], a[136:139], v[184:187], v[44:47]
  v_mfma_f32_16x16x32_bf16 v[32:35], a[140:143], v[140:143], v[32:35]
  v_mfma_f32_16x16x32_bf16 v[36:39], a[140:143], v[156:159], v[36:39]
  v_mfma_f32_16x16x32_bf16 v[40:43], a[140:143], v[172:175], v[40:43]
  v_mfma_f32_16x16x32_bf16 v[44:47], a[140:143], v[188:191], v[44:47]
  v_mfma_f32_16x16x32_bf16 v[60:63], a[144:147], v[176:179], 0
  v_mfma_f32_16x16x32_bf16 v[56:59], a[144:147], v[160:163], 0
  v_mfma_f32_16x16x32_bf16 v[52:55], a[144:147], v[144:147], 0
  v_mfma_f32_16x16x32_bf16 v[48:51], a[144:147], v[128:131], 0
  v_mfma_f32_16x16x32_bf16 v[60:63], a[148:151], v[180:183], v[60:63]
  v_mfma_f32_16x16x32_bf16 v[56:59], a[148:151], v[164:167], v[56:59]
  v_mfma_f32_16x16x32_bf16 v[52:55], a[148:151], v[148:151], v[52:55]
  v_mfma_f32_16x16x32_bf16 v[48:51], a[148:151], v[132:135], v[48:51]
  v_mfma_f32_16x16x32_bf16 v[60:63], a[152:155], v[184:187], v[60:63]
  v_mfma_f32_16x16x32_bf16 v[56:59], a[152:155], v[168:171], v[56:59]
  v_mfma_f32_16x16x32_bf16 v[52:55], a[152:155], v[152:155], v[52:55]
  v_mfma_f32_16x16x32_bf16 v[48:51], a[152:155], v[136:139], v[48:51]
  v_mfma_f32_16x16x32_bf16 v[60:63], a[156:159], v[188:191], v[60:63]
  v_mfma_f32_16x16x32_bf16 v[56:59], a[156:159], v[172:175], v[56:59]
  v_mfma_f32_16x16x32_bf16 v[52:55], a[156:159], v[156:159], v[52:55]
  v_mfma_f32_16x16x32_bf16 v[48:51], a[156:159], v[140:143], v[48:51]
  s_nop 7
  v_max3_f32 v228, v228, v32, v33
  v_max3_f32 v228, v228, v34, v35
  v_max3_f32 v228, v228, v48, v49
  v_max3_f32 v228, v228, v50, v51
  v_max3_f32 v229, v229, v36, v37
  v_max3_f32 v229, v229, v38, v39
  v_max3_f32 v229, v229, v52, v53
  v_max3_f32 v229, v229, v54, v55
  v_max3_f32 v230, v230, v40, v41
  v_max3_f32 v230, v230, v42, v43
  v_max3_f32 v230, v230, v56, v57
  v_max3_f32 v230, v230, v58, v59
  v_max3_f32 v231, v231, v44, v45
  v_max3_f32 v231, v231, v46, v47
  v_max3_f32 v231, v231, v60, v61
  v_max3_f32 v231, v231, v62, v63
  s_add_u32 s86, s86, 8192
  s_sub_u32 s88, s88, 1
  s_cmp_lg_u32 s88, 0
  s_cbranch_scc1 L_main_slow1
  v_mov_b32 v232, v228
  v_mov_b32 v233, v229
  v_mov_b32 v234, v230
  v_mov_b32 v235, v231
  s_nop 0
  v_permlane16_swap_b32 v228, v232
  v_permlane16_swap_b32 v229, v233
  v_permlane16_swap_b32 v230, v234
  v_permlane16_swap_b32 v231, v235
  v_max_f32 v228, v228, v232
  v_max_f32 v229, v229, v233
  v_max_f32 v230, v230, v234
  v_max_f32 v231, v231, v235
  v_mov_b32 v232, v228
  v_mov_b32 v233, v229
  v_mov_b32 v234, v230
  v_mov_b32 v235, v231
  s_nop 0
  v_permlane32_swap_b32 v228, v232
  v_permlane32_swap_b32 v229, v233
  v_permlane32_swap_b32 v230, v234
  v_permlane32_swap_b32 v231, v235
  v_max_f32 v228, v228, v232
  v_max_f32 v229, v229, v233
  v_max_f32 v230, v230, v234
  v_max_f32 v231, v231, v235
  v_sub_f32 v192, 0, v228
  v_sub_f32 v193, 0, v228
  v_sub_f32 v194, 0, v228
  v_sub_f32 v195, 0, v228
  v_sub_f32 v196, 0, v229
  v_sub_f32 v197, 0, v229
  v_sub_f32 v198, 0, v229
  v_sub_f32 v199, 0, v229
  v_sub_f32 v200, 0, v230
  v_sub_f32 v201, 0, v230
  v_sub_f32 v202, 0, v230
  v_sub_f32 v203, 0, v230
  v_sub_f32 v204, 0, v231
  v_sub_f32 v205, 0, v231
  v_sub_f32 v206, 0, v231
  v_sub_f32 v207, 0, v231
  s_nop 1
  v_accvgpr_write_b32 a0, 0
  v_accvgpr_write_b32 a1, 0
  v_accvgpr_write_b32 a2, 0
  v_accvgpr_write_b32 a3, 0
  v_accvgpr_write_b32 a4, 0
  v_accvgpr_write_b32 a5, 0
  v_accvgpr_write_b32 a6, 0
  v_accvgpr_write_b32 a7, 0
  v_accvgpr_write_b32 a8, 0
  v_accvgpr_write_b32 a9, 0
  v_accvgpr_write_b32 a10, 0
  v_accvgpr_write_b32 a11, 0
  v_accvgpr_write_b32 a12, 0
  v_accvgpr_write_b32 a13, 0
  v_accvgpr_write_b32 a14, 0
  v_accvgpr_write_b32 a15, 0
  v_accvgpr_write_b32 a16, 0
  v_accvgpr_write_b32 a17, 0
  v_accvgpr_write_b32 a18, 0
  v_accvgpr_write_b32 a19, 0
  v_accvgpr_write_b32 a20, 0
  v_accvgpr_write_b32 a21, 0
  v_accvgpr_write_b32 a22, 0
  v_accvgpr_write_b32 a23, 0
  v_accvgpr_write_b32 a24, 0
  v_accvgpr_write_b32 a25, 0
  v_accvgpr_write_b32 a26, 0
  v_accvgpr_write_b32 a27, 0
  v_accvgpr_write_b32 a28, 0
  v_accvgpr_write_b32 a29, 0
  v_accvgpr_write_b32 a30, 0
  v_accvgpr_write_b32 a31, 0
  v_accvgpr_write_b32 a32, 0
  v_accvgpr_write_b32 a33, 0
  v_accvgpr_write_b32 a34, 0
  v_accvgpr_write_b32 a35, 0
  v_accvgpr_write_b32 a36, 0
  v_accvgpr_write_b32 a37, 0
  v_accvgpr_write_b32 a38, 0
  v_accvgpr_write_b32 a39, 0
  v_accvgpr_write_b32 a40, 0
  v_accvgpr_write_b32 a41, 0
  v_accvgpr_write_b32 a42, 0
  v_accvgpr_write_b32 a43, 0
  v_accvgpr_write_b32 a44, 0
  v_accvgpr_write_b32 a45, 0
  v_accvgpr_write_b32 a46, 0
  v_accvgpr_write_b32 a47, 0
  v_accvgpr_write_b32 a48, 0
  v_accvgpr_write_b32 a49, 0
  v_accvgpr_write_b32 a50, 0
  v_accvgpr_write_b32 a51, 0
  v_accvgpr_write_b32 a52, 0
  v_accvgpr_write_b32 a53, 0
  v_accvgpr_write_b32 a54, 0
  v_accvgpr_write_b32 a55, 0
  v_accvgpr_write_b32 a56, 0
  v_accvgpr_write_b32 a57, 0
  v_accvgpr_write_b32 a58, 0
  v_accvgpr_write_b32 a59, 0
  v_accvgpr_write_b32 a60, 0
  v_accvgpr_write_b32 a61, 0
  v_accvgpr_write_b32 a62, 0
  v_accvgpr_write_b32 a63, 0
  v_accvgpr_write_b32 a64, 0
  v_accvgpr_write_b32 a65, 0
  v_accvgpr_write_b32 a66, 0
  v_accvgpr_write_b32 a67, 0
  v_accvgpr_write_b32 a68, 0
  v_accvgpr_write_b32 a69, 0
  v_accvgpr_write_b32 a70, 0
  v_accvgpr_write_b32 a71, 0
  v_accvgpr_write_b32 a72, 0
  v_accvgpr_write_b32 a73, 0
  v_accvgpr_write_b32 a74, 0
  v_accvgpr_write_b32 a75, 0
  v_accvgpr_write_b32 a76, 0
  v_accvgpr_write_b32 a77, 0
  v_accvgpr_write_b32 a78, 0
  v_accvgpr_write_b32 a79, 0
  v_accvgpr_write_b32 a80, 0
  v_accvgpr_write_b32 a81, 0
  v_accvgpr_write_b32 a82, 0
  v_accvgpr_write_b32 a83, 0
  v_accvgpr_write_b32 a84, 0
  v_accvgpr_write_b32 a85, 0
  v_accvgpr_write_b32 a86, 0
  v_accvgpr_write_b32 a87, 0
  v_accvgpr_write_b32 a88, 0
  v_accvgpr_write_b32 a89, 0
  v_accvgpr_write_b32 a90, 0
  v_accvgpr_write_b32 a91, 0
  v_accvgpr_write_b32 a92, 0
  v_accvgpr_write_b32 a93, 0
  v_accvgpr_write_b32 a94, 0
  v_accvgpr_write_b32 a95, 0
  v_accvgpr_write_b32 a96, 0
  v_accvgpr_write_b32 a97, 0
  v_accvgpr_write_b32 a98, 0
  v_accvgpr_write_b32 a99, 0
  v_accvgpr_write_b32 a100, 0
  v_accvgpr_write_b32 a101, 0
  v_accvgpr_write_b32 a102, 0
  v_accvgpr_write_b32 a103, 0
  v_accvgpr_write_b32 a104, 0
  v_accvgpr_write_b32 a105, 0
  v_accvgpr_write_b32 a106, 0
  v_accvgpr_write_b32 a107, 0
  v_accvgpr_write_b32 a108, 0
  v_accvgpr_write_b32 a109, 0
  v_accvgpr_write_b32 a110, 0
  v_accvgpr_write_b32 a111, 0
  v_accvgpr_write_b32 a112, 0
  v_accvgpr_write_b32 a113, 0
  v_accvgpr_write_b32 a114, 0
  v_accvgpr_write_b32 a115, 0
  v_accvgpr_write_b32 a116, 0
  v_accvgpr_write_b32 a117, 0
  v_accvgpr_write_b32 a118, 0
  v_accvgpr_write_b32 a119, 0
  v_accvgpr_write_b32 a120, 0
  v_accvgpr_write_b32 a121, 0
  v_accvgpr_write_b32 a122, 0
  v_accvgpr_write_b32 a123, 0
  v_accvgpr_write_b32 a124, 0
  v_accvgpr_write_b32 a125, 0
  v_accvgpr_write_b32 a126, 0
  v_accvgpr_write_b32 a127, 0
  v_mov_b32 v212, 0
  v_mov_b32 v213, 0
  v_mov_b32 v214, 0
  v_mov_b32 v215, 0
  v_mov_b32 v216, 0
  v_mov_b32 v217, 0
  v_mov_b32 v218, 0
  v_mov_b32 v219, 0
  v_mov_b32 v220, 0
  v_mov_b32 v221, 0
  v_mov_b32 v222, 0
  v_mov_b32 v223, 0
  v_mov_b32 v224, 0
  v_mov_b32 v225, 0
  v_mov_b32 v226, 0
  v_mov_b32 v227, 0
  s_add_u32 s86, s48, 2048
  s_mov_b32 s88, 16
L_main_slow2:
  s_add_u32 s87, s86, 4096
  buffer_load_dwordx4 a[128:131], v236, s[24:27], s86 offen offset:0
  buffer_load_dwordx4 a[132:135], v236, s[24:27], s86 offen offset:64
  buffer_load_dwordx4 a[136:139], v236, s[24:27], s86 offen offset:128
  buffer_load_dwordx4 a[140:143], v236, s[24:27], s86 offen offset:192
  buffer_load_dwordx4 a[144:147], v236, s[24:27], s87 offen offset:0
  buffer_load_dwordx4 a[148:151], v236, s[24:27], s87 offen offset:64
  buffer_load_dwordx4 a[152:155], v236, s[24:27], s87 offen offset:128
  buffer_load_dwordx4 a[156:159], v236, s[24:27], s87 offen offset:192
  buffer_load_ushort v64, v237, s[28:31], s86 offen offset:0
  buffer_load_ushort v65, v237, s[28:31], s86 offen offset:256
  buffer_load_ushort v66, v237, s[28:31], s86 offen offset:512
  buffer_load_ushort v67, v237, s[28:31], s86 offen offset:768
  buffer_load_ushort v68, v237, s[28:31], s87 offen offset:0
  buffer_load_ushort v69, v237, s[28:31], s87 offen offset:256
  buffer_load_ushort v70, v237, s[28:31], s87 offen offset:512
  buffer_load_ushort v71, v237, s[28:31], s87 offen offset:768
  s_waitcnt vmcnt(0)
  v_lshl_or_b32 v72, v65, 16, v64
  v_lshl_or_b32 v73, v67, 16, v66
  v_lshl_or_b32 v74, v69, 16, v68
  v_lshl_or_b32 v75, v71, 16, v70
  v_accvgpr_write_b32 a160, v72
  v_accvgpr_write_b32 a161, v73
  v_accvgpr_write_b32 a162, v74
  v_accvgpr_write_b32 a163, v75
  buffer_load_ushort v64, v237, s[28:31], s86 offen offset:32
  buffer_load_ushort v65, v237, s[28:31], s86 offen offset:288
  buffer_load_ushort v66, v237, s[28:31], s86 offen offset:544
  buffer_load_ushort v67, v237, s[28:31], s86 offen offset:800
  buffer_load_ushort v68, v237, s[28:31], s87 offen offset:32
  buffer_load_ushort v69, v237, s[28:31], s87 offen offset:288
  buffer_load_ushort v70, v237, s[28:31], s87 offen offset:544
  buffer_load_ushort v71, v237, s[28:31], s87 offen offset:800
  s_waitcnt vmcnt(0)
  v_lshl_or_b32 v72, v65, 16, v64
  v_lshl_or_b32 v73, v67, 16, v66
  v_lshl_or_b32 v74, v69, 16, v68
  v_lshl_or_b32 v75, v71, 16, v70
  v_accvgpr_write_b32 a164, v72
  v_accvgpr_write_b32 a165, v73
  v_accvgpr_write_b32 a166, v74
  v_accvgpr_write_b32 a167, v75
  buffer_load_ushort v64, v237, s[28:31], s86 offen offset:64
  buffer_load_ushort v65, v237, s[28:31], s86 offen offset:320
  buffer_load_ushort v66, v237, s[28:31], s86 offen offset:576
  buffer_load_ushort v67, v237, s[28:31], s86 offen offset:832
  buffer_load_ushort v68, v237, s[28:31], s87 offen offset:64
  buffer_load_ushort v69, v237, s[28:31], s87 offen offset:320
  buffer_load_ushort v70, v237, s[28:31], s87 offen offset:576
  buffer_load_ushort v71, v237, s[28:31], s87 offen offset:832
  s_waitcnt vmcnt(0)
  v_lshl_or_b32 v72, v65, 16, v64
  v_lshl_or_b32 v73, v67, 16, v66
  v_lshl_or_b32 v74, v69, 16, v68
  v_lshl_or_b32 v75, v71, 16, v70
  v_accvgpr_write_b32 a168, v72
  v_accvgpr_write_b32 a169, v73
  v_accvgpr_write_b32 a170, v74
  v_accvgpr_write_b32 a171, v75
  buffer_load_ushort v64, v237, s[28:31], s86 offen offset:96
  buffer_load_ushort v65, v237, s[28:31], s86 offen offset:352
  buffer_load_ushort v66, v237, s[28:31], s86 offen offset:608
  buffer_load_ushort v67, v237, s[28:31], s86 offen offset:864
  buffer_load_ushort v68, v237, s[28:31], s87 offen offset:96
  buffer_load_ushort v69, v237, s[28:31], s87 offen offset:352
  buffer_load_ushort v70, v237, s[28:31], s87 offen offset:608
  buffer_load_ushort v71, v237, s[28:31], s87 offen offset:864
  s_waitcnt vmcnt(0)
  v_lshl_or_b32 v72, v65, 16, v64
  v_lshl_or_b32 v73, v67, 16, v66
  v_lshl_or_b32 v74, v69, 16, v68
  v_lshl_or_b32 v75, v71, 16, v70
  v_accvgpr_write_b32 a172, v72
  v_accvgpr_write_b32 a173, v73
  v_accvgpr_write_b32 a174, v74
  v_accvgpr_write_b32 a175, v75
  buffer_load_ushort v64, v237, s[28:31], s86 offen offset:128
  buffer_load_ushort v65, v237, s[28:31], s86 offen offset:384
  buffer_load_ushort v66, v237, s[28:31], s86 offen offset:640
  buffer_load_ushort v67, v237, s[28:31], s86 offen offset:896
  buffer_load_ushort v68, v237, s[28:31], s87 offen offset:128
  buffer_load_ushort v69, v237, s[28:31], s87 offen offset:384
  buffer_load_ushort v70, v237, s[28:31], s87 offen offset:640
  buffer_load_ushort v71, v237, s[28:31], s87 offen offset:896
  s_waitcnt vmcnt(0)
  v_lshl_or_b32 v72, v65, 16, v64
  v_lshl_or_b32 v73, v67, 16, v66
  v_lshl_or_b32 v74, v69, 16, v68
  v_lshl_or_b32 v75, v71, 16, v70
  v_accvgpr_write_b32 a176, v72
  v_accvgpr_write_b32 a177, v73
  v_accvgpr_write_b32 a178, v74
  v_accvgpr_write_b32 a179, v75
  buffer_load_ushort v64, v237, s[28:31], s86 offen offset:160
  buffer_load_ushort v65, v237, s[28:31], s86 offen offset:416
  buffer_load_ushort v66, v237, s[28:31], s86 offen offset:672
  buffer_load_ushort v67, v237, s[28:31], s86 offen offset:928
  buffer_load_ushort v68, v237, s[28:31], s87 offen offset:160
  buffer_load_ushort v69, v237, s[28:31], s87 offen offset:416
  buffer_load_ushort v70, v237, s[28:31], s87 offen offset:672
  buffer_load_ushort v71, v237, s[28:31], s87 offen offset:928
  s_waitcnt vmcnt(0)
  v_lshl_or_b32 v72, v65, 16, v64
  v_lshl_or_b32 v73, v67, 16, v66
  v_lshl_or_b32 v74, v69, 16, v68
  v_lshl_or_b32 v75, v71, 16, v70
  v_accvgpr_write_b32 a180, v72
  v_accvgpr_write_b32 a181, v73
  v_accvgpr_write_b32 a182, v74
  v_accvgpr_write_b32 a183, v75
  buffer_load_ushort v64, v237, s[28:31], s86 offen offset:192
  buffer_load_ushort v65, v237, s[28:31], s86 offen offset:448
  buffer_load_ushort v66, v237, s[28:31], s86 offen offset:704
  buffer_load_ushort v67, v237, s[28:31], s86 offen offset:960
  buffer_load_ushort v68, v237, s[28:31], s87 offen offset:192
  buffer_load_ushort v69, v237, s[28:31], s87 offen offset:448
  buffer_load_ushort v70, v237, s[28:31], s87 offen offset:704
  buffer_load_ushort v71, v237, s[28:31], s87 offen offset:960
  s_waitcnt vmcnt(0)
  v_lshl_or_b32 v72, v65, 16, v64
  v_lshl_or_b32 v73, v67, 16, v66
  v_lshl_or_b32 v74, v69, 16, v68
  v_lshl_or_b32 v75, v71, 16, v70
  v_accvgpr_write_b32 a184, v72
  v_accvgpr_write_b32 a185, v73
  v_accvgpr_write_b32 a186, v74
  v_accvgpr_write_b32 a187, v75
  buffer_load_ushort v64, v237, s[28:31], s86 offen offset:224
  buffer_load_ushort v65, v237, s[28:31], s86 offen offset:480
  buffer_load_ushort v66, v237, s[28:31], s86 offen offset:736
  buffer_load_ushort v67, v237, s[28:31], s86 offen offset:992
  buffer_load_ushort v68, v237, s[28:31], s87 offen offset:224
  buffer_load_ushort v69, v237, s[28:31], s87 offen offset:480
  buffer_load_ushort v70, v237, s[28:31], s87 offen offset:736
  buffer_load_ushort v71, v237, s[28:31], s87 offen offset:992
  s_waitcnt vmcnt(0)
  v_lshl_or_b32 v72, v65, 16, v64
  v_lshl_or_b32 v73, v67, 16, v66
  v_lshl_or_b32 v74, v69, 16, v68
  v_lshl_or_b32 v75, v71, 16, v70
  v_accvgpr_write_b32 a188, v72
  v_accvgpr_write_b32 a189, v73
  v_accvgpr_write_b32 a190, v74
  v_accvgpr_write_b32 a191, v75
  v_mfma_f32_16x16x32_bf16 v[32:35], a[128:131], v[128:131], v[192:195]
  v_mfma_f32_16x16x32_bf16 v[36:39], a[128:131], v[144:147], v[196:199]
  v_mfma_f32_16x16x32_bf16 v[40:43], a[128:131], v[160:163], v[200:203]
  v_mfma_f32_16x16x32_bf16 v[44:47], a[128:131], v[176:179], v[204:207]
  v_mfma_f32_16x16x32_bf16 v[32:35], a[132:135], v[132:135], v[32:35]
  v_mfma_f32_16x16x32_bf16 v[36:39], a[132:135], v[148:151], v[36:39]
  v_mfma_f32_16x16x32_bf16 v[40:43], a[132:135], v[164:167], v[40:43]
  v_mfma_f32_16x16x32_bf16 v[44:47], a[132:135], v[180:183], v[44:47]
  v_mfma_f32_16x16x32_bf16 v[32:35], a[136:139], v[136:139], v[32:35]
  v_mfma_f32_16x16x32_bf16 v[36:39], a[136:139], v[152:155], v[36:39]
  v_mfma_f32_16x16x32_bf16 v[40:43], a[136:139], v[168:171], v[40:43]
  v_mfma_f32_16x16x32_bf16 v[44:47], a[136:139], v[184:187], v[44:47]
  v_mfma_f32_16x16x32_bf16 v[32:35], a[140:143], v[140:143], v[32:35]
  v_mfma_f32_16x16x32_bf16 v[36:39], a[140:143], v[156:159], v[36:39]
  v_mfma_f32_16x16x32_bf16 v[40:43], a[140:143], v[172:175], v[40:43]
  v_mfma_f32_16x16x32_bf16 v[44:47], a[140:143], v[188:191], v[44:47]
  v_mfma_f32_16x16x32_bf16 v[60:63], a[144:147], v[176:179], v[204:207]
  v_mfma_f32_16x16x32_bf16 v[56:59], a[144:147], v[160:163], v[200:203]
  v_mfma_f32_16x16x32_bf16 v[52:55], a[144:147], v[144:147], v[196:199]
  v_mfma_f32_16x16x32_bf16 v[48:51], a[144:147], v[128:131], v[192:195]
  v_mfma_f32_16x16x32_bf16 v[60:63], a[148:151], v[180:183], v[60:63]
  v_mfma_f32_16x16x32_bf16 v[56:59], a[148:151], v[164:167], v[56:59]
  v_mfma_f32_16x16x32_bf16 v[52:55], a[148:151], v[148:151], v[52:55]
  v_mfma_f32_16x16x32_bf16 v[48:51], a[148:151], v[132:135], v[48:51]
  v_mfma_f32_16x16x32_bf16 v[60:63], a[152:155], v[184:187], v[60:63]
  v_mfma_f32_16x16x32_bf16 v[56:59], a[152:155], v[168:171], v[56:59]
  v_mfma_f32_16x16x32_bf16 v[52:55], a[152:155], v[152:155], v[52:55]
  v_mfma_f32_16x16x32_bf16 v[48:51], a[152:155], v[136:139], v[48:51]
  v_mfma_f32_16x16x32_bf16 v[60:63], a[156:159], v[188:191], v[60:63]
  v_mfma_f32_16x16x32_bf16 v[56:59], a[156:159], v[172:175], v[56:59]
  v_mfma_f32_16x16x32_bf16 v[52:55], a[156:159], v[156:159], v[52:55]
  v_mfma_f32_16x16x32_bf16 v[48:51], a[156:159], v[140:143], v[48:51]
  s_nop 7
  v_exp_f32 v32, v32
  v_exp_f32 v33, v33
  v_exp_f32 v34, v34
  v_exp_f32 v35, v35
  v_cvt_pk_bf16_f32 v96, v32, v33
  v_exp_f32 v48, v48
  v_exp_f32 v49, v49
  v_cvt_pk_bf16_f32 v97, v34, v35
  v_exp_f32 v50, v50
  v_exp_f32 v51, v51
  v_cvt_pk_bf16_f32 v98, v48, v49
  v_exp_f32 v36, v36
  v_exp_f32 v37, v37
  v_cvt_pk_bf16_f32 v99, v50, v51
  v_exp_f32 v38, v38
  v_exp_f32 v39, v39
  v_cvt_pk_bf16_f32 v100, v36, v37
  v_exp_f32 v52, v52
  v_exp_f32 v53, v53
  v_cvt_pk_bf16_f32 v101, v38, v39
  v_exp_f32 v54, v54
  v_exp_f32 v55, v55
  v_cvt_pk_bf16_f32 v102, v52, v53
  v_exp_f32 v40, v40
  v_exp_f32 v41, v41
  v_cvt_pk_bf16_f32 v103, v54, v55
  v_exp_f32 v42, v42
  v_exp_f32 v43, v43
  v_cvt_pk_bf16_f32 v104, v40, v41
  v_exp_f32 v56, v56
  v_exp_f32 v57, v57
  v_cvt_pk_bf16_f32 v105, v42, v43
  v_exp_f32 v58, v58
  v_exp_f32 v59, v59
  v_cvt_pk_bf16_f32 v106, v56, v57
  v_exp_f32 v44, v44
  v_exp_f32 v45, v45
  v_cvt_pk_bf16_f32 v107, v58, v59
  v_exp_f32 v46, v46
  v_exp_f32 v47, v47
  v_cvt_pk_bf16_f32 v108, v44, v45
  v_exp_f32 v60, v60
  v_exp_f32 v61, v61
  v_cvt_pk_bf16_f32 v109, v46, v47
  v_exp_f32 v62, v62
  v_exp_f32 v63, v63
  v_cvt_pk_bf16_f32 v110, v60, v61
  s_nop 0
  v_cvt_pk_bf16_f32 v111, v62, v63
  s_nop 1
  v_mfma_f32_16x16x32_bf16 a[0:3], a[160:163], v[96:99], a[0:3]
  v_mfma_f32_16x16x32_bf16 a[4:7], a[160:163], v[100:103], a[4:7]
  v_mfma_f32_16x16x32_bf16 a[8:11], a[160:163], v[104:107], a[8:11]
  v_mfma_f32_16x16x32_bf16 a[12:15], a[160:163], v[108:111], a[12:15]
  v_mfma_f32_16x16x32_bf16 a[28:31], a[164:167], v[108:111], a[28:31]
  v_mfma_f32_16x16x32_bf16 a[24:27], a[164:167], v[104:107], a[24:27]
  v_mfma_f32_16x16x32_bf16 a[20:23], a[164:167], v[100:103], a[20:23]
  v_mfma_f32_16x16x32_bf16 a[16:19], a[164:167], v[96:99], a[16:19]
  v_mfma_f32_16x16x32_bf16 a[32:35], a[168:171], v[96:99], a[32:35]
  v_mfma_f32_16x16x32_bf16 a[36:39], a[168:171], v[100:103], a[36:39]
  v_mfma_f32_16x16x32_bf16 a[40:43], a[168:171], v[104:107], a[40:43]
  v_mfma_f32_16x16x32_bf16 a[44:47], a[168:171], v[108:111], a[44:47]
  v_mfma_f32_16x16x32_bf16 a[60:63], a[172:175], v[108:111], a[60:63]
  v_mfma_f32_16x16x32_bf16 a[56:59], a[172:175], v[104:107], a[56:59]
  v_mfma_f32_16x16x32_bf16 a[52:55], a[172:175], v[100:103], a[52:55]
  v_mfma_f32_16x16x32_bf16 a[48:51], a[172:175], v[96:99], a[48:51]
  v_mfma_f32_16x16x32_bf16 a[64:67], a[176:179], v[96:99], a[64:67]
  v_mfma_f32_16x16x32_bf16 a[68:71], a[176:179], v[100:103], a[68:71]
  v_mfma_f32_16x16x32_bf16 a[72:75], a[176:179], v[104:107], a[72:75]
  v_mfma_f32_16x16x32_bf16 a[76:79], a[176:179], v[108:111], a[76:79]
  v_mfma_f32_16x16x32_bf16 a[92:95], a[180:183], v[108:111], a[92:95]
  v_mfma_f32_16x16x32_bf16 a[88:91], a[180:183], v[104:107], a[88:91]
  v_mfma_f32_16x16x32_bf16 a[84:87], a[180:183], v[100:103], a[84:87]
  v_mfma_f32_16x16x32_bf16 a[80:83], a[180:183], v[96:99], a[80:83]
  v_mfma_f32_16x16x32_bf16 a[96:99], a[184:187], v[96:99], a[96:99]
  v_mfma_f32_16x16x32_bf16 a[100:103], a[184:187], v[100:103], a[100:103]
  v_mfma_f32_16x16x32_bf16 a[104:107], a[184:187], v[104:107], a[104:107]
  v_mfma_f32_16x16x32_bf16 a[108:111], a[184:187], v[108:111], a[108:111]
  v_mfma_f32_16x16x32_bf16 a[124:127], a[188:191], v[108:111], a[124:127]
  v_mfma_f32_16x16x32_bf16 a[120:123], a[188:191], v[104:107], a[120:123]
  v_mfma_f32_16x16x32_bf16 a[116:119], a[188:191], v[100:103], a[116:119]
  v_mfma_f32_16x16x32_bf16 a[112:115], a[188:191], v[96:99], a[112:115]
  v_mfma_f32_16x16x32_bf16 v[212:215], v[208:211], v[96:99], v[212:215]
  v_mfma_f32_16x16x32_bf16 v[216:219], v[208:211], v[100:103], v[216:219]
  v_mfma_f32_16x16x32_bf16 v[220:223], v[208:211], v[104:107], v[220:223]
  v_mfma_f32_16x16x32_bf16 v[224:227], v[208:211], v[108:111], v[224:227]
  s_add_u32 s86, s86, 8192
  s_sub_u32 s88, s88, 1
  s_cmp_lg_u32 s88, 0
  s_cbranch_scc1 L_main_slow2
  s_nop 7
  s_branch L_main_slow_ret
L_main_end:
.section .rodata,"a"
.p2align 6
.amdhsa_kernel recurrent_scan__sliding_block_cached__dense_activation_silu__prompt_kernel
  .amdhsa_next_free_vgpr 512
  .amdhsa_next_free_sgpr 102
  .amdhsa_accum_offset 256
  .amdhsa_group_segment_fixed_size 0
  .amdhsa_kernarg_size 88
  .amdhsa_user_sgpr_count 2
  .amdhsa_user_sgpr_kernarg_segment_ptr 1
  .amdhsa_system_sgpr_workgroup_id_x 1
.end_amdhsa_kernel
```
